```python
import torch

def _softmax(x, axis=-1):
    return torch.softmax(x, dim=axis)
def _gelu(x):
    return torch.nn.functional.gelu(x, approximate="tanh")
def _silu(x):
    return torch.nn.functional.silu(x)
def _sigmoid(x):
    return torch.sigmoid(x)
def _layernorm(x, axis=-1, eps=1e-5):
    m = x.mean(dim=axis, keepdim=True)
    v = x.var(dim=axis, keepdim=True, unbiased=False)
    return (x - m) / torch.sqrt(v + eps)
def _scatter_add(tgt, idx, src, axis=0):
    return tgt.clone().index_add_(axis, idx, src)
def _segment_sum(src, seg, n):
    out = torch.zeros((n,) + src.shape[1:], dtype=src.dtype)
    return out.index_add_(0, seg, src)
def _pad(x, pw):
    flat = tuple(v for pair in reversed(pw) for v in pair)
    return torch.nn.functional.pad(x, flat)

kernel_name = 'interleave_layers__spectral_gfnet__mixer_channel_mlp__prompt'

def setup_inputs():

    _w = (lambda a: (lambda t: t.to(torch.bfloat16) if t.is_floating_point() else t)(torch.as_tensor(a)))
    def _A_setup():
        B, S, D = 1, 2048, 448
        Df = D // 2 + 1
        return {
            "x": _w((lambda *s: torch.randn(*s, dtype=torch.bfloat16) * 0.05)(B, S, D)),
            "w_r": _w((lambda *s: torch.randn(*s, dtype=torch.bfloat16) * 0.8)(S, Df) * 0.02),
            "w_i": _w((lambda *s: torch.randn(*s, dtype=torch.bfloat16) * 0.8)(S, Df) * 0.02),
        }
    _A_in = _A_setup()

    def _B_setup():
        B, S, D, F = 1, 2048, 448, 1792
        return {
            "x": _w((lambda *s: torch.randn(*s, dtype=torch.bfloat16) * 0.05)(B, S, D)),
            "w1": _w((lambda *s: torch.randn(*s, dtype=torch.bfloat16) * 0.8)(D, F) * (D ** -0.5)),
            "b1": _w((lambda *s: torch.randn(*s, dtype=torch.bfloat16) * 0.4)(F)),
            "w2": _w((lambda *s: torch.randn(*s, dtype=torch.bfloat16) * 0.05)(F, D) * (F ** -0.5)),
            "b2": _w((lambda *s: torch.randn(*s, dtype=torch.bfloat16) * 0.05)(D)),
        }
    _B_in = _B_setup()

    return {
        "A_x": _A_in["x"],
        "A_w_r": _A_in["w_r"],
        "A_w_i": _A_in["w_i"],
        "B_x": _B_in["x"],
        "B_w1": _B_in["w1"],
        "B_b1": _B_in["b1"],
        "B_w2": _B_in["w2"],
        "B_b2": _B_in["b2"],
    }

def reference(A_x, A_w_r, A_w_i, B_x, B_w1, B_b1, B_w2, B_b2):
    def _A_ref(x, w_r, w_i):
        B, S, D = x.shape
        X = (lambda x, axes=(-2,-1): torch.fft.rfft2(x.float(), dim=axes))(x, axes=(-2, -1))
        W = w_r + 1j * w_i
        X = X * W
        y = (lambda x, s, axes=(-2,-1): torch.fft.irfft2(x, s=s, dim=axes).to(torch.bfloat16))(X, (S, D), axes=(-2, -1))
        return y

    def _B_ref(x, w1, b1, w2, b2):
        y = _layernorm(x, axis=-1)
        h = _gelu(torch.einsum("bsd,df->bsf", y, w1) + b1)
        return torch.einsum("bsf,fd->bsd", h, w2) + b2

    x = A_x
    x = x + _A_ref(_layernorm(x, axis=-1), A_w_r, A_w_i)
    x = x + _B_ref(_layernorm(x, axis=-1), B_w1, B_b1, B_w2, B_b2)
    x = x + _A_ref(_layernorm(x, axis=-1), A_w_r, A_w_i)
    x = x + _B_ref(_layernorm(x, axis=-1), B_w1, B_b1, B_w2, B_b2)
    return x
```

```asm
; @launch grid=(256,1,1) block=(256,1,1) lds=163840
.amdgcn_target "amdgcn-amd-amdhsa--gfx950"

.text
.globl interleave_layers__spectral_gfnet__mixer_channel_mlp__prompt_kernel
.p2align 8
.type interleave_layers__spectral_gfnet__mixer_channel_mlp__prompt_kernel,@function
interleave_layers__spectral_gfnet__mixer_channel_mlp__prompt_kernel:
    s_load_dwordx16 s[4:19], s[0:1], 0
    s_load_dwordx4 s[20:23], s[0:1], 64
    s_load_dwordx2 s[24:25], s[0:1], 80
    s_memrealtime s[90:91]
    v_lshrrev_b32 v1, 6, v0
    v_and_b32 v2, 63, v0
    v_readfirstlane_b32 s26, v1
    v_and_b32 v3, 15, v0
    v_lshrrev_b32 v4, 4, v2
    v_lshlrev_b32 v2, 4, v2
    s_cmp_ge_u32 s2, 256
    s_cbranch_scc1 L_end
    s_getpc_b64 s[44:45]
    s_add_u32 s44, s44, interleave_layers__spectral_gfnet__mixer_channel_mlp__prompt_kernel@rel32@lo+4
    s_addc_u32 s45, s45, interleave_layers__spectral_gfnet__mixer_channel_mlp__prompt_kernel@rel32@hi+12
    s_mov_b32 s46, L_code_end-interleave_layers__spectral_gfnet__mixer_channel_mlp__prompt_kernel
    s_mov_b32 s47, 0x20000
    s_lshr_b32 s51, s2, 3
    s_and_b32 s50, s2, 7
    s_lshl_b32 s53, s51, 2
    s_add_u32 s88, s53, s26
    v_lshl_add_u32 v9, s88, 10, v2
    buffer_load_dwordx4 v[168:171], v9, s[44:47], 0 offen
    s_and_b32 s80, s51, 3
    s_lshl_b32 s80, s80, 8
    s_lshr_b32 s78, s51, 3
    s_lshl_b32 s78, s78, 7
    s_and_b32 s79, s51, 4
    s_add_u32 s78, s78, s79
    s_lshl_b32 s79, s50, 4
    s_add_u32 s78, s78, s79
    s_mul_i32 s78, s78, 3584
    s_sub_u32 s42, 1835008, s78
    s_mov_b32 s43, 0x20000
    s_lshl_b32 s94, s26, 10
    s_movk_i32 s55, 896
    v_lshrrev_b32 v9, 6, v2
    v_and_b32 v10, 2, v4
    v_xor_b32 v10, v3, v10
    v_and_b32 v10, 3, v10
    v_lshlrev_b32 v10, 4, v10
    v_lshrrev_b32 v11, 1, v1
    v_lshl_add_u32 v10, v11, 6, v10
    v_and_b32 v12, 1, v1
    v_lshl_add_u32 v11, v12, 5, v9
    v_mad_u32_u24 v172, v11, s55, v10
    s_and_b32 s88, s88, 15
    s_cmp_lt_u32 s88, 14
    s_cselect_b32 s93, 268435456, 0
    s_min_u32 s88, s88, 13
    s_waitcnt lgkmcnt(0)
    s_add_u32 s40, s4, s78
    s_addc_u32 s41, s5, 0
    s_or_b32 s53, s2, s94
    s_cbranch_scc1 L_tagr
    s_mov_b32 s32, s22
    s_mov_b32 s33, s23
    s_mov_b32 s34, 256
    s_mov_b32 s35, 0x20000
    s_lshr_b64 s[58:59], s[90:91], 22
    s_lshl_b32 s59, s90, 1
    s_or_b32 s59, s59, 0xff800000
    v_mov_b32 v14, s59
    v_mov_b32 v15, s58
    s_mov_b64 exec, 1
    buffer_store_dwordx2 v[14:15], off, s[32:35], 0 sc1
    s_mov_b64 exec, -1
L_tagr:
    s_add_u32 m0, s94, 0
    s_add_u32 s81, s80, 128
    buffer_load_dwordx4 v172, s[40:43], s80 offen lds
    s_cmp_eq_u32 s81, 896
    s_cselect_b32 s81, 0, s81
    s_mul_i32 s52, s51, 293
    s_lshr_b32 s52, s52, 11
    s_mul_i32 s49, s52, 7
    s_sub_u32 s49, s51, s49
    s_lshl_b32 s48, s50, 2
    s_add_u32 s48, s48, s52
    s_lshr_b32 s95, s48, 3
    s_add_u32 m0, s94, 4096
    s_add_u32 s82, s81, 128
    buffer_load_dwordx4 v172, s[40:43], s81 offen lds
    s_cmp_eq_u32 s82, 896
    s_cselect_b32 s82, 0, s82
    s_lshl_b32 s95, s95, 4
    s_and_b32 s73, s48, 7
    s_lshl_b32 s73, s73, 8
    s_add_u32 s95, s95, s73
    s_add_u32 m0, s94, 8192
    s_add_u32 s83, s82, 128
    buffer_load_dwordx4 v172, s[40:43], s82 offen lds
    s_cmp_eq_u32 s83, 896
    s_cselect_b32 s83, 0, s83
    s_lshl_b32 s73, s26, 6
    s_add_u32 s95, s95, s73
    s_mul_i32 s95, s95, 450
    s_lshl_b32 s73, s49, 6
    s_add_u32 m0, s94, 12288
    s_add_u32 s84, s83, 128
    buffer_load_dwordx4 v172, s[40:43], s83 offen lds
    s_cmp_eq_u32 s84, 896
    s_cselect_b32 s84, 0, s84
    s_add_u32 s95, s95, s73
    v_mul_u32_u24 v175, 450, v9
    v_and_b32 v11, 0x30, v2
    v_add3_u32 v175, v175, v11, 2
    s_add_u32 m0, s94, 16384
    s_add_u32 s85, s84, 128
    buffer_load_dwordx4 v172, s[40:43], s84 offen lds
    s_cmp_eq_u32 s85, 896
    s_cselect_b32 s85, 0, s85
    s_cmp_lt_u32 s2, 224
    s_cselect_b32 s38, 921600, 0
    s_cselect_b32 s74, 268435456, 0
    s_mov_b32 s39, 0x20000
    s_mov_b32 s46, s38
    s_lshr_b32 s87, s51, 2
    s_add_u32 m0, s94, 20480
    s_add_u32 s86, s85, 128
    buffer_load_dwordx4 v172, s[40:43], s85 offen lds
    s_cmp_eq_u32 s86, 896
    s_cselect_b32 s86, 0, s86
    s_lshl_b32 s87, s87, 3
    s_add_u32 s87, s87, s50
    s_and_b32 s11, s51, 24
    s_add_u32 s11, s11, s50
    s_add_u32 m0, s94, 24576
    s_nop 0
    buffer_load_dwordx4 v172, s[40:43], s86 offen lds
    s_bfe_u32 s79, s51, 0x10002
    s_lshl1_add_u32 s11, s11, s79
    s_cmp_ge_u32 s51, 24
    s_cselect_b32 s11, s87, s11
    s_lshl_b32 s79, s11, 6
    s_sub_u32 s66, 1605632, s79
    s_min_u32 s66, s66, s74
    s_mov_b32 s67, 0x20000
    v_lshl_add_u32 v11, v12, 4, v9
    v_mad_u32_u24 v173, v11, s55, v10
    v_and_b32 v11, 1, v4
    v_lshl_add_u32 v11, v12, 1, v11
    v_lshlrev_b32 v11, 5, v11
    v_xor_b32 v11, v11, v2
    v_lshrrev_b32 v12, 7, v2
    v_lshl_add_u32 v12, v1, 3, v12
    v_and_b32 v13, 0x40, v11
    v_lshrrev_b32 v13, 1, v13
    v_add_u32 v12, v12, v13
    v_and_b32 v11, 0x30, v11
    v_mul_u32_u24 v174, 3584, v12
    v_add_u32 v174, v174, v11
    s_add_u32 s64, s12, s79
    s_addc_u32 s65, s13, 0
    s_mov_b64 s[32:33], s[22:23]
    s_cmp_eq_u32 s26, 0
    s_cselect_b32 s34, 256, 0
    s_mov_b32 s35, 0x20000
    s_mov_b32 s27, 30000
    s_mov_b64 s[36:37], s[6:7]
    s_mov_b64 s[44:45], s[8:9]
    s_mov_b32 s9, s94
    s_movk_i32 s10, 1792
    s_cmp_lt_u32 s2, 224
    s_cbranch_scc1 L_hred
    s_mov_b32 s10, 1
    v_mov_b32 v174, v173
    s_and_b32 s11, s51, 3
    s_lshl_b32 s11, s11, 13
    s_mul_i32 s53, s50, 28672
    s_add_u32 s53, s53, s11
    s_mul_i32 s53, s53, 7
    s_add_u32 s64, s16, s53
    s_addc_u32 s65, s17, 0
    s_movk_i32 s66, 28672
L_hred:
    v_and_b32 v131, 1, v3
    v_lshrrev_b32 v128, 1, v3
    v_lshl_add_u32 v128, s88, 3, v128
    v_cvt_f32_u32 v130, v131
    v_mul_f32 v130, 0x3e800000, v130
    s_add_u32 m0, s94, 57344
    s_nop 0
    buffer_load_dwordx4 v175, s[36:39], s95 offen nt lds
    v_mul_u32_u24 v131, 224, v131
    v_sub_u32 v131, 224, v131
    s_mov_b32 s56, 0x3b124925
    s_mov_b32 s57, 0xc3e00000
    v_cmp_eq_u32 vcc, 0, v128
    v_mov_b32 v132, 0x3d88d677
    v_mov_b32 v133, 0x3d41848f
    v_cndmask_b32 v128, v128, v131, vcc
    v_cndmask_b32 v130, v130, 0, vcc
    v_cndmask_b32 v132, v132, v133, vcc
    v_cvt_f32_u32 v128, v128
    s_lshr_b32 s53, s80, 1
    v_lshl_add_u32 v131, v4, 3, s53
    v_cvt_f32_u32 v131, v131
    v_mul_f32 v129, s56, v128
    v_mul_f32 v131, v131, v128
    s_add_u32 m0, s94, 61440
    s_nop 0
    buffer_load_dwordx4 v175, s[44:47], s95 offen nt lds
    v_mul_f32 v136, s56, v131
    v_mul_f32 v134, 0x42000000, v129
    v_rndne_f32 v136, v136
    v_fract_f32 v134, v134
    v_fma_f32 v131, v136, s57, v131
    v_fma_f32 v136, v131, s56, v130
    v_add_f32 v137, v136, v134
    v_cos_f32 v134, v134
    v_fmamk_f32 v145, v129, 0x3f800000, v136
    v_fmamk_f32 v146, v129, 0x40000000, v136
    v_fmamk_f32 v147, v129, 0x40400000, v136
    v_fmamk_f32 v148, v129, 0x40800000, v136
    v_fmamk_f32 v149, v129, 0x40a00000, v136
    v_fmamk_f32 v150, v129, 0x40c00000, v136
    v_fmamk_f32 v151, v129, 0x40e00000, v136
    v_cos_f32 v144, v136
    v_cos_f32 v145, v145
    v_cos_f32 v146, v146
    v_cos_f32 v147, v147
    v_cos_f32 v148, v148
    v_cos_f32 v149, v149
    v_cos_f32 v150, v150
    v_cos_f32 v151, v151
    v_fmamk_f32 v153, v129, 0x3f800000, v137
    v_fmamk_f32 v154, v129, 0x40000000, v137
    v_fmamk_f32 v155, v129, 0x40400000, v137
    v_fmamk_f32 v156, v129, 0x40800000, v137
    v_fmamk_f32 v157, v129, 0x40a00000, v137
    v_fmamk_f32 v158, v129, 0x40c00000, v137
    v_fmamk_f32 v159, v129, 0x40e00000, v137
    v_cos_f32 v152, v137
    v_cos_f32 v153, v153
    v_cos_f32 v154, v154
    v_cos_f32 v155, v155
    v_cos_f32 v156, v156
    v_cos_f32 v157, v157
    v_cos_f32 v158, v158
    v_cos_f32 v159, v159
    v_add_f32 v134, v134, v134
    v_pk_mul_f32 v[144:145], v[144:145], v[132:133] op_sel_hi:[1,0]
    v_pk_mul_f32 v[146:147], v[146:147], v[132:133] op_sel_hi:[1,0]
    v_pk_mul_f32 v[148:149], v[148:149], v[132:133] op_sel_hi:[1,0]
    v_pk_mul_f32 v[150:151], v[150:151], v[132:133] op_sel_hi:[1,0]
    v_pk_mul_f32 v[152:153], v[152:153], v[132:133] op_sel_hi:[1,0]
    v_pk_mul_f32 v[154:155], v[154:155], v[132:133] op_sel_hi:[1,0]
    v_pk_mul_f32 v[156:157], v[156:157], v[132:133] op_sel_hi:[1,0]
    v_pk_mul_f32 v[158:159], v[158:159], v[132:133] op_sel_hi:[1,0]
    v_cvt_pk_bf16_f32 v16, v144, v145
    v_cvt_pk_bf16_f32 v17, v146, v147
    v_cvt_pk_bf16_f32 v18, v148, v149
    v_cvt_pk_bf16_f32 v19, v150, v151
    v_cvt_pk_bf16_f32 v20, v152, v153
    v_cvt_pk_bf16_f32 v21, v154, v155
    v_cvt_pk_bf16_f32 v22, v156, v157
    v_cvt_pk_bf16_f32 v23, v158, v159
    v_pk_fma_f32 v[160:161], v[134:135], v[152:153], v[144:145] op_sel_hi:[0,1,1] neg_lo:[0,0,1] neg_hi:[0,0,1]
    v_pk_fma_f32 v[162:163], v[134:135], v[154:155], v[146:147] op_sel_hi:[0,1,1] neg_lo:[0,0,1] neg_hi:[0,0,1]
    v_pk_fma_f32 v[164:165], v[134:135], v[156:157], v[148:149] op_sel_hi:[0,1,1] neg_lo:[0,0,1] neg_hi:[0,0,1]
    v_pk_fma_f32 v[166:167], v[134:135], v[158:159], v[150:151] op_sel_hi:[0,1,1] neg_lo:[0,0,1] neg_hi:[0,0,1]
    v_cvt_pk_bf16_f32 v24, v160, v161
    v_cvt_pk_bf16_f32 v25, v162, v163
    v_cvt_pk_bf16_f32 v26, v164, v165
    v_cvt_pk_bf16_f32 v27, v166, v167
    v_pk_fma_f32 v[144:145], v[134:135], v[160:161], v[152:153] op_sel_hi:[0,1,1] neg_lo:[0,0,1] neg_hi:[0,0,1]
    v_pk_fma_f32 v[146:147], v[134:135], v[162:163], v[154:155] op_sel_hi:[0,1,1] neg_lo:[0,0,1] neg_hi:[0,0,1]
    v_pk_fma_f32 v[148:149], v[134:135], v[164:165], v[156:157] op_sel_hi:[0,1,1] neg_lo:[0,0,1] neg_hi:[0,0,1]
    v_pk_fma_f32 v[150:151], v[134:135], v[166:167], v[158:159] op_sel_hi:[0,1,1] neg_lo:[0,0,1] neg_hi:[0,0,1]
    v_cvt_pk_bf16_f32 v28, v144, v145
    v_cvt_pk_bf16_f32 v29, v146, v147
    v_cvt_pk_bf16_f32 v30, v148, v149
    v_cvt_pk_bf16_f32 v31, v150, v151
    v_pk_fma_f32 v[152:153], v[134:135], v[144:145], v[160:161] op_sel_hi:[0,1,1] neg_lo:[0,0,1] neg_hi:[0,0,1]
    v_pk_fma_f32 v[154:155], v[134:135], v[146:147], v[162:163] op_sel_hi:[0,1,1] neg_lo:[0,0,1] neg_hi:[0,0,1]
    v_pk_fma_f32 v[156:157], v[134:135], v[148:149], v[164:165] op_sel_hi:[0,1,1] neg_lo:[0,0,1] neg_hi:[0,0,1]
    v_pk_fma_f32 v[158:159], v[134:135], v[150:151], v[166:167] op_sel_hi:[0,1,1] neg_lo:[0,0,1] neg_hi:[0,0,1]
    v_cvt_pk_bf16_f32 v32, v152, v153
    v_cvt_pk_bf16_f32 v33, v154, v155
    v_cvt_pk_bf16_f32 v34, v156, v157
    v_cvt_pk_bf16_f32 v35, v158, v159
    v_pk_fma_f32 v[160:161], v[134:135], v[152:153], v[144:145] op_sel_hi:[0,1,1] neg_lo:[0,0,1] neg_hi:[0,0,1]
    buffer_load_dwordx2 v[12:13], off, s[32:35], 0 sc1
    v_pk_fma_f32 v[162:163], v[134:135], v[154:155], v[146:147] op_sel_hi:[0,1,1] neg_lo:[0,0,1] neg_hi:[0,0,1]
    v_pk_fma_f32 v[164:165], v[134:135], v[156:157], v[148:149] op_sel_hi:[0,1,1] neg_lo:[0,0,1] neg_hi:[0,0,1]
    v_pk_fma_f32 v[166:167], v[134:135], v[158:159], v[150:151] op_sel_hi:[0,1,1] neg_lo:[0,0,1] neg_hi:[0,0,1]
    v_cvt_pk_bf16_f32 v36, v160, v161
    v_cvt_pk_bf16_f32 v37, v162, v163
    v_cvt_pk_bf16_f32 v38, v164, v165
    v_cvt_pk_bf16_f32 v39, v166, v167
    v_pk_fma_f32 v[144:145], v[134:135], v[160:161], v[152:153] op_sel_hi:[0,1,1] neg_lo:[0,0,1] neg_hi:[0,0,1]
    v_pk_fma_f32 v[146:147], v[134:135], v[162:163], v[154:155] op_sel_hi:[0,1,1] neg_lo:[0,0,1] neg_hi:[0,0,1]
    v_pk_fma_f32 v[148:149], v[134:135], v[164:165], v[156:157] op_sel_hi:[0,1,1] neg_lo:[0,0,1] neg_hi:[0,0,1]
    v_pk_fma_f32 v[150:151], v[134:135], v[166:167], v[158:159] op_sel_hi:[0,1,1] neg_lo:[0,0,1] neg_hi:[0,0,1]
    v_cvt_pk_bf16_f32 v40, v144, v145
    v_cvt_pk_bf16_f32 v41, v146, v147
    v_cvt_pk_bf16_f32 v42, v148, v149
    v_cvt_pk_bf16_f32 v43, v150, v151
    v_pk_fma_f32 v[152:153], v[134:135], v[144:145], v[160:161] op_sel_hi:[0,1,1] neg_lo:[0,0,1] neg_hi:[0,0,1]
    v_pk_fma_f32 v[154:155], v[134:135], v[146:147], v[162:163] op_sel_hi:[0,1,1] neg_lo:[0,0,1] neg_hi:[0,0,1]
    v_pk_fma_f32 v[156:157], v[134:135], v[148:149], v[164:165] op_sel_hi:[0,1,1] neg_lo:[0,0,1] neg_hi:[0,0,1]
    v_pk_fma_f32 v[158:159], v[134:135], v[150:151], v[166:167] op_sel_hi:[0,1,1] neg_lo:[0,0,1] neg_hi:[0,0,1]
    v_cvt_pk_bf16_f32 v44, v152, v153
    v_cvt_pk_bf16_f32 v45, v154, v155
    v_cvt_pk_bf16_f32 v46, v156, v157
    v_cvt_pk_bf16_f32 v47, v158, v159
    v_pk_fma_f32 v[160:161], v[134:135], v[152:153], v[144:145] op_sel_hi:[0,1,1] neg_lo:[0,0,1] neg_hi:[0,0,1]
    v_pk_fma_f32 v[162:163], v[134:135], v[154:155], v[146:147] op_sel_hi:[0,1,1] neg_lo:[0,0,1] neg_hi:[0,0,1]
    v_pk_fma_f32 v[164:165], v[134:135], v[156:157], v[148:149] op_sel_hi:[0,1,1] neg_lo:[0,0,1] neg_hi:[0,0,1]
    v_pk_fma_f32 v[166:167], v[134:135], v[158:159], v[150:151] op_sel_hi:[0,1,1] neg_lo:[0,0,1] neg_hi:[0,0,1]
    v_cvt_pk_bf16_f32 v48, v160, v161
    v_cvt_pk_bf16_f32 v49, v162, v163
    v_cvt_pk_bf16_f32 v50, v164, v165
    v_cvt_pk_bf16_f32 v51, v166, v167
    v_pk_fma_f32 v[144:145], v[134:135], v[160:161], v[152:153] op_sel_hi:[0,1,1] neg_lo:[0,0,1] neg_hi:[0,0,1]
    v_pk_fma_f32 v[146:147], v[134:135], v[162:163], v[154:155] op_sel_hi:[0,1,1] neg_lo:[0,0,1] neg_hi:[0,0,1]
    v_pk_fma_f32 v[148:149], v[134:135], v[164:165], v[156:157] op_sel_hi:[0,1,1] neg_lo:[0,0,1] neg_hi:[0,0,1]
    v_pk_fma_f32 v[150:151], v[134:135], v[166:167], v[158:159] op_sel_hi:[0,1,1] neg_lo:[0,0,1] neg_hi:[0,0,1]
    v_cvt_pk_bf16_f32 v52, v144, v145
    v_cvt_pk_bf16_f32 v53, v146, v147
    v_cvt_pk_bf16_f32 v54, v148, v149
    v_cvt_pk_bf16_f32 v55, v150, v151
    v_pk_fma_f32 v[152:153], v[134:135], v[144:145], v[160:161] op_sel_hi:[0,1,1] neg_lo:[0,0,1] neg_hi:[0,0,1]
    v_pk_fma_f32 v[154:155], v[134:135], v[146:147], v[162:163] op_sel_hi:[0,1,1] neg_lo:[0,0,1] neg_hi:[0,0,1]
    v_pk_fma_f32 v[156:157], v[134:135], v[148:149], v[164:165] op_sel_hi:[0,1,1] neg_lo:[0,0,1] neg_hi:[0,0,1]
    v_pk_fma_f32 v[158:159], v[134:135], v[150:151], v[166:167] op_sel_hi:[0,1,1] neg_lo:[0,0,1] neg_hi:[0,0,1]
    v_cvt_pk_bf16_f32 v56, v152, v153
    v_cvt_pk_bf16_f32 v57, v154, v155
    v_cvt_pk_bf16_f32 v58, v156, v157
    v_cvt_pk_bf16_f32 v59, v158, v159
    v_pk_fma_f32 v[160:161], v[134:135], v[152:153], v[144:145] op_sel_hi:[0,1,1] neg_lo:[0,0,1] neg_hi:[0,0,1]
    v_pk_fma_f32 v[162:163], v[134:135], v[154:155], v[146:147] op_sel_hi:[0,1,1] neg_lo:[0,0,1] neg_hi:[0,0,1]
    v_pk_fma_f32 v[164:165], v[134:135], v[156:157], v[148:149] op_sel_hi:[0,1,1] neg_lo:[0,0,1] neg_hi:[0,0,1]
    s_add_u32 m0, s94, 28672
    s_mul_i32 s53, s80, s10
    buffer_load_dwordx4 v174, s[64:67], s53 offen lds
    v_pk_fma_f32 v[166:167], v[134:135], v[158:159], v[150:151] op_sel_hi:[0,1,1] neg_lo:[0,0,1] neg_hi:[0,0,1]
    v_cvt_pk_bf16_f32 v60, v160, v161
    v_cvt_pk_bf16_f32 v61, v162, v163
    v_cvt_pk_bf16_f32 v62, v164, v165
    v_cvt_pk_bf16_f32 v63, v166, v167
    v_pk_fma_f32 v[144:145], v[134:135], v[160:161], v[152:153] op_sel_hi:[0,1,1] neg_lo:[0,0,1] neg_hi:[0,0,1]
    v_pk_fma_f32 v[146:147], v[134:135], v[162:163], v[154:155] op_sel_hi:[0,1,1] neg_lo:[0,0,1] neg_hi:[0,0,1]
    v_pk_fma_f32 v[148:149], v[134:135], v[164:165], v[156:157] op_sel_hi:[0,1,1] neg_lo:[0,0,1] neg_hi:[0,0,1]
    v_pk_fma_f32 v[150:151], v[134:135], v[166:167], v[158:159] op_sel_hi:[0,1,1] neg_lo:[0,0,1] neg_hi:[0,0,1]
    v_cvt_pk_bf16_f32 v64, v144, v145
    v_cvt_pk_bf16_f32 v65, v146, v147
    v_cvt_pk_bf16_f32 v66, v148, v149
    v_cvt_pk_bf16_f32 v67, v150, v151
    v_pk_fma_f32 v[152:153], v[134:135], v[144:145], v[160:161] op_sel_hi:[0,1,1] neg_lo:[0,0,1] neg_hi:[0,0,1]
    v_pk_fma_f32 v[154:155], v[134:135], v[146:147], v[162:163] op_sel_hi:[0,1,1] neg_lo:[0,0,1] neg_hi:[0,0,1]
    v_pk_fma_f32 v[156:157], v[134:135], v[148:149], v[164:165] op_sel_hi:[0,1,1] neg_lo:[0,0,1] neg_hi:[0,0,1]
    v_pk_fma_f32 v[158:159], v[134:135], v[150:151], v[166:167] op_sel_hi:[0,1,1] neg_lo:[0,0,1] neg_hi:[0,0,1]
    v_cvt_pk_bf16_f32 v68, v152, v153
    v_cvt_pk_bf16_f32 v69, v154, v155
    v_cvt_pk_bf16_f32 v70, v156, v157
    v_cvt_pk_bf16_f32 v71, v158, v159
    v_lshrrev_b32 v9, 2, v3
    v_and_b32 v10, 2, v9
    v_xor_b32 v10, v10, v4
    v_lshlrev_b32 v10, 4, v10
    v_lshl_add_u32 v244, v3, 6, v10
    v_lshl_add_u32 v245, v1, 10, v244
    v_mov_b32 v240, 0x3f803f80
    v_mov_b32 v241, 0x3f803f80
    v_mov_b32 v242, 0x3f803f80
    v_mov_b32 v243, 0x3f803f80
    v_and_b32 v10, 1, v3
    v_lshlrev_b32 v252, 4, v10
    v_sub_u32 v10, 0, v10
    s_brev_b32 s53, 1
    v_lshrrev_b32 v253, v252, s53
    v_lshl_add_u32 v11, s88, 4, v3
    v_cmp_gt_u32 vcc, 2, v11
    v_and_b32 v10, 0x80008000, v10
    v_xor_b32 v11, 0x80008000, v10
    v_cndmask_b32 v252, v253, v10, vcc
    v_cndmask_b32 v253, v253, v11, vcc
    v_lshlrev_b32 v250, 4, v3
    s_lshl_b32 s3, s49, 2
    s_add_u32 s3, s3, s26
    v_lshlrev_b32 v9, 6, v3
    v_lshl_add_u32 v9, v1, 4, v9
    v_lshl_add_u32 v9, v4, 2, v9
    v_add_u32 v247, 57344, v9
    v_lshlrev_b32 v10, 1, v4
    v_lshl_add_u32 v10, s3, 3, v10
    v_add_u32 v248, 1, v10
    v_sub_u32 v11, 224, v248
    v_cmp_lt_u32 vcc, v248, v11
    v_min_u32 v248, v248, v11
    v_and_b32 v11, 0x78, v248
    v_cndmask_b32 v9, 8, 0, vcc
    v_add3_u32 v248, v248, v11, v9
    s_add_u32 m0, s94, 32768
    s_mul_i32 s53, s81, s10
    buffer_load_dwordx4 v174, s[64:67], s53 offen lds
    s_movk_i32 s57, 232
    v_add_u32 v249, 2, v10
    v_sub_u32 v11, 224, v249
    v_cmp_lt_u32 vcc, v249, v11
    v_min_u32 v249, v249, v11
    v_and_b32 v11, 0x78, v249
    v_cndmask_b32 v9, 8, 0, vcc
    v_add3_u32 v249, v249, v11, v9
    v_cmp_eq_u32 s[98:99], 8, v249
    v_cmp_eq_u32 s[58:59], s57, v249
    v_lshl_add_u32 v248, v248, 13, v250
    v_cndmask_b32 v249, v249, 0, s[98:99]
    v_cndmask_b32 v249, v249, 8, s[58:59]
    v_lshl_add_u32 v249, v249, 13, v250
    s_lshl_b32 s89, s48, 8
    s_add_u32 s89, s89, 3670016
    s_mov_b32 s62, 0x05040100
    s_mov_b32 s63, 0x07060302
    s_mov_b64 s[72:73], s[24:25]
    s_mov_b32 s75, 0x20000
    s_mov_b32 s53, 65536
    v_lshl_add_u32 v246, v250, 1, s53
    v_lshl_add_u32 v15, v1, 3, v246
    v_lshl_add_u32 v251, v4, 9, v250
    s_mov_b64 s[68:69], s[24:25]
    s_mov_b32 s70, s93
    s_mov_b32 s71, 0x20000
    s_lshl_b32 s92, s88, 12
    s_mul_i32 s78, s87, 57344
    s_add_u32 s78, s78, s92
    s_mov_b32 s58, 0xaaaaaaaa
    s_mov_b32 s59, s58
    s_mov_b32 s76, 0xcccccccc
    s_mov_b32 s77, s76
    s_lshl_b32 s97, s3, 5
    s_add_u32 s97, s97, s48
    s_lshl_b32 s97, s97, 5
    s_add_u32 s97, s97, 14356480
    v_lshrrev_b32 v9, 2, v3
    v_lshl_add_u32 v9, v4, 3, v9
    v_lshlrev_b32 v9, 7, v9
    v_and_b32 v10, 3, v3
    v_lshl_add_u32 v9, v10, 3, v9
    v_lshrrev_b32 v10, 2, v2
    v_and_b32 v10, 0x60, v10
    v_add_u32 v9, 28672, v9
    v_or_b32 v5, v9, v10
    v_xor_b32 v6, 32, v5
    v_xor_b32 v7, 64, v5
    v_xor_b32 v8, 96, v5
    s_lshl_b32 s61, s50, 2
    s_add_u32 s61, s61, s26
    s_mul_i32 s61, s61, 56
    s_lshl_b32 s60, s51, 1
    s_add_u32 m0, s94, 36864
    s_mul_i32 s53, s82, s10
    buffer_load_dwordx4 v174, s[64:67], s53 offen lds
    s_add_u32 s61, s61, s60
    s_lshl_b32 s61, s61, 12
    v_cvt_f32_u32 v14, v4
    v_cvt_f32_u32 v0, v3
    v_mul_f32 v0, 0x3d000000, v0
    v_mul_f32 v14, 4.0, v14
    v_mul_f32 v172, v0, v14
    v_mov_b32 v224, v172
    v_fmamk_f32 v225, v0, 0x3f800000, v172
    v_fmamk_f32 v226, v0, 0x40000000, v172
    v_fmamk_f32 v227, v0, 0x40400000, v172
    v_fmamk_f32 v228, v0, 0x41800000, v172
    v_fmamk_f32 v229, v0, 0x41880000, v172
    v_fmamk_f32 v230, v0, 0x41900000, v172
    v_fmamk_f32 v231, v0, 0x41980000, v172
    v_sin_f32 v232, v224
    v_sin_f32 v233, v225
    v_sin_f32 v234, v226
    v_sin_f32 v235, v227
    v_sin_f32 v236, v228
    v_sin_f32 v237, v229
    v_sin_f32 v238, v230
    v_sin_f32 v239, v231
    v_cos_f32 v224, v224
    v_cos_f32 v225, v225
    v_cos_f32 v226, v226
    v_cos_f32 v227, v227
    v_cos_f32 v228, v228
    v_cos_f32 v229, v229
    v_cos_f32 v230, v230
    v_cos_f32 v231, v231
    v_cvt_pk_bf16_f32 v216, v232, v233
    v_cvt_pk_bf16_f32 v217, v234, v235
    v_cvt_pk_bf16_f32 v218, v236, v237
    v_cvt_pk_bf16_f32 v219, v238, v239
    v_cvt_pk_bf16_f32 v208, v224, v225
    v_cvt_pk_bf16_f32 v209, v226, v227
    v_cvt_pk_bf16_f32 v210, v228, v229
    v_cvt_pk_bf16_f32 v211, v230, v231
    v_xor_b32 v220, 0x80000000, v216
    v_xor_b32 v221, 0x80000000, v217
    v_xor_b32 v222, 0x80000000, v218
    v_xor_b32 v223, 0x80000000, v219
    v_xor_b32 v212, 0x80000000, v208
    v_xor_b32 v213, 0x80000000, v209
    v_xor_b32 v214, 0x80000000, v210
    v_xor_b32 v215, 0x80000000, v211
    s_add_u32 m0, s94, 40960
    s_mul_i32 s53, s83, s10
    buffer_load_dwordx4 v174, s[64:67], s53 offen lds
    s_memrealtime s[90:91]
    s_waitcnt vmcnt(7)
    s_waitcnt lgkmcnt(0)
    s_barrier
    ds_read_b128 a[112:115], v245 offset:0
    ds_read_b128 a[0:3], v244 offset:0
    ds_read_b128 a[4:7], v244 offset:1024
    ds_read_b128 a[116:119], v245 offset:4096
    ds_read_b128 a[8:11], v244 offset:2048
    ds_read_b128 a[12:15], v244 offset:3072
    s_waitcnt lgkmcnt(5)
    v_mfma_f32_16x16x32_bf16 v[144:147], a[112:115], a[112:115], 0
    ds_read_b128 a[120:123], v245 offset:8192
    v_xor_b32 v72, v252, v16
    s_waitcnt lgkmcnt(5)
    v_mfma_f32_16x16x32_bf16 v[128:131], v[16:19], a[0:3], 0
    ds_read_b128 a[16:19], v244 offset:4096
    s_add_u32 m0, s94, 45056
    s_mul_i32 s53, s84, s10
    buffer_load_dwordx4 v174, s[64:67], s53 offen lds
    v_mfma_f32_16x16x32_bf16 v[148:151], v[240:243], a[112:115], 0
    ds_read_b128 a[20:23], v244 offset:5120
    v_xor_b32 v73, v253, v17
    s_waitcnt lgkmcnt(6)
    v_mfma_f32_16x16x32_bf16 v[132:135], v[16:19], a[4:7], 0
    ds_read_b128 a[124:127], v245 offset:12288
    v_xor_b32 v74, v252, v18
    s_waitcnt lgkmcnt(6)
    v_mfma_f32_16x16x32_bf16 v[144:147], a[116:119], a[116:119], v[144:147]
    ds_read_b128 a[24:27], v244 offset:6144
    v_xor_b32 v75, v253, v19
    s_waitcnt lgkmcnt(6)
    v_mfma_f32_16x16x32_bf16 v[128:131], v[20:23], a[8:11], v[128:131]
    ds_read_b128 a[28:31], v244 offset:7168
    s_add_u32 m0, s94, 49152
    s_mul_i32 s53, s85, s10
    buffer_load_dwordx4 v174, s[64:67], s53 offen lds
    v_mfma_f32_16x16x32_bf16 v[148:151], v[240:243], a[116:119], v[148:151]
    ds_read_b128 a[128:131], v245 offset:16384
    v_xor_b32 v76, v252, v20
    s_waitcnt lgkmcnt(7)
    v_mfma_f32_16x16x32_bf16 v[132:135], v[20:23], a[12:15], v[132:135]
    ds_read_b128 a[32:35], v244 offset:8192
    v_xor_b32 v77, v253, v21
    s_waitcnt lgkmcnt(7)
    v_mfma_f32_16x16x32_bf16 v[144:147], a[120:123], a[120:123], v[144:147]
    ds_read_b128 a[36:39], v244 offset:9216
    v_xor_b32 v78, v252, v22
    s_waitcnt lgkmcnt(7)
    v_mfma_f32_16x16x32_bf16 v[128:131], v[24:27], a[16:19], v[128:131]
    ds_read_b128 a[132:135], v245 offset:20480
    s_add_u32 m0, s94, 53248
    s_mul_i32 s53, s86, s10
    buffer_load_dwordx4 v174, s[64:67], s53 offen lds
    v_mfma_f32_16x16x32_bf16 v[148:151], v[240:243], a[120:123], v[148:151]
    ds_read_b128 a[40:43], v244 offset:10240
    v_xor_b32 v79, v253, v23
    s_waitcnt lgkmcnt(8)
    v_mfma_f32_16x16x32_bf16 v[132:135], v[24:27], a[20:23], v[132:135]
    ds_read_b128 a[44:47], v244 offset:11264
    v_xor_b32 v80, v252, v24
    s_waitcnt lgkmcnt(8)
    v_mfma_f32_16x16x32_bf16 v[144:147], a[124:127], a[124:127], v[144:147]
    ds_read_b128 a[136:139], v245 offset:24576
    v_xor_b32 v81, v253, v25
    s_waitcnt lgkmcnt(8)
    v_mfma_f32_16x16x32_bf16 v[128:131], v[28:31], a[24:27], v[128:131]
    ds_read_b128 a[48:51], v244 offset:12288
    v_xor_b32 v82, v252, v26
    v_mfma_f32_16x16x32_bf16 v[148:151], v[240:243], a[124:127], v[148:151]
    ds_read_b128 a[52:55], v244 offset:13312
    v_xor_b32 v83, v253, v27
    s_waitcnt lgkmcnt(9)
    v_mfma_f32_16x16x32_bf16 v[132:135], v[28:31], a[28:31], v[132:135]
    ds_read_b128 a[56:59], v244 offset:14336
    v_xor_b32 v84, v252, v28
    s_waitcnt lgkmcnt(9)
    v_mfma_f32_16x16x32_bf16 v[144:147], a[128:131], a[128:131], v[144:147]
    ds_read_b128 a[60:63], v244 offset:15360
    v_xor_b32 v85, v253, v29
    s_waitcnt lgkmcnt(9)
    v_mfma_f32_16x16x32_bf16 v[128:131], v[32:35], a[32:35], v[128:131]
    ds_read_b128 a[64:67], v244 offset:16384
    v_xor_b32 v86, v252, v30
    v_mfma_f32_16x16x32_bf16 v[148:151], v[240:243], a[128:131], v[148:151]
    ds_read_b128 a[68:71], v244 offset:17408
    v_xor_b32 v87, v253, v31
    s_waitcnt lgkmcnt(10)
    v_mfma_f32_16x16x32_bf16 v[132:135], v[32:35], a[36:39], v[132:135]
    ds_read_b128 a[72:75], v244 offset:18432
    v_xor_b32 v88, v252, v32
    s_waitcnt lgkmcnt(10)
    v_mfma_f32_16x16x32_bf16 v[144:147], a[132:135], a[132:135], v[144:147]
    ds_read_b128 a[76:79], v244 offset:19456
    v_xor_b32 v89, v253, v33
    s_waitcnt lgkmcnt(10)
    v_mfma_f32_16x16x32_bf16 v[128:131], v[36:39], a[40:43], v[128:131]
    ds_read_b128 a[80:83], v244 offset:20480
    v_xor_b32 v90, v252, v34
    v_mfma_f32_16x16x32_bf16 v[148:151], v[240:243], a[132:135], v[148:151]
    ds_read_b128 a[84:87], v244 offset:21504
    v_xor_b32 v91, v253, v35
    s_waitcnt lgkmcnt(11)
    v_mfma_f32_16x16x32_bf16 v[132:135], v[36:39], a[44:47], v[132:135]
    ds_read_b128 a[88:91], v244 offset:22528
    v_xor_b32 v92, v252, v36
    s_waitcnt lgkmcnt(11)
    v_mfma_f32_16x16x32_bf16 v[144:147], a[136:139], a[136:139], v[144:147]
    ds_read_b128 a[92:95], v244 offset:23552
    v_xor_b32 v93, v253, v37
    s_waitcnt lgkmcnt(11)
    v_mfma_f32_16x16x32_bf16 v[128:131], v[40:43], a[48:51], v[128:131]
    ds_read_b128 a[96:99], v244 offset:24576
    v_xor_b32 v94, v252, v38
    v_mfma_f32_16x16x32_bf16 v[148:151], v[240:243], a[136:139], v[148:151]
    ds_read_b128 a[100:103], v244 offset:25600
    s_cmp_lg_u32 s26, 0
    s_cbranch_scc1 L_tg2
    s_waitcnt vmcnt(7)
    v_cmp_eq_u32 vcc, 0, v12
    s_cbranch_vccnz L_slow_tgw
L_back_tgw:
    ds_write_b64 v246, v[12:13] offset:1024
    s_waitcnt lgkmcnt(0)
L_tg2:
    s_waitcnt lgkmcnt(12)
    v_mfma_f32_16x16x32_bf16 v[132:135], v[40:43], a[52:55], v[132:135]
    ds_read_b128 a[104:107], v244 offset:26624
    v_xor_b32 v95, v253, v39
    s_waitcnt lgkmcnt(12)
    v_mfma_f32_16x16x32_bf16 v[128:131], v[44:47], a[56:59], v[128:131]
    ds_read_b128 a[108:111], v244 offset:27648
    v_xor_b32 v96, v252, v40
    s_waitcnt lgkmcnt(12)
    v_mfma_f32_16x16x32_bf16 v[132:135], v[44:47], a[60:63], v[132:135]
    v_cndmask_b32 v149, v144, v145, s[58:59]
    v_cndmask_b32 v144, v146, v147, s[58:59]
    s_waitcnt lgkmcnt(11)
    v_mfma_f32_16x16x32_bf16 v[128:131], v[48:51], a[64:67], v[128:131]
    v_cndmask_b32 v149, v149, v144, s[76:77]
    s_mov_b32 exec_lo, 0x00f0000f
    s_mov_b32 exec_hi, 0xf0000f00
    ds_write_b64 v15, v[148:149]
    s_mov_b64 exec, -1
    s_waitcnt lgkmcnt(11)
    v_mfma_f32_16x16x32_bf16 v[132:135], v[48:51], a[68:71], v[132:135]
    v_xor_b32 v97, v253, v41
    v_xor_b32 v98, v252, v42
    s_waitcnt lgkmcnt(10)
    v_mfma_f32_16x16x32_bf16 v[128:131], v[52:55], a[72:75], v[128:131]
    v_xor_b32 v99, v253, v43
    v_xor_b32 v100, v252, v44
    s_waitcnt lgkmcnt(9)
    v_mfma_f32_16x16x32_bf16 v[132:135], v[52:55], a[76:79], v[132:135]
    s_waitcnt vmcnt(8)
    s_waitcnt lgkmcnt(0)
    s_barrier
    ds_read_b128 v[144:147], v246 offset:0
    ds_read_b128 v[148:151], v246 offset:16
    v_mfma_f32_16x16x32_bf16 v[128:131], v[56:59], a[80:83], v[128:131]
    s_waitcnt vmcnt(7)
    ds_read_b64 v[12:13], v246 offset:1024
    v_mov_b32 v240, 0x3727c5ac
    v_mfma_f32_16x16x32_bf16 v[132:135], v[56:59], a[84:87], v[132:135]
    ds_read_b32 v176, v247 offset:0
    ds_read_b32 v177, v247 offset:1024
    v_mfma_f32_16x16x32_bf16 v[128:131], v[60:63], a[88:91], v[128:131]
    ds_read_b32 v178, v247 offset:2048
    ds_read_b32 v179, v247 offset:3072
    v_mfma_f32_16x16x32_bf16 v[132:135], v[60:63], a[92:95], v[132:135]
    ds_read_b32 v180, v247 offset:4096
    ds_read_b32 v181, v247 offset:5120
    v_mfma_f32_16x16x32_bf16 v[128:131], v[64:67], a[96:99], v[128:131]
    s_waitcnt lgkmcnt(7)
    v_add_f32 v144, v144, v148
    v_add_f32 v145, v145, v149
    ds_read_b32 v182, v247 offset:6144
    ds_read_b32 v183, v247 offset:7168
    v_mfma_f32_16x16x32_bf16 v[132:135], v[64:67], a[100:103], v[132:135]
    v_add_f32 v146, v146, v150
    v_add_f32 v147, v147, v151
    v_mfma_f32_16x16x32_bf16 v[128:131], v[68:71], a[104:107], v[128:131]
    v_mul_f32 v144, s56, v144
    v_mul_f32 v146, s56, v146
    s_waitcnt lgkmcnt(3)
    v_perm_b32 v184, v180, v176, s62
    s_waitcnt lgkmcnt(2)
    v_perm_b32 v185, v181, v177, s62
    s_waitcnt lgkmcnt(1)
    v_perm_b32 v186, v182, v178, s62
    s_waitcnt lgkmcnt(0)
    v_perm_b32 v187, v183, v179, s62
    buffer_store_dwordx4 v[184:187], v248, s[72:75], s89 offen sc1
    v_perm_b32 v188, v180, v176, s63
    v_perm_b32 v189, v181, v177, s63
    v_perm_b32 v190, v182, v178, s63
    v_perm_b32 v191, v183, v179, s63
    buffer_store_dwordx4 v[188:191], v249, s[72:75], s89 offen sc1
    v_mfma_f32_16x16x32_bf16 v[132:135], v[68:71], a[108:111], v[132:135]
    v_fma_f32 v144, -v144, v144, v240
    v_fma_f32 v146, -v146, v146, v240
    v_mfma_f32_16x16x32_bf16 v[136:139], v[72:75], a[0:3], 0
    v_fma_f32 v144, v145, s56, v144
    v_fma_f32 v146, v147, s56, v146
    v_mfma_f32_16x16x32_bf16 v[140:143], v[72:75], a[4:7], 0
    v_rsq_f32 v144, v144
    v_rsq_f32 v146, v146
    v_mfma_f32_16x16x32_bf16 v[136:139], v[76:79], a[8:11], v[136:139]
    v_mov_b32 v155, v12
    v_mov_b32 v159, v12
    v_mfma_f32_16x16x32_bf16 v[140:143], v[76:79], a[12:15], v[140:143]
    v_mov_b32 v163, v12
    v_mov_b32 v167, v12
    v_mfma_f32_16x16x32_bf16 v[136:139], v[80:83], a[16:19], v[136:139]
    v_cvt_pk_bf16_f32 v154, v144, v146
    v_cvt_pk_bf16_f32 v158, v144, v146
    v_mfma_f32_16x16x32_bf16 v[140:143], v[80:83], a[20:23], v[140:143]
    v_cvt_pk_bf16_f32 v162, v144, v146
    v_cvt_pk_bf16_f32 v166, v144, v146
    v_mfma_f32_16x16x32_bf16 v[136:139], v[84:87], a[24:27], v[136:139]
    v_cvt_pk_bf16_f32 v152, v128, v129
    v_cvt_pk_bf16_f32 v153, v132, v133
    v_mfma_f32_16x16x32_bf16 v[140:143], v[84:87], a[28:31], v[140:143]
    buffer_store_dwordx4 v[152:155], v251, s[68:71], s78 offen offset:0 sc1
    v_cvt_pk_bf16_f32 v156, v130, v131
    v_mfma_f32_16x16x32_bf16 v[136:139], v[88:91], a[32:35], v[136:139]
    v_cvt_pk_bf16_f32 v157, v134, v135
    buffer_store_dwordx4 v[156:159], v251, s[68:71], s78 offen offset:256 sc1
    v_mfma_f32_16x16x32_bf16 v[140:143], v[88:91], a[36:39], v[140:143]
    v_xor_b32 v101, v253, v45
    v_mfma_f32_16x16x32_bf16 v[136:139], v[92:95], a[40:43], v[136:139]
    v_xor_b32 v102, v252, v46
    v_xor_b32 v103, v253, v47
    v_mfma_f32_16x16x32_bf16 v[140:143], v[92:95], a[44:47], v[140:143]
    v_xor_b32 v104, v252, v48
    v_xor_b32 v105, v253, v49
    v_mfma_f32_16x16x32_bf16 v[136:139], v[96:99], a[48:51], v[136:139]
    v_xor_b32 v106, v252, v50
    v_xor_b32 v107, v253, v51
    v_mfma_f32_16x16x32_bf16 v[140:143], v[96:99], a[52:55], v[140:143]
    v_xor_b32 v108, v252, v52
    v_xor_b32 v109, v253, v53
    v_mfma_f32_16x16x32_bf16 v[136:139], v[100:103], a[56:59], v[136:139]
    v_xor_b32 v110, v252, v54
    v_xor_b32 v111, v253, v55
    v_mfma_f32_16x16x32_bf16 v[140:143], v[100:103], a[60:63], v[140:143]
    v_xor_b32 v112, v252, v56
    v_xor_b32 v113, v253, v57
    v_mfma_f32_16x16x32_bf16 v[136:139], v[104:107], a[64:67], v[136:139]
    v_xor_b32 v114, v252, v58
    v_xor_b32 v115, v253, v59
    v_mfma_f32_16x16x32_bf16 v[140:143], v[104:107], a[68:71], v[140:143]
    v_xor_b32 v116, v252, v60
    v_xor_b32 v117, v253, v61
    v_mfma_f32_16x16x32_bf16 v[136:139], v[108:111], a[72:75], v[136:139]
    v_xor_b32 v118, v252, v62
    v_xor_b32 v119, v253, v63
    v_mfma_f32_16x16x32_bf16 v[140:143], v[108:111], a[76:79], v[140:143]
    v_xor_b32 v120, v252, v64
    v_xor_b32 v121, v253, v65
    v_mfma_f32_16x16x32_bf16 v[136:139], v[112:115], a[80:83], v[136:139]
    v_xor_b32 v122, v252, v66
    v_xor_b32 v123, v253, v67
    v_mfma_f32_16x16x32_bf16 v[140:143], v[112:115], a[84:87], v[140:143]
    v_xor_b32 v124, v252, v68
    v_xor_b32 v125, v253, v69
    v_mfma_f32_16x16x32_bf16 v[136:139], v[116:119], a[88:91], v[136:139]
    v_xor_b32 v126, v252, v70
    v_xor_b32 v127, v253, v71
    v_mfma_f32_16x16x32_bf16 v[140:143], v[116:119], a[92:95], v[140:143]
    v_mfma_f32_16x16x32_bf16 v[136:139], v[120:123], a[96:99], v[136:139]
    v_mfma_f32_16x16x32_bf16 v[140:143], v[120:123], a[100:103], v[140:143]
    v_mfma_f32_16x16x32_bf16 v[136:139], v[124:127], a[104:107], v[136:139]
    v_mfma_f32_16x16x32_bf16 v[140:143], v[124:127], a[108:111], v[140:143]
    s_nop 6
    v_cvt_pk_bf16_f32 v160, v136, v137
    v_cvt_pk_bf16_f32 v161, v140, v141
    buffer_store_dwordx4 v[160:163], v251, s[68:71], s78 offen offset:2048 sc1
    v_cvt_pk_bf16_f32 v164, v138, v139
    v_cvt_pk_bf16_f32 v165, v142, v143
    buffer_store_dwordx4 v[164:167], v251, s[68:71], s78 offen offset:2304 sc1
    s_cmp_ge_u32 s2, 224
    s_cbranch_scc1 L_helper
    s_waitcnt vmcnt(6)
    s_barrier
    ds_read_b64_tr_b16 a[0:1], v5 offset:0
    ds_read_b64_tr_b16 a[2:3], v5 offset:512
    ds_read_b64_tr_b16 a[4:5], v6 offset:0
    ds_read_b64_tr_b16 a[6:7], v6 offset:512
    ds_read_b64_tr_b16 a[8:9], v7 offset:0
    ds_read_b64_tr_b16 a[10:11], v7 offset:512
    ds_read_b64_tr_b16 a[12:13], v8 offset:0
    ds_read_b64_tr_b16 a[14:15], v8 offset:512
    ds_read_b64_tr_b16 a[16:17], v5 offset:4096
    ds_read_b64_tr_b16 a[18:19], v5 offset:4608
    ds_read_b64_tr_b16 a[20:21], v6 offset:4096
    ds_read_b64_tr_b16 a[22:23], v6 offset:4608
    s_mul_i32 s53, s50, 200704
    s_add_u32 s28, s16, s53
    s_addc_u32 s29, s17, 0
    s_mov_b32 s30, 200704
    s_mov_b32 s31, 0x20000
    s_lshl2_add_u32 s53, s51, s26
    s_lshl_b32 s53, s53, 11
    v_lshlrev_b32 v191, 1, v2
    buffer_load_dword v191, v191, s[28:31], s53 offen
    s_waitcnt lgkmcnt(8)
    v_mfma_f32_16x16x32_bf16 v[132:135], v[16:19], a[4:7], 0
    ds_read_b64_tr_b16 a[24:25], v7 offset:4096
    v_mov_b32 v168, -1
    v_mfma_f32_16x16x32_bf16 v[140:143], v[72:75], a[4:7], 0
    ds_read_b64_tr_b16 a[26:27], v7 offset:4608
    v_mov_b32 v169, -1
    v_mfma_f32_16x16x32_bf16 v[128:131], v[16:19], a[0:3], 0
    ds_read_b64_tr_b16 a[28:29], v8 offset:4096
    v_mov_b32 v170, -1
    v_mfma_f32_16x16x32_bf16 v[136:139], v[72:75], a[0:3], 0
    ds_read_b64_tr_b16 a[30:31], v8 offset:4608
    v_mov_b32 v171, -1
    s_waitcnt lgkmcnt(8)
    v_mfma_f32_16x16x32_bf16 v[132:135], v[20:23], a[12:15], v[132:135]
    ds_read_b64_tr_b16 a[32:33], v5 offset:8192
    s_mov_b32 s28, s24
    s_mov_b32 s29, s25
    s_mov_b32 s30, 268435456
    s_mov_b32 s31, 0x20000
    v_mfma_f32_16x16x32_bf16 v[140:143], v[76:79], a[12:15], v[140:143]
    ds_read_b64_tr_b16 a[34:35], v5 offset:8704
    s_getreg_b32 s60, hwreg(HW_REG_XCC_ID, 0, 4)
    v_mfma_f32_16x16x32_bf16 v[128:131], v[20:23], a[8:11], v[128:131]
    ds_read_b64_tr_b16 a[36:37], v6 offset:8192
    s_lshl_b32 s96, s2, 7
    v_mfma_f32_16x16x32_bf16 v[136:139], v[76:79], a[8:11], v[136:139]
    ds_read_b64_tr_b16 a[38:39], v6 offset:8704
    s_lshl_b32 s58, s26, 5
    s_waitcnt lgkmcnt(8)
    v_mfma_f32_16x16x32_bf16 v[132:135], v[24:27], a[20:23], v[132:135]
    ds_read_b64_tr_b16 a[0:1], v7 offset:8192
    s_waitcnt vmcnt(5)
    s_mov_b64 exec, 1
    buffer_store_dwordx2 v[12:13], off, s[28:31], s97 offset:0 sc1
    s_mov_b64 exec, -1
    s_add_u32 s96, s96, s58
    v_mfma_f32_16x16x32_bf16 v[140:143], v[80:83], a[20:23], v[140:143]
    ds_read_b64_tr_b16 a[2:3], v7 offset:8704
    s_add_u32 s96, s96, 14389248
    v_mfma_f32_16x16x32_bf16 v[128:131], v[24:27], a[16:19], v[128:131]
    ds_read_b64_tr_b16 a[4:5], v8 offset:8192
    v_readfirstlane_b32 s12, v12
    v_mfma_f32_16x16x32_bf16 v[136:139], v[80:83], a[16:19], v[136:139]
    ds_read_b64_tr_b16 a[6:7], v8 offset:8704
    v_readfirstlane_b32 s13, v13
    s_waitcnt lgkmcnt(8)
    v_mfma_f32_16x16x32_bf16 v[132:135], v[28:31], a[28:31], v[132:135]
    ds_read_b64_tr_b16 a[8:9], v5 offset:12288
    s_lshr_b32 s79, s11, 1
    v_mfma_f32_16x16x32_bf16 v[140:143], v[84:87], a[28:31], v[140:143]
    ds_read_b64_tr_b16 a[10:11], v5 offset:12800
    s_mul_i32 s79, s79, 57344
    v_mfma_f32_16x16x32_bf16 v[128:131], v[28:31], a[24:27], v[128:131]
    ds_read_b64_tr_b16 a[12:13], v6 offset:12288
    s_add_u32 s79, s79, s92
    v_mfma_f32_16x16x32_bf16 v[136:139], v[84:87], a[24:27], v[136:139]
    ds_read_b64_tr_b16 a[14:15], v6 offset:12800
    s_and_b32 s92, s11, 1
    s_waitcnt lgkmcnt(8)
    v_mfma_f32_16x16x32_bf16 v[132:135], v[32:35], a[36:39], v[132:135]
    ds_read_b64_tr_b16 a[16:17], v7 offset:12288
    s_lshl_b32 s92, s92, 11
    v_mfma_f32_16x16x32_bf16 v[140:143], v[88:91], a[36:39], v[140:143]
    ds_read_b64_tr_b16 a[18:19], v7 offset:12800
    s_add_u32 s79, s79, s92
    v_mfma_f32_16x16x32_bf16 v[128:131], v[32:35], a[32:35], v[128:131]
    ds_read_b64_tr_b16 a[20:21], v8 offset:12288
    s_add_u32 s79, s79, 9535488
    v_mfma_f32_16x16x32_bf16 v[136:139], v[88:91], a[32:35], v[136:139]
    ds_read_b64_tr_b16 a[22:23], v8 offset:12800
    v_or_b32 v11, s88, v4
    s_waitcnt lgkmcnt(8)
    v_mfma_f32_16x16x32_bf16 v[132:135], v[36:39], a[4:7], v[132:135]
    ds_read_b64_tr_b16 a[24:25], v5 offset:16384
    v_cmp_eq_u32 s[76:77], 0, v11
    v_mfma_f32_16x16x32_bf16 v[140:143], v[92:95], a[4:7], v[140:143]
    ds_read_b64_tr_b16 a[26:27], v5 offset:16896
    v_lshl_add_u32 v0, v1, 4, v3
    v_mfma_f32_16x16x32_bf16 v[128:131], v[36:39], a[0:3], v[128:131]
    ds_read_b64_tr_b16 a[28:29], v6 offset:16384
    v_cvt_f32_u32 v0, v0
    v_mfma_f32_16x16x32_bf16 v[136:139], v[92:95], a[0:3], v[136:139]
    ds_read_b64_tr_b16 a[30:31], v6 offset:16896
    v_mul_f32 v0, 0x3c800000, v0
    s_waitcnt lgkmcnt(8)
    v_mfma_f32_16x16x32_bf16 v[132:135], v[40:43], a[12:15], v[132:135]
    ds_read_b64_tr_b16 a[32:33], v7 offset:16384
    v_mul_f32 v172, v0, v14
    v_mfma_f32_16x16x32_bf16 v[140:143], v[96:99], a[12:15], v[140:143]
    ds_read_b64_tr_b16 a[34:35], v7 offset:16896
    v_and_b32 v14, 1, v3
    v_mfma_f32_16x16x32_bf16 v[128:131], v[40:43], a[8:11], v[128:131]
    ds_read_b64_tr_b16 a[36:37], v8 offset:16384
    v_mul_u32_u24 v14, 0x8000, v14
    v_mfma_f32_16x16x32_bf16 v[136:139], v[96:99], a[8:11], v[136:139]
    ds_read_b64_tr_b16 a[38:39], v8 offset:16896
    v_lshl_or_b32 v14, v14, 16, v14
    s_waitcnt lgkmcnt(8)
    v_mfma_f32_16x16x32_bf16 v[132:135], v[44:47], a[20:23], v[132:135]
    ds_read_b64_tr_b16 a[0:1], v5 offset:20480
    v_mov_b32 v224, v172
    v_mfma_f32_16x16x32_bf16 v[140:143], v[100:103], a[20:23], v[140:143]
    ds_read_b64_tr_b16 a[2:3], v5 offset:20992
    v_fmamk_f32 v225, v0, 0x3f800000, v172
    v_mfma_f32_16x16x32_bf16 v[128:131], v[44:47], a[16:19], v[128:131]
    ds_read_b64_tr_b16 a[4:5], v6 offset:20480
    v_fmamk_f32 v226, v0, 0x40000000, v172
    v_mfma_f32_16x16x32_bf16 v[136:139], v[100:103], a[16:19], v[136:139]
    ds_read_b64_tr_b16 a[6:7], v6 offset:20992
    v_fmamk_f32 v227, v0, 0x40400000, v172
    s_waitcnt lgkmcnt(8)
    v_mfma_f32_16x16x32_bf16 v[132:135], v[48:51], a[28:31], v[132:135]
    ds_read_b64_tr_b16 a[8:9], v7 offset:20480
    v_fmamk_f32 v228, v0, 0x41800000, v172
    v_mfma_f32_16x16x32_bf16 v[140:143], v[104:107], a[28:31], v[140:143]
    ds_read_b64_tr_b16 a[10:11], v7 offset:20992
    v_fmamk_f32 v229, v0, 0x41880000, v172
    v_mfma_f32_16x16x32_bf16 v[128:131], v[48:51], a[24:27], v[128:131]
    ds_read_b64_tr_b16 a[12:13], v8 offset:20480
    v_fmamk_f32 v230, v0, 0x41900000, v172
    v_mfma_f32_16x16x32_bf16 v[136:139], v[104:107], a[24:27], v[136:139]
    ds_read_b64_tr_b16 a[14:15], v8 offset:20992
    v_fmamk_f32 v231, v0, 0x41980000, v172
    s_waitcnt lgkmcnt(8)
    v_mfma_f32_16x16x32_bf16 v[132:135], v[52:55], a[36:39], v[132:135]
    ds_read_b64_tr_b16 a[16:17], v5 offset:24576
    v_sin_f32 v232, v224
    v_mfma_f32_16x16x32_bf16 v[140:143], v[108:111], a[36:39], v[140:143]
    ds_read_b64_tr_b16 a[18:19], v5 offset:25088
    v_sin_f32 v233, v225
    v_mfma_f32_16x16x32_bf16 v[128:131], v[52:55], a[32:35], v[128:131]
    ds_read_b64_tr_b16 a[20:21], v6 offset:24576
    v_sin_f32 v234, v226
    v_mfma_f32_16x16x32_bf16 v[136:139], v[108:111], a[32:35], v[136:139]
    ds_read_b64_tr_b16 a[22:23], v6 offset:25088
    v_sin_f32 v235, v227
    s_waitcnt lgkmcnt(8)
    v_mfma_f32_16x16x32_bf16 v[132:135], v[56:59], a[4:7], v[132:135]
    ds_read_b64_tr_b16 a[24:25], v7 offset:24576
    v_sin_f32 v236, v228
    v_mfma_f32_16x16x32_bf16 v[140:143], v[112:115], a[4:7], v[140:143]
    ds_read_b64_tr_b16 a[26:27], v7 offset:25088
    v_sin_f32 v237, v229
    v_mfma_f32_16x16x32_bf16 v[128:131], v[56:59], a[0:3], v[128:131]
    ds_read_b64_tr_b16 a[28:29], v8 offset:24576
    v_sin_f32 v238, v230
    v_mfma_f32_16x16x32_bf16 v[136:139], v[112:115], a[0:3], v[136:139]
    ds_read_b64_tr_b16 a[30:31], v8 offset:25088
    v_sin_f32 v239, v231
    s_waitcnt lgkmcnt(8)
    v_mfma_f32_16x16x32_bf16 v[132:135], v[60:63], a[12:15], v[132:135]
    v_cos_f32 v224, v224
    v_cos_f32 v225, v225
    v_mfma_f32_16x16x32_bf16 v[140:143], v[116:119], a[12:15], v[140:143]
    v_cos_f32 v226, v226
    v_cos_f32 v227, v227
    v_mfma_f32_16x16x32_bf16 v[128:131], v[60:63], a[8:11], v[128:131]
    v_cos_f32 v228, v228
    v_cos_f32 v229, v229
    v_mfma_f32_16x16x32_bf16 v[136:139], v[116:119], a[8:11], v[136:139]
    v_cos_f32 v230, v230
    v_cos_f32 v231, v231
    s_waitcnt lgkmcnt(4)
    v_mfma_f32_16x16x32_bf16 v[132:135], v[64:67], a[20:23], v[132:135]
    v_cvt_pk_bf16_f32 v200, v232, v233
    v_cvt_pk_bf16_f32 v201, v234, v235
    v_mfma_f32_16x16x32_bf16 v[140:143], v[120:123], a[20:23], v[140:143]
    v_cvt_pk_bf16_f32 v202, v236, v237
    v_cvt_pk_bf16_f32 v203, v238, v239
    v_mfma_f32_16x16x32_bf16 v[128:131], v[64:67], a[16:19], v[128:131]
    v_cvt_pk_bf16_f32 v192, v224, v225
    v_cvt_pk_bf16_f32 v193, v226, v227
    v_mfma_f32_16x16x32_bf16 v[136:139], v[120:123], a[16:19], v[136:139]
    v_cvt_pk_bf16_f32 v194, v228, v229
    v_cvt_pk_bf16_f32 v195, v230, v231
    s_waitcnt lgkmcnt(0)
    v_mfma_f32_16x16x32_bf16 v[132:135], v[68:71], a[28:31], v[132:135]
    v_xor_b32 v204, v14, v200
    v_xor_b32 v205, v14, v201
    v_mfma_f32_16x16x32_bf16 v[140:143], v[124:127], a[28:31], v[140:143]
    v_xor_b32 v206, v14, v202
    v_xor_b32 v207, v14, v203
    v_mfma_f32_16x16x32_bf16 v[128:131], v[68:71], a[24:27], v[128:131]
    v_xor_b32 v196, v14, v192
    v_xor_b32 v197, v14, v193
    v_mfma_f32_16x16x32_bf16 v[136:139], v[124:127], a[24:27], v[136:139]
    v_xor_b32 v198, v14, v194
    v_xor_b32 v199, v14, v195
    s_lshr_b32 s78, s78, 4
    s_add_u32 s78, s78, 5505024
    s_mov_b64 exec, 0xffff
    buffer_store_dwordx4 v[168:171], v2, s[68:71], s78 offen sc1
    s_mov_b64 exec, -1
    v_mov_b32 v6, s12
    v_mov_b32 v7, s13
    v_mov_b32 v8, s60
    s_lshr_b32 s58, s2, 4
    s_lshl_b32 s58, s58, 3
    s_add_u32 s58, s58, s50
    s_sub_u32 s59, 224, s58
    v_cndmask_b32 v133, v133, 0, s[76:77]
    v_cvt_pk_bf16_f32 v165, v134, v135
    v_cvt_pk_bf16_f32 v166, v140, v141
    v_cvt_pk_bf16_f32 v167, v142, v143
    v_cvt_pk_bf16_f32 v164, v132, v133
    v_cndmask_b32 v129, v129, 0, s[76:77]
    v_cvt_pk_bf16_f32 v161, v130, v131
    v_cvt_pk_bf16_f32 v162, v136, v137
    v_cvt_pk_bf16_f32 v163, v138, v139
    v_cvt_pk_bf16_f32 v160, v128, v129
    s_cmp_eq_u32 s58, 0
    s_cselect_b32 s59, 112, s59
    s_cselect_b32 s58, 224, s58
    s_bitcmp1_b32 s2, 3
    s_cselect_b32 s58, s59, s58
    s_sub_u32 s58, s58, 1
    s_lshr_b32 s58, s58, 3
    s_lshl_b32 s58, s58, 10
    s_add_u32 s78, s58, 14356480
    v_and_b32 v254, 0x1f0, v2
    v_lshlrev_b32 v254, 1, v254
    s_mul_i32 s54, s26, 917504
    s_lshl_b32 s53, s2, 8
    s_add_u32 s54, s54, s53
    s_add_u32 s89, s54, 57344
    v_mul_u32_u24 v248, 114688, v4
    v_add_u32 v248, v250, v248
    v_add_u32 v249, 458752, v248
    s_lshl_b32 s95, s2, 13
    s_lshl_b32 s58, s26, 11
    s_add_u32 s95, s95, s58
    s_add_u32 s95, s95, 3670016
    v_mul_f32 v0, 0x3d000000, v0
    v_mul_f32 v172, 0x3d000000, v172
    buffer_store_dwordx4 v[164:167], v2, s[68:71], s79 offen offset:1024 sc1
    buffer_store_dwordx4 v[160:163], v2, s[68:71], s79 offen offset:0 sc1
    v_mov_b32 v224, v172
    v_fmamk_f32 v225, v0, 0x3f800000, v172
    v_fmamk_f32 v226, v0, 0x40000000, v172
    v_fmamk_f32 v227, v0, 0x40400000, v172
    v_fmamk_f32 v228, v0, 0x41800000, v172
    v_fmamk_f32 v229, v0, 0x41880000, v172
    v_fmamk_f32 v230, v0, 0x41900000, v172
    v_fmamk_f32 v231, v0, 0x41980000, v172
    v_sin_f32 v232, v224
    v_sin_f32 v233, v225
    v_sin_f32 v234, v226
    v_sin_f32 v235, v227
    v_sin_f32 v236, v228
    v_sin_f32 v237, v229
    v_sin_f32 v238, v230
    v_sin_f32 v239, v231
    v_cos_f32 v224, v224
    v_cos_f32 v225, v225
    v_cos_f32 v226, v226
    v_cos_f32 v227, v227
    v_cos_f32 v228, v228
    v_cos_f32 v229, v229
    v_cos_f32 v230, v230
    v_cos_f32 v231, v231
L_ut:
    s_sleep 1
    s_memrealtime s[62:63]
    s_waitcnt lgkmcnt(0)
    s_sub_u32 s62, s62, s90
    s_cmp_lt_u32 s62, 250
    s_cbranch_scc1 L_ut
    buffer_load_dwordx4 v[176:179], v248, s[28:31], s54 offen sc1
    buffer_load_dwordx4 v[180:183], v248, s[28:31], s89 offen sc1
    buffer_load_dwordx4 v[184:187], v249, s[28:31], s54 offen sc1
    s_waitcnt vmcnt(7)
    buffer_load_dwordx4 v[188:191], v249, s[28:31], s89 offen sc1
    s_waitcnt vmcnt(4)
    s_mov_b64 exec, 1
    buffer_store_dwordx3 v[6:8], off, s[28:31], s96 offset:0 sc1
    s_mov_b64 exec, -1
    s_cmp_eq_u32 s2, 0
    s_cselect_b32 s57, 0, 0xffff0000
    s_cselect_b32 s58, 0, 0x3a000000
    s_mov_b32 s59, 0x3a000000
    s_mov_b32 s60, 0x80008000
    v_lshrrev_b32 v12, 1, v1
    v_lshl_add_u32 v12, v12, 10, v2
    v_and_b32 v13, 1, v1
    v_lshl_add_u32 v12, v13, 3, v12
    v_add_u32 v12, 57344, v12
    v_lshlrev_b32 v13, 9, v1
    v_lshl_add_u32 v13, v3, 5, v13
    v_lshl_add_u32 v13, v4, 3, v13
    v_add_u32 v13, 57344, v13
    v_add_u32 v10, 57344, v2
    v_lshrrev_b32 v11, 1, v2
    v_add_u32 v11, 57344, v11
    v_xor_b32 v48, s60, v200
    v_xor_b32 v49, s60, v201
    v_xor_b32 v50, s60, v202
    v_xor_b32 v51, s60, v203
    v_xor_b32 v52, s60, v204
    v_xor_b32 v53, s60, v205
    v_xor_b32 v54, s60, v206
    v_xor_b32 v55, s60, v207
    v_xor_b32 v56, s60, v216
    v_xor_b32 v57, s60, v217
    v_xor_b32 v58, s60, v218
    v_xor_b32 v59, s60, v219
    v_xor_b32 v60, s60, v220
    v_xor_b32 v61, s60, v221
    v_xor_b32 v62, s60, v222
    v_xor_b32 v63, s60, v223
    s_waitcnt vmcnt(4)
    v_cmp_ne_u32 vcc, s12, v179
    v_lshlrev_b32 v24, 16, v178
    v_and_b32 v25, 0xffff0000, v178
    v_lshlrev_b32 v72, 16, v176
    v_lshlrev_b32 v73, 16, v177
    v_and_b32 v88, s57, v176
    v_and_b32 v89, s57, v177
    s_waitcnt vmcnt(3)
    v_cmp_ne_u32 s[98:99], s12, v183
    v_lshlrev_b32 v26, 16, v182
    v_and_b32 v27, 0xffff0000, v182
    v_lshlrev_b32 v74, 16, v180
    v_lshlrev_b32 v75, 16, v181
    v_and_b32 v90, s57, v180
    v_and_b32 v91, s57, v181
    s_or_b64 vcc, vcc, s[98:99]
    s_waitcnt vmcnt(2)
    v_cmp_ne_u32 s[98:99], s12, v187
    v_lshlrev_b32 v28, 16, v186
    v_and_b32 v29, 0xffff0000, v186
    v_lshlrev_b32 v76, 16, v184
    v_lshlrev_b32 v77, 16, v185
    v_and_b32 v92, s57, v184
    v_and_b32 v93, s57, v185
    s_or_b64 vcc, vcc, s[98:99]
    s_waitcnt vmcnt(1)
    v_cmp_ne_u32 s[98:99], s12, v191
    v_lshlrev_b32 v30, 16, v190
    v_and_b32 v31, 0xffff0000, v190
    s_or_b64 vcc, vcc, s[98:99]
    s_cbranch_scc1 L_slow_c1x
L_back_c1x:
    buffer_load_dwordx2 v[252:253], v254, s[28:31], s78 offen sc1
    v_lshlrev_b32 v78, 16, v188
    v_lshlrev_b32 v79, 16, v189
    v_and_b32 v94, s57, v188
    v_and_b32 v95, s57, v189
    v_pk_mul_f32 v[96:97], v[72:73], v[24:25]
    v_pk_mul_f32 v[98:99], v[74:75], v[26:27]
    v_pk_mul_f32 v[100:101], v[76:77], v[28:29]
    v_pk_mul_f32 v[102:103], v[78:79], v[30:31]
    v_pk_mul_f32 v[88:89], v[88:89], v[24:25]
    v_pk_mul_f32 v[90:91], v[90:91], v[26:27]
    v_pk_mul_f32 v[92:93], v[92:93], v[28:29]
    v_pk_mul_f32 v[94:95], v[94:95], v[30:31]
    v_cvt_pk_bf16_f32 v64, v96, v97
    v_cvt_pk_bf16_f32 v65, v98, v99
    v_cvt_pk_bf16_f32 v66, v100, v101
    v_cvt_pk_bf16_f32 v67, v102, v103
    v_cvt_pk_bf16_f32 v68, v88, v89
    v_cvt_pk_bf16_f32 v69, v90, v91
    v_cvt_pk_bf16_f32 v70, v92, v93
    v_cvt_pk_bf16_f32 v71, v94, v95
    ds_write_b64 v12, v[64:65] offset:0
    ds_write_b64 v12, v[66:67] offset:2048
    ds_write_b64 v12, v[68:69] offset:4096
    ds_write_b64 v12, v[70:71] offset:6144
    v_and_b32 v80, 0xffff0000, v176
    v_and_b32 v81, 0xffff0000, v177
    v_and_b32 v82, 0xffff0000, v180
    v_and_b32 v83, 0xffff0000, v181
    v_and_b32 v84, 0xffff0000, v184
    v_and_b32 v85, 0xffff0000, v185
    v_and_b32 v86, 0xffff0000, v188
    v_and_b32 v87, 0xffff0000, v189
    s_waitcnt lgkmcnt(0)
    s_barrier
    ds_read_b128 v[104:107], v10 offset:0
    ds_read_b128 v[108:111], v10 offset:1024
    ds_read_b128 v[112:115], v10 offset:2048
    ds_read_b128 v[116:119], v10 offset:3072
    ds_read_b128 v[120:123], v10 offset:4096
    ds_read_b128 v[124:127], v10 offset:5120
    ds_read_b128 v[128:131], v10 offset:6144
    ds_read_b128 v[132:135], v10 offset:7168
    s_waitcnt lgkmcnt(7)
    v_mfma_f32_16x16x32_bf16 v[136:139], v[104:107], v[192:195], 0
    s_waitcnt vmcnt(0)
    v_cmp_ne_u64 vcc, s[12:13], v[252:253]
    s_cbranch_vccnz L_slow_arr
L_back_arr:
    buffer_load_dwordx4 v[240:243], v2, s[28:31], s95 offen offset:0 sc1 nt
    buffer_load_dwordx4 v[244:247], v2, s[28:31], s95 offen offset:1024 sc1 nt
    s_lshr_b32 s4, s51, 2
    s_lshl_b32 s4, s4, 4
    v_mfma_f32_16x16x32_bf16 v[144:147], v[104:107], v[48:51], 0
    s_and_b32 s5, s51, 3
    s_add_u32 s4, s4, s5
    s_waitcnt lgkmcnt(5)
    v_mfma_f32_16x16x32_bf16 v[140:143], v[112:115], v[192:195], 0
    s_lshl_b32 s4, s4, 8
    s_and_b32 s5, s51, 24
    s_lshl_b32 s5, s5, 3
    v_mfma_f32_16x16x32_bf16 v[148:151], v[112:115], v[48:51], 0
    s_and_b32 s6, s51, 7
    s_add_u32 s5, s5, s6
    v_mfma_f32_16x16x32_bf16 v[136:139], v[108:111], v[196:199], v[136:139]
    s_lshl_b32 s5, s5, 7
    s_cmp_ge_u32 s51, 24
    s_cselect_b32 s4, s4, s5
    s_cselect_b32 s6, 0, 3968
    s_lshl_b32 s5, s50, 4
    v_mfma_f32_16x16x32_bf16 v[144:147], v[108:111], v[52:55], v[144:147]
    s_add_u32 s5, s5, s26
    s_lshl_b32 s5, s5, 8
    s_waitcnt lgkmcnt(4)
    v_mfma_f32_16x16x32_bf16 v[140:143], v[116:119], v[196:199], v[140:143]
    s_sub_u32 s5, s5, s4
    s_add_u32 s4, s4, 14389248
    v_and_b32 v175, 12, v3
    v_mfma_f32_16x16x32_bf16 v[148:151], v[116:119], v[52:55], v[148:151]
    v_lshlrev_b32 v175, 8, v175
    v_and_b32 v9, 3, v3
    s_waitcnt lgkmcnt(3)
    v_mfma_f32_16x16x32_bf16 v[136:139], v[120:123], v[200:203], v[136:139]
    v_lshl_add_u32 v175, v9, 5, v175
    v_and_b32 v9, 1, v4
    v_lshl_add_u32 v175, v9, 7, v175
    v_mfma_f32_16x16x32_bf16 v[144:147], v[120:123], v[192:195], v[144:147]
    v_lshrrev_b32 v9, 1, v4
    v_mul_lo_u32 v9, v9, s5
    s_waitcnt lgkmcnt(1)
    v_mfma_f32_16x16x32_bf16 v[140:143], v[128:131], v[200:203], v[140:143]
    v_add3_u32 v175, v175, v9, s4
    v_add_u32 v9, s6, v175
    v_cmp_eq_u32 vcc, 1, v4
    s_nop 1
    v_cndmask_b32 v175, v175, v9, vcc
    v_mfma_f32_16x16x32_bf16 v[148:151], v[128:131], v[192:195], v[148:151]
    s_add_u32 s40, s24, 9535488
    s_addc_u32 s41, s25, 0
    s_mov_b32 s42, 1605632
    s_mov_b32 s43, 0x20000
    s_lshl_b32 s94, s50, 2
    v_mfma_f32_16x16x32_bf16 v[136:139], v[124:127], v[204:207], v[136:139]
    s_add_u32 s94, s94, s26
    s_mul_i32 s94, s94, 114688
    s_lshr_b32 s64, s51, 1
    s_lshl1_add_u32 s64, s50, s64
    s_sub_u32 s92, s64, 14
    s_cselect_b32 s64, s64, s92
    v_mfma_f32_16x16x32_bf16 v[144:147], v[124:127], v[196:199], v[144:147]
    s_lshl_b32 s64, s64, 12
    s_add_u32 s64, s64, s94
    s_waitcnt lgkmcnt(0)
    v_mfma_f32_16x16x32_bf16 v[140:143], v[132:135], v[204:207], v[140:143]
    s_add_u32 s92, s94, 57344
    s_mul_i32 s78, s51, 57344
    s_add_u32 s78, s78, s9
    v_mfma_f32_16x16x32_bf16 v[148:151], v[132:135], v[196:199], v[148:151]
    s_sub_u32 s78, s78, s94
    s_mov_b32 s79, s9
    v_pk_mul_f32 v[88:89], v[136:137], v[224:225]
    v_pk_mul_f32 v[90:91], v[138:139], v[226:227]
    v_pk_mul_f32 v[92:93], v[140:141], v[228:229]
    v_pk_mul_f32 v[94:95], v[142:143], v[230:231]
    v_pk_mul_f32 v[96:97], v[144:145], v[224:225]
    v_pk_mul_f32 v[98:99], v[146:147], v[226:227]
    v_pk_mul_f32 v[100:101], v[148:149], v[228:229]
    v_pk_mul_f32 v[102:103], v[150:151], v[230:231]
    v_pk_fma_f32 v[88:89], v[144:145], v[232:233], v[88:89]
    v_pk_fma_f32 v[90:91], v[146:147], v[234:235], v[90:91]
    v_pk_fma_f32 v[92:93], v[148:149], v[236:237], v[92:93]
    v_pk_fma_f32 v[94:95], v[150:151], v[238:239], v[94:95]
    v_pk_fma_f32 v[96:97], v[136:137], v[232:233], v[96:97] neg_lo:[1,0,0] neg_hi:[1,0,0]
    v_pk_fma_f32 v[98:99], v[138:139], v[234:235], v[98:99] neg_lo:[1,0,0] neg_hi:[1,0,0]
    v_pk_fma_f32 v[100:101], v[140:141], v[236:237], v[100:101] neg_lo:[1,0,0] neg_hi:[1,0,0]
    v_pk_fma_f32 v[102:103], v[142:143], v[238:239], v[102:103] neg_lo:[1,0,0] neg_hi:[1,0,0]
    v_cvt_pk_bf16_f32 v64, v88, v89
    v_cvt_pk_bf16_f32 v65, v90, v91
    v_cvt_pk_bf16_f32 v66, v92, v93
    v_cvt_pk_bf16_f32 v67, v94, v95
    v_cvt_pk_bf16_f32 v68, v96, v97
    v_cvt_pk_bf16_f32 v69, v98, v99
    v_cvt_pk_bf16_f32 v70, v100, v101
    v_cvt_pk_bf16_f32 v71, v102, v103
    v_mfma_f32_16x16x32_bf16 v[32:35], v[208:211], v[64:67], 0
    v_lshlrev_b32 v174, 3, v4
    s_waitcnt vmcnt(1)
    v_lshlrev_b32 v152, 16, v240
    v_lshlrev_b32 v153, 16, v241
    v_mfma_f32_16x16x32_bf16 v[40:43], v[56:59], v[64:67], 0
    v_lshlrev_b32 v154, 16, v242
    v_lshlrev_b32 v155, 16, v243
    v_mfma_f32_16x16x32_bf16 v[36:39], v[212:215], v[64:67], 0
    s_waitcnt vmcnt(0)
    v_lshlrev_b32 v156, 16, v244
    v_lshlrev_b32 v157, 16, v245
    s_lshl_b32 s7, s51, 7
    v_mfma_f32_16x16x32_bf16 v[44:47], v[60:63], v[64:67], 0
    v_lshlrev_b32 v158, 16, v246
    v_lshlrev_b32 v159, 16, v247
    v_mfma_f32_16x16x32_bf16 v[32:35], v[216:219], v[68:71], v[32:35]
    v_and_b32 v240, 0xffff0000, v240
    v_and_b32 v241, 0xffff0000, v241
    v_mfma_f32_16x16x32_bf16 v[40:43], v[208:211], v[68:71], v[40:43]
    v_and_b32 v242, 0xffff0000, v242
    s_mov_b32 s36, s14
    s_mov_b32 s37, s15
    s_mov_b32 s38, 3584
    s_mov_b32 s39, 0x20000
    v_and_b32 v243, 0xffff0000, v243
    v_mfma_f32_16x16x32_bf16 v[36:39], v[220:223], v[68:71], v[36:39]
    v_and_b32 v244, 0xffff0000, v244
    v_and_b32 v245, 0xffff0000, v245
    v_mfma_f32_16x16x32_bf16 v[44:47], v[212:215], v[68:71], v[44:47]
    v_and_b32 v246, 0xffff0000, v246
    v_and_b32 v247, 0xffff0000, v247
    v_pk_mul_f32 v[88:89], v[32:33], v[152:153]
    v_pk_mul_f32 v[90:91], v[34:35], v[154:155]
    s_nop 0
    v_pk_mul_f32 v[92:93], v[36:37], v[156:157]
    v_pk_mul_f32 v[94:95], v[38:39], v[158:159]
    v_pk_mul_f32 v[96:97], v[40:41], v[152:153]
    v_pk_mul_f32 v[98:99], v[42:43], v[154:155]
    v_pk_mul_f32 v[100:101], v[44:45], v[156:157]
    v_pk_mul_f32 v[102:103], v[46:47], v[158:159]
    v_pk_fma_f32 v[88:89], v[40:41], v[240:241], v[88:89] neg_lo:[1,0,0] neg_hi:[1,0,0]
    v_pk_fma_f32 v[90:91], v[42:43], v[242:243], v[90:91] neg_lo:[1,0,0] neg_hi:[1,0,0]
    v_pk_fma_f32 v[92:93], v[44:45], v[244:245], v[92:93] neg_lo:[1,0,0] neg_hi:[1,0,0]
    v_pk_fma_f32 v[94:95], v[46:47], v[246:247], v[94:95] neg_lo:[1,0,0] neg_hi:[1,0,0]
    v_pk_fma_f32 v[96:97], v[32:33], v[240:241], v[96:97]
    v_pk_fma_f32 v[98:99], v[34:35], v[242:243], v[98:99]
    v_pk_fma_f32 v[100:101], v[36:37], v[244:245], v[100:101]
    v_pk_fma_f32 v[102:103], v[38:39], v[246:247], v[102:103]
    v_cvt_pk_bf16_f32 v64, v88, v89
    v_cvt_pk_bf16_f32 v65, v90, v91
    v_cvt_pk_bf16_f32 v66, v92, v93
    v_cvt_pk_bf16_f32 v67, v94, v95
    v_cvt_pk_bf16_f32 v68, v96, v97
    v_cvt_pk_bf16_f32 v69, v98, v99
    v_cvt_pk_bf16_f32 v70, v100, v101
    v_cvt_pk_bf16_f32 v71, v102, v103
    v_mfma_f32_16x16x32_bf16 v[136:139], v[208:211], v[64:67], 0
    s_add_u32 s65, s64, 4096
    s_cmp_eq_u32 s65, s92
    s_cselect_b32 s65, s94, s65
    v_mfma_f32_16x16x32_bf16 v[144:147], v[216:219], v[64:67], 0
    s_add_u32 s66, s65, 4096
    s_cmp_eq_u32 s66, s92
    s_cselect_b32 s66, s94, s66
    v_mfma_f32_16x16x32_bf16 v[140:143], v[212:215], v[64:67], 0
    s_add_u32 s67, s66, 4096
    s_cmp_eq_u32 s67, s92
    s_cselect_b32 s67, s94, s67
    v_mfma_f32_16x16x32_bf16 v[148:151], v[220:223], v[64:67], 0
    s_add_u32 s68, s67, 4096
    v_mfma_f32_16x16x32_bf16 v[136:139], v[56:59], v[68:71], v[136:139]
    s_cmp_eq_u32 s68, s92
    s_cselect_b32 s68, s94, s68
    s_add_u32 s69, s68, 4096
    v_mfma_f32_16x16x32_bf16 v[144:147], v[208:211], v[68:71], v[144:147]
    s_cmp_eq_u32 s69, s92
    s_cselect_b32 s69, s94, s69
    buffer_load_dwordx2 v[160:161], v174, s[36:39], s7 offen offset:0
    v_mfma_f32_16x16x32_bf16 v[140:143], v[60:63], v[68:71], v[140:143]
    buffer_load_dwordx2 v[162:163], v174, s[36:39], s7 offen offset:32
    buffer_load_dwordx2 v[164:165], v174, s[36:39], s7 offen offset:64
    v_mfma_f32_16x16x32_bf16 v[148:151], v[212:215], v[68:71], v[148:151]
    buffer_load_dwordx2 v[166:167], v174, s[36:39], s7 offen offset:96
    v_pk_mul_f32 v[88:89], v[136:137], v[224:225]
    v_pk_mul_f32 v[90:91], v[138:139], v[226:227]
    s_nop 1
    v_pk_mul_f32 v[92:93], v[140:141], v[228:229]
    v_pk_mul_f32 v[94:95], v[142:143], v[230:231]
    v_pk_mul_f32 v[96:97], v[144:145], v[224:225]
    v_pk_mul_f32 v[98:99], v[146:147], v[226:227]
    v_pk_mul_f32 v[100:101], v[148:149], v[228:229]
    v_pk_mul_f32 v[102:103], v[150:151], v[230:231]
    v_pk_fma_f32 v[88:89], v[144:145], v[232:233], v[88:89] neg_lo:[1,0,0] neg_hi:[1,0,0]
    v_pk_fma_f32 v[90:91], v[146:147], v[234:235], v[90:91] neg_lo:[1,0,0] neg_hi:[1,0,0]
    v_pk_fma_f32 v[92:93], v[148:149], v[236:237], v[92:93] neg_lo:[1,0,0] neg_hi:[1,0,0]
    v_pk_fma_f32 v[94:95], v[150:151], v[238:239], v[94:95] neg_lo:[1,0,0] neg_hi:[1,0,0]
    v_pk_fma_f32 v[96:97], v[136:137], v[232:233], v[96:97]
    v_pk_fma_f32 v[98:99], v[138:139], v[234:235], v[98:99]
    v_pk_fma_f32 v[100:101], v[140:141], v[236:237], v[100:101]
    v_pk_fma_f32 v[102:103], v[142:143], v[238:239], v[102:103]
    v_cvt_pk_bf16_f32 v64, v88, v89
    v_cvt_pk_bf16_f32 v65, v90, v91
    v_cvt_pk_bf16_f32 v66, v92, v93
    v_cvt_pk_bf16_f32 v67, v94, v95
    v_cvt_pk_bf16_f32 v68, v96, v97
    v_cvt_pk_bf16_f32 v69, v98, v99
    v_cvt_pk_bf16_f32 v70, v100, v101
    v_cvt_pk_bf16_f32 v71, v102, v103
    ds_write_b64 v13, v[64:65] offset:8192
    ds_write_b64 v13, v[66:67] offset:10240
    ds_write_b64 v13, v[68:69] offset:12288
    ds_write_b64 v13, v[70:71] offset:14336
    s_waitcnt lgkmcnt(0)
    s_barrier
    ds_read_b64_tr_b16 v[104:105], v11 offset:8192
    ds_read_b64_tr_b16 v[106:107], v11 offset:8704
    ds_read_b64_tr_b16 v[108:109], v11 offset:9216
    ds_read_b64_tr_b16 v[110:111], v11 offset:9728
    ds_read_b64_tr_b16 v[112:113], v11 offset:10240
    ds_read_b64_tr_b16 v[114:115], v11 offset:10752
    ds_read_b64_tr_b16 v[116:117], v11 offset:11264
    ds_read_b64_tr_b16 v[118:119], v11 offset:11776
    ds_read_b64_tr_b16 v[120:121], v11 offset:12288
    ds_read_b64_tr_b16 v[122:123], v11 offset:12800
    ds_read_b64_tr_b16 v[124:125], v11 offset:13312
    ds_read_b64_tr_b16 v[126:127], v11 offset:13824
    ds_read_b64_tr_b16 v[128:129], v11 offset:14336
    ds_read_b64_tr_b16 v[130:131], v11 offset:14848
    ds_read_b64_tr_b16 v[132:133], v11 offset:15360
    ds_read_b64_tr_b16 v[134:135], v11 offset:15872
    s_add_u32 s70, s69, 4096
    s_cmp_eq_u32 s70, s92
    s_cselect_b32 s70, s94, s70
    s_waitcnt lgkmcnt(14)
    v_mfma_f32_16x16x32_bf16 v[32:35], v[192:195], v[104:107], 0
    s_add_u32 s71, s70, 4096
    v_mfma_f32_16x16x32_bf16 v[40:43], v[200:203], v[104:107], 0
    s_cmp_eq_u32 s71, s92
    s_cselect_b32 s71, s94, s71
    s_waitcnt lgkmcnt(10)
    v_mfma_f32_16x16x32_bf16 v[36:39], v[192:195], v[112:115], 0
    s_add_u32 s72, s71, 4096
    v_mfma_f32_16x16x32_bf16 v[44:47], v[200:203], v[112:115], 0
    s_cmp_eq_u32 s72, s92
    s_cselect_b32 s72, s94, s72
    v_mfma_f32_16x16x32_bf16 v[32:35], v[196:199], v[108:111], v[32:35]
    s_add_u32 s73, s72, 4096
    v_mfma_f32_16x16x32_bf16 v[40:43], v[204:207], v[108:111], v[40:43]
    s_cmp_eq_u32 s73, s92
    s_cselect_b32 s73, s94, s73
    s_waitcnt lgkmcnt(8)
    v_mfma_f32_16x16x32_bf16 v[36:39], v[196:199], v[116:119], v[36:39]
    s_add_u32 s74, s73, 4096
    v_mfma_f32_16x16x32_bf16 v[44:47], v[204:207], v[116:119], v[44:47]
    s_cmp_eq_u32 s74, s92
    s_cselect_b32 s74, s94, s74
    s_waitcnt lgkmcnt(6)
    v_mfma_f32_16x16x32_bf16 v[32:35], v[48:51], v[120:123], v[32:35]
    s_add_u32 s75, s74, 4096
    v_mfma_f32_16x16x32_bf16 v[40:43], v[192:195], v[120:123], v[40:43]
    s_cmp_eq_u32 s75, s92
    s_cselect_b32 s75, s94, s75
    s_waitcnt lgkmcnt(4)
    v_mfma_f32_16x16x32_bf16 v[32:35], v[52:55], v[124:127], v[32:35]
    s_add_u32 s76, s75, 4096
    v_mfma_f32_16x16x32_bf16 v[40:43], v[196:199], v[124:127], v[40:43]
    s_cmp_eq_u32 s76, s92
    s_cselect_b32 s76, s94, s76
    s_waitcnt lgkmcnt(2)
    v_mfma_f32_16x16x32_bf16 v[36:39], v[48:51], v[128:131], v[36:39]
    s_add_u32 s77, s76, 4096
    v_mfma_f32_16x16x32_bf16 v[44:47], v[192:195], v[128:131], v[44:47]
    s_cmp_eq_u32 s77, s92
    s_cselect_b32 s77, s94, s77
    s_waitcnt lgkmcnt(0)
    v_mfma_f32_16x16x32_bf16 v[36:39], v[52:55], v[132:135], v[36:39]
    s_mov_b32 s32, s24
    s_mov_b32 s33, s25
    s_mov_b32 s34, 3670016
    s_mov_b32 s35, 0x20000
    v_mfma_f32_16x16x32_bf16 v[44:47], v[196:199], v[132:135], v[44:47]
    s_add_u32 s55, s54, 0
    buffer_load_dwordx2 v[252:253], v175, s[28:31], 0 offen sc1
    v_fma_f32 v72, v32, s59, v72
    v_fma_f32 v80, v40, s58, v80
    v_fma_f32 v73, v33, s59, v73
    v_fma_f32 v81, v41, s58, v81
    v_fma_f32 v74, v34, s59, v74
    v_fma_f32 v82, v42, s58, v82
    v_fma_f32 v75, v35, s59, v75
    v_fma_f32 v83, v43, s58, v83
    v_cvt_pk_bf16_f32 v67, v75, v83
    v_cvt_pk_bf16_f32 v66, v74, v82
    v_cvt_pk_bf16_f32 v65, v73, v81
    v_cvt_pk_bf16_f32 v64, v72, v80
    v_and_b32 v67, -2, v67
    buffer_store_dwordx4 v[64:67], v248, s[28:31], s55 offen sc1
    v_fma_f32 v76, v36, s59, v76
    v_fma_f32 v84, v44, s58, v84
    v_fma_f32 v77, v37, s59, v77
    v_fma_f32 v85, v45, s58, v85
    v_fma_f32 v78, v38, s59, v78
    v_fma_f32 v86, v46, s58, v86
    v_fma_f32 v79, v39, s59, v79
    v_fma_f32 v87, v47, s58, v87
    v_cvt_pk_bf16_f32 v71, v79, v87
    v_cvt_pk_bf16_f32 v70, v78, v86
    v_cvt_pk_bf16_f32 v69, v77, v85
    v_cvt_pk_bf16_f32 v68, v76, v84
    v_and_b32 v71, -2, v71
    buffer_store_dwordx4 v[68:71], v249, s[28:31], s55 offen sc1
    s_add_u32 s53, s61, 15114240
    buffer_store_dwordx4 v[168:171], v2, s[28:31], s53 offen offset:0
    s_lshl_b32 s58, s3, 11
    s_mul_i32 s11, s48, 114688
    s_add_u32 s11, s11, s58
    s_lshl_b32 s97, s48, 5
    s_add_u32 s97, s97, 14389248
    v_xor_b32 v5, 0, v1
    v_lshl_add_u32 v5, v5, 10, v2
    v_xor_b32 v6, 1, v1
    v_lshl_add_u32 v6, v6, 10, v2
    s_add_u32 s53, s61, 15114240
    buffer_store_dwordx4 v[168:171], v2, s[28:31], s53 offen offset:1024
    v_xor_b32 v7, 2, v1
    v_lshl_add_u32 v7, v7, 10, v2
    v_xor_b32 v8, 3, v1
    v_lshl_add_u32 v8, v8, 10, v2
    s_mov_b32 s4, 0xaaaaaaaa
    s_mov_b32 s5, s4
    s_lshr_b32 s8, s64, 4
    s_add_u32 s8, s8, 5505024
    s_lshr_b32 s9, s94, 4
    s_add_u32 s53, s61, 15114240
    buffer_store_dwordx4 v[168:171], v2, s[28:31], s53 offen offset:2048
    s_add_u32 s9, s9, 5505024
    s_sub_u32 s53, s64, s94
    v_or_b32 v15, s53, v4
    v_cmp_eq_u32 vcc, 0, v15
    v_mov_b32 v14, 0xffff
    s_nop 0
    v_cndmask_b32 v15, -1, v14, vcc
    s_mul_i32 s53, s49, 229376
    s_add_u32 s53, s53, 11141120
    s_add_u32 s44, s24, s53
    s_addc_u32 s45, s25, 0
    s_mov_b32 s46, 229376
    s_mov_b32 s47, 0x20000
    s_lshl_b32 s58, s49, 9
    s_lshl_b32 s59, s26, 6
    s_add_u32 s58, s58, s59
    s_add_u32 s58, s58, 14422016
    v_and_b32 v0, 1, v3
    s_add_u32 s53, s61, 15114240
    buffer_store_dwordx4 v[168:171], v2, s[28:31], s53 offen offset:3072
    v_lshlrev_b32 v0, 4, v0
    v_and_or_b32 v0, v3, 2, v0
    v_lshlrev_b32 v0, 4, v0
    s_mul_i32 s60, s26, 57344
    s_mul_i32 s62, s50, 1
    s_add_u32 s62, s62, s49
    s_sub_u32 s63, s62, 7
    s_cmp_ge_u32 s62, 7
    s_cselect_b32 s62, s63, s62
    s_add_u32 s53, s61, 15118336
    buffer_store_dwordx4 v[168:171], v2, s[28:31], s53 offen offset:0
    s_lshl_b32 s80, s62, 13
    s_add_u32 s80, s80, s60
    s_add_u32 s87, s80, 4096
    s_add_u32 s62, s62, 1
    s_cmp_eq_u32 s62, 7
    s_cselect_b32 s62, 0, s62
    s_lshl_b32 s81, s62, 13
    s_add_u32 s81, s81, s60
    s_add_u32 s88, s81, 4096
    s_add_u32 s62, s62, 1
    s_add_u32 s53, s61, 15118336
    buffer_store_dwordx4 v[168:171], v2, s[28:31], s53 offen offset:1024
    s_cmp_eq_u32 s62, 7
    s_cselect_b32 s62, 0, s62
    s_lshl_b32 s82, s62, 13
    s_add_u32 s82, s82, s60
    s_add_u32 s89, s82, 4096
    s_add_u32 s62, s62, 1
    s_cmp_eq_u32 s62, 7
    s_cselect_b32 s62, 0, s62
    s_lshl_b32 s83, s62, 13
    s_add_u32 s83, s83, s60
    s_add_u32 s90, s83, 4096
    s_add_u32 s53, s61, 15118336
    buffer_store_dwordx4 v[168:171], v2, s[28:31], s53 offen offset:2048
    s_add_u32 s62, s62, 1
    s_cmp_eq_u32 s62, 7
    s_cselect_b32 s62, 0, s62
    s_lshl_b32 s84, s62, 13
    s_add_u32 s84, s84, s60
    s_add_u32 s91, s84, 4096
    s_add_u32 s62, s62, 1
    s_cmp_eq_u32 s62, 7
    s_cselect_b32 s62, 0, s62
    s_lshl_b32 s85, s62, 13
    s_add_u32 s85, s85, s60
    s_add_u32 s53, s61, 15118336
    buffer_store_dwordx4 v[168:171], v2, s[28:31], s53 offen offset:3072
    s_add_u32 s92, s85, 4096
    s_add_u32 s62, s62, 1
    s_cmp_eq_u32 s62, 7
    s_cselect_b32 s62, 0, s62
    s_lshl_b32 s86, s62, 13
    s_add_u32 s86, s86, s60
    s_add_u32 s93, s86, 4096
    s_add_u32 s62, s62, 1
    s_cmp_eq_u32 s62, 7
    s_cselect_b32 s62, 0, s62
    s_waitcnt vmcnt(10)
    v_cmp_ne_u64 vcc, s[12:13], v[252:253]
    s_cbranch_vccnz L_slow_f1
L_back_f1:
    s_add_u32 m0, s79, 0
    s_add_u32 s53, s78, s64
    buffer_load_dwordx4 v2, s[40:43], s53 offen sc1 lds
    s_add_u32 m0, s79, 4096
    s_add_u32 s53, s78, s65
    buffer_load_dwordx4 v2, s[40:43], s53 offen sc1 lds
    s_add_u32 m0, s79, 8192
    s_add_u32 s53, s78, s66
    buffer_load_dwordx4 v2, s[40:43], s53 offen sc1 lds
    s_add_u32 m0, s79, 12288
    s_add_u32 s53, s78, s67
    buffer_load_dwordx4 v2, s[40:43], s53 offen sc1 lds
    s_add_u32 m0, s79, 16384
    s_add_u32 s53, s78, s68
    buffer_load_dwordx4 v2, s[40:43], s53 offen sc1 lds
    s_add_u32 m0, s79, 20480
    s_add_u32 s53, s78, s69
    buffer_load_dwordx4 v2, s[40:43], s53 offen sc1 lds
    s_add_u32 m0, s79, 24576
    s_add_u32 s53, s78, s70
    buffer_load_dwordx4 v2, s[40:43], s53 offen sc1 lds
    s_add_u32 m0, s79, 28672
    s_add_u32 s53, s78, s71
    buffer_load_dwordx4 v2, s[40:43], s53 offen sc1 lds
    buffer_load_dwordx4 v[80:83], v251, s[32:35], s64 offen offset:0 sc1
    buffer_load_dwordx4 v[84:87], v251, s[32:35], s64 offen offset:256 sc1
    buffer_load_dwordx4 v[88:91], v251, s[32:35], s64 offen offset:2048 sc1
    buffer_load_dwordx4 v[92:95], v251, s[32:35], s64 offen offset:2304 sc1
    buffer_load_dwordx4 v[96:99], v251, s[32:35], s65 offen offset:0 sc1
    buffer_load_dwordx4 v[100:103], v251, s[32:35], s65 offen offset:256 sc1
    buffer_load_dwordx4 v[104:107], v251, s[32:35], s65 offen offset:2048 sc1
    buffer_load_dwordx4 v[108:111], v251, s[32:35], s65 offen offset:2304 sc1
    buffer_load_dwordx4 v[112:115], v251, s[32:35], s66 offen offset:0 sc1
    buffer_load_dwordx4 v[116:119], v251, s[32:35], s66 offen offset:256 sc1
    buffer_load_dwordx4 v[120:123], v251, s[32:35], s66 offen offset:2048 sc1
    buffer_load_dwordx4 v[124:127], v251, s[32:35], s66 offen offset:2304 sc1
    s_add_u32 m0, s79, 32768
    s_add_u32 s53, s78, s72
    buffer_load_dwordx4 v2, s[40:43], s53 offen sc1 lds
    s_add_u32 m0, s79, 36864
    s_add_u32 s53, s78, s73
    buffer_load_dwordx4 v2, s[40:43], s53 offen sc1 lds
    v_lshlrev_b32 v16, 16, v160
    v_and_b32 v17, 0xffff0000, v160
    v_lshlrev_b32 v18, 16, v161
    v_and_b32 v19, 0xffff0000, v161
    v_lshlrev_b32 v20, 16, v162
    v_and_b32 v21, 0xffff0000, v162
    v_lshlrev_b32 v22, 16, v163
    v_and_b32 v23, 0xffff0000, v163
    v_lshlrev_b32 v24, 16, v164
    v_and_b32 v25, 0xffff0000, v164
    v_lshlrev_b32 v26, 16, v165
    v_and_b32 v27, 0xffff0000, v165
    v_lshlrev_b32 v28, 16, v166
    v_and_b32 v29, 0xffff0000, v166
    v_lshlrev_b32 v30, 16, v167
    v_and_b32 v31, 0xffff0000, v167
    s_mov_b32 s56, 0x3eeff558
    v_pk_mul_f32 v[16:17], v[16:17], s[56:57] op_sel_hi:[1,0]
    v_pk_mul_f32 v[18:19], v[18:19], s[56:57] op_sel_hi:[1,0]
    v_pk_mul_f32 v[20:21], v[20:21], s[56:57] op_sel_hi:[1,0]
    v_pk_mul_f32 v[22:23], v[22:23], s[56:57] op_sel_hi:[1,0]
    v_pk_mul_f32 v[24:25], v[24:25], s[56:57] op_sel_hi:[1,0]
    v_pk_mul_f32 v[26:27], v[26:27], s[56:57] op_sel_hi:[1,0]
    v_pk_mul_f32 v[28:29], v[28:29], s[56:57] op_sel_hi:[1,0]
    v_pk_mul_f32 v[30:31], v[30:31], s[56:57] op_sel_hi:[1,0]
    v_accvgpr_write_b32 a224, v16
    v_accvgpr_write_b32 a225, v17
    v_accvgpr_write_b32 a226, v18
    v_accvgpr_write_b32 a227, v19
    v_accvgpr_write_b32 a228, v20
    v_accvgpr_write_b32 a229, v21
    v_accvgpr_write_b32 a230, v22
    v_accvgpr_write_b32 a231, v23
    v_accvgpr_write_b32 a232, v24
    v_accvgpr_write_b32 a233, v25
    v_accvgpr_write_b32 a234, v26
    v_accvgpr_write_b32 a235, v27
    v_accvgpr_write_b32 a236, v28
    v_accvgpr_write_b32 a237, v29
    v_accvgpr_write_b32 a238, v30
    v_accvgpr_write_b32 a239, v31
    s_mov_b32 s6, 0xcccccccc
    s_mov_b32 s7, s6
    s_waitcnt vmcnt(19)
    s_barrier
    ds_read_b128 v[208:211], v2 offset:0
    ds_read_b128 v[212:215], v2 offset:1024
    ds_read_b128 v[216:219], v2 offset:2048
    ds_read_b128 v[220:223], v2 offset:3072
    s_waitcnt vmcnt(10)
    v_max3_u32 v9, v95, v87, v91
    v_max_u32 v9, v9, v83
    v_cmp_le_u32 vcc, 0xff800000, v9
    s_cbranch_vccnz L_slow_g1a_0
L_back_g1a_0:
    v_swap_b32 v84, v81
    v_swap_b32 v88, v82
    v_swap_b32 v92, v83
    v_and_b32 v80, v15, v80
    s_waitcnt lgkmcnt(3)
    s_nop 0
    v_mfma_f32_16x16x32_bf16 v[16:19], v[208:211], v[80:83], 0
    v_swap_b32 v89, v86
    s_waitcnt lgkmcnt(2)
    v_mfma_f32_16x16x32_bf16 v[32:35], v[212:215], v[80:83], 0
    v_swap_b32 v93, v87
    s_waitcnt lgkmcnt(1)
    v_mfma_f32_16x16x32_bf16 v[48:51], v[216:219], v[80:83], 0
    v_and_b32 v84, v15, v84
    buffer_load_dwordx4 v[128:131], v251, s[32:35], s67 offen offset:0 sc1
    s_waitcnt lgkmcnt(0)
    v_mfma_f32_16x16x32_bf16 v[64:67], v[220:223], v[80:83], 0
    v_swap_b32 v94, v91
    s_add_u32 m0, s79, 40960
    s_add_u32 s53, s78, s74
    buffer_load_dwordx4 v2, s[40:43], s53 offen sc1 lds
    v_mfma_f32_16x16x32_bf16 v[240:243], v[80:83], v[80:83], 0
    v_and_b32 v88, v15, v88
    v_and_b32 v92, v15, v92
    v_mfma_f32_16x16x32_bf16 v[20:23], v[208:211], v[84:87], 0
    ds_read_b128 v[224:227], v2 offset:4096
    buffer_load_dwordx4 v[132:135], v251, s[32:35], s67 offen offset:256 sc1
    v_mfma_f32_16x16x32_bf16 v[36:39], v[212:215], v[84:87], 0
    ds_read_b128 v[228:231], v2 offset:5120
    buffer_load_dwordx4 v[136:139], v251, s[32:35], s67 offen offset:2048 sc1
    v_mfma_f32_16x16x32_bf16 v[52:55], v[216:219], v[84:87], 0
    ds_read_b128 v[232:235], v2 offset:6144
    buffer_load_dwordx4 v[140:143], v251, s[32:35], s67 offen offset:2304 sc1
    v_cndmask_b32 v10, v240, v241, s[4:5]
    v_mfma_f32_16x16x32_bf16 v[68:71], v[220:223], v[84:87], 0
    s_waitcnt vmcnt(11)
    v_max3_u32 v9, v111, v103, v107
    v_max_u32 v9, v9, v99
    v_mfma_f32_16x16x32_bf16 v[244:247], v[84:87], v[84:87], 0
    v_cmp_le_u32 vcc, 0xff800000, v9
    ds_read_b128 v[236:239], v2 offset:7168
    v_mfma_f32_16x16x32_bf16 v[24:27], v[208:211], v[88:91], 0
    buffer_load_dwordx4 v[144:147], v251, s[32:35], s68 offen offset:0 sc1
    v_cndmask_b32 v240, v242, v243, s[4:5]
    v_mfma_f32_16x16x32_bf16 v[40:43], v[212:215], v[88:91], 0
    s_cbranch_vccnz L_slow_g1a_1
L_back_g1a_1:
    v_mfma_f32_16x16x32_bf16 v[56:59], v[216:219], v[88:91], 0
    buffer_load_dwordx4 v[148:151], v251, s[32:35], s68 offen offset:256 sc1
    v_cndmask_b32 v10, v10, v240, s[6:7]
    v_cndmask_b32 v11, v244, v245, s[4:5]
    v_cndmask_b32 v244, v246, v247, s[4:5]
    v_mfma_f32_16x16x32_bf16 v[72:75], v[220:223], v[88:91], 0
    v_swap_b32 v100, v97
    v_mfma_f32_16x16x32_bf16 v[240:243], v[88:91], v[88:91], 0
    v_swap_b32 v104, v98
    v_mfma_f32_16x16x32_bf16 v[28:31], v[208:211], v[92:95], 0
    v_swap_b32 v108, v99
    v_mfma_f32_16x16x32_bf16 v[44:47], v[212:215], v[92:95], 0
    buffer_load_dwordx4 v[152:155], v251, s[32:35], s68 offen offset:2048 sc1
    v_cndmask_b32 v11, v11, v244, s[6:7]
    v_mfma_f32_16x16x32_bf16 v[60:63], v[216:219], v[92:95], 0
    v_swap_b32 v105, v102
    v_cndmask_b32 v12, v240, v241, s[4:5]
    v_cndmask_b32 v240, v242, v243, s[4:5]
    v_mfma_f32_16x16x32_bf16 v[76:79], v[220:223], v[92:95], 0
    v_swap_b32 v109, v103
    v_mfma_f32_16x16x32_bf16 v[244:247], v[92:95], v[92:95], 0
    v_swap_b32 v110, v107
    s_waitcnt lgkmcnt(0)
    v_mfma_f32_16x16x32_bf16 v[16:19], v[224:227], v[96:99], v[16:19]
    ds_read_b128 v[208:211], v2 offset:8192
    buffer_load_dwordx4 v[156:159], v251, s[32:35], s68 offen offset:2304 sc1
    v_mfma_f32_16x16x32_bf16 v[20:23], v[224:227], v[100:103], v[20:23]
    ds_read_b128 v[212:215], v2 offset:9216
    v_cndmask_b32 v12, v12, v240, s[6:7]
    v_mfma_f32_16x16x32_bf16 v[24:27], v[224:227], v[104:107], v[24:27]
    ds_read_b128 v[216:219], v2 offset:10240
    buffer_load_dwordx4 v[160:163], v251, s[32:35], s69 offen offset:0 sc1
    v_cndmask_b32 v13, v244, v245, s[4:5]
    v_mfma_f32_16x16x32_bf16 v[28:31], v[224:227], v[108:111], v[28:31]
    ds_read_b128 v[220:223], v2 offset:11264
    buffer_load_dwordx4 v[164:167], v251, s[32:35], s69 offen offset:256 sc1
    s_add_u32 m0, s79, 45056
    s_add_u32 s53, s78, s75
    buffer_load_dwordx4 v2, s[40:43], s53 offen sc1 lds
    v_mfma_f32_16x16x32_bf16 v[32:35], v[228:231], v[96:99], v[32:35]
    s_waitcnt vmcnt(14)
    v_max3_u32 v9, v127, v119, v123
    v_max_u32 v9, v9, v115
    v_mfma_f32_16x16x32_bf16 v[36:39], v[228:231], v[100:103], v[36:39]
    v_cmp_le_u32 vcc, 0xff800000, v9
    buffer_load_dwordx4 v[168:171], v251, s[32:35], s69 offen offset:2048 sc1
    v_mfma_f32_16x16x32_bf16 v[40:43], v[228:231], v[104:107], v[40:43]
    buffer_load_dwordx4 v[172:175], v251, s[32:35], s69 offen offset:2304 sc1
    v_cndmask_b32 v244, v246, v247, s[4:5]
    v_mfma_f32_16x16x32_bf16 v[44:47], v[228:231], v[108:111], v[44:47]
    s_cbranch_vccnz L_slow_g1a_2
L_back_g1a_2:
    v_mfma_f32_16x16x32_bf16 v[48:51], v[232:235], v[96:99], v[48:51]
    buffer_load_dwordx4 v[176:179], v251, s[32:35], s70 offen offset:0 sc1
    v_cndmask_b32 v13, v13, v244, s[6:7]
    v_mfma_f32_16x16x32_bf16 v[52:55], v[232:235], v[100:103], v[52:55]
    v_swap_b32 v116, v113
    v_mfma_f32_16x16x32_bf16 v[56:59], v[232:235], v[104:107], v[56:59]
    v_swap_b32 v120, v114
    v_mfma_f32_16x16x32_bf16 v[60:63], v[232:235], v[108:111], v[60:63]
    v_swap_b32 v124, v115
    v_mfma_f32_16x16x32_bf16 v[64:67], v[236:239], v[96:99], v[64:67]
    buffer_load_dwordx4 v[180:183], v251, s[32:35], s70 offen offset:256 sc1
    s_mov_b32 exec_lo, 0x00f0000f
    s_mov_b32 exec_hi, 0xf0000f00
    buffer_store_dwordx4 v[10:13], v250, s[28:31], s8 offen sc1
    s_mov_b64 exec, -1
    v_mfma_f32_16x16x32_bf16 v[68:71], v[236:239], v[100:103], v[68:71]
    v_swap_b32 v121, v118
    v_mfma_f32_16x16x32_bf16 v[72:75], v[236:239], v[104:107], v[72:75]
    v_swap_b32 v125, v119
    v_mfma_f32_16x16x32_bf16 v[76:79], v[236:239], v[108:111], v[76:79]
    v_swap_b32 v126, v123
    s_waitcnt lgkmcnt(0)
    v_mfma_f32_16x16x32_bf16 v[16:19], v[208:211], v[112:115], v[16:19]
    s_barrier
    v_mov_b32 v10, s12
    v_mfma_f32_16x16x32_bf16 v[20:23], v[208:211], v[116:119], v[20:23]
    ds_read_b128 v[224:227], v2 offset:12288
    buffer_load_dwordx4 v[184:187], v251, s[32:35], s70 offen offset:2048 sc1
    v_mfma_f32_16x16x32_bf16 v[24:27], v[208:211], v[120:123], v[24:27]
    ds_read_b128 v[228:231], v2 offset:13312
    buffer_load_dwordx4 v[188:191], v251, s[32:35], s70 offen offset:2304 sc1
    v_mfma_f32_16x16x32_bf16 v[28:31], v[208:211], v[124:127], v[28:31]
    ds_read_b128 v[232:235], v2 offset:14336
    buffer_load_dwordx4 v[192:195], v251, s[32:35], s71 offen offset:0 sc1
    s_add_u32 m0, s79, 49152
    s_add_u32 s53, s78, s76
    buffer_load_dwordx4 v2, s[40:43], s53 offen sc1 lds
    v_mfma_f32_16x16x32_bf16 v[32:35], v[212:215], v[112:115], v[32:35]
    s_waitcnt vmcnt(16)
    v_max3_u32 v9, v143, v135, v139
    v_max_u32 v9, v9, v131
    v_mfma_f32_16x16x32_bf16 v[36:39], v[212:215], v[116:119], v[36:39]
    v_cmp_le_u32 vcc, 0xff800000, v9
    ds_read_b128 v[236:239], v2 offset:15360
    v_mfma_f32_16x16x32_bf16 v[40:43], v[212:215], v[120:123], v[40:43]
    buffer_load_dwordx4 v[196:199], v251, s[32:35], s71 offen offset:256 sc1
    v_mov_b32 v11, s13
    v_mfma_f32_16x16x32_bf16 v[44:47], v[212:215], v[124:127], v[44:47]
    s_cbranch_vccnz L_slow_g1a_3
L_back_g1a_3:
    v_mfma_f32_16x16x32_bf16 v[48:51], v[216:219], v[112:115], v[48:51]
    buffer_load_dwordx4 v[200:203], v251, s[32:35], s71 offen offset:2048 sc1
    v_min_u32 v13, 864, v254
    v_mfma_f32_16x16x32_bf16 v[52:55], v[216:219], v[116:119], v[52:55]
    v_swap_b32 v132, v129
    v_mfma_f32_16x16x32_bf16 v[56:59], v[216:219], v[120:123], v[56:59]
    v_swap_b32 v136, v130
    buffer_load_dwordx4 v[204:207], v251, s[32:35], s71 offen offset:2304 sc1
    v_mfma_f32_16x16x32_bf16 v[60:63], v[216:219], v[124:127], v[60:63]
    v_swap_b32 v140, v131
    v_mfma_f32_16x16x32_bf16 v[64:67], v[220:223], v[112:115], v[64:67]
    buffer_load_dwordx4 v[80:83], v251, s[32:35], s72 offen offset:0 sc1
    v_lshlrev_b32 v13, 5, v13
    v_mfma_f32_16x16x32_bf16 v[68:71], v[220:223], v[116:119], v[68:71]
    v_swap_b32 v137, v134
    v_mfma_f32_16x16x32_bf16 v[72:75], v[220:223], v[120:123], v[72:75]
    v_swap_b32 v141, v135
    v_mfma_f32_16x16x32_bf16 v[76:79], v[220:223], v[124:127], v[76:79]
    v_swap_b32 v142, v139
    s_mov_b64 exec, 1
    buffer_store_dwordx2 v[10:11], off, s[28:31], s96 offset:16 sc1
    s_mov_b64 exec, -1
    s_waitcnt lgkmcnt(0)
    v_mfma_f32_16x16x32_bf16 v[16:19], v[224:227], v[128:131], v[16:19]
    ds_read_b128 v[208:211], v2 offset:16384
    buffer_load_dwordx4 v[84:87], v251, s[32:35], s72 offen offset:256 sc1
    v_mfma_f32_16x16x32_bf16 v[20:23], v[224:227], v[132:135], v[20:23]
    ds_read_b128 v[212:215], v2 offset:17408
    v_mfma_f32_16x16x32_bf16 v[24:27], v[224:227], v[136:139], v[24:27]
    ds_read_b128 v[216:219], v2 offset:18432
    buffer_load_dwordx4 v[88:91], v251, s[32:35], s72 offen offset:2048 sc1
    v_mfma_f32_16x16x32_bf16 v[28:31], v[224:227], v[140:143], v[28:31]
    ds_read_b128 v[220:223], v2 offset:19456
    buffer_load_dwordx4 v[92:95], v251, s[32:35], s72 offen offset:2304 sc1
    v_mfma_f32_16x16x32_bf16 v[32:35], v[228:231], v[128:131], v[32:35]
    s_waitcnt vmcnt(20)
    v_max3_u32 v9, v159, v151, v155
    v_max_u32 v9, v9, v147
    v_mfma_f32_16x16x32_bf16 v[36:39], v[228:231], v[132:135], v[36:39]
    v_cmp_le_u32 vcc, 0xff800000, v9
    buffer_load_dwordx4 v[96:99], v251, s[32:35], s73 offen offset:0 sc1
    v_mfma_f32_16x16x32_bf16 v[40:43], v[228:231], v[136:139], v[40:43]
    buffer_load_dwordx4 v[100:103], v251, s[32:35], s73 offen offset:256 sc1
    buffer_load_dwordx2 v[252:253], v0, s[28:31], s58 offen sc1
    v_mfma_f32_16x16x32_bf16 v[44:47], v[228:231], v[140:143], v[44:47]
    s_cbranch_vccnz L_slow_g1a_4
L_back_g1a_4:
    v_mfma_f32_16x16x32_bf16 v[48:51], v[232:235], v[128:131], v[48:51]
    buffer_load_dwordx4 v[104:107], v251, s[32:35], s73 offen offset:2048 sc1
    s_add_u32 m0, s79, 53248
    s_add_u32 s53, s78, s77
    buffer_load_dwordx4 v2, s[40:43], s53 offen sc1 lds
    v_mfma_f32_16x16x32_bf16 v[52:55], v[232:235], v[132:135], v[52:55]
    v_swap_b32 v148, v145
    v_mfma_f32_16x16x32_bf16 v[56:59], v[232:235], v[136:139], v[56:59]
    v_swap_b32 v152, v146
    v_mfma_f32_16x16x32_bf16 v[60:63], v[232:235], v[140:143], v[60:63]
    v_swap_b32 v156, v147
    v_mfma_f32_16x16x32_bf16 v[64:67], v[236:239], v[128:131], v[64:67]
    buffer_load_dwordx4 v[108:111], v251, s[32:35], s73 offen offset:2304 sc1
    v_mfma_f32_16x16x32_bf16 v[68:71], v[236:239], v[132:135], v[68:71]
    v_swap_b32 v153, v150
    v_mfma_f32_16x16x32_bf16 v[72:75], v[236:239], v[136:139], v[72:75]
    v_swap_b32 v157, v151
    v_mfma_f32_16x16x32_bf16 v[76:79], v[236:239], v[140:143], v[76:79]
    v_swap_b32 v158, v155
    s_waitcnt lgkmcnt(0)
    v_mfma_f32_16x16x32_bf16 v[16:19], v[208:211], v[144:147], v[16:19]
    ds_read_b128 v[224:227], v2 offset:20480
    buffer_load_dwordx4 v[112:115], v251, s[32:35], s74 offen offset:0 sc1
    v_mfma_f32_16x16x32_bf16 v[20:23], v[208:211], v[148:151], v[20:23]
    ds_read_b128 v[228:231], v2 offset:21504
    v_mfma_f32_16x16x32_bf16 v[24:27], v[208:211], v[152:155], v[24:27]
    ds_read_b128 v[232:235], v2 offset:22528
    buffer_load_dwordx4 v[116:119], v251, s[32:35], s74 offen offset:256 sc1
    v_mfma_f32_16x16x32_bf16 v[28:31], v[208:211], v[156:159], v[28:31]
    ds_read_b128 v[236:239], v2 offset:23552
    buffer_load_dwordx4 v[120:123], v251, s[32:35], s74 offen offset:2048 sc1
    v_mfma_f32_16x16x32_bf16 v[32:35], v[212:215], v[144:147], v[32:35]
    s_waitcnt vmcnt(24)
    v_max3_u32 v9, v175, v167, v171
    v_max_u32 v9, v9, v163
    v_mfma_f32_16x16x32_bf16 v[36:39], v[212:215], v[148:151], v[36:39]
    v_cmp_le_u32 vcc, 0xff800000, v9
    buffer_load_dwordx4 v[124:127], v251, s[32:35], s74 offen offset:2304 sc1
    v_mfma_f32_16x16x32_bf16 v[40:43], v[212:215], v[152:155], v[40:43]
    buffer_load_dwordx4 v[128:131], v251, s[32:35], s75 offen offset:0 sc1
    v_mfma_f32_16x16x32_bf16 v[44:47], v[212:215], v[156:159], v[44:47]
    s_cbranch_vccnz L_slow_g1a_5
L_back_g1a_5:
    v_mfma_f32_16x16x32_bf16 v[48:51], v[216:219], v[144:147], v[48:51]
    buffer_load_dwordx4 v[132:135], v251, s[32:35], s75 offen offset:256 sc1
    v_mfma_f32_16x16x32_bf16 v[52:55], v[216:219], v[148:151], v[52:55]
    v_swap_b32 v164, v161
    v_mfma_f32_16x16x32_bf16 v[56:59], v[216:219], v[152:155], v[56:59]
    v_swap_b32 v168, v162
    v_mfma_f32_16x16x32_bf16 v[60:63], v[216:219], v[156:159], v[60:63]
    v_swap_b32 v172, v163
    v_mfma_f32_16x16x32_bf16 v[64:67], v[220:223], v[144:147], v[64:67]
    buffer_load_dwordx4 v[136:139], v251, s[32:35], s75 offen offset:2048 sc1
    v_mfma_f32_16x16x32_bf16 v[68:71], v[220:223], v[148:151], v[68:71]
    v_swap_b32 v169, v166
    v_mfma_f32_16x16x32_bf16 v[72:75], v[220:223], v[152:155], v[72:75]
    v_swap_b32 v173, v167
    v_mfma_f32_16x16x32_bf16 v[76:79], v[220:223], v[156:159], v[76:79]
    v_swap_b32 v174, v171
    s_waitcnt lgkmcnt(0)
    v_mfma_f32_16x16x32_bf16 v[16:19], v[224:227], v[160:163], v[16:19]
    s_barrier
    v_mfma_f32_16x16x32_bf16 v[20:23], v[224:227], v[164:167], v[20:23]
    ds_read_b128 v[208:211], v2 offset:24576
    buffer_load_dwordx4 v[140:143], v251, s[32:35], s75 offen offset:2304 sc1
    v_mfma_f32_16x16x32_bf16 v[24:27], v[224:227], v[168:171], v[24:27]
    ds_read_b128 v[212:215], v2 offset:25600
    buffer_load_dwordx4 v[144:147], v251, s[32:35], s76 offen offset:0 sc1
    v_mfma_f32_16x16x32_bf16 v[28:31], v[224:227], v[172:175], v[28:31]
    ds_read_b128 v[216:219], v2 offset:26624
    buffer_load_dwordx4 v[148:151], v251, s[32:35], s76 offen offset:256 sc1
    v_mfma_f32_16x16x32_bf16 v[32:35], v[228:231], v[160:163], v[32:35]
    s_waitcnt vmcnt(26)
    v_max3_u32 v9, v191, v183, v187
    v_max_u32 v9, v9, v179
    v_mfma_f32_16x16x32_bf16 v[36:39], v[228:231], v[164:167], v[36:39]
    v_cmp_le_u32 vcc, 0xff800000, v9
    ds_read_b128 v[220:223], v2 offset:27648
    v_mfma_f32_16x16x32_bf16 v[40:43], v[228:231], v[168:171], v[40:43]
    buffer_load_dwordx4 v[152:155], v251, s[32:35], s76 offen offset:2048 sc1
    s_waitcnt vmcnt(14)
    v_cmp_ne_u64 s[98:99], s[12:13], v[252:253]
    v_mfma_f32_16x16x32_bf16 v[44:47], v[228:231], v[172:175], v[44:47]
    s_cbranch_vccnz L_slow_g1a_6
L_back_g1a_6:
    v_mfma_f32_16x16x32_bf16 v[48:51], v[232:235], v[160:163], v[48:51]
    buffer_load_dwordx4 v[156:159], v251, s[32:35], s76 offen offset:2304 sc1
    v_mfma_f32_16x16x32_bf16 v[52:55], v[232:235], v[164:167], v[52:55]
    v_swap_b32 v180, v177
    v_mfma_f32_16x16x32_bf16 v[56:59], v[232:235], v[168:171], v[56:59]
    v_swap_b32 v184, v178
    v_mfma_f32_16x16x32_bf16 v[60:63], v[232:235], v[172:175], v[60:63]
    v_swap_b32 v188, v179
    v_mfma_f32_16x16x32_bf16 v[64:67], v[236:239], v[160:163], v[64:67]
    s_cmp_lg_u64 s[98:99], 0
    s_cbranch_scc1 L_slow_f2
L_back_f2:
    v_mfma_f32_16x16x32_bf16 v[68:71], v[236:239], v[164:167], v[68:71]
    v_swap_b32 v185, v182
    v_mfma_f32_16x16x32_bf16 v[72:75], v[236:239], v[168:171], v[72:75]
    v_swap_b32 v189, v183
    v_mfma_f32_16x16x32_bf16 v[76:79], v[236:239], v[172:175], v[76:79]
    v_swap_b32 v190, v187
    s_waitcnt lgkmcnt(0)
    v_mfma_f32_16x16x32_bf16 v[16:19], v[208:211], v[176:179], v[16:19]
    ds_read_b128 v[224:227], v2 offset:28672
    buffer_load_dwordx4 v[160:163], v251, s[32:35], s77 offen offset:0 sc1
    v_mfma_f32_16x16x32_bf16 v[20:23], v[208:211], v[180:183], v[20:23]
    ds_read_b128 v[228:231], v2 offset:29696
    v_mfma_f32_16x16x32_bf16 v[24:27], v[208:211], v[184:187], v[24:27]
    ds_read_b128 v[232:235], v2 offset:30720
    buffer_load_dwordx4 a[0:3], v5, s[44:47], s80 offen sc1
    v_mfma_f32_16x16x32_bf16 v[28:31], v[208:211], v[188:191], v[28:31]
    ds_read_b128 v[236:239], v2 offset:31744
    v_mfma_f32_16x16x32_bf16 v[32:35], v[212:215], v[176:179], v[32:35]
    v_max3_u32 v9, v207, v199, v203
    v_max_u32 v9, v9, v195
    v_mfma_f32_16x16x32_bf16 v[36:39], v[212:215], v[180:183], v[36:39]
    v_cmp_le_u32 vcc, 0xff800000, v9
    buffer_load_dwordx4 v[164:167], v251, s[32:35], s77 offen offset:256 sc1
    v_mfma_f32_16x16x32_bf16 v[40:43], v[212:215], v[184:187], v[40:43]
    buffer_load_dwordx4 a[4:7], v6, s[44:47], s80 offen sc1
    v_mfma_f32_16x16x32_bf16 v[44:47], v[212:215], v[188:191], v[44:47]
    s_cbranch_vccnz L_slow_g1a_7
L_back_g1a_7:
    v_mfma_f32_16x16x32_bf16 v[48:51], v[216:219], v[176:179], v[48:51]
    buffer_load_dwordx4 v[168:171], v251, s[32:35], s77 offen offset:2048 sc1
    v_mfma_f32_16x16x32_bf16 v[52:55], v[216:219], v[180:183], v[52:55]
    v_swap_b32 v196, v193
    v_mfma_f32_16x16x32_bf16 v[56:59], v[216:219], v[184:187], v[56:59]
    v_swap_b32 v200, v194
    v_mfma_f32_16x16x32_bf16 v[60:63], v[216:219], v[188:191], v[60:63]
    v_swap_b32 v204, v195
    v_mfma_f32_16x16x32_bf16 v[64:67], v[220:223], v[176:179], v[64:67]
    buffer_load_dwordx4 v[172:175], v251, s[32:35], s77 offen offset:2304 sc1
    buffer_load_dwordx4 a[8:11], v7, s[44:47], s80 offen sc1
    v_mfma_f32_16x16x32_bf16 v[68:71], v[220:223], v[180:183], v[68:71]
    v_swap_b32 v201, v198
    v_mfma_f32_16x16x32_bf16 v[72:75], v[220:223], v[184:187], v[72:75]
    v_swap_b32 v205, v199
    v_mfma_f32_16x16x32_bf16 v[76:79], v[220:223], v[188:191], v[76:79]
    v_swap_b32 v206, v203
    s_waitcnt lgkmcnt(0)
    v_mfma_f32_16x16x32_bf16 v[16:19], v[224:227], v[192:195], v[16:19]
    ds_read_b128 v[208:211], v2 offset:32768
    v_mov_b32 v188, 0
    v_mfma_f32_16x16x32_bf16 v[20:23], v[224:227], v[196:199], v[20:23]
    ds_read_b128 v[212:215], v2 offset:33792
    v_mov_b32 v189, 0
    v_mfma_f32_16x16x32_bf16 v[24:27], v[224:227], v[200:203], v[24:27]
    ds_read_b128 v[216:219], v2 offset:34816
    v_mov_b32 v190, 0
    buffer_load_dwordx4 a[12:15], v8, s[44:47], s80 offen sc1
    v_mfma_f32_16x16x32_bf16 v[28:31], v[224:227], v[204:207], v[28:31]
    ds_read_b128 v[220:223], v2 offset:35840
    v_mov_b32 v191, 0
    v_mfma_f32_16x16x32_bf16 v[32:35], v[228:231], v[192:195], v[32:35]
    v_max3_u32 v9, v95, v87, v91
    v_max_u32 v9, v9, v83
    v_mfma_f32_16x16x32_bf16 v[36:39], v[228:231], v[196:199], v[36:39]
    v_cmp_le_u32 vcc, 0xff800000, v9
    buffer_load_dwordx4 a[16:19], v5, s[44:47], s81 offen sc1
    v_mfma_f32_16x16x32_bf16 v[40:43], v[228:231], v[200:203], v[40:43]
    v_mfma_f32_16x16x32_bf16 v[44:47], v[228:231], v[204:207], v[44:47]
    s_cbranch_vccnz L_slow_g1a_8
L_back_g1a_8:
    v_mfma_f32_16x16x32_bf16 v[48:51], v[232:235], v[192:195], v[48:51]
    buffer_load_dwordx4 a[20:23], v6, s[44:47], s81 offen sc1
    v_mfma_f32_16x16x32_bf16 v[52:55], v[232:235], v[196:199], v[52:55]
    v_swap_b32 v84, v81
    v_mfma_f32_16x16x32_bf16 v[56:59], v[232:235], v[200:203], v[56:59]
    v_swap_b32 v88, v82
    v_mfma_f32_16x16x32_bf16 v[60:63], v[232:235], v[204:207], v[60:63]
    v_swap_b32 v92, v83
    v_mfma_f32_16x16x32_bf16 v[64:67], v[236:239], v[192:195], v[64:67]
    buffer_load_dwordx4 a[24:27], v7, s[44:47], s81 offen sc1
    v_mfma_f32_16x16x32_bf16 v[68:71], v[236:239], v[196:199], v[68:71]
    v_swap_b32 v89, v86
    v_mfma_f32_16x16x32_bf16 v[72:75], v[236:239], v[200:203], v[72:75]
    v_swap_b32 v93, v87
    v_mfma_f32_16x16x32_bf16 v[76:79], v[236:239], v[204:207], v[76:79]
    v_swap_b32 v94, v91
    s_waitcnt lgkmcnt(0)
    v_mfma_f32_16x16x32_bf16 v[16:19], v[208:211], v[80:83], v[16:19]
    ds_read_b128 v[224:227], v2 offset:36864
    buffer_load_dwordx4 v[176:179], v2, s[28:31], s9 offen offset:0 sc1
    v_mfma_f32_16x16x32_bf16 v[20:23], v[208:211], v[84:87], v[20:23]
    ds_read_b128 v[228:231], v2 offset:37888
    buffer_load_dwordx4 a[28:31], v8, s[44:47], s81 offen sc1
    v_mfma_f32_16x16x32_bf16 v[24:27], v[208:211], v[88:91], v[24:27]
    ds_read_b128 v[232:235], v2 offset:38912
    v_mfma_f32_16x16x32_bf16 v[28:31], v[208:211], v[92:95], v[28:31]
    ds_read_b128 v[236:239], v2 offset:39936
    buffer_load_dwordx4 v[180:183], v2, s[28:31], s9 offen offset:1024 sc1
    buffer_load_dwordx4 a[32:35], v5, s[44:47], s82 offen sc1
    v_mfma_f32_16x16x32_bf16 v[32:35], v[212:215], v[80:83], v[32:35]
    s_waitcnt vmcnt(27)
    v_max3_u32 v9, v111, v103, v107
    v_max_u32 v9, v9, v99
    v_mfma_f32_16x16x32_bf16 v[36:39], v[212:215], v[84:87], v[36:39]
    v_cmp_le_u32 vcc, 0xff800000, v9
    v_mfma_f32_16x16x32_bf16 v[40:43], v[212:215], v[88:91], v[40:43]
    buffer_load_dwordx4 v[184:187], v2, s[28:31], s9 offen offset:2048 sc1
    buffer_load_dwordx4 a[36:39], v6, s[44:47], s82 offen sc1
    v_mfma_f32_16x16x32_bf16 v[44:47], v[212:215], v[92:95], v[44:47]
    s_cbranch_vccnz L_slow_g1a_9
L_back_g1a_9:
    v_mfma_f32_16x16x32_bf16 v[48:51], v[216:219], v[80:83], v[48:51]
    s_mov_b32 exec_hi, 0
    buffer_load_dwordx4 v[188:191], v2, s[28:31], s9 offen offset:3072 sc1
    s_mov_b64 exec, -1
    v_mfma_f32_16x16x32_bf16 v[52:55], v[216:219], v[84:87], v[52:55]
    v_swap_b32 v100, v97
    buffer_load_dwordx4 a[40:43], v7, s[44:47], s82 offen sc1
    v_mfma_f32_16x16x32_bf16 v[56:59], v[216:219], v[88:91], v[56:59]
    v_swap_b32 v104, v98
    v_mfma_f32_16x16x32_bf16 v[60:63], v[216:219], v[92:95], v[60:63]
    v_swap_b32 v108, v99
    v_mfma_f32_16x16x32_bf16 v[64:67], v[220:223], v[80:83], v[64:67]
    buffer_load_dwordx4 a[44:47], v8, s[44:47], s82 offen sc1
    v_mfma_f32_16x16x32_bf16 v[68:71], v[220:223], v[84:87], v[68:71]
    v_swap_b32 v105, v102
    v_mfma_f32_16x16x32_bf16 v[72:75], v[220:223], v[88:91], v[72:75]
    v_swap_b32 v109, v103
    v_mfma_f32_16x16x32_bf16 v[76:79], v[220:223], v[92:95], v[76:79]
    v_swap_b32 v110, v107
    s_waitcnt lgkmcnt(0)
    v_mfma_f32_16x16x32_bf16 v[16:19], v[224:227], v[96:99], v[16:19]
    s_barrier
    v_mfma_f32_16x16x32_bf16 v[20:23], v[224:227], v[100:103], v[20:23]
    ds_read_b128 v[208:211], v2 offset:40960
    buffer_load_dwordx4 a[48:51], v5, s[44:47], s83 offen sc1
    v_mfma_f32_16x16x32_bf16 v[24:27], v[224:227], v[104:107], v[24:27]
    ds_read_b128 v[212:215], v2 offset:41984
    v_mfma_f32_16x16x32_bf16 v[28:31], v[224:227], v[108:111], v[28:31]
    ds_read_b128 v[216:219], v2 offset:43008
    buffer_load_dwordx4 a[52:55], v6, s[44:47], s83 offen sc1
    v_mfma_f32_16x16x32_bf16 v[32:35], v[228:231], v[96:99], v[32:35]
    s_waitcnt vmcnt(30)
    v_max3_u32 v9, v127, v119, v123
    v_max_u32 v9, v9, v115
    v_mfma_f32_16x16x32_bf16 v[36:39], v[228:231], v[100:103], v[36:39]
    v_cmp_le_u32 vcc, 0xff800000, v9
    ds_read_b128 v[220:223], v2 offset:44032
    v_mfma_f32_16x16x32_bf16 v[40:43], v[228:231], v[104:107], v[40:43]
    buffer_load_dwordx4 a[56:59], v7, s[44:47], s83 offen sc1
    v_mfma_f32_16x16x32_bf16 v[44:47], v[228:231], v[108:111], v[44:47]
    s_cbranch_vccnz L_slow_g1a_10
L_back_g1a_10:
    v_mfma_f32_16x16x32_bf16 v[48:51], v[232:235], v[96:99], v[48:51]
    buffer_load_dwordx4 a[60:63], v8, s[44:47], s83 offen sc1
    v_mfma_f32_16x16x32_bf16 v[52:55], v[232:235], v[100:103], v[52:55]
    v_swap_b32 v116, v113
    v_mfma_f32_16x16x32_bf16 v[56:59], v[232:235], v[104:107], v[56:59]
    v_swap_b32 v120, v114
    v_mfma_f32_16x16x32_bf16 v[60:63], v[232:235], v[108:111], v[60:63]
    v_swap_b32 v124, v115
    v_mfma_f32_16x16x32_bf16 v[64:67], v[236:239], v[96:99], v[64:67]
    buffer_load_dwordx4 a[64:67], v5, s[44:47], s84 offen sc1
    v_mfma_f32_16x16x32_bf16 v[68:71], v[236:239], v[100:103], v[68:71]
    v_swap_b32 v121, v118
    v_mfma_f32_16x16x32_bf16 v[72:75], v[236:239], v[104:107], v[72:75]
    v_swap_b32 v125, v119
    v_mfma_f32_16x16x32_bf16 v[76:79], v[236:239], v[108:111], v[76:79]
    v_swap_b32 v126, v123
    s_waitcnt lgkmcnt(0)
    v_mfma_f32_16x16x32_bf16 v[16:19], v[208:211], v[112:115], v[16:19]
    ds_read_b128 v[224:227], v2 offset:45056
    buffer_load_dwordx4 a[68:71], v6, s[44:47], s84 offen sc1
    v_mfma_f32_16x16x32_bf16 v[20:23], v[208:211], v[116:119], v[20:23]
    ds_read_b128 v[228:231], v2 offset:46080
    v_mfma_f32_16x16x32_bf16 v[24:27], v[208:211], v[120:123], v[24:27]
    ds_read_b128 v[232:235], v2 offset:47104
    v_mfma_f32_16x16x32_bf16 v[28:31], v[208:211], v[124:127], v[28:31]
    ds_read_b128 v[236:239], v2 offset:48128
    buffer_load_dwordx4 a[72:75], v7, s[44:47], s84 offen sc1
    v_mfma_f32_16x16x32_bf16 v[32:35], v[212:215], v[112:115], v[32:35]
    s_waitcnt vmcnt(31)
    v_max3_u32 v9, v143, v135, v139
    v_max_u32 v9, v9, v131
    v_mfma_f32_16x16x32_bf16 v[36:39], v[212:215], v[116:119], v[36:39]
    v_cmp_le_u32 vcc, 0xff800000, v9
    v_mfma_f32_16x16x32_bf16 v[40:43], v[212:215], v[120:123], v[40:43]
    buffer_load_dwordx4 a[76:79], v8, s[44:47], s84 offen sc1
    v_mfma_f32_16x16x32_bf16 v[44:47], v[212:215], v[124:127], v[44:47]
    s_cbranch_vccnz L_slow_g1a_11
L_back_g1a_11:
    v_mfma_f32_16x16x32_bf16 v[48:51], v[216:219], v[112:115], v[48:51]
    buffer_load_dwordx4 a[80:83], v5, s[44:47], s85 offen sc1
    v_mfma_f32_16x16x32_bf16 v[52:55], v[216:219], v[116:119], v[52:55]
    v_swap_b32 v132, v129
    v_mfma_f32_16x16x32_bf16 v[56:59], v[216:219], v[120:123], v[56:59]
    v_swap_b32 v136, v130
    v_mfma_f32_16x16x32_bf16 v[60:63], v[216:219], v[124:127], v[60:63]
    v_swap_b32 v140, v131
    v_mfma_f32_16x16x32_bf16 v[64:67], v[220:223], v[112:115], v[64:67]
    buffer_load_dwordx4 a[84:87], v6, s[44:47], s85 offen sc1
    v_mfma_f32_16x16x32_bf16 v[68:71], v[220:223], v[116:119], v[68:71]
    v_swap_b32 v137, v134
    v_mfma_f32_16x16x32_bf16 v[72:75], v[220:223], v[120:123], v[72:75]
    v_swap_b32 v141, v135
    v_mfma_f32_16x16x32_bf16 v[76:79], v[220:223], v[124:127], v[76:79]
    v_swap_b32 v142, v139
    s_waitcnt lgkmcnt(0)
    v_mfma_f32_16x16x32_bf16 v[16:19], v[224:227], v[128:131], v[16:19]
    ds_read_b128 v[208:211], v2 offset:49152
    buffer_load_dwordx4 a[88:91], v7, s[44:47], s85 offen sc1
    v_accvgpr_read_b32 v112, a224
    v_accvgpr_read_b32 v113, a225
    v_accvgpr_read_b32 v114, a226
    v_accvgpr_read_b32 v115, a227
    v_accvgpr_read_b32 v116, a228
    v_accvgpr_read_b32 v117, a229
    v_accvgpr_read_b32 v118, a230
    v_accvgpr_read_b32 v119, a231
    v_accvgpr_read_b32 v120, a232
    v_mfma_f32_16x16x32_bf16 v[20:23], v[224:227], v[132:135], v[20:23]
    ds_read_b128 v[212:215], v2 offset:50176
    v_accvgpr_read_b32 v121, a233
    v_mfma_f32_16x16x32_bf16 v[24:27], v[224:227], v[136:139], v[24:27]
    ds_read_b128 v[216:219], v2 offset:51200
    v_accvgpr_read_b32 v122, a234
    v_mfma_f32_16x16x32_bf16 v[28:31], v[224:227], v[140:143], v[28:31]
    ds_read_b128 v[220:223], v2 offset:52224
    buffer_load_dwordx4 a[92:95], v8, s[44:47], s85 offen sc1
    v_mfma_f32_16x16x32_bf16 v[32:35], v[228:231], v[128:131], v[32:35]
    s_waitcnt vmcnt(32)
    v_max3_u32 v9, v159, v151, v155
    v_max_u32 v9, v9, v147
    v_mfma_f32_16x16x32_bf16 v[36:39], v[228:231], v[132:135], v[36:39]
    v_cmp_le_u32 vcc, 0xff800000, v9
    buffer_load_dwordx4 a[96:99], v5, s[44:47], s86 offen sc1
    v_mfma_f32_16x16x32_bf16 v[40:43], v[228:231], v[136:139], v[40:43]
    s_mul_i32 s53, s48, 229376
    s_add_u32 s53, s53, 15114240
    s_add_u32 s40, s24, s53
    s_addc_u32 s41, s25, 0
    s_mov_b32 s42, 229376
    s_mov_b32 s43, 0x20000
    v_mfma_f32_16x16x32_bf16 v[44:47], v[228:231], v[140:143], v[44:47]
    s_cbranch_vccnz L_slow_g1a_12
L_back_g1a_12:
    v_mfma_f32_16x16x32_bf16 v[48:51], v[232:235], v[128:131], v[48:51]
    buffer_load_dwordx4 a[100:103], v6, s[44:47], s86 offen sc1
    v_accvgpr_read_b32 v123, a235
    v_mfma_f32_16x16x32_bf16 v[52:55], v[232:235], v[132:135], v[52:55]
    v_swap_b32 v148, v145
    v_mfma_f32_16x16x32_bf16 v[56:59], v[232:235], v[136:139], v[56:59]
    v_swap_b32 v152, v146
    v_mfma_f32_16x16x32_bf16 v[60:63], v[232:235], v[140:143], v[60:63]
    v_swap_b32 v156, v147
    v_mfma_f32_16x16x32_bf16 v[64:67], v[236:239], v[128:131], v[64:67]
    buffer_load_dwordx4 a[104:107], v7, s[44:47], s86 offen sc1
    v_accvgpr_read_b32 v124, a236
    v_mfma_f32_16x16x32_bf16 v[68:71], v[236:239], v[132:135], v[68:71]
    v_swap_b32 v153, v150
    v_mfma_f32_16x16x32_bf16 v[72:75], v[236:239], v[136:139], v[72:75]
    v_swap_b32 v157, v151
    v_mfma_f32_16x16x32_bf16 v[76:79], v[236:239], v[140:143], v[76:79]
    v_swap_b32 v158, v155
    s_waitcnt lgkmcnt(0)
    v_mfma_f32_16x16x32_bf16 v[16:19], v[208:211], v[144:147], v[16:19]
    ds_read_b128 v[224:227], v2 offset:53248
    buffer_load_dwordx4 a[108:111], v8, s[44:47], s86 offen sc1
    s_waitcnt vmcnt(22)
    v_add_f32 v192, v176, v180
    v_add_f32 v193, v177, v181
    v_add_f32 v194, v178, v182
    v_add_f32 v195, v179, v183
    s_waitcnt vmcnt(18)
    v_add_f32 v196, v184, v188
    v_add_f32 v197, v185, v189
    v_add_f32 v198, v186, v190
    v_add_f32 v199, v187, v191
    v_add_f32 v192, v192, v196
    v_add_f32 v193, v193, v197
    v_add_f32 v194, v194, v198
    v_mfma_f32_16x16x32_bf16 v[20:23], v[208:211], v[148:151], v[20:23]
    ds_read_b128 v[228:231], v2 offset:54272
    buffer_load_dwordx4 v[128:131], v13, s[28:31], s97 offen offset:8 sc1
    v_mfma_f32_16x16x32_bf16 v[24:27], v[208:211], v[152:155], v[24:27]
    ds_read_b128 v[232:235], v2 offset:55296
    v_add_f32 v195, v195, v199
    v_mfma_f32_16x16x32_bf16 v[28:31], v[208:211], v[156:159], v[28:31]
    ds_read_b128 v[236:239], v2 offset:56320
    buffer_load_dwordx4 a[112:115], v5, s[44:47], s87 offen sc1
    v_mfma_f32_16x16x32_bf16 v[32:35], v[212:215], v[144:147], v[32:35]
    v_max3_u32 v9, v175, v167, v171
    v_max_u32 v9, v9, v163
    v_mfma_f32_16x16x32_bf16 v[36:39], v[212:215], v[148:151], v[36:39]
    v_cmp_le_u32 vcc, 0xff800000, v9
    v_permlane32_swap_b32 v192, v194
    v_mfma_f32_16x16x32_bf16 v[40:43], v[212:215], v[152:155], v[40:43]
    buffer_load_dwordx4 a[116:119], v6, s[44:47], s87 offen sc1
    v_permlane32_swap_b32 v193, v195
    v_mfma_f32_16x16x32_bf16 v[44:47], v[212:215], v[156:159], v[44:47]
    s_cbranch_vccnz L_slow_g1a_13
L_back_g1a_13:
    v_mfma_f32_16x16x32_bf16 v[48:51], v[216:219], v[144:147], v[48:51]
    buffer_load_dwordx4 a[120:123], v7, s[44:47], s87 offen sc1
    v_add_f32 v192, v192, v194
    v_mfma_f32_16x16x32_bf16 v[52:55], v[216:219], v[148:151], v[52:55]
    v_swap_b32 v164, v161
    v_mfma_f32_16x16x32_bf16 v[56:59], v[216:219], v[152:155], v[56:59]
    v_swap_b32 v168, v162
    v_mfma_f32_16x16x32_bf16 v[60:63], v[216:219], v[156:159], v[60:63]
    v_swap_b32 v172, v163
    v_mfma_f32_16x16x32_bf16 v[64:67], v[220:223], v[144:147], v[64:67]
    buffer_load_dwordx4 a[124:127], v8, s[44:47], s87 offen sc1
    v_add_f32 v193, v193, v195
    v_mfma_f32_16x16x32_bf16 v[68:71], v[220:223], v[148:151], v[68:71]
    v_swap_b32 v169, v166
    v_mfma_f32_16x16x32_bf16 v[72:75], v[220:223], v[152:155], v[72:75]
    v_swap_b32 v173, v167
    v_mfma_f32_16x16x32_bf16 v[76:79], v[220:223], v[156:159], v[76:79]
    v_swap_b32 v174, v171
    s_waitcnt lgkmcnt(0)
    v_mfma_f32_16x16x32_bf16 v[16:19], v[224:227], v[160:163], v[16:19]
    buffer_load_dwordx4 a[128:131], v5, s[44:47], s88 offen sc1
    v_permlane16_swap_b32 v192, v193
    s_mov_b32 s56, 0x409d30fc
    v_mfma_f32_16x16x32_bf16 v[20:23], v[224:227], v[164:167], v[20:23]
    v_add_f32 v192, v192, v193
    v_cmp_u_f32 s[98:99], v192, v192
    s_mov_b32 s57, 0x3eeff558
    v_mfma_f32_16x16x32_bf16 v[24:27], v[224:227], v[168:171], v[24:27]
    s_add_u32 s55, s61, 15114240
    s_add_u32 s59, s61, 15118336
    v_accvgpr_read_b32 v125, a237
    v_mfma_f32_16x16x32_bf16 v[28:31], v[224:227], v[172:175], v[28:31]
    buffer_load_dwordx4 a[132:135], v6, s[44:47], s88 offen sc1
    s_cmp_lg_u64 s[98:99], 0
    s_cbranch_scc1 L_slow_g1ars
L_back_g1ars:
    v_mfma_f32_16x16x32_bf16 v[32:35], v[228:231], v[160:163], v[32:35]
    v_mov_b32 v194, 0x3727c5ac
    v_mul_f32 v192, 0x3b124925, v192
    v_add_f32 v193, v192, v194
    v_mfma_f32_16x16x32_bf16 v[36:39], v[228:231], v[164:167], v[36:39]
    v_rsq_f32 v193, v193
    v_mfma_f32_16x16x32_bf16 v[40:43], v[228:231], v[168:171], v[40:43]
    buffer_load_dwordx4 a[136:139], v7, s[44:47], s88 offen sc1
    v_mul_f32 v192, v192, v193
    v_mfma_f32_16x16x32_bf16 v[44:47], v[228:231], v[172:175], v[44:47]
    v_fma_f32 v192, v192, v193, v194
    v_accvgpr_read_b32 v126, a238
    v_mfma_f32_16x16x32_bf16 v[48:51], v[232:235], v[160:163], v[48:51]
    v_rsq_f32 v192, v192
    v_mfma_f32_16x16x32_bf16 v[52:55], v[232:235], v[164:167], v[52:55]
    buffer_load_dwordx4 a[140:143], v8, s[44:47], s88 offen sc1
    v_mul_f32 v193, 0x3eeff558, v193
    v_mfma_f32_16x16x32_bf16 v[56:59], v[232:235], v[168:171], v[56:59]
    v_mul_f32 v240, v192, v193
    v_mul_f32 v241, v192, v193
    v_mfma_f32_16x16x32_bf16 v[60:63], v[232:235], v[172:175], v[60:63]
    s_nop 0
    v_permlane16_swap_b32 v240, v241
    v_mfma_f32_16x16x32_bf16 v[64:67], v[236:239], v[160:163], v[64:67]
    buffer_load_dwordx4 a[144:147], v5, s[44:47], s89 offen sc1
    v_mov_b32 v242, v240
    v_mfma_f32_16x16x32_bf16 v[68:71], v[236:239], v[164:167], v[68:71]
    v_mov_b32 v243, v241
    v_accvgpr_read_b32 v127, a239
    v_mfma_f32_16x16x32_bf16 v[72:75], v[236:239], v[168:171], v[72:75]
    v_permlane32_swap_b32 v240, v242
    v_mfma_f32_16x16x32_bf16 v[76:79], v[236:239], v[172:175], v[76:79]
    v_permlane32_swap_b32 v241, v243
    v_pk_fma_f32 v[16:17], v[16:17], v[240:241], v[112:113] op_sel:[0,0,0] op_sel_hi:[1,0,1]
    buffer_load_dwordx4 a[148:151], v6, s[44:47], s89 offen sc1
    v_pk_fma_f32 v[18:19], v[18:19], v[240:241], v[114:115] op_sel:[0,0,0] op_sel_hi:[1,0,1]
    v_pk_fma_f32 v[208:209], v[16:17], v[16:17], s[56:57] op_sel_hi:[1,1,0]
    v_pk_fma_f32 v[32:33], v[32:33], v[240:241], v[116:117] op_sel:[0,0,0] op_sel_hi:[1,0,1]
    v_pk_fma_f32 v[210:211], v[18:19], v[18:19], s[56:57] op_sel_hi:[1,1,0]
    v_pk_mul_f32 v[208:209], v[208:209], v[16:17] neg_lo:[1,0] neg_hi:[1,0]
    v_exp_f32 v208, v208
    v_pk_fma_f32 v[34:35], v[34:35], v[240:241], v[118:119] op_sel:[0,0,0] op_sel_hi:[1,0,1]
    v_exp_f32 v209, v209
    v_pk_fma_f32 v[212:213], v[32:33], v[32:33], s[56:57] op_sel_hi:[1,1,0]
    v_pk_mul_f32 v[210:211], v[210:211], v[18:19] neg_lo:[1,0] neg_hi:[1,0]
    v_exp_f32 v210, v210
    v_pk_fma_f32 v[20:21], v[20:21], v[240:241], v[112:113] op_sel:[0,1,0] op_sel_hi:[1,1,1]
    v_exp_f32 v211, v211
    v_pk_fma_f32 v[214:215], v[34:35], v[34:35], s[56:57] op_sel_hi:[1,1,0]
    buffer_load_dwordx4 a[152:155], v7, s[44:47], s89 offen sc1
    v_pk_mul_f32 v[212:213], v[212:213], v[32:33] neg_lo:[1,0] neg_hi:[1,0]
    v_exp_f32 v212, v212
    v_pk_fma_f32 v[22:23], v[22:23], v[240:241], v[114:115] op_sel:[0,1,0] op_sel_hi:[1,1,1]
    v_pk_fma_f32 v[208:209], v[208:209], s[56:57], s[56:57] op_sel:[0,1,1] op_sel_hi:[1,1,1]
    v_exp_f32 v213, v213
    v_pk_fma_f32 v[216:217], v[20:21], v[20:21], s[56:57] op_sel_hi:[1,1,0]
    v_pk_mul_f32 v[214:215], v[214:215], v[34:35] neg_lo:[1,0] neg_hi:[1,0]
    v_exp_f32 v214, v214
    v_pk_fma_f32 v[36:37], v[36:37], v[240:241], v[116:117] op_sel:[0,1,0] op_sel_hi:[1,1,1]
    v_pk_fma_f32 v[210:211], v[210:211], s[56:57], s[56:57] op_sel:[0,1,1] op_sel_hi:[1,1,1]
    v_exp_f32 v215, v215
    v_pk_fma_f32 v[218:219], v[22:23], v[22:23], s[56:57] op_sel_hi:[1,1,0]
    v_rcp_f32 v208, v208
    v_pk_mul_f32 v[216:217], v[216:217], v[20:21] neg_lo:[1,0] neg_hi:[1,0]
    v_rcp_f32 v209, v209
    buffer_load_dwordx4 a[156:159], v8, s[44:47], s89 offen sc1
    v_exp_f32 v216, v216
    v_pk_fma_f32 v[38:39], v[38:39], v[240:241], v[118:119] op_sel:[0,1,0] op_sel_hi:[1,1,1]
    v_pk_fma_f32 v[212:213], v[212:213], s[56:57], s[56:57] op_sel:[0,1,1] op_sel_hi:[1,1,1]
    v_exp_f32 v217, v217
    v_pk_fma_f32 v[220:221], v[36:37], v[36:37], s[56:57] op_sel_hi:[1,1,0]
    v_rcp_f32 v210, v210
    v_pk_mul_f32 v[218:219], v[218:219], v[22:23] neg_lo:[1,0] neg_hi:[1,0]
    v_rcp_f32 v211, v211
    v_exp_f32 v218, v218
    v_pk_fma_f32 v[24:25], v[24:25], v[242:243], v[112:113] op_sel:[0,0,0] op_sel_hi:[1,0,1]
    v_pk_fma_f32 v[214:215], v[214:215], s[56:57], s[56:57] op_sel:[0,1,1] op_sel_hi:[1,1,1]
    v_exp_f32 v219, v219
    v_pk_fma_f32 v[222:223], v[38:39], v[38:39], s[56:57] op_sel_hi:[1,1,0]
    v_rcp_f32 v212, v212
    v_pk_mul_f32 v[220:221], v[220:221], v[36:37] neg_lo:[1,0] neg_hi:[1,0]
    s_waitcnt vmcnt(12)
    v_cmp_ne_u64 vcc, s[12:13], v[130:131]
    s_cbranch_vccnz L_slow_f0
L_back_f0:
    s_getreg_b32 s98, hwreg(HW_REG_XCC_ID, 0, 4)
    v_cmp_ne_u32 vcc, s98, v128
    s_nop 0
    s_cmp_lg_u64 vcc, 0
    s_cselect_b32 s10, 1, 0
    s_cmp_lg_u32 s10, 0
    s_cbranch_scc1 L_far_hp
L_near_hp:
    v_pk_mul_f32 v[208:209], v[208:209], v[16:17]
    v_rcp_f32 v213, v213
    v_exp_f32 v220, v220
    v_pk_fma_f32 v[26:27], v[26:27], v[242:243], v[114:115] op_sel:[0,0,0] op_sel_hi:[1,0,1]
    v_pk_fma_f32 v[216:217], v[216:217], s[56:57], s[56:57] op_sel:[0,1,1] op_sel_hi:[1,1,1]
    v_exp_f32 v221, v221
    v_pk_fma_f32 v[224:225], v[24:25], v[24:25], s[56:57] op_sel_hi:[1,1,0]
    v_rcp_f32 v214, v214
    v_pk_mul_f32 v[222:223], v[222:223], v[38:39] neg_lo:[1,0] neg_hi:[1,0]
    v_pk_mul_f32 v[210:211], v[210:211], v[18:19]
    v_rcp_f32 v215, v215
    v_cvt_pk_bf16_f32 v208, v208, v209
    v_exp_f32 v222, v222
    v_pk_fma_f32 v[40:41], v[40:41], v[242:243], v[116:117] op_sel:[0,0,0] op_sel_hi:[1,0,1]
    v_pk_fma_f32 v[218:219], v[218:219], s[56:57], s[56:57] op_sel:[0,1,1] op_sel_hi:[1,1,1]
    buffer_load_dwordx4 a[160:163], v5, s[44:47], s90 offen sc1
    v_exp_f32 v223, v223
    v_pk_fma_f32 v[226:227], v[26:27], v[26:27], s[56:57] op_sel_hi:[1,1,0]
    v_rcp_f32 v216, v216
    v_pk_mul_f32 v[224:225], v[224:225], v[24:25] neg_lo:[1,0] neg_hi:[1,0]
    v_pk_mul_f32 v[212:213], v[212:213], v[32:33]
    v_rcp_f32 v217, v217
    v_cvt_pk_bf16_f32 v209, v210, v211
    v_and_b32 v208, -2, v208
    v_exp_f32 v224, v224
    v_pk_fma_f32 v[42:43], v[42:43], v[242:243], v[118:119] op_sel:[0,0,0] op_sel_hi:[1,0,1]
    v_pk_fma_f32 v[220:221], v[220:221], s[56:57], s[56:57] op_sel:[0,1,1] op_sel_hi:[1,1,1]
    v_exp_f32 v225, v225
    v_pk_fma_f32 v[228:229], v[40:41], v[40:41], s[56:57] op_sel_hi:[1,1,0]
    v_rcp_f32 v218, v218
    buffer_load_dwordx4 a[164:167], v6, s[44:47], s90 offen sc1
    v_pk_mul_f32 v[226:227], v[226:227], v[26:27] neg_lo:[1,0] neg_hi:[1,0]
    v_pk_mul_f32 v[214:215], v[214:215], v[34:35]
    v_rcp_f32 v219, v219
    v_cvt_pk_bf16_f32 v210, v212, v213
    v_exp_f32 v226, v226
    v_pk_fma_f32 v[28:29], v[28:29], v[242:243], v[112:113] op_sel:[0,1,0] op_sel_hi:[1,1,1]
    v_pk_fma_f32 v[222:223], v[222:223], s[56:57], s[56:57] op_sel:[0,1,1] op_sel_hi:[1,1,1]
    v_exp_f32 v227, v227
    v_pk_fma_f32 v[230:231], v[42:43], v[42:43], s[56:57] op_sel_hi:[1,1,0]
    v_rcp_f32 v220, v220
    v_pk_mul_f32 v[228:229], v[228:229], v[40:41] neg_lo:[1,0] neg_hi:[1,0]
    v_pk_mul_f32 v[216:217], v[216:217], v[20:21]
    v_rcp_f32 v221, v221
    v_cvt_pk_bf16_f32 v211, v214, v215
    v_exp_f32 v228, v228
    buffer_load_dwordx4 a[168:171], v7, s[44:47], s90 offen sc1
    v_pk_fma_f32 v[30:31], v[30:31], v[242:243], v[114:115] op_sel:[0,1,0] op_sel_hi:[1,1,1]
    v_pk_fma_f32 v[224:225], v[224:225], s[56:57], s[56:57] op_sel:[0,1,1] op_sel_hi:[1,1,1]
    v_exp_f32 v229, v229
    v_pk_fma_f32 v[232:233], v[28:29], v[28:29], s[56:57] op_sel_hi:[1,1,0]
    v_rcp_f32 v222, v222
    v_pk_mul_f32 v[230:231], v[230:231], v[42:43] neg_lo:[1,0] neg_hi:[1,0]
    v_pk_mul_f32 v[218:219], v[218:219], v[22:23]
    v_rcp_f32 v223, v223
    v_cvt_pk_bf16_f32 v212, v216, v217
    v_exp_f32 v230, v230
    v_pk_fma_f32 v[44:45], v[44:45], v[242:243], v[116:117] op_sel:[0,1,0] op_sel_hi:[1,1,1]
    v_pk_fma_f32 v[226:227], v[226:227], s[56:57], s[56:57] op_sel:[0,1,1] op_sel_hi:[1,1,1]
    v_exp_f32 v231, v231
    v_pk_fma_f32 v[234:235], v[30:31], v[30:31], s[56:57] op_sel_hi:[1,1,0]
    v_rcp_f32 v224, v224
    buffer_load_dwordx4 a[172:175], v8, s[44:47], s90 offen sc1
    v_pk_mul_f32 v[232:233], v[232:233], v[28:29] neg_lo:[1,0] neg_hi:[1,0]
    v_pk_mul_f32 v[220:221], v[220:221], v[36:37]
    v_rcp_f32 v225, v225
    v_cvt_pk_bf16_f32 v213, v218, v219
    v_and_b32 v212, -2, v212
    v_exp_f32 v232, v232
    v_pk_fma_f32 v[46:47], v[46:47], v[242:243], v[118:119] op_sel:[0,1,0] op_sel_hi:[1,1,1]
    v_pk_fma_f32 v[228:229], v[228:229], s[56:57], s[56:57] op_sel:[0,1,1] op_sel_hi:[1,1,1]
    v_exp_f32 v233, v233
    v_pk_fma_f32 v[236:237], v[44:45], v[44:45], s[56:57] op_sel_hi:[1,1,0]
    v_rcp_f32 v226, v226
    v_pk_mul_f32 v[234:235], v[234:235], v[30:31] neg_lo:[1,0] neg_hi:[1,0]
    v_pk_mul_f32 v[222:223], v[222:223], v[38:39]
    v_rcp_f32 v227, v227
    v_cvt_pk_bf16_f32 v214, v220, v221
    buffer_load_dwordx4 a[176:179], v5, s[44:47], s91 offen sc1
    v_exp_f32 v234, v234
    v_pk_fma_f32 v[56:57], v[56:57], v[242:243], v[120:121] op_sel:[0,0,0] op_sel_hi:[1,0,1]
    v_pk_fma_f32 v[230:231], v[230:231], s[56:57], s[56:57] op_sel:[0,1,1] op_sel_hi:[1,1,1]
    v_exp_f32 v235, v235
    v_pk_fma_f32 v[238:239], v[46:47], v[46:47], s[56:57] op_sel_hi:[1,1,0]
    v_rcp_f32 v228, v228
    v_pk_mul_f32 v[236:237], v[236:237], v[44:45] neg_lo:[1,0] neg_hi:[1,0]
    v_pk_mul_f32 v[224:225], v[224:225], v[24:25]
    v_rcp_f32 v229, v229
    v_cvt_pk_bf16_f32 v215, v222, v223
    s_cmp_lg_u32 s10, 0
    s_cbranch_scc1 L_alt_g1ah00
    buffer_store_dwordx4 v[208:211], v2, s[28:31], s55 offen offset:0
    buffer_store_dwordx4 v[212:215], v2, s[28:31], s55 offen offset:1024
L_ret_g1ah00:
    v_exp_f32 v236, v236
    v_pk_fma_f32 v[58:59], v[58:59], v[242:243], v[122:123] op_sel:[0,0,0] op_sel_hi:[1,0,1]
    v_pk_fma_f32 v[232:233], v[232:233], s[56:57], s[56:57] op_sel:[0,1,1] op_sel_hi:[1,1,1]
    buffer_load_dwordx4 a[180:183], v6, s[44:47], s91 offen sc1
    v_exp_f32 v237, v237
    v_pk_fma_f32 v[208:209], v[56:57], v[56:57], s[56:57] op_sel_hi:[1,1,0]
    v_rcp_f32 v230, v230
    v_pk_mul_f32 v[238:239], v[238:239], v[46:47] neg_lo:[1,0] neg_hi:[1,0]
    v_pk_mul_f32 v[226:227], v[226:227], v[26:27]
    v_rcp_f32 v231, v231
    v_cvt_pk_bf16_f32 v224, v224, v225
    v_exp_f32 v238, v238
    v_pk_fma_f32 v[72:73], v[72:73], v[242:243], v[124:125] op_sel:[0,0,0] op_sel_hi:[1,0,1]
    v_pk_fma_f32 v[234:235], v[234:235], s[56:57], s[56:57] op_sel:[0,1,1] op_sel_hi:[1,1,1]
    v_exp_f32 v239, v239
    v_pk_fma_f32 v[210:211], v[58:59], v[58:59], s[56:57] op_sel_hi:[1,1,0]
    v_rcp_f32 v232, v232
    v_pk_mul_f32 v[208:209], v[208:209], v[56:57] neg_lo:[1,0] neg_hi:[1,0]
    v_pk_mul_f32 v[228:229], v[228:229], v[40:41]
    buffer_load_dwordx4 a[184:187], v7, s[44:47], s91 offen sc1
    v_rcp_f32 v233, v233
    v_cvt_pk_bf16_f32 v225, v226, v227
    v_and_b32 v224, -2, v224
    v_exp_f32 v208, v208
    v_pk_fma_f32 v[74:75], v[74:75], v[242:243], v[126:127] op_sel:[0,0,0] op_sel_hi:[1,0,1]
    v_pk_fma_f32 v[236:237], v[236:237], s[56:57], s[56:57] op_sel:[0,1,1] op_sel_hi:[1,1,1]
    v_exp_f32 v209, v209
    v_pk_fma_f32 v[212:213], v[72:73], v[72:73], s[56:57] op_sel_hi:[1,1,0]
    v_rcp_f32 v234, v234
    v_pk_mul_f32 v[210:211], v[210:211], v[58:59] neg_lo:[1,0] neg_hi:[1,0]
    v_pk_mul_f32 v[230:231], v[230:231], v[42:43]
    v_rcp_f32 v235, v235
    v_cvt_pk_bf16_f32 v226, v228, v229
    v_exp_f32 v210, v210
    v_pk_fma_f32 v[60:61], v[60:61], v[242:243], v[120:121] op_sel:[0,1,0] op_sel_hi:[1,1,1]
    buffer_load_dwordx4 a[188:191], v8, s[44:47], s91 offen sc1
    v_pk_fma_f32 v[238:239], v[238:239], s[56:57], s[56:57] op_sel:[0,1,1] op_sel_hi:[1,1,1]
    v_exp_f32 v211, v211
    v_pk_fma_f32 v[214:215], v[74:75], v[74:75], s[56:57] op_sel_hi:[1,1,0]
    v_rcp_f32 v236, v236
    v_pk_mul_f32 v[212:213], v[212:213], v[72:73] neg_lo:[1,0] neg_hi:[1,0]
    v_pk_mul_f32 v[232:233], v[232:233], v[28:29]
    v_rcp_f32 v237, v237
    v_cvt_pk_bf16_f32 v227, v230, v231
    v_exp_f32 v212, v212
    v_pk_fma_f32 v[62:63], v[62:63], v[242:243], v[122:123] op_sel:[0,1,0] op_sel_hi:[1,1,1]
    v_pk_fma_f32 v[208:209], v[208:209], s[56:57], s[56:57] op_sel:[0,1,1] op_sel_hi:[1,1,1]
    v_exp_f32 v213, v213
    v_pk_fma_f32 v[216:217], v[60:61], v[60:61], s[56:57] op_sel_hi:[1,1,0]
    v_rcp_f32 v238, v238
    v_pk_mul_f32 v[214:215], v[214:215], v[74:75] neg_lo:[1,0] neg_hi:[1,0]
    buffer_load_dwordx4 a[192:195], v5, s[44:47], s92 offen sc1
    v_pk_mul_f32 v[234:235], v[234:235], v[30:31]
    v_rcp_f32 v239, v239
    v_cvt_pk_bf16_f32 v228, v232, v233
    v_exp_f32 v214, v214
    v_pk_fma_f32 v[76:77], v[76:77], v[242:243], v[124:125] op_sel:[0,1,0] op_sel_hi:[1,1,1]
    v_pk_fma_f32 v[210:211], v[210:211], s[56:57], s[56:57] op_sel:[0,1,1] op_sel_hi:[1,1,1]
    v_exp_f32 v215, v215
    v_pk_fma_f32 v[218:219], v[62:63], v[62:63], s[56:57] op_sel_hi:[1,1,0]
    v_rcp_f32 v208, v208
    v_pk_mul_f32 v[216:217], v[216:217], v[60:61] neg_lo:[1,0] neg_hi:[1,0]
    v_pk_mul_f32 v[236:237], v[236:237], v[44:45]
    v_rcp_f32 v209, v209
    v_cvt_pk_bf16_f32 v229, v234, v235
    v_and_b32 v228, -2, v228
    v_exp_f32 v216, v216
    buffer_load_dwordx4 a[196:199], v6, s[44:47], s92 offen sc1
    v_pk_fma_f32 v[78:79], v[78:79], v[242:243], v[126:127] op_sel:[0,1,0] op_sel_hi:[1,1,1]
    v_pk_fma_f32 v[212:213], v[212:213], s[56:57], s[56:57] op_sel:[0,1,1] op_sel_hi:[1,1,1]
    v_exp_f32 v217, v217
    v_pk_fma_f32 v[220:221], v[76:77], v[76:77], s[56:57] op_sel_hi:[1,1,0]
    buffer_load_dwordx4 a[200:203], v7, s[44:47], s92 offen sc1
    v_rcp_f32 v210, v210
    v_pk_mul_f32 v[218:219], v[218:219], v[62:63] neg_lo:[1,0] neg_hi:[1,0]
    v_pk_mul_f32 v[238:239], v[238:239], v[46:47]
    v_rcp_f32 v211, v211
    v_cvt_pk_bf16_f32 v230, v236, v237
    buffer_load_dwordx4 a[204:207], v8, s[44:47], s92 offen sc1
    v_exp_f32 v218, v218
    v_pk_fma_f32 v[128:129], v[48:49], v[240:241], v[120:121] op_sel:[0,0,0] op_sel_hi:[1,0,1]
    v_pk_fma_f32 v[214:215], v[214:215], s[56:57], s[56:57] op_sel:[0,1,1] op_sel_hi:[1,1,1]
    v_exp_f32 v219, v219
    v_pk_fma_f32 v[222:223], v[78:79], v[78:79], s[56:57] op_sel_hi:[1,1,0]
    buffer_load_dwordx4 a[208:211], v5, s[44:47], s93 offen sc1
    v_rcp_f32 v212, v212
    v_pk_mul_f32 v[220:221], v[220:221], v[76:77] neg_lo:[1,0] neg_hi:[1,0]
    v_pk_mul_f32 v[208:209], v[208:209], v[56:57]
    v_rcp_f32 v213, v213
    v_cvt_pk_bf16_f32 v231, v238, v239
    buffer_load_dwordx4 a[212:215], v6, s[44:47], s93 offen sc1
    s_cmp_lg_u32 s10, 0
    s_cbranch_scc1 L_alt_g1ah01
    buffer_store_dwordx4 v[224:227], v2, s[28:31], s55 offen offset:2048
    buffer_store_dwordx4 v[228:231], v2, s[28:31], s55 offen offset:3072
L_ret_g1ah01:
    v_exp_f32 v220, v220
    v_pk_fma_f32 v[130:131], v[50:51], v[240:241], v[122:123] op_sel:[0,0,0] op_sel_hi:[1,0,1]
    v_pk_fma_f32 v[216:217], v[216:217], s[56:57], s[56:57] op_sel:[0,1,1] op_sel_hi:[1,1,1]
    v_exp_f32 v221, v221
    buffer_load_dwordx4 a[216:219], v7, s[44:47], s93 offen sc1
    v_pk_fma_f32 v[224:225], v[128:129], v[128:129], s[56:57] op_sel_hi:[1,1,0]
    v_rcp_f32 v214, v214
    v_pk_mul_f32 v[222:223], v[222:223], v[78:79] neg_lo:[1,0] neg_hi:[1,0]
    v_pk_mul_f32 v[210:211], v[210:211], v[58:59]
    v_rcp_f32 v215, v215
    buffer_load_dwordx4 a[220:223], v8, s[44:47], s93 offen sc1
    v_cvt_pk_bf16_f32 v208, v208, v209
    v_exp_f32 v222, v222
    v_pk_fma_f32 v[132:133], v[64:65], v[240:241], v[124:125] op_sel:[0,0,0] op_sel_hi:[1,0,1]
    v_pk_fma_f32 v[218:219], v[218:219], s[56:57], s[56:57] op_sel:[0,1,1] op_sel_hi:[1,1,1]
    s_cmp_lg_u32 s10, 0
    s_cbranch_scc1 L_far_hc
L_near_hc:
    v_exp_f32 v223, v223
    v_pk_fma_f32 v[226:227], v[130:131], v[130:131], s[56:57] op_sel_hi:[1,1,0]
    v_rcp_f32 v216, v216
    v_pk_mul_f32 v[224:225], v[224:225], v[128:129] neg_lo:[1,0] neg_hi:[1,0]
    v_pk_mul_f32 v[212:213], v[212:213], v[72:73]
    buffer_load_dwordx4 v[144:147], v2, s[40:43], s80 offen offset:0 sc1
    v_rcp_f32 v217, v217
    v_cvt_pk_bf16_f32 v209, v210, v211
    v_and_b32 v208, -2, v208
    v_exp_f32 v224, v224
    v_pk_fma_f32 v[134:135], v[66:67], v[240:241], v[126:127] op_sel:[0,0,0] op_sel_hi:[1,0,1]
    buffer_load_dwordx4 v[148:151], v2, s[40:43], s80 offen offset:1024 sc1
    v_pk_fma_f32 v[220:221], v[220:221], s[56:57], s[56:57] op_sel:[0,1,1] op_sel_hi:[1,1,1]
    v_exp_f32 v225, v225
    v_pk_fma_f32 v[228:229], v[132:133], v[132:133], s[56:57] op_sel_hi:[1,1,0]
    v_rcp_f32 v218, v218
    v_pk_mul_f32 v[226:227], v[226:227], v[130:131] neg_lo:[1,0] neg_hi:[1,0]
    buffer_load_dwordx4 v[152:155], v2, s[40:43], s81 offen offset:0 sc1
    v_pk_mul_f32 v[214:215], v[214:215], v[74:75]
    v_rcp_f32 v219, v219
    v_cvt_pk_bf16_f32 v210, v212, v213
    v_exp_f32 v226, v226
    v_pk_fma_f32 v[136:137], v[52:53], v[240:241], v[120:121] op_sel:[0,1,0] op_sel_hi:[1,1,1]
    buffer_load_dwordx4 v[156:159], v2, s[40:43], s81 offen offset:1024 sc1
    v_pk_fma_f32 v[222:223], v[222:223], s[56:57], s[56:57] op_sel:[0,1,1] op_sel_hi:[1,1,1]
    v_exp_f32 v227, v227
    v_pk_fma_f32 v[230:231], v[134:135], v[134:135], s[56:57] op_sel_hi:[1,1,0]
    v_rcp_f32 v220, v220
    v_pk_mul_f32 v[228:229], v[228:229], v[132:133] neg_lo:[1,0] neg_hi:[1,0]
    buffer_load_dwordx4 v[160:163], v2, s[40:43], s82 offen offset:0 sc1
    v_pk_mul_f32 v[216:217], v[216:217], v[60:61]
    v_rcp_f32 v221, v221
    v_cvt_pk_bf16_f32 v211, v214, v215
    v_exp_f32 v228, v228
    v_pk_fma_f32 v[138:139], v[54:55], v[240:241], v[122:123] op_sel:[0,1,0] op_sel_hi:[1,1,1]
    buffer_load_dwordx4 v[164:167], v2, s[40:43], s82 offen offset:1024 sc1
    v_exp_f32 v229, v229
    v_pk_fma_f32 v[232:233], v[136:137], v[136:137], s[56:57] op_sel_hi:[1,1,0]
    v_rcp_f32 v222, v222
    v_pk_mul_f32 v[230:231], v[230:231], v[134:135] neg_lo:[1,0] neg_hi:[1,0]
    buffer_load_dwordx4 v[168:171], v2, s[40:43], s83 offen offset:0 sc1
    v_pk_mul_f32 v[218:219], v[218:219], v[62:63]
    v_rcp_f32 v223, v223
    v_cvt_pk_bf16_f32 v212, v216, v217
    v_exp_f32 v230, v230
    v_pk_fma_f32 v[140:141], v[68:69], v[240:241], v[124:125] op_sel:[0,1,0] op_sel_hi:[1,1,1]
    buffer_load_dwordx4 v[172:175], v2, s[40:43], s83 offen offset:1024 sc1
    v_exp_f32 v231, v231
    v_pk_fma_f32 v[234:235], v[138:139], v[138:139], s[56:57] op_sel_hi:[1,1,0]
    v_pk_mul_f32 v[232:233], v[232:233], v[136:137] neg_lo:[1,0] neg_hi:[1,0]
    v_pk_mul_f32 v[220:221], v[220:221], v[76:77]
    v_cvt_pk_bf16_f32 v213, v218, v219
    buffer_load_dwordx4 v[176:179], v2, s[40:43], s84 offen offset:0 sc1
    v_and_b32 v212, -2, v212
    v_exp_f32 v232, v232
    v_pk_fma_f32 v[142:143], v[70:71], v[240:241], v[126:127] op_sel:[0,1,0] op_sel_hi:[1,1,1]
    v_exp_f32 v233, v233
    v_pk_fma_f32 v[236:237], v[140:141], v[140:141], s[56:57] op_sel_hi:[1,1,0]
    buffer_load_dwordx4 v[180:183], v2, s[40:43], s84 offen offset:1024 sc1
    v_pk_mul_f32 v[234:235], v[234:235], v[138:139] neg_lo:[1,0] neg_hi:[1,0]
    v_pk_mul_f32 v[222:223], v[222:223], v[78:79]
    v_cvt_pk_bf16_f32 v214, v220, v221
    v_exp_f32 v234, v234
    v_exp_f32 v235, v235
    buffer_load_dwordx4 v[184:187], v2, s[40:43], s85 offen offset:0 sc1
    v_pk_fma_f32 v[238:239], v[142:143], v[142:143], s[56:57] op_sel_hi:[1,1,0]
    v_pk_mul_f32 v[236:237], v[236:237], v[140:141] neg_lo:[1,0] neg_hi:[1,0]
    v_cvt_pk_bf16_f32 v215, v222, v223
    s_cmp_lg_u32 s10, 0
    s_cbranch_scc1 L_alt_g1ah11
    buffer_store_dwordx4 v[208:211], v2, s[28:31], s59 offen offset:2048
    buffer_store_dwordx4 v[212:215], v2, s[28:31], s59 offen offset:3072
L_ret_g1ah11:
    v_exp_f32 v236, v236
    buffer_load_dwordx4 v[188:191], v2, s[40:43], s85 offen offset:1024 sc1
    v_exp_f32 v237, v237
    v_pk_mul_f32 v[238:239], v[238:239], v[142:143] neg_lo:[1,0] neg_hi:[1,0]
    v_exp_f32 v238, v238
    v_exp_f32 v239, v239
    s_waitcnt vmcnt(10)
    v_max3_u32 v9, v156, v148, v152
    v_max_u32 v9, v9, v144
    v_cmp_eq_u32 vcc, -1, v9
    s_cbranch_vccnz L_slow_g2a_0
L_back_g2a_0:
    v_mfma_f32_16x16x32_bf16 v[16:19], a[0:3], v[144:147], 0
    buffer_load_dwordx4 v[192:195], v2, s[40:43], s86 offen offset:0 sc1
    v_fma_f32 v224, v224, s57, s57
    v_mfma_f32_16x16x32_bf16 v[20:23], a[0:3], v[148:151], 0
    v_fma_f32 v225, v225, s57, s57
    v_fma_f32 v226, v226, s57, s57
    v_mfma_f32_16x16x32_bf16 v[32:35], a[4:7], v[144:147], 0
    buffer_load_dwordx4 v[196:199], v2, s[40:43], s86 offen offset:1024 sc1
    v_fma_f32 v227, v227, s57, s57
    v_mfma_f32_16x16x32_bf16 v[36:39], a[4:7], v[148:151], 0
    s_add_u32 s58, s11, 0
    v_rcp_f32 v224, v224
    v_mfma_f32_16x16x32_bf16 v[48:51], a[8:11], v[144:147], 0
    buffer_load_dwordx4 v[200:203], v2, s[40:43], s80 offen offset:2048 sc1
    v_fma_f32 v228, v228, s57, s57
    v_mfma_f32_16x16x32_bf16 v[52:55], a[8:11], v[148:151], 0
    v_rcp_f32 v225, v225
    v_mfma_f32_16x16x32_bf16 v[64:67], a[12:15], v[144:147], 0
    buffer_load_dwordx4 v[204:207], v2, s[40:43], s80 offen offset:3072 sc1
    v_fma_f32 v229, v229, s57, s57
    v_mfma_f32_16x16x32_bf16 v[68:71], a[12:15], v[148:151], 0
    buffer_load_dwordx4 v[112:115], v251, s[28:31], s58 offen offset:0 sc1
    v_fma_f32 v230, v230, s57, s57
    v_mfma_f32_16x16x32_bf16 v[16:19], a[16:19], v[152:155], v[16:19]
    buffer_load_dwordx4 v[80:83], v2, s[40:43], s81 offen offset:2048 sc1
    v_fma_f32 v231, v231, s57, s57
    v_mfma_f32_16x16x32_bf16 v[20:23], a[16:19], v[156:159], v[20:23]
    v_rcp_f32 v226, v226
    v_mfma_f32_16x16x32_bf16 v[32:35], a[20:23], v[152:155], v[32:35]
    buffer_load_dwordx4 v[84:87], v2, s[40:43], s81 offen offset:3072 sc1
    v_mul_f32 v224, v224, v128
    v_mfma_f32_16x16x32_bf16 v[36:39], a[20:23], v[156:159], v[36:39]
    buffer_load_dwordx4 v[116:119], v251, s[28:31], s58 offen offset:256 sc1
    v_mul_f32 v225, v225, v129
    v_mfma_f32_16x16x32_bf16 v[48:51], a[24:27], v[152:155], v[48:51]
    s_waitcnt vmcnt(14)
    v_max3_u32 v9, v172, v164, v168
    v_max_u32 v9, v9, v160
    v_mfma_f32_16x16x32_bf16 v[52:55], a[24:27], v[156:159], v[52:55]
    v_cmp_eq_u32 vcc, -1, v9
    buffer_load_dwordx4 v[88:91], v2, s[40:43], s82 offen offset:2048 sc1
    v_mfma_f32_16x16x32_bf16 v[64:67], a[28:31], v[152:155], v[64:67]
    buffer_load_dwordx4 v[92:95], v2, s[40:43], s82 offen offset:3072 sc1
    v_fma_f32 v232, v232, s57, s57
    v_mfma_f32_16x16x32_bf16 v[68:71], a[28:31], v[156:159], v[68:71]
    s_cbranch_vccnz L_slow_g2a_1
L_back_g2a_1:
    v_mfma_f32_16x16x32_bf16 v[16:19], a[32:35], v[160:163], v[16:19]
    v_rcp_f32 v227, v227
    v_mfma_f32_16x16x32_bf16 v[20:23], a[32:35], v[164:167], v[20:23]
    buffer_load_dwordx4 v[96:99], v2, s[40:43], s83 offen offset:2048 sc1
    v_fma_f32 v233, v233, s57, s57
    v_mfma_f32_16x16x32_bf16 v[32:35], a[36:39], v[160:163], v[32:35]
    v_rcp_f32 v228, v228
    v_mfma_f32_16x16x32_bf16 v[36:39], a[36:39], v[164:167], v[36:39]
    v_rcp_f32 v229, v229
    v_mfma_f32_16x16x32_bf16 v[48:51], a[40:43], v[160:163], v[48:51]
    v_rcp_f32 v230, v230
    v_mfma_f32_16x16x32_bf16 v[52:55], a[40:43], v[164:167], v[52:55]
    buffer_load_dwordx4 v[100:103], v2, s[40:43], s83 offen offset:3072 sc1
    v_mul_f32 v226, v226, v130
    v_mfma_f32_16x16x32_bf16 v[64:67], a[44:47], v[160:163], v[64:67]
    v_rcp_f32 v231, v231
    v_mfma_f32_16x16x32_bf16 v[68:71], a[44:47], v[164:167], v[68:71]
    v_rcp_f32 v232, v232
    v_mfma_f32_16x16x32_bf16 v[16:19], a[48:51], v[168:171], v[16:19]
    v_mul_f32 v227, v227, v131
    v_fma_f32 v234, v234, s57, s57
    v_mfma_f32_16x16x32_bf16 v[20:23], a[48:51], v[172:175], v[20:23]
    buffer_load_dwordx4 v[104:107], v2, s[40:43], s84 offen offset:2048 sc1
    v_fma_f32 v235, v235, s57, s57
    v_mfma_f32_16x16x32_bf16 v[32:35], a[52:55], v[168:171], v[32:35]
    v_rcp_f32 v233, v233
    v_mfma_f32_16x16x32_bf16 v[36:39], a[52:55], v[172:175], v[36:39]
    v_rcp_f32 v234, v234
    v_mfma_f32_16x16x32_bf16 v[48:51], a[56:59], v[168:171], v[48:51]
    s_waitcnt vmcnt(13)
    v_max3_u32 v9, v188, v180, v184
    v_max_u32 v9, v9, v176
    v_mfma_f32_16x16x32_bf16 v[52:55], a[56:59], v[172:175], v[52:55]
    v_cmp_eq_u32 vcc, -1, v9
    buffer_load_dwordx4 v[108:111], v2, s[40:43], s84 offen offset:3072 sc1
    v_mfma_f32_16x16x32_bf16 v[64:67], a[60:63], v[168:171], v[64:67]
    v_mul_f32 v228, v228, v132
    v_mul_f32 v229, v229, v133
    v_mfma_f32_16x16x32_bf16 v[68:71], a[60:63], v[172:175], v[68:71]
    s_cbranch_vccnz L_slow_g2a_2
L_back_g2a_2:
    v_mfma_f32_16x16x32_bf16 v[16:19], a[64:67], v[176:179], v[16:19]
    v_fma_f32 v236, v236, s57, s57
    v_fma_f32 v237, v237, s57, s57
    v_mfma_f32_16x16x32_bf16 v[20:23], a[64:67], v[180:183], v[20:23]
    buffer_load_dwordx4 v[144:147], v2, s[40:43], s85 offen offset:2048 sc1
    v_cvt_pk_bf16_f32 v224, v224, v225
    v_mfma_f32_16x16x32_bf16 v[32:35], a[68:71], v[176:179], v[32:35]
    s_mov_b32 s79, 14454784
    buffer_load_dwordx2 v[252:253], v254, s[28:31], s79 offen sc1
    v_mul_f32 v230, v230, v134
    v_mfma_f32_16x16x32_bf16 v[36:39], a[68:71], v[180:183], v[36:39]
    v_rcp_f32 v235, v235
    v_mfma_f32_16x16x32_bf16 v[48:51], a[72:75], v[176:179], v[48:51]
    v_rcp_f32 v236, v236
    v_mfma_f32_16x16x32_bf16 v[52:55], a[72:75], v[180:183], v[52:55]
    buffer_load_dwordx4 v[148:151], v2, s[40:43], s85 offen offset:3072 sc1
    v_mul_f32 v231, v231, v135
    v_mfma_f32_16x16x32_bf16 v[64:67], a[76:79], v[176:179], v[64:67]
    v_fma_f32 v238, v238, s57, s57
    v_fma_f32 v239, v239, s57, s57
    v_mfma_f32_16x16x32_bf16 v[68:71], a[76:79], v[180:183], v[68:71]
    v_rcp_f32 v237, v237
    v_mfma_f32_16x16x32_bf16 v[16:19], a[80:83], v[184:187], v[16:19]
    v_rcp_f32 v238, v238
    v_mfma_f32_16x16x32_bf16 v[20:23], a[80:83], v[188:191], v[20:23]
    buffer_load_dwordx4 v[152:155], v2, s[40:43], s86 offen offset:2048 sc1
    v_cvt_pk_bf16_f32 v225, v226, v227
    v_mfma_f32_16x16x32_bf16 v[32:35], a[84:87], v[184:187], v[32:35]
    v_mul_f32 v232, v232, v136
    v_mul_f32 v233, v233, v137
    v_mfma_f32_16x16x32_bf16 v[36:39], a[84:87], v[188:191], v[36:39]
    v_cvt_pk_bf16_f32 v226, v228, v229
    v_mul_f32 v234, v234, v138
    v_mfma_f32_16x16x32_bf16 v[48:51], a[88:91], v[184:187], v[48:51]
    s_waitcnt vmcnt(14)
    v_max3_u32 v9, v204, v196, v200
    v_max_u32 v9, v9, v192
    v_mfma_f32_16x16x32_bf16 v[52:55], a[88:91], v[188:191], v[52:55]
    v_cmp_eq_u32 vcc, -1, v9
    buffer_load_dwordx4 v[156:159], v2, s[40:43], s86 offen offset:3072 sc1
    v_mfma_f32_16x16x32_bf16 v[64:67], a[92:95], v[184:187], v[64:67]
    s_waitcnt vmcnt(14)
    v_lshlrev_b32 v216, 16, v114
    v_and_b32 v217, 0xffff0000, v114
    v_mfma_f32_16x16x32_bf16 v[68:71], a[92:95], v[188:191], v[68:71]
    s_cbranch_vccnz L_slow_g2a_3
L_back_g2a_3:
    v_mfma_f32_16x16x32_bf16 v[16:19], a[96:99], v[192:195], v[16:19]
    s_waitcnt vmcnt(11)
    v_lshlrev_b32 v218, 16, v118
    v_and_b32 v219, 0xffff0000, v118
    v_mfma_f32_16x16x32_bf16 v[20:23], a[96:99], v[196:199], v[20:23]
    buffer_load_dwordx4 v[160:163], v2, s[40:43], s87 offen offset:2048 sc1
    v_lshlrev_b32 v220, 16, v115
    v_mfma_f32_16x16x32_bf16 v[32:35], a[100:103], v[192:195], v[32:35]
    v_and_b32 v221, 0xffff0000, v115
    v_lshlrev_b32 v222, 16, v119
    v_mfma_f32_16x16x32_bf16 v[36:39], a[100:103], v[196:199], v[36:39]
    v_and_b32 v223, 0xffff0000, v119
    v_mul_f32 v235, v235, v139
    v_mfma_f32_16x16x32_bf16 v[48:51], a[104:107], v[192:195], v[48:51]
    v_rcp_f32 v239, v239
    v_mfma_f32_16x16x32_bf16 v[52:55], a[104:107], v[196:199], v[52:55]
    buffer_load_dwordx4 v[164:167], v2, s[40:43], s87 offen offset:3072 sc1
    v_cvt_pk_bf16_f32 v227, v230, v231
    v_mfma_f32_16x16x32_bf16 v[64:67], a[108:111], v[192:195], v[64:67]
    v_and_b32 v224, -2, v224
    v_mul_f32 v236, v236, v140
    v_mfma_f32_16x16x32_bf16 v[68:71], a[108:111], v[196:199], v[68:71]
    v_mul_f32 v237, v237, v141
    v_cvt_pk_bf16_f32 v228, v232, v233
    v_mfma_f32_16x16x32_bf16 v[24:27], a[0:3], v[200:203], v[216:219]
    v_mul_f32 v238, v238, v142
    v_mul_f32 v239, v239, v143
    v_mfma_f32_16x16x32_bf16 v[28:31], a[0:3], v[204:207], v[220:223]
    buffer_load_dwordx4 v[168:171], v2, s[40:43], s88 offen offset:2048 sc1
    v_cvt_pk_bf16_f32 v229, v234, v235
    v_mfma_f32_16x16x32_bf16 v[40:43], a[4:7], v[200:203], 0
    v_cvt_pk_bf16_f32 v230, v236, v237
    v_and_b32 v228, -2, v228
    v_mfma_f32_16x16x32_bf16 v[44:47], a[4:7], v[204:207], 0
    v_cvt_pk_bf16_f32 v231, v238, v239
    v_mfma_f32_16x16x32_bf16 v[56:59], a[8:11], v[200:203], 0
    s_waitcnt vmcnt(12)
    v_max3_u32 v9, v92, v84, v88
    v_max_u32 v9, v9, v80
    v_mfma_f32_16x16x32_bf16 v[60:63], a[8:11], v[204:207], 0
    v_cmp_eq_u32 vcc, -1, v9
    buffer_load_dwordx4 v[172:175], v2, s[40:43], s88 offen offset:3072 sc1
    v_mfma_f32_16x16x32_bf16 v[72:75], a[12:15], v[200:203], 0
    s_cmp_lg_u32 s10, 0
    s_cbranch_scc1 L_alt_g1ah10
    buffer_store_dwordx4 v[224:227], v2, s[28:31], s59 offen offset:0
    buffer_store_dwordx4 v[228:231], v2, s[28:31], s59 offen offset:1024
L_ret_g1ah10:
    v_mfma_f32_16x16x32_bf16 v[76:79], a[12:15], v[204:207], 0
    s_cbranch_vccnz L_slow_g2a_4
L_back_g2a_4:
    v_mfma_f32_16x16x32_bf16 v[24:27], a[16:19], v[80:83], v[24:27]
    v_lshlrev_b32 v208, 16, v112
    v_and_b32 v209, 0xffff0000, v112
    v_mfma_f32_16x16x32_bf16 v[28:31], a[16:19], v[84:87], v[28:31]
    buffer_load_dwordx4 v[176:179], v2, s[40:43], s89 offen offset:2048 sc1
    v_lshlrev_b32 v210, 16, v116
    v_mfma_f32_16x16x32_bf16 v[40:43], a[20:23], v[80:83], v[40:43]
    v_and_b32 v211, 0xffff0000, v116
    v_lshlrev_b32 v212, 16, v113
    v_mfma_f32_16x16x32_bf16 v[44:47], a[20:23], v[84:87], v[44:47]
    v_and_b32 v213, 0xffff0000, v113
    v_lshlrev_b32 v214, 16, v117
    v_mfma_f32_16x16x32_bf16 v[56:59], a[24:27], v[80:83], v[56:59]
    v_and_b32 v215, 0xffff0000, v117
    v_add_f32 v16, v16, v208
    v_mfma_f32_16x16x32_bf16 v[60:63], a[24:27], v[84:87], v[60:63]
    buffer_load_dwordx4 v[180:183], v2, s[40:43], s89 offen offset:3072 sc1
    v_add_f32 v17, v17, v209
    v_mfma_f32_16x16x32_bf16 v[72:75], a[28:31], v[80:83], v[72:75]
    s_waitcnt vmcnt(11)
    v_cmp_ne_u64 s[98:99], s[12:13], v[252:253]
    v_add_f32 v18, v18, v210
    v_mfma_f32_16x16x32_bf16 v[76:79], a[28:31], v[84:87], v[76:79]
    v_add_f32 v19, v19, v211
    v_add_f32 v20, v20, v212
    v_mfma_f32_16x16x32_bf16 v[24:27], a[32:35], v[88:91], v[24:27]
    s_cmp_lg_u64 s[98:99], 0
    s_cbranch_scc1 L_slow_ha
L_back_ha:
    v_mfma_f32_16x16x32_bf16 v[28:31], a[32:35], v[92:95], v[28:31]
    buffer_load_dwordx4 v[184:187], v2, s[40:43], s90 offen offset:2048 sc1
    v_add_f32 v21, v21, v213
    v_mfma_f32_16x16x32_bf16 v[40:43], a[36:39], v[88:91], v[40:43]
    s_lshl_b32 s53, s3, 6
    s_add_u32 s53, s53, 14352384
    v_lshlrev_b32 v15, 4, v4
    buffer_load_dwordx4 v[120:123], v15, s[28:31], s53 offen sc1
    v_mfma_f32_16x16x32_bf16 v[44:47], a[36:39], v[92:95], v[44:47]
    v_add_f32 v22, v22, v214
    v_add_f32 v23, v23, v215
    v_mfma_f32_16x16x32_bf16 v[56:59], a[40:43], v[88:91], v[56:59]
    v_max3_u32 v9, v108, v100, v104
    v_max_u32 v9, v9, v96
    v_mfma_f32_16x16x32_bf16 v[60:63], a[40:43], v[92:95], v[60:63]
    v_cmp_eq_u32 vcc, -1, v9
    buffer_load_dwordx4 v[188:191], v2, s[40:43], s90 offen offset:3072 sc1
    v_mfma_f32_16x16x32_bf16 v[72:75], a[44:47], v[88:91], v[72:75]
    v_mfma_f32_16x16x32_bf16 v[76:79], a[44:47], v[92:95], v[76:79]
    s_cbranch_vccnz L_slow_g2a_5
L_back_g2a_5:
    v_mfma_f32_16x16x32_bf16 v[24:27], a[48:51], v[96:99], v[24:27]
    v_mfma_f32_16x16x32_bf16 v[28:31], a[48:51], v[100:103], v[28:31]
    buffer_load_dwordx4 v[192:195], v2, s[40:43], s91 offen offset:2048 sc1
    v_mfma_f32_16x16x32_bf16 v[40:43], a[52:55], v[96:99], v[40:43]
    v_mfma_f32_16x16x32_bf16 v[44:47], a[52:55], v[100:103], v[44:47]
    v_mfma_f32_16x16x32_bf16 v[56:59], a[56:59], v[96:99], v[56:59]
    v_mfma_f32_16x16x32_bf16 v[60:63], a[56:59], v[100:103], v[60:63]
    buffer_load_dwordx4 v[196:199], v2, s[40:43], s91 offen offset:3072 sc1
    v_mfma_f32_16x16x32_bf16 v[72:75], a[60:63], v[96:99], v[72:75]
    v_mfma_f32_16x16x32_bf16 v[76:79], a[60:63], v[100:103], v[76:79]
    v_mfma_f32_16x16x32_bf16 v[24:27], a[64:67], v[104:107], v[24:27]
    v_mfma_f32_16x16x32_bf16 v[28:31], a[64:67], v[108:111], v[28:31]
    buffer_load_dwordx4 v[200:203], v2, s[40:43], s92 offen offset:2048 sc1
    v_mfma_f32_16x16x32_bf16 v[40:43], a[68:71], v[104:107], v[40:43]
    v_mfma_f32_16x16x32_bf16 v[44:47], a[68:71], v[108:111], v[44:47]
    v_mfma_f32_16x16x32_bf16 v[56:59], a[72:75], v[104:107], v[56:59]
    s_waitcnt vmcnt(14)
    v_max3_u32 v9, v156, v148, v152
    v_max_u32 v9, v9, v144
    v_mfma_f32_16x16x32_bf16 v[60:63], a[72:75], v[108:111], v[60:63]
    v_cmp_eq_u32 vcc, -1, v9
    buffer_load_dwordx4 v[204:207], v2, s[40:43], s92 offen offset:3072 sc1
    v_mfma_f32_16x16x32_bf16 v[72:75], a[76:79], v[104:107], v[72:75]
    v_mfma_f32_16x16x32_bf16 v[76:79], a[76:79], v[108:111], v[76:79]
    s_cbranch_vccnz L_slow_g2a_6
L_back_g2a_6:
    v_mfma_f32_16x16x32_bf16 v[24:27], a[80:83], v[144:147], v[24:27]
    v_or_b32 v13, s3, v4
    v_cmp_eq_u32 s[56:57], 0, v13
    v_mfma_f32_16x16x32_bf16 v[28:31], a[80:83], v[148:151], v[28:31]
    buffer_load_dwordx4 v[80:83], v2, s[40:43], s93 offen offset:2048 sc1
    v_mul_u32_u24 v13, 65, v4
    v_mfma_f32_16x16x32_bf16 v[40:43], a[84:87], v[144:147], v[40:43]
    v_and_b32 v13, 0x81, v13
    v_lshl_add_u32 v13, v13, 3, v250
    s_lshl3_add_u32 s55, s50, s52
    v_mfma_f32_16x16x32_bf16 v[44:47], a[84:87], v[148:151], v[44:47]
    s_lshl_b32 s55, s55, 8
    s_add_u32 s55, s55, 5734400
    v_lshl_add_u32 v14, v1, 2, v2
    v_mfma_f32_16x16x32_bf16 v[56:59], a[88:91], v[144:147], v[56:59]
    v_add_u32 v14, 161792, v14
    v_mfma_f32_16x16x32_bf16 v[60:63], a[88:91], v[148:151], v[60:63]
    buffer_load_dwordx4 v[84:87], v2, s[40:43], s93 offen offset:3072 sc1
    v_mfma_f32_16x16x32_bf16 v[72:75], a[92:95], v[144:147], v[72:75]
    v_mfma_f32_16x16x32_bf16 v[76:79], a[92:95], v[148:151], v[76:79]
    v_mfma_f32_16x16x32_bf16 v[24:27], a[96:99], v[152:155], v[24:27]
    v_mfma_f32_16x16x32_bf16 v[28:31], a[96:99], v[156:159], v[28:31]
    buffer_load_dwordx4 v[88:91], v2, s[40:43], s87 offen offset:0 sc1
    v_mfma_f32_16x16x32_bf16 v[40:43], a[100:103], v[152:155], v[40:43]
    v_mfma_f32_16x16x32_bf16 v[44:47], a[100:103], v[156:159], v[44:47]
    v_mfma_f32_16x16x32_bf16 v[56:59], a[104:107], v[152:155], v[56:59]
    s_waitcnt vmcnt(14)
    v_max3_u32 v9, v172, v164, v168
    v_max_u32 v9, v9, v160
    v_mfma_f32_16x16x32_bf16 v[60:63], a[104:107], v[156:159], v[60:63]
    v_cmp_eq_u32 vcc, -1, v9
    buffer_load_dwordx4 v[92:95], v2, s[40:43], s87 offen offset:1024 sc1
    v_mfma_f32_16x16x32_bf16 v[72:75], a[108:111], v[152:155], v[72:75]
    v_mfma_f32_16x16x32_bf16 v[76:79], a[108:111], v[156:159], v[76:79]
    s_cbranch_vccnz L_slow_g2a_7
L_back_g2a_7:
    v_mfma_f32_16x16x32_bf16 v[24:27], a[112:115], v[160:163], v[24:27]
    v_and_b32 v5, 2, v1
    v_lshl_add_u32 v5, v5, 10, v2
    v_mfma_f32_16x16x32_bf16 v[28:31], a[112:115], v[164:167], v[28:31]
    buffer_load_dwordx4 v[96:99], v2, s[40:43], s88 offen offset:0 sc1
    v_xor_b32 v6, 2048, v5
    v_mfma_f32_16x16x32_bf16 v[40:43], a[116:119], v[160:163], v[40:43]
    v_and_b32 v7, 1, v1
    v_lshl_add_u32 v7, v7, 10, v2
    v_mfma_f32_16x16x32_bf16 v[44:47], a[116:119], v[164:167], v[44:47]
    v_xor_b32 v8, 1024, v7
    v_mfma_f32_16x16x32_bf16 v[56:59], a[120:123], v[160:163], v[56:59]
    v_mfma_f32_16x16x32_bf16 v[60:63], a[120:123], v[164:167], v[60:63]
    buffer_load_dwordx4 v[100:103], v2, s[40:43], s88 offen offset:1024 sc1
    v_mfma_f32_16x16x32_bf16 v[72:75], a[124:127], v[160:163], v[72:75]
    v_mfma_f32_16x16x32_bf16 v[76:79], a[124:127], v[164:167], v[76:79]
    v_mfma_f32_16x16x32_bf16 v[24:27], a[128:131], v[168:171], v[24:27]
    v_mfma_f32_16x16x32_bf16 v[28:31], a[128:131], v[172:175], v[28:31]
    buffer_load_dwordx4 v[104:107], v2, s[40:43], s89 offen offset:0 sc1
    v_mfma_f32_16x16x32_bf16 v[40:43], a[132:135], v[168:171], v[40:43]
    v_mfma_f32_16x16x32_bf16 v[44:47], a[132:135], v[172:175], v[44:47]
    v_mfma_f32_16x16x32_bf16 v[56:59], a[136:139], v[168:171], v[56:59]
    s_waitcnt vmcnt(11)
    v_max3_u32 v9, v188, v180, v184
    v_max_u32 v9, v9, v176
    v_mfma_f32_16x16x32_bf16 v[60:63], a[136:139], v[172:175], v[60:63]
    v_cmp_eq_u32 vcc, -1, v9
    buffer_load_dwordx4 v[108:111], v2, s[40:43], s89 offen offset:1024 sc1
    v_mfma_f32_16x16x32_bf16 v[72:75], a[140:143], v[168:171], v[72:75]
    v_mfma_f32_16x16x32_bf16 v[76:79], a[140:143], v[172:175], v[76:79]
    s_cbranch_vccnz L_slow_g2a_8
L_back_g2a_8:
    v_mfma_f32_16x16x32_bf16 v[24:27], a[144:147], v[176:179], v[24:27]
    v_mfma_f32_16x16x32_bf16 v[28:31], a[144:147], v[180:183], v[28:31]
    buffer_load_dwordx4 v[144:147], v2, s[40:43], s90 offen offset:0 sc1
    v_mfma_f32_16x16x32_bf16 v[40:43], a[148:151], v[176:179], v[40:43]
    s_mul_i32 s53, s49, 229376
    s_add_u32 s53, s53, 12746752
    s_add_u32 s44, s24, s53
    s_addc_u32 s45, s25, 0
    s_mov_b32 s46, 229376
    s_mov_b32 s47, 0x20000
    v_mfma_f32_16x16x32_bf16 v[44:47], a[148:151], v[180:183], v[44:47]
    v_mfma_f32_16x16x32_bf16 v[56:59], a[152:155], v[176:179], v[56:59]
    v_mfma_f32_16x16x32_bf16 v[60:63], a[152:155], v[180:183], v[60:63]
    buffer_load_dwordx4 v[148:151], v2, s[40:43], s90 offen offset:1024 sc1
    v_mfma_f32_16x16x32_bf16 v[72:75], a[156:159], v[176:179], v[72:75]
    v_mfma_f32_16x16x32_bf16 v[76:79], a[156:159], v[180:183], v[76:79]
    v_mfma_f32_16x16x32_bf16 v[24:27], a[160:163], v[184:187], v[24:27]
    v_mfma_f32_16x16x32_bf16 v[28:31], a[160:163], v[188:191], v[28:31]
    buffer_load_dwordx4 v[152:155], v2, s[40:43], s91 offen offset:0 sc1
    v_mfma_f32_16x16x32_bf16 v[40:43], a[164:167], v[184:187], v[40:43]
    v_mfma_f32_16x16x32_bf16 v[44:47], a[164:167], v[188:191], v[44:47]
    v_mfma_f32_16x16x32_bf16 v[56:59], a[168:171], v[184:187], v[56:59]
    s_waitcnt vmcnt(11)
    v_max3_u32 v9, v204, v196, v200
    v_max_u32 v9, v9, v192
    v_mfma_f32_16x16x32_bf16 v[60:63], a[168:171], v[188:191], v[60:63]
    v_cmp_eq_u32 vcc, -1, v9
    buffer_load_dwordx4 v[156:159], v2, s[40:43], s91 offen offset:1024 sc1
    v_mfma_f32_16x16x32_bf16 v[72:75], a[172:175], v[184:187], v[72:75]
    v_mfma_f32_16x16x32_bf16 v[76:79], a[172:175], v[188:191], v[76:79]
    s_cbranch_vccnz L_slow_g2a_9
L_back_g2a_9:
    v_mfma_f32_16x16x32_bf16 v[24:27], a[176:179], v[192:195], v[24:27]
    v_add_u32 v180, 57344, v2
    v_mul_u32_u24 v176, 12288, v1
    v_mfma_f32_16x16x32_bf16 v[28:31], a[176:179], v[196:199], v[28:31]
    buffer_load_dwordx4 v[160:163], v2, s[40:43], s92 offen offset:0 sc1
    v_add_u32 v176, v176, v180
    v_mfma_f32_16x16x32_bf16 v[40:43], a[180:183], v[192:195], v[40:43]
    v_xor_b32 v177, 1, v1
    v_mul_u32_u24 v177, 12288, v177
    v_mfma_f32_16x16x32_bf16 v[44:47], a[180:183], v[196:199], v[44:47]
    v_add_u32 v177, v177, v180
    v_xor_b32 v178, 2, v1
    v_mfma_f32_16x16x32_bf16 v[56:59], a[184:187], v[192:195], v[56:59]
    v_mul_u32_u24 v178, 12288, v178
    v_add_u32 v178, v178, v180
    v_mfma_f32_16x16x32_bf16 v[60:63], a[184:187], v[196:199], v[60:63]
    buffer_load_dwordx4 v[164:167], v2, s[40:43], s92 offen offset:1024 sc1
    v_xor_b32 v179, 3, v1
    v_mfma_f32_16x16x32_bf16 v[72:75], a[188:191], v[192:195], v[72:75]
    v_mul_u32_u24 v179, 12288, v179
    v_add_u32 v179, v179, v180
    v_mfma_f32_16x16x32_bf16 v[76:79], a[188:191], v[196:199], v[76:79]
    v_add_f32 v16, v16, v120
    v_add_f32 v17, v17, v121
    v_mfma_f32_16x16x32_bf16 v[24:27], a[192:195], v[200:203], v[24:27]
    v_add_f32 v18, v18, v122
    v_add_f32 v19, v19, v123
    v_mfma_f32_16x16x32_bf16 v[28:31], a[192:195], v[204:207], v[28:31]
    buffer_load_dwordx4 v[168:171], v2, s[40:43], s93 offen offset:0 sc1
    v_add_f32 v20, v20, v120
    v_mfma_f32_16x16x32_bf16 v[40:43], a[196:199], v[200:203], v[40:43]
    v_add_f32 v21, v21, v121
    v_add_f32 v22, v22, v122
    v_mfma_f32_16x16x32_bf16 v[44:47], a[196:199], v[204:207], v[44:47]
    v_add_f32 v23, v23, v123
    v_mfma_f32_16x16x32_bf16 v[56:59], a[200:203], v[200:203], v[56:59]
    s_waitcnt vmcnt(11)
    v_max3_u32 v9, v92, v84, v88
    v_max_u32 v9, v9, v80
    v_mfma_f32_16x16x32_bf16 v[60:63], a[200:203], v[204:207], v[60:63]
    v_cmp_eq_u32 vcc, -1, v9
    buffer_load_dwordx4 v[172:175], v2, s[40:43], s93 offen offset:1024 sc1
    v_mfma_f32_16x16x32_bf16 v[72:75], a[204:207], v[200:203], v[72:75]
    v_mfma_f32_16x16x32_bf16 v[76:79], a[204:207], v[204:207], v[76:79]
    s_cbranch_vccnz L_slow_g2a_10
L_back_g2a_10:
    v_mfma_f32_16x16x32_bf16 v[40:43], a[212:215], v[80:83], v[40:43]
    v_mfma_f32_16x16x32_bf16 v[44:47], a[212:215], v[84:87], v[44:47]
    v_mfma_f32_16x16x32_bf16 v[56:59], a[216:219], v[80:83], v[56:59]
    v_mfma_f32_16x16x32_bf16 v[60:63], a[216:219], v[84:87], v[60:63]
    v_mfma_f32_16x16x32_bf16 v[72:75], a[220:223], v[80:83], v[72:75]
    v_mfma_f32_16x16x32_bf16 v[76:79], a[220:223], v[84:87], v[76:79]
    v_mfma_f32_16x16x32_bf16 v[24:27], a[208:211], v[80:83], v[24:27]
    v_mfma_f32_16x16x32_bf16 v[28:31], a[208:211], v[84:87], v[28:31]
    v_mfma_f32_16x16x32_bf16 v[16:19], a[112:115], v[88:91], v[16:19]
    ds_write_b128 v177, v[40:43] offset:2048
    v_mfma_f32_16x16x32_bf16 v[20:23], a[112:115], v[92:95], v[20:23]
    v_mfma_f32_16x16x32_bf16 v[32:35], a[116:119], v[88:91], v[32:35]
    ds_write_b128 v177, v[44:47] offset:3072
    v_mfma_f32_16x16x32_bf16 v[36:39], a[116:119], v[92:95], v[36:39]
    v_mfma_f32_16x16x32_bf16 v[48:51], a[120:123], v[88:91], v[48:51]
    s_waitcnt vmcnt(8)
    v_max3_u32 v9, v108, v100, v104
    v_max_u32 v9, v9, v96
    v_mfma_f32_16x16x32_bf16 v[52:55], a[120:123], v[92:95], v[52:55]
    v_cmp_eq_u32 vcc, -1, v9
    ds_write_b128 v178, v[56:59] offset:6144
    v_mfma_f32_16x16x32_bf16 v[64:67], a[124:127], v[88:91], v[64:67]
    ds_write_b128 v178, v[60:63] offset:7168
    v_add_f32 v24, v24, v120
    v_mfma_f32_16x16x32_bf16 v[68:71], a[124:127], v[92:95], v[68:71]
    s_cbranch_vccnz L_slow_g2a_11
L_back_g2a_11:
    v_mfma_f32_16x16x32_bf16 v[16:19], a[128:131], v[96:99], v[16:19]
    ds_write_b128 v179, v[72:75] offset:10240
    v_add_f32 v25, v25, v121
    v_mfma_f32_16x16x32_bf16 v[20:23], a[128:131], v[100:103], v[20:23]
    v_add_f32 v26, v26, v122
    v_add_f32 v27, v27, v123
    v_mfma_f32_16x16x32_bf16 v[32:35], a[132:135], v[96:99], v[32:35]
    ds_write_b128 v179, v[76:79] offset:11264
    v_add_f32 v28, v28, v120
    v_mfma_f32_16x16x32_bf16 v[36:39], a[132:135], v[100:103], v[36:39]
    v_add_f32 v29, v29, v121
    v_add_f32 v30, v30, v122
    v_mfma_f32_16x16x32_bf16 v[48:51], a[136:139], v[96:99], v[48:51]
    v_add_f32 v31, v31, v123
    buffer_load_dwordx4 a[0:3], v5, s[44:47], s80 offen offset:0 sc1
    v_mfma_f32_16x16x32_bf16 v[52:55], a[136:139], v[100:103], v[52:55]
    v_mfma_f32_16x16x32_bf16 v[64:67], a[140:143], v[96:99], v[64:67]
    buffer_load_dwordx4 a[4:7], v5, s[44:47], s80 offen offset:1024 sc1
    v_mfma_f32_16x16x32_bf16 v[68:71], a[140:143], v[100:103], v[68:71]
    v_mfma_f32_16x16x32_bf16 v[16:19], a[144:147], v[104:107], v[16:19]
    buffer_load_dwordx4 a[8:11], v6, s[44:47], s80 offen offset:0 sc1
    v_mfma_f32_16x16x32_bf16 v[20:23], a[144:147], v[108:111], v[20:23]
    v_mfma_f32_16x16x32_bf16 v[32:35], a[148:151], v[104:107], v[32:35]
    buffer_load_dwordx4 a[12:15], v6, s[44:47], s80 offen offset:1024 sc1
    v_mfma_f32_16x16x32_bf16 v[36:39], a[148:151], v[108:111], v[36:39]
    v_mfma_f32_16x16x32_bf16 v[48:51], a[152:155], v[104:107], v[48:51]
    s_waitcnt vmcnt(8)
    v_max3_u32 v9, v156, v148, v152
    v_max_u32 v9, v9, v144
    v_mfma_f32_16x16x32_bf16 v[52:55], a[152:155], v[108:111], v[52:55]
    v_cmp_eq_u32 vcc, -1, v9
    v_mfma_f32_16x16x32_bf16 v[64:67], a[156:159], v[104:107], v[64:67]
    v_mfma_f32_16x16x32_bf16 v[68:71], a[156:159], v[108:111], v[68:71]
    s_cbranch_vccnz L_slow_g2a_12
L_back_g2a_12:
    v_mfma_f32_16x16x32_bf16 v[16:19], a[160:163], v[144:147], v[16:19]
    buffer_load_dwordx4 a[16:19], v5, s[44:47], s81 offen offset:0 sc1
    v_mfma_f32_16x16x32_bf16 v[20:23], a[160:163], v[148:151], v[20:23]
    v_mfma_f32_16x16x32_bf16 v[32:35], a[164:167], v[144:147], v[32:35]
    v_mfma_f32_16x16x32_bf16 v[36:39], a[164:167], v[148:151], v[36:39]
    buffer_load_dwordx4 a[20:23], v5, s[44:47], s81 offen offset:1024 sc1
    v_mfma_f32_16x16x32_bf16 v[48:51], a[168:171], v[144:147], v[48:51]
    v_mfma_f32_16x16x32_bf16 v[52:55], a[168:171], v[148:151], v[52:55]
    v_mfma_f32_16x16x32_bf16 v[64:67], a[172:175], v[144:147], v[64:67]
    buffer_load_dwordx4 a[24:27], v6, s[44:47], s81 offen offset:0 sc1
    v_mfma_f32_16x16x32_bf16 v[68:71], a[172:175], v[148:151], v[68:71]
    v_mfma_f32_16x16x32_bf16 v[16:19], a[176:179], v[152:155], v[16:19]
    v_mfma_f32_16x16x32_bf16 v[20:23], a[176:179], v[156:159], v[20:23]
    buffer_load_dwordx4 a[28:31], v6, s[44:47], s81 offen offset:1024 sc1
    v_mfma_f32_16x16x32_bf16 v[32:35], a[180:183], v[152:155], v[32:35]
    v_mfma_f32_16x16x32_bf16 v[36:39], a[180:183], v[156:159], v[36:39]
    v_mfma_f32_16x16x32_bf16 v[48:51], a[184:187], v[152:155], v[48:51]
    s_waitcnt vmcnt(8)
    v_max3_u32 v9, v172, v164, v168
    v_max_u32 v9, v9, v160
    v_mfma_f32_16x16x32_bf16 v[52:55], a[184:187], v[156:159], v[52:55]
    v_cmp_eq_u32 vcc, -1, v9
    v_mfma_f32_16x16x32_bf16 v[64:67], a[188:191], v[152:155], v[64:67]
    v_mfma_f32_16x16x32_bf16 v[68:71], a[188:191], v[156:159], v[68:71]
    s_cbranch_vccnz L_slow_g2a_13
L_back_g2a_13:
    v_mfma_f32_16x16x32_bf16 v[32:35], a[196:199], v[160:163], v[32:35]
    buffer_load_dwordx4 a[32:35], v5, s[44:47], s82 offen offset:0 sc1
    v_mfma_f32_16x16x32_bf16 v[36:39], a[196:199], v[164:167], v[36:39]
    v_mfma_f32_16x16x32_bf16 v[48:51], a[200:203], v[160:163], v[48:51]
    s_add_u32 s78, s54, 57344
    s_lshl_b32 s79, s26, 12
    s_add_u32 s79, s79, 5734400
    v_mfma_f32_16x16x32_bf16 v[32:35], a[212:215], v[168:171], v[32:35]
    buffer_load_dwordx4 a[36:39], v5, s[44:47], s82 offen offset:1024 sc1
    v_mfma_f32_16x16x32_bf16 v[36:39], a[212:215], v[172:175], v[36:39]
    v_mfma_f32_16x16x32_bf16 v[48:51], a[216:219], v[168:171], v[48:51]
    v_mfma_f32_16x16x32_bf16 v[52:55], a[200:203], v[164:167], v[52:55]
    s_nop 3
    ds_write_b128 v177, v[32:35] offset:0
    buffer_load_dwordx4 a[40:43], v6, s[44:47], s82 offen offset:0 sc1
    v_mfma_f32_16x16x32_bf16 v[64:67], a[204:207], v[160:163], v[64:67]
    v_mfma_f32_16x16x32_bf16 v[68:71], a[204:207], v[164:167], v[68:71]
    ds_write_b128 v177, v[36:39] offset:1024
    v_mfma_f32_16x16x32_bf16 v[52:55], a[216:219], v[172:175], v[52:55]
    buffer_load_dwordx4 a[44:47], v6, s[44:47], s82 offen offset:1024 sc1
    v_mfma_f32_16x16x32_bf16 v[64:67], a[220:223], v[168:171], v[64:67]
    ds_write_b128 v178, v[48:51] offset:4096
    v_mfma_f32_16x16x32_bf16 v[68:71], a[220:223], v[172:175], v[68:71]
    v_mfma_f32_16x16x32_bf16 v[16:19], a[192:195], v[160:163], v[16:19]
    s_nop 2
    ds_write_b128 v178, v[52:55] offset:5120
    v_mfma_f32_16x16x32_bf16 v[20:23], a[192:195], v[164:167], v[20:23]
    ds_write_b128 v179, v[64:67] offset:8192
    v_mfma_f32_16x16x32_bf16 v[16:19], a[208:211], v[168:171], v[16:19]
    ds_write_b128 v179, v[68:71] offset:9216
    v_mfma_f32_16x16x32_bf16 v[20:23], a[208:211], v[172:175], v[20:23]
    s_waitcnt lgkmcnt(0)
    s_barrier
    ds_read_b128 v[40:43], v176 offset:2048
    ds_read_b128 v[56:59], v176 offset:6144
    ds_read_b128 v[72:75], v176 offset:10240
    ds_read_b128 v[44:47], v176 offset:3072
    ds_read_b128 v[60:63], v176 offset:7168
    ds_read_b128 v[76:79], v176 offset:11264
    ds_read_b128 v[32:35], v176 offset:0
    ds_read_b128 v[48:51], v176 offset:4096
    ds_read_b128 v[64:67], v176 offset:8192
    ds_read_b128 v[36:39], v176 offset:1024
    ds_read_b128 v[52:55], v176 offset:5120
    ds_read_b128 v[68:71], v176 offset:9216
    s_waitcnt lgkmcnt(11)
    v_pk_add_f32 v[24:25], v[24:25], v[40:41]
    v_pk_add_f32 v[26:27], v[26:27], v[42:43]
    s_waitcnt lgkmcnt(9)
    v_pk_add_f32 v[56:57], v[56:57], v[72:73]
    v_pk_add_f32 v[58:59], v[58:59], v[74:75]
    v_pk_add_f32 v[24:25], v[24:25], v[56:57]
    v_pk_add_f32 v[26:27], v[26:27], v[58:59]
    s_waitcnt lgkmcnt(8)
    v_pk_add_f32 v[28:29], v[28:29], v[44:45]
    v_pk_add_f32 v[30:31], v[30:31], v[46:47]
    s_waitcnt lgkmcnt(6)
    v_pk_add_f32 v[60:61], v[60:61], v[76:77]
    v_pk_add_f32 v[62:63], v[62:63], v[78:79]
    v_pk_add_f32 v[28:29], v[28:29], v[60:61]
    v_pk_add_f32 v[30:31], v[30:31], v[62:63]
    s_waitcnt lgkmcnt(5)
    v_pk_add_f32 v[16:17], v[16:17], v[32:33]
    v_pk_add_f32 v[18:19], v[18:19], v[34:35]
    s_waitcnt lgkmcnt(3)
    v_pk_add_f32 v[48:49], v[48:49], v[64:65]
    v_pk_add_f32 v[50:51], v[50:51], v[66:67]
    v_pk_add_f32 v[16:17], v[16:17], v[48:49]
    v_pk_add_f32 v[18:19], v[18:19], v[50:51]
    s_waitcnt lgkmcnt(2)
    v_pk_add_f32 v[20:21], v[20:21], v[36:37]
    v_pk_add_f32 v[22:23], v[22:23], v[38:39]
    s_waitcnt lgkmcnt(0)
    v_pk_add_f32 v[52:53], v[52:53], v[68:69]
    v_pk_add_f32 v[54:55], v[54:55], v[70:71]
    v_pk_add_f32 v[20:21], v[20:21], v[52:53]
    v_pk_add_f32 v[22:23], v[22:23], v[54:55]
    s_add_u32 s53, s11, 57344
    v_cvt_pk_bf16_f32 v147, v28, v29
    v_cvt_pk_bf16_f32 v144, v16, v17
    v_cvt_pk_bf16_f32 v145, v20, v21
    v_cvt_pk_bf16_f32 v146, v24, v25
    buffer_store_dwordx4 v[144:147], v251, s[28:31], s53 offen offset:0 sc1
    v_cvt_pk_bf16_f32 v151, v30, v31
    v_cvt_pk_bf16_f32 v148, v18, v19
    v_cvt_pk_bf16_f32 v149, v22, v23
    v_cvt_pk_bf16_f32 v150, v26, v27
    buffer_store_dwordx4 v[148:151], v251, s[28:31], s53 offen offset:256 sc1
    v_cndmask_b32 v88, v17, 0, s[56:57]
    v_cndmask_b32 v89, v21, 0, s[56:57]
    v_cndmask_b32 v90, v25, 0, s[56:57]
    v_cndmask_b32 v91, v29, 0, s[56:57]
    v_mul_f32 v80, v16, v16
    v_mul_f32 v81, v20, v20
    v_mul_f32 v82, v24, v24
    v_mul_f32 v83, v28, v28
    v_fmac_f32 v80, v18, v18
    v_fmac_f32 v81, v22, v22
    v_fmac_f32 v82, v26, v26
    v_fmac_f32 v83, v30, v30
    v_fmac_f32 v80, v19, v19
    v_fmac_f32 v81, v23, v23
    v_fmac_f32 v82, v27, v27
    v_fmac_f32 v83, v31, v31
    v_fmac_f32 v80, v88, v88
    v_fmac_f32 v81, v89, v89
    v_fmac_f32 v82, v90, v90
    v_fmac_f32 v83, v91, v91
    s_nop 0
    v_permlane32_swap_b32 v80, v82
    v_permlane32_swap_b32 v81, v83
    v_add_f32 v80, v80, v82
    v_add_f32 v81, v81, v83
    s_nop 1
    v_permlane16_swap_b32 v80, v81
    v_add_f32 v80, v80, v81
    ds_write_b32 v14, v80
    s_waitcnt lgkmcnt(0)
    s_barrier
    s_cmp_lg_u32 s26, 0
    s_cbranch_scc1 L_sq2
    ds_read_b128 v[84:87], v14
    s_waitcnt lgkmcnt(0)
    v_pk_add_f32 v[84:85], v[84:85], v[86:87]
    v_add_f32 v84, v84, v85
    v_mul_f32 v85, 0x3b000000, v84
    v_cvt_u32_f32 v85, v85
    v_min_u32 v85, 268435456, v85
    v_cvt_f32_u32 v86, v85
    v_fmac_f32 v84, 0xc4000000, v86
    v_mul_f32 v84, 0x49800000, v84
    v_cvt_u32_f32 v84, v84
    v_lshl_or_b32 v84, v84, 3, 1
    buffer_atomic_add_x2 v[84:85], v13, s[28:31], s55 offen sc1
L_sq2:
    v_cvt_f32_u32 v34, v4
    buffer_load_dwordx4 v[240:243], v2, s[28:31], s95 offen offset:0 sc1 nt
    v_cvt_f32_u32 v32, v3
    v_mul_f32 v32, 0x3d000000, v32
    v_mul_f32 v34, 4.0, v34
    v_mul_f32 v33, v32, v34
    v_mov_b32 v224, v33
    v_fmamk_f32 v225, v32, 0x3f800000, v33
    v_fmamk_f32 v226, v32, 0x40000000, v33
    v_fmamk_f32 v227, v32, 0x40400000, v33
    buffer_load_dwordx4 v[244:247], v2, s[28:31], s95 offen offset:1024 sc1 nt
    v_fmamk_f32 v228, v32, 0x41800000, v33
    v_fmamk_f32 v229, v32, 0x41880000, v33
    v_fmamk_f32 v230, v32, 0x41900000, v33
    v_fmamk_f32 v231, v32, 0x41980000, v33
    v_sin_f32 v232, v224
    v_sin_f32 v233, v225
    v_sin_f32 v234, v226
    v_sin_f32 v235, v227
    v_sin_f32 v236, v228
    buffer_load_dwordx4 a[48:51], v5, s[44:47], s83 offen offset:0 sc1
    v_sin_f32 v237, v229
    v_sin_f32 v238, v230
    v_sin_f32 v239, v231
    v_cos_f32 v224, v224
    v_cos_f32 v225, v225
    v_cos_f32 v226, v226
    v_cos_f32 v227, v227
    v_cos_f32 v228, v228
    v_cos_f32 v229, v229
    buffer_load_dwordx4 a[52:55], v5, s[44:47], s83 offen offset:1024 sc1
    v_cos_f32 v230, v230
    v_cos_f32 v231, v231
    v_cvt_pk_bf16_f32 v216, v232, v233
    v_cvt_pk_bf16_f32 v217, v234, v235
    v_cvt_pk_bf16_f32 v218, v236, v237
    v_cvt_pk_bf16_f32 v219, v238, v239
    v_cvt_pk_bf16_f32 v208, v224, v225
    v_cvt_pk_bf16_f32 v209, v226, v227
    v_cvt_pk_bf16_f32 v210, v228, v229
    buffer_load_dwordx4 a[56:59], v6, s[44:47], s83 offen offset:0 sc1
    v_cvt_pk_bf16_f32 v211, v230, v231
    v_xor_b32 v220, 0x80000000, v216
    v_xor_b32 v221, 0x80000000, v217
    v_xor_b32 v222, 0x80000000, v218
    v_xor_b32 v223, 0x80000000, v219
    v_xor_b32 v212, 0x80000000, v208
    v_xor_b32 v213, 0x80000000, v209
    v_xor_b32 v214, 0x80000000, v210
    buffer_load_dwordx4 a[60:63], v6, s[44:47], s83 offen offset:1024 sc1
    v_xor_b32 v215, 0x80000000, v211
    v_lshl_add_u32 v32, v1, 4, v3
    v_cvt_f32_u32 v32, v32
    v_mul_f32 v32, 0x3c800000, v32
    v_mul_f32 v33, v32, v34
    v_and_b32 v34, 1, v3
    v_mul_u32_u24 v34, 0x8000, v34
    v_lshl_or_b32 v34, v34, 16, v34
    v_mov_b32 v224, v33
    buffer_load_dwordx4 a[64:67], v5, s[44:47], s84 offen offset:0 sc1
    v_fmamk_f32 v225, v32, 0x3f800000, v33
    v_fmamk_f32 v226, v32, 0x40000000, v33
    v_fmamk_f32 v227, v32, 0x40400000, v33
    v_fmamk_f32 v228, v32, 0x41800000, v33
    v_fmamk_f32 v229, v32, 0x41880000, v33
    v_fmamk_f32 v230, v32, 0x41900000, v33
    v_fmamk_f32 v231, v32, 0x41980000, v33
    v_sin_f32 v232, v224
    v_sin_f32 v233, v225
    buffer_load_dwordx4 a[68:71], v5, s[44:47], s84 offen offset:1024 sc1
    v_sin_f32 v234, v226
    v_sin_f32 v235, v227
    v_sin_f32 v236, v228
    v_sin_f32 v237, v229
    v_sin_f32 v238, v230
    v_sin_f32 v239, v231
    v_cos_f32 v224, v224
    v_cos_f32 v225, v225
    s_waitcnt vmcnt(8)
    v_cos_f32 v226, v226
    v_cos_f32 v227, v227
    v_cos_f32 v228, v228
    v_cos_f32 v229, v229
    v_cos_f32 v230, v230
    v_cos_f32 v231, v231
    v_cvt_pk_bf16_f32 v200, v232, v233
    v_cvt_pk_bf16_f32 v201, v234, v235
    v_cvt_pk_bf16_f32 v202, v236, v237
    v_cvt_pk_bf16_f32 v203, v238, v239
    v_cvt_pk_bf16_f32 v192, v224, v225
    v_cvt_pk_bf16_f32 v193, v226, v227
    v_cvt_pk_bf16_f32 v194, v228, v229
    v_cvt_pk_bf16_f32 v195, v230, v231
    v_xor_b32 v204, v34, v200
    v_xor_b32 v205, v34, v201
    v_xor_b32 v206, v34, v202
    v_xor_b32 v207, v34, v203
    v_xor_b32 v196, v34, v192
    v_xor_b32 v197, v34, v193
    v_xor_b32 v198, v34, v194
    v_xor_b32 v199, v34, v195
    v_mul_f32 v32, 0x3d000000, v32
    v_mul_f32 v33, 0x3d000000, v33
    v_mov_b32 v224, v33
    v_fmamk_f32 v225, v32, 0x3f800000, v33
    v_fmamk_f32 v226, v32, 0x40000000, v33
    v_fmamk_f32 v227, v32, 0x40400000, v33
    v_fmamk_f32 v228, v32, 0x41800000, v33
    v_fmamk_f32 v229, v32, 0x41880000, v33
    v_fmamk_f32 v230, v32, 0x41900000, v33
    v_fmamk_f32 v231, v32, 0x41980000, v33
    v_sin_f32 v232, v224
    v_sin_f32 v233, v225
    v_sin_f32 v234, v226
    v_sin_f32 v235, v227
    v_sin_f32 v236, v228
    v_sin_f32 v237, v229
    v_sin_f32 v238, v230
    v_sin_f32 v239, v231
    v_cos_f32 v224, v224
    v_cos_f32 v225, v225
    v_cos_f32 v226, v226
    v_cos_f32 v227, v227
    v_cos_f32 v228, v228
    v_cos_f32 v229, v229
    v_cos_f32 v230, v230
    v_cos_f32 v231, v231
    s_sleep 1
    s_sleep 1
    s_sleep 1
    s_sleep 1
    s_sleep 1
    s_sleep 1
    s_sleep 1
    s_sleep 1
    s_sleep 1
    s_sleep 1
    s_sleep 1
    s_sleep 1
    buffer_load_dwordx4 v[176:179], v248, s[28:31], s78 offen sc1 nt
    buffer_load_dwordx4 v[180:183], v249, s[28:31], s78 offen sc1 nt
    buffer_load_dwordx4 v[104:107], v2, s[28:31], s79 offen offset:0 sc1
    buffer_load_dwordx4 v[108:111], v2, s[28:31], s79 offen offset:1024 sc1
    buffer_load_dwordx4 v[112:115], v2, s[28:31], s79 offen offset:2048 sc1
    buffer_load_dwordx4 v[116:119], v2, s[28:31], s79 offen offset:3072 sc1
    s_cmp_eq_u32 s2, 0
    s_cselect_b32 s57, 0, 0xffff0000
    s_cselect_b32 s58, 0, 0x3a000000
    s_mov_b32 s59, 0x3a000000
    s_mov_b32 s60, 0x80008000
    s_mov_b32 s62, 0x2f924925
    s_mov_b32 s63, 0x3727c5ac
    s_mov_b32 s56, 0x3f924925
    v_lshrrev_b32 v12, 1, v1
    v_lshl_add_u32 v12, v12, 10, v2
    v_and_b32 v13, 1, v1
    v_lshl_add_u32 v12, v13, 3, v12
    v_add_u32 v12, 122880, v12
    v_lshlrev_b32 v13, 9, v1
    v_lshl_add_u32 v13, v3, 5, v13
    v_lshl_add_u32 v13, v4, 3, v13
    v_add_u32 v13, 122880, v13
    v_add_u32 v10, 122880, v2
    v_lshrrev_b32 v11, 1, v2
    v_add_u32 v11, 122880, v11
    v_xor_b32 v48, s60, v200
    v_xor_b32 v49, s60, v201
    v_xor_b32 v50, s60, v202
    v_xor_b32 v51, s60, v203
    v_xor_b32 v52, s60, v204
    v_xor_b32 v53, s60, v205
    v_xor_b32 v54, s60, v206
    v_xor_b32 v55, s60, v207
    v_xor_b32 v56, s60, v216
    v_xor_b32 v57, s60, v217
    v_xor_b32 v58, s60, v218
    v_xor_b32 v59, s60, v219
    v_xor_b32 v60, s60, v220
    v_xor_b32 v61, s60, v221
    v_xor_b32 v62, s60, v222
    v_xor_b32 v63, s60, v223
    s_waitcnt vmcnt(4)
    v_max_u32 v16, v179, v183
    v_lshlrev_b32 v72, 16, v176
    v_lshlrev_b32 v73, 16, v177
    v_lshlrev_b32 v74, 16, v178
    v_lshlrev_b32 v75, 16, v179
    v_lshlrev_b32 v76, 16, v180
    v_lshlrev_b32 v77, 16, v181
    v_lshlrev_b32 v78, 16, v182
    v_lshlrev_b32 v79, 16, v183
    v_and_b32 v88, s57, v176
    v_and_b32 v89, s57, v177
    v_and_b32 v90, s57, v178
    v_and_b32 v91, s57, v179
    v_and_b32 v92, s57, v180
    v_and_b32 v93, s57, v181
    v_and_b32 v94, s57, v182
    v_and_b32 v95, s57, v183
    v_cmp_le_u32 vcc, 0xff800000, v16
    s_waitcnt vmcnt(3)
    v_bitop3_b32 v17, v104, v106, 7 bitop3:0x80
    v_cvt_f32_u32 v24, v104
    v_cvt_f32_u32 v25, v106
    s_waitcnt vmcnt(2)
    v_bitop3_b32 v17, v108, v110, v17 bitop3:0x80
    v_cvt_f32_u32 v26, v108
    v_cvt_f32_u32 v27, v110
    s_waitcnt vmcnt(1)
    v_bitop3_b32 v17, v112, v114, v17 bitop3:0x80
    v_cvt_f32_u32 v28, v112
    v_cvt_f32_u32 v29, v114
    s_waitcnt vmcnt(0)
    v_bitop3_b32 v17, v116, v118, v17 bitop3:0x80
    v_cvt_f32_u32 v30, v116
    v_cvt_f32_u32 v31, v118
    v_cmp_ne_u32 s[98:99], 7, v17
    v_cvt_f32_u32 v18, v105
    s_or_b64 vcc, vcc, s[98:99]
    s_cbranch_scc1 L_slow_c2x
L_back_c2x:
    v_pk_fma_f32 v[24:25], v[24:25], s[62:63], s[62:63] op_sel:[0,0,1] op_sel_hi:[1,0,1]
    v_pk_fma_f32 v[26:27], v[26:27], s[62:63], s[62:63] op_sel:[0,0,1] op_sel_hi:[1,0,1]
    v_pk_fma_f32 v[28:29], v[28:29], s[62:63], s[62:63] op_sel:[0,0,1] op_sel_hi:[1,0,1]
    v_pk_fma_f32 v[30:31], v[30:31], s[62:63], s[62:63] op_sel:[0,0,1] op_sel_hi:[1,0,1]
    v_cvt_f32_u32 v19, v107
    v_fmac_f32 v24, s56, v18
    v_cvt_f32_u32 v18, v109
    v_fmac_f32 v25, s56, v19
    v_cvt_f32_u32 v19, v111
    v_fmac_f32 v26, s56, v18
    v_cvt_f32_u32 v18, v113
    v_fmac_f32 v27, s56, v19
    v_cvt_f32_u32 v19, v115
    v_fmac_f32 v28, s56, v18
    v_cvt_f32_u32 v18, v117
    v_fmac_f32 v29, s56, v19
    v_cvt_f32_u32 v19, v119
    v_fmac_f32 v30, s56, v18
    v_fmac_f32 v31, s56, v19
    v_rsq_f32 v24, v24
    v_rsq_f32 v25, v25
    v_rsq_f32 v26, v26
    v_rsq_f32 v27, v27
    v_rsq_f32 v28, v28
    v_rsq_f32 v29, v29
    v_rsq_f32 v30, v30
    v_rsq_f32 v31, v31
    v_pk_mul_f32 v[96:97], v[72:73], v[24:25]
    v_pk_mul_f32 v[98:99], v[74:75], v[26:27]
    v_pk_mul_f32 v[100:101], v[76:77], v[28:29]
    v_pk_mul_f32 v[102:103], v[78:79], v[30:31]
    v_pk_mul_f32 v[88:89], v[88:89], v[24:25]
    v_pk_mul_f32 v[90:91], v[90:91], v[26:27]
    v_pk_mul_f32 v[92:93], v[92:93], v[28:29]
    v_pk_mul_f32 v[94:95], v[94:95], v[30:31]
    v_cvt_pk_bf16_f32 v64, v96, v97
    v_cvt_pk_bf16_f32 v65, v98, v99
    v_cvt_pk_bf16_f32 v66, v100, v101
    v_cvt_pk_bf16_f32 v67, v102, v103
    v_cvt_pk_bf16_f32 v68, v88, v89
    v_cvt_pk_bf16_f32 v69, v90, v91
    v_cvt_pk_bf16_f32 v70, v92, v93
    v_cvt_pk_bf16_f32 v71, v94, v95
    ds_write_b64 v12, v[64:65] offset:0
    ds_write_b64 v12, v[66:67] offset:2048
    ds_write_b64 v12, v[68:69] offset:4096
    ds_write_b64 v12, v[70:71] offset:6144
    v_and_b32 v80, 0xffff0000, v176
    v_and_b32 v81, 0xffff0000, v177
    v_and_b32 v82, 0xffff0000, v178
    v_and_b32 v83, 0xffff0000, v179
    v_and_b32 v84, 0xffff0000, v180
    v_and_b32 v85, 0xffff0000, v181
    v_and_b32 v86, 0xffff0000, v182
    v_and_b32 v87, 0xffff0000, v183
    s_waitcnt lgkmcnt(0)
    s_barrier
    ds_read_b128 v[104:107], v10 offset:0
    ds_read_b128 v[108:111], v10 offset:1024
    ds_read_b128 v[112:115], v10 offset:2048
    ds_read_b128 v[116:119], v10 offset:3072
    ds_read_b128 v[120:123], v10 offset:4096
    ds_read_b128 v[124:127], v10 offset:5120
    ds_read_b128 v[128:131], v10 offset:6144
    ds_read_b128 v[132:135], v10 offset:7168
    s_waitcnt lgkmcnt(7)
    v_mfma_f32_16x16x32_bf16 v[136:139], v[104:107], v[192:195], 0
    v_mfma_f32_16x16x32_bf16 v[144:147], v[104:107], v[48:51], 0
    s_waitcnt lgkmcnt(5)
    v_mfma_f32_16x16x32_bf16 v[140:143], v[112:115], v[192:195], 0
    v_mfma_f32_16x16x32_bf16 v[148:151], v[112:115], v[48:51], 0
    v_mfma_f32_16x16x32_bf16 v[136:139], v[108:111], v[196:199], v[136:139]
    v_mfma_f32_16x16x32_bf16 v[144:147], v[108:111], v[52:55], v[144:147]
    s_waitcnt lgkmcnt(4)
    v_mfma_f32_16x16x32_bf16 v[140:143], v[116:119], v[196:199], v[140:143]
    v_mfma_f32_16x16x32_bf16 v[148:151], v[116:119], v[52:55], v[148:151]
    s_waitcnt lgkmcnt(3)
    v_mfma_f32_16x16x32_bf16 v[136:139], v[120:123], v[200:203], v[136:139]
    v_mfma_f32_16x16x32_bf16 v[144:147], v[120:123], v[192:195], v[144:147]
    s_waitcnt lgkmcnt(1)
    v_mfma_f32_16x16x32_bf16 v[140:143], v[128:131], v[200:203], v[140:143]
    v_mfma_f32_16x16x32_bf16 v[148:151], v[128:131], v[192:195], v[148:151]
    v_mfma_f32_16x16x32_bf16 v[136:139], v[124:127], v[204:207], v[136:139]
    v_mfma_f32_16x16x32_bf16 v[144:147], v[124:127], v[196:199], v[144:147]
    s_waitcnt lgkmcnt(0)
    v_mfma_f32_16x16x32_bf16 v[140:143], v[132:135], v[204:207], v[140:143]
    v_mfma_f32_16x16x32_bf16 v[148:151], v[132:135], v[196:199], v[148:151]
    buffer_load_dwordx4 a[72:75], v6, s[44:47], s84 offen offset:0 sc1
    s_nop 2
    v_pk_mul_f32 v[88:89], v[136:137], v[224:225]
    v_pk_mul_f32 v[90:91], v[138:139], v[226:227]
    s_nop 0
    v_pk_mul_f32 v[92:93], v[140:141], v[228:229]
    v_pk_mul_f32 v[94:95], v[142:143], v[230:231]
    v_pk_mul_f32 v[96:97], v[144:145], v[224:225]
    v_pk_mul_f32 v[98:99], v[146:147], v[226:227]
    v_pk_mul_f32 v[100:101], v[148:149], v[228:229]
    v_pk_mul_f32 v[102:103], v[150:151], v[230:231]
    buffer_load_dwordx4 a[76:79], v6, s[44:47], s84 offen offset:1024 sc1
    v_pk_fma_f32 v[88:89], v[144:145], v[232:233], v[88:89]
    v_pk_fma_f32 v[90:91], v[146:147], v[234:235], v[90:91]
    v_pk_fma_f32 v[92:93], v[148:149], v[236:237], v[92:93]
    v_pk_fma_f32 v[94:95], v[150:151], v[238:239], v[94:95]
    v_pk_fma_f32 v[96:97], v[136:137], v[232:233], v[96:97] neg_lo:[1,0,0] neg_hi:[1,0,0]
    v_pk_fma_f32 v[98:99], v[138:139], v[234:235], v[98:99] neg_lo:[1,0,0] neg_hi:[1,0,0]
    v_pk_fma_f32 v[100:101], v[140:141], v[236:237], v[100:101] neg_lo:[1,0,0] neg_hi:[1,0,0]
    v_pk_fma_f32 v[102:103], v[142:143], v[238:239], v[102:103] neg_lo:[1,0,0] neg_hi:[1,0,0]
    buffer_load_dwordx4 a[80:83], v5, s[44:47], s85 offen offset:0 sc1
    v_cvt_pk_bf16_f32 v64, v88, v89
    v_cvt_pk_bf16_f32 v65, v90, v91
    v_cvt_pk_bf16_f32 v66, v92, v93
    v_cvt_pk_bf16_f32 v67, v94, v95
    v_cvt_pk_bf16_f32 v68, v96, v97
    v_cvt_pk_bf16_f32 v69, v98, v99
    v_cvt_pk_bf16_f32 v70, v100, v101
    v_cvt_pk_bf16_f32 v71, v102, v103
    v_mfma_f32_16x16x32_bf16 v[32:35], v[208:211], v[64:67], 0
    buffer_load_dwordx4 a[84:87], v5, s[44:47], s85 offen offset:1024 sc1
    v_lshlrev_b32 v152, 16, v240
    v_lshlrev_b32 v153, 16, v241
    v_mfma_f32_16x16x32_bf16 v[40:43], v[56:59], v[64:67], 0
    v_lshlrev_b32 v154, 16, v242
    v_lshlrev_b32 v155, 16, v243
    v_mfma_f32_16x16x32_bf16 v[36:39], v[212:215], v[64:67], 0
    v_lshlrev_b32 v156, 16, v244
    v_lshlrev_b32 v157, 16, v245
    v_mfma_f32_16x16x32_bf16 v[44:47], v[60:63], v[64:67], 0
    v_lshlrev_b32 v158, 16, v246
    v_lshlrev_b32 v159, 16, v247
    v_mfma_f32_16x16x32_bf16 v[32:35], v[216:219], v[68:71], v[32:35]
    buffer_load_dwordx4 a[88:91], v6, s[44:47], s85 offen offset:0 sc1
    v_and_b32 v240, 0xffff0000, v240
    v_and_b32 v241, 0xffff0000, v241
    v_mfma_f32_16x16x32_bf16 v[40:43], v[208:211], v[68:71], v[40:43]
    v_and_b32 v242, 0xffff0000, v242
    v_and_b32 v243, 0xffff0000, v243
    v_mfma_f32_16x16x32_bf16 v[36:39], v[220:223], v[68:71], v[36:39]
    v_and_b32 v244, 0xffff0000, v244
    v_and_b32 v245, 0xffff0000, v245
    v_mfma_f32_16x16x32_bf16 v[44:47], v[212:215], v[68:71], v[44:47]
    v_and_b32 v246, 0xffff0000, v246
    v_and_b32 v247, 0xffff0000, v247
    buffer_load_dwordx4 a[92:95], v6, s[44:47], s85 offen offset:1024 sc1
    v_pk_mul_f32 v[88:89], v[32:33], v[152:153]
    v_pk_mul_f32 v[90:91], v[34:35], v[154:155]
    v_pk_mul_f32 v[92:93], v[36:37], v[156:157]
    v_pk_mul_f32 v[94:95], v[38:39], v[158:159]
    v_pk_mul_f32 v[96:97], v[40:41], v[152:153]
    v_pk_mul_f32 v[98:99], v[42:43], v[154:155]
    v_pk_mul_f32 v[100:101], v[44:45], v[156:157]
    v_pk_mul_f32 v[102:103], v[46:47], v[158:159]
    buffer_load_dwordx4 a[96:99], v5, s[44:47], s86 offen offset:0 sc1
    v_pk_fma_f32 v[88:89], v[40:41], v[240:241], v[88:89] neg_lo:[1,0,0] neg_hi:[1,0,0]
    v_pk_fma_f32 v[90:91], v[42:43], v[242:243], v[90:91] neg_lo:[1,0,0] neg_hi:[1,0,0]
    v_pk_fma_f32 v[92:93], v[44:45], v[244:245], v[92:93] neg_lo:[1,0,0] neg_hi:[1,0,0]
    v_pk_fma_f32 v[94:95], v[46:47], v[246:247], v[94:95] neg_lo:[1,0,0] neg_hi:[1,0,0]
    v_pk_fma_f32 v[96:97], v[32:33], v[240:241], v[96:97]
    v_pk_fma_f32 v[98:99], v[34:35], v[242:243], v[98:99]
    v_pk_fma_f32 v[100:101], v[36:37], v[244:245], v[100:101]
    v_pk_fma_f32 v[102:103], v[38:39], v[246:247], v[102:103]
    buffer_load_dwordx4 a[100:103], v5, s[44:47], s86 offen offset:1024 sc1
    v_cvt_pk_bf16_f32 v64, v88, v89
    v_cvt_pk_bf16_f32 v65, v90, v91
    v_cvt_pk_bf16_f32 v66, v92, v93
    v_cvt_pk_bf16_f32 v67, v94, v95
    v_cvt_pk_bf16_f32 v68, v96, v97
    v_cvt_pk_bf16_f32 v69, v98, v99
    v_cvt_pk_bf16_f32 v70, v100, v101
    v_cvt_pk_bf16_f32 v71, v102, v103
    v_mfma_f32_16x16x32_bf16 v[136:139], v[208:211], v[64:67], 0
    buffer_load_dwordx4 a[104:107], v6, s[44:47], s86 offen offset:0 sc1
    v_mfma_f32_16x16x32_bf16 v[144:147], v[216:219], v[64:67], 0
    v_mfma_f32_16x16x32_bf16 v[140:143], v[212:215], v[64:67], 0
    buffer_load_dwordx4 a[108:111], v6, s[44:47], s86 offen offset:1024 sc1
    v_mfma_f32_16x16x32_bf16 v[148:151], v[220:223], v[64:67], 0
    v_mfma_f32_16x16x32_bf16 v[136:139], v[56:59], v[68:71], v[136:139]
    v_mfma_f32_16x16x32_bf16 v[144:147], v[208:211], v[68:71], v[144:147]
    buffer_load_dwordx4 a[112:115], v5, s[44:47], s87 offen offset:0 sc1
    v_mfma_f32_16x16x32_bf16 v[140:143], v[60:63], v[68:71], v[140:143]
    v_mfma_f32_16x16x32_bf16 v[148:151], v[212:215], v[68:71], v[148:151]
    buffer_load_dwordx4 a[116:119], v5, s[44:47], s87 offen offset:1024 sc1
    s_nop 2
    v_pk_mul_f32 v[88:89], v[136:137], v[224:225]
    v_pk_mul_f32 v[90:91], v[138:139], v[226:227]
    s_nop 0
    v_pk_mul_f32 v[92:93], v[140:141], v[228:229]
    v_pk_mul_f32 v[94:95], v[142:143], v[230:231]
    v_pk_mul_f32 v[96:97], v[144:145], v[224:225]
    v_pk_mul_f32 v[98:99], v[146:147], v[226:227]
    v_pk_mul_f32 v[100:101], v[148:149], v[228:229]
    v_pk_mul_f32 v[102:103], v[150:151], v[230:231]
    buffer_load_dwordx4 a[120:123], v6, s[44:47], s87 offen offset:0 sc1
    v_pk_fma_f32 v[88:89], v[144:145], v[232:233], v[88:89] neg_lo:[1,0,0] neg_hi:[1,0,0]
    v_pk_fma_f32 v[90:91], v[146:147], v[234:235], v[90:91] neg_lo:[1,0,0] neg_hi:[1,0,0]
    v_pk_fma_f32 v[92:93], v[148:149], v[236:237], v[92:93] neg_lo:[1,0,0] neg_hi:[1,0,0]
    v_pk_fma_f32 v[94:95], v[150:151], v[238:239], v[94:95] neg_lo:[1,0,0] neg_hi:[1,0,0]
    v_pk_fma_f32 v[96:97], v[136:137], v[232:233], v[96:97]
    v_pk_fma_f32 v[98:99], v[138:139], v[234:235], v[98:99]
    v_pk_fma_f32 v[100:101], v[140:141], v[236:237], v[100:101]
    v_pk_fma_f32 v[102:103], v[142:143], v[238:239], v[102:103]
    buffer_load_dwordx4 a[124:127], v6, s[44:47], s87 offen offset:1024 sc1
    v_cvt_pk_bf16_f32 v64, v88, v89
    v_cvt_pk_bf16_f32 v65, v90, v91
    v_cvt_pk_bf16_f32 v66, v92, v93
    v_cvt_pk_bf16_f32 v67, v94, v95
    v_cvt_pk_bf16_f32 v68, v96, v97
    v_cvt_pk_bf16_f32 v69, v98, v99
    v_cvt_pk_bf16_f32 v70, v100, v101
    v_cvt_pk_bf16_f32 v71, v102, v103
    ds_write_b64 v13, v[64:65] offset:8192
    ds_write_b64 v13, v[66:67] offset:10240
    ds_write_b64 v13, v[68:69] offset:12288
    ds_write_b64 v13, v[70:71] offset:14336
    s_waitcnt lgkmcnt(0)
    s_barrier
    ds_read_b64_tr_b16 v[104:105], v11 offset:8192
    ds_read_b64_tr_b16 v[106:107], v11 offset:8704
    ds_read_b64_tr_b16 v[108:109], v11 offset:9216
    ds_read_b64_tr_b16 v[110:111], v11 offset:9728
    ds_read_b64_tr_b16 v[112:113], v11 offset:10240
    ds_read_b64_tr_b16 v[114:115], v11 offset:10752
    ds_read_b64_tr_b16 v[116:117], v11 offset:11264
    ds_read_b64_tr_b16 v[118:119], v11 offset:11776
    ds_read_b64_tr_b16 v[120:121], v11 offset:12288
    ds_read_b64_tr_b16 v[122:123], v11 offset:12800
    ds_read_b64_tr_b16 v[124:125], v11 offset:13312
    ds_read_b64_tr_b16 v[126:127], v11 offset:13824
    ds_read_b64_tr_b16 v[128:129], v11 offset:14336
    ds_read_b64_tr_b16 v[130:131], v11 offset:14848
    ds_read_b64_tr_b16 v[132:133], v11 offset:15360
    ds_read_b64_tr_b16 v[134:135], v11 offset:15872
    buffer_load_dwordx4 a[128:131], v5, s[44:47], s88 offen offset:0 sc1
    buffer_load_dwordx4 a[132:135], v5, s[44:47], s88 offen offset:1024 sc1
    s_waitcnt lgkmcnt(14)
    v_mfma_f32_16x16x32_bf16 v[32:35], v[192:195], v[104:107], 0
    buffer_load_dwordx4 a[136:139], v6, s[44:47], s88 offen offset:0 sc1
    v_mfma_f32_16x16x32_bf16 v[40:43], v[200:203], v[104:107], 0
    s_waitcnt lgkmcnt(10)
    v_mfma_f32_16x16x32_bf16 v[36:39], v[192:195], v[112:115], 0
    v_mfma_f32_16x16x32_bf16 v[44:47], v[200:203], v[112:115], 0
    v_mfma_f32_16x16x32_bf16 v[32:35], v[196:199], v[108:111], v[32:35]
    buffer_load_dwordx4 a[140:143], v6, s[44:47], s88 offen offset:1024 sc1
    v_mfma_f32_16x16x32_bf16 v[40:43], v[204:207], v[108:111], v[40:43]
    s_waitcnt lgkmcnt(8)
    v_mfma_f32_16x16x32_bf16 v[36:39], v[196:199], v[116:119], v[36:39]
    v_mfma_f32_16x16x32_bf16 v[44:47], v[204:207], v[116:119], v[44:47]
    s_waitcnt lgkmcnt(6)
    v_mfma_f32_16x16x32_bf16 v[32:35], v[48:51], v[120:123], v[32:35]
    buffer_load_dwordx4 a[144:147], v5, s[44:47], s89 offen offset:0 sc1
    v_mfma_f32_16x16x32_bf16 v[40:43], v[192:195], v[120:123], v[40:43]
    s_waitcnt lgkmcnt(4)
    v_mfma_f32_16x16x32_bf16 v[32:35], v[52:55], v[124:127], v[32:35]
    v_mfma_f32_16x16x32_bf16 v[40:43], v[196:199], v[124:127], v[40:43]
    s_waitcnt lgkmcnt(2)
    v_mfma_f32_16x16x32_bf16 v[36:39], v[48:51], v[128:131], v[36:39]
    buffer_load_dwordx4 a[148:151], v5, s[44:47], s89 offen offset:1024 sc1
    v_mfma_f32_16x16x32_bf16 v[44:47], v[192:195], v[128:131], v[44:47]
    s_waitcnt lgkmcnt(0)
    v_mfma_f32_16x16x32_bf16 v[36:39], v[52:55], v[132:135], v[36:39]
    v_mfma_f32_16x16x32_bf16 v[44:47], v[196:199], v[132:135], v[44:47]
    s_add_u32 s55, s54, 0
    v_fma_f32 v72, v32, s59, v72
    v_fma_f32 v80, v40, s58, v80
    v_fma_f32 v73, v33, s59, v73
    v_fma_f32 v81, v41, s58, v81
    v_fma_f32 v74, v34, s59, v74
    v_fma_f32 v82, v42, s58, v82
    v_fma_f32 v75, v35, s59, v75
    v_fma_f32 v83, v43, s58, v83
    v_cvt_pk_bf16_f32 v67, v75, v83
    v_cvt_pk_bf16_f32 v66, v74, v82
    v_cvt_pk_bf16_f32 v65, v73, v81
    v_cvt_pk_bf16_f32 v64, v72, v80
    v_or_b32 v67, 1, v67
    buffer_store_dwordx4 v[64:67], v248, s[28:31], s55 offen sc1
    v_fma_f32 v76, v36, s59, v76
    v_fma_f32 v84, v44, s58, v84
    v_fma_f32 v77, v37, s59, v77
    v_fma_f32 v85, v45, s58, v85
    v_fma_f32 v78, v38, s59, v78
    v_fma_f32 v86, v46, s58, v86
    v_fma_f32 v79, v39, s59, v79
    v_fma_f32 v87, v47, s58, v87
    v_cvt_pk_bf16_f32 v71, v79, v87
    v_cvt_pk_bf16_f32 v70, v78, v86
    v_cvt_pk_bf16_f32 v69, v77, v85
    v_cvt_pk_bf16_f32 v68, v76, v84
    v_or_b32 v71, 1, v71
    buffer_store_dwordx4 v[68:71], v249, s[28:31], s55 offen sc1
    buffer_load_dwordx4 a[152:155], v6, s[44:47], s89 offen offset:0 sc1
    s_mov_b32 s4, 0xaaaaaaaa
    s_mov_b32 s5, s4
    buffer_load_dwordx4 a[156:159], v6, s[44:47], s89 offen offset:1024 sc1
    s_mov_b32 s6, 0xcccccccc
    buffer_load_dwordx4 a[160:163], v5, s[44:47], s90 offen offset:0 sc1
    s_mov_b32 s7, s6
    s_lshr_b32 s8, s64, 4
    buffer_load_dwordx4 a[164:167], v5, s[44:47], s90 offen offset:1024 sc1
    s_add_u32 s8, s8, 5508608
    buffer_load_dwordx4 a[168:171], v6, s[44:47], s90 offen offset:0 sc1
    s_lshr_b32 s9, s94, 4
    s_add_u32 s9, s9, 5508608
    buffer_load_dwordx4 a[172:175], v6, s[44:47], s90 offen offset:1024 sc1
    s_sub_u32 s53, s64, s94
    v_or_b32 v15, s53, v4
    buffer_load_dwordx4 a[176:179], v5, s[44:47], s91 offen offset:0 sc1
    v_cmp_eq_u32 vcc, 0, v15
    v_mov_b32 v14, 0xffff
    buffer_load_dwordx4 a[180:183], v5, s[44:47], s91 offen offset:1024 sc1
    v_cndmask_b32 v15, -1, v14, vcc
    s_waitcnt vmcnt(8)
    buffer_load_dwordx4 v[80:83], v251, s[32:35], s64 offen offset:0 sc1
    buffer_load_dwordx4 v[84:87], v251, s[32:35], s64 offen offset:256 sc1
    buffer_load_dwordx4 v[88:91], v251, s[32:35], s64 offen offset:2048 sc1
    buffer_load_dwordx4 v[92:95], v251, s[32:35], s64 offen offset:2304 sc1
    buffer_load_dwordx4 v[96:99], v251, s[32:35], s65 offen offset:0 sc1
    buffer_load_dwordx4 v[100:103], v251, s[32:35], s65 offen offset:256 sc1
    buffer_load_dwordx4 v[104:107], v251, s[32:35], s65 offen offset:2048 sc1
    buffer_load_dwordx4 v[108:111], v251, s[32:35], s65 offen offset:2304 sc1
    buffer_load_dwordx4 v[112:115], v251, s[32:35], s66 offen offset:0 sc1
    buffer_load_dwordx4 v[116:119], v251, s[32:35], s66 offen offset:256 sc1
    buffer_load_dwordx4 v[120:123], v251, s[32:35], s66 offen offset:2048 sc1
    buffer_load_dwordx4 v[124:127], v251, s[32:35], s66 offen offset:2304 sc1
    ds_read_b128 v[208:211], v2 offset:0
    ds_read_b128 v[212:215], v2 offset:1024
    ds_read_b128 v[216:219], v2 offset:2048
    ds_read_b128 v[220:223], v2 offset:3072
    s_waitcnt vmcnt(8)
    v_bitop3_b32 v9, v95, v87, v91 bitop3:0x80
    v_bitop3_b32 v9, v9, v83, 1 bitop3:0x80
    v_cmp_eq_u32 vcc, 0, v9
    s_cbranch_vccnz L_slow_g1b_0
L_back_g1b_0:
    v_swap_b32 v84, v81
    v_swap_b32 v88, v82
    v_swap_b32 v92, v83
    v_and_b32 v80, v15, v80
    s_waitcnt lgkmcnt(3)
    s_nop 0
    v_mfma_f32_16x16x32_bf16 v[16:19], v[208:211], v[80:83], 0
    v_swap_b32 v89, v86
    s_waitcnt lgkmcnt(2)
    v_mfma_f32_16x16x32_bf16 v[32:35], v[212:215], v[80:83], 0
    v_swap_b32 v93, v87
    s_waitcnt lgkmcnt(1)
    v_mfma_f32_16x16x32_bf16 v[48:51], v[216:219], v[80:83], 0
    v_and_b32 v84, v15, v84
    buffer_load_dwordx4 v[128:131], v251, s[32:35], s67 offen offset:0 sc1
    s_waitcnt lgkmcnt(0)
    v_mfma_f32_16x16x32_bf16 v[64:67], v[220:223], v[80:83], 0
    v_swap_b32 v94, v91
    v_mfma_f32_16x16x32_bf16 v[240:243], v[80:83], v[80:83], 0
    v_and_b32 v88, v15, v88
    v_and_b32 v92, v15, v92
    v_mfma_f32_16x16x32_bf16 v[20:23], v[208:211], v[84:87], 0
    ds_read_b128 v[224:227], v2 offset:4096
    buffer_load_dwordx4 v[132:135], v251, s[32:35], s67 offen offset:256 sc1
    v_mfma_f32_16x16x32_bf16 v[36:39], v[212:215], v[84:87], 0
    ds_read_b128 v[228:231], v2 offset:5120
    buffer_load_dwordx4 v[136:139], v251, s[32:35], s67 offen offset:2048 sc1
    v_mfma_f32_16x16x32_bf16 v[52:55], v[216:219], v[84:87], 0
    ds_read_b128 v[232:235], v2 offset:6144
    buffer_load_dwordx4 v[140:143], v251, s[32:35], s67 offen offset:2304 sc1
    v_cndmask_b32 v10, v240, v241, s[4:5]
    v_mfma_f32_16x16x32_bf16 v[68:71], v[220:223], v[84:87], 0
    s_waitcnt vmcnt(8)
    v_bitop3_b32 v9, v111, v103, v107 bitop3:0x80
    v_bitop3_b32 v9, v9, v99, 1 bitop3:0x80
    v_mfma_f32_16x16x32_bf16 v[244:247], v[84:87], v[84:87], 0
    v_cmp_eq_u32 vcc, 0, v9
    ds_read_b128 v[236:239], v2 offset:7168
    v_mfma_f32_16x16x32_bf16 v[24:27], v[208:211], v[88:91], 0
    buffer_load_dwordx4 v[144:147], v251, s[32:35], s68 offen offset:0 sc1
    v_cndmask_b32 v240, v242, v243, s[4:5]
    v_mfma_f32_16x16x32_bf16 v[40:43], v[212:215], v[88:91], 0
    s_cbranch_vccnz L_slow_g1b_1
L_back_g1b_1:
    v_mfma_f32_16x16x32_bf16 v[56:59], v[216:219], v[88:91], 0
    buffer_load_dwordx4 v[148:151], v251, s[32:35], s68 offen offset:256 sc1
    v_cndmask_b32 v10, v10, v240, s[6:7]
    v_cndmask_b32 v11, v244, v245, s[4:5]
    v_cndmask_b32 v244, v246, v247, s[4:5]
    v_mfma_f32_16x16x32_bf16 v[72:75], v[220:223], v[88:91], 0
    v_swap_b32 v100, v97
    v_mfma_f32_16x16x32_bf16 v[240:243], v[88:91], v[88:91], 0
    v_swap_b32 v104, v98
    v_mfma_f32_16x16x32_bf16 v[28:31], v[208:211], v[92:95], 0
    v_swap_b32 v108, v99
    v_mfma_f32_16x16x32_bf16 v[44:47], v[212:215], v[92:95], 0
    buffer_load_dwordx4 v[152:155], v251, s[32:35], s68 offen offset:2048 sc1
    v_cndmask_b32 v11, v11, v244, s[6:7]
    v_mfma_f32_16x16x32_bf16 v[60:63], v[216:219], v[92:95], 0
    v_swap_b32 v105, v102
    v_cndmask_b32 v12, v240, v241, s[4:5]
    v_mfma_f32_16x16x32_bf16 v[76:79], v[220:223], v[92:95], 0
    v_swap_b32 v109, v103
    v_mfma_f32_16x16x32_bf16 v[244:247], v[92:95], v[92:95], 0
    v_swap_b32 v110, v107
    s_waitcnt lgkmcnt(0)
    v_mfma_f32_16x16x32_bf16 v[16:19], v[224:227], v[96:99], v[16:19]
    ds_read_b128 v[208:211], v2 offset:8192
    buffer_load_dwordx4 v[156:159], v251, s[32:35], s68 offen offset:2304 sc1
    v_mfma_f32_16x16x32_bf16 v[20:23], v[224:227], v[100:103], v[20:23]
    ds_read_b128 v[212:215], v2 offset:9216
    v_cndmask_b32 v240, v242, v243, s[4:5]
    v_mfma_f32_16x16x32_bf16 v[24:27], v[224:227], v[104:107], v[24:27]
    ds_read_b128 v[216:219], v2 offset:10240
    buffer_load_dwordx4 v[160:163], v251, s[32:35], s69 offen offset:0 sc1
    v_cndmask_b32 v13, v244, v245, s[4:5]
    v_mfma_f32_16x16x32_bf16 v[28:31], v[224:227], v[108:111], v[28:31]
    ds_read_b128 v[220:223], v2 offset:11264
    v_cndmask_b32 v12, v12, v240, s[6:7]
    v_mfma_f32_16x16x32_bf16 v[32:35], v[228:231], v[96:99], v[32:35]
    s_waitcnt vmcnt(9)
    v_bitop3_b32 v9, v127, v119, v123 bitop3:0x80
    v_bitop3_b32 v9, v9, v115, 1 bitop3:0x80
    v_mfma_f32_16x16x32_bf16 v[36:39], v[228:231], v[100:103], v[36:39]
    v_cmp_eq_u32 vcc, 0, v9
    buffer_load_dwordx4 v[164:167], v251, s[32:35], s69 offen offset:256 sc1
    v_mfma_f32_16x16x32_bf16 v[40:43], v[228:231], v[104:107], v[40:43]
    buffer_load_dwordx4 v[168:171], v251, s[32:35], s69 offen offset:2048 sc1
    v_cndmask_b32 v244, v246, v247, s[4:5]
    v_mfma_f32_16x16x32_bf16 v[44:47], v[228:231], v[108:111], v[44:47]
    s_cbranch_vccnz L_slow_g1b_2
L_back_g1b_2:
    v_mfma_f32_16x16x32_bf16 v[48:51], v[232:235], v[96:99], v[48:51]
    buffer_load_dwordx4 v[172:175], v251, s[32:35], s69 offen offset:2304 sc1
    v_cndmask_b32 v13, v13, v244, s[6:7]
    v_mfma_f32_16x16x32_bf16 v[52:55], v[232:235], v[100:103], v[52:55]
    v_swap_b32 v116, v113
    v_mfma_f32_16x16x32_bf16 v[56:59], v[232:235], v[104:107], v[56:59]
    v_swap_b32 v120, v114
    v_mfma_f32_16x16x32_bf16 v[60:63], v[232:235], v[108:111], v[60:63]
    v_swap_b32 v124, v115
    v_mfma_f32_16x16x32_bf16 v[64:67], v[236:239], v[96:99], v[64:67]
    s_mov_b32 exec_lo, 0x00f0000f
    s_mov_b32 exec_hi, 0xf0000f00
    buffer_store_dwordx4 v[10:13], v250, s[28:31], s8 offen sc1
    s_mov_b64 exec, -1
    v_mfma_f32_16x16x32_bf16 v[68:71], v[236:239], v[100:103], v[68:71]
    v_swap_b32 v121, v118
    v_mfma_f32_16x16x32_bf16 v[72:75], v[236:239], v[104:107], v[72:75]
    v_swap_b32 v125, v119
    v_mfma_f32_16x16x32_bf16 v[76:79], v[236:239], v[108:111], v[76:79]
    v_swap_b32 v126, v123
    s_waitcnt lgkmcnt(0)
    v_mfma_f32_16x16x32_bf16 v[16:19], v[208:211], v[112:115], v[16:19]
    ds_read_b128 v[224:227], v2 offset:12288
    buffer_load_dwordx4 v[176:179], v251, s[32:35], s70 offen offset:0 sc1
    v_mfma_f32_16x16x32_bf16 v[20:23], v[208:211], v[116:119], v[20:23]
    ds_read_b128 v[228:231], v2 offset:13312
    v_mfma_f32_16x16x32_bf16 v[24:27], v[208:211], v[120:123], v[24:27]
    ds_read_b128 v[232:235], v2 offset:14336
    v_mfma_f32_16x16x32_bf16 v[28:31], v[208:211], v[124:127], v[28:31]
    ds_read_b128 v[236:239], v2 offset:15360
    v_mfma_f32_16x16x32_bf16 v[32:35], v[212:215], v[112:115], v[32:35]
    s_waitcnt vmcnt(10)
    v_bitop3_b32 v9, v143, v135, v139 bitop3:0x80
    v_bitop3_b32 v9, v9, v131, 1 bitop3:0x80
    v_mfma_f32_16x16x32_bf16 v[36:39], v[212:215], v[116:119], v[36:39]
    v_cmp_eq_u32 vcc, 0, v9
    buffer_load_dwordx4 v[180:183], v251, s[32:35], s70 offen offset:256 sc1
    v_mfma_f32_16x16x32_bf16 v[40:43], v[212:215], v[120:123], v[40:43]
    v_mfma_f32_16x16x32_bf16 v[44:47], v[212:215], v[124:127], v[44:47]
    s_cbranch_vccnz L_slow_g1b_3
L_back_g1b_3:
    v_mfma_f32_16x16x32_bf16 v[48:51], v[216:219], v[112:115], v[48:51]
    buffer_load_dwordx4 v[184:187], v251, s[32:35], s70 offen offset:2048 sc1
    v_mfma_f32_16x16x32_bf16 v[52:55], v[216:219], v[116:119], v[52:55]
    v_swap_b32 v132, v129
    v_mfma_f32_16x16x32_bf16 v[56:59], v[216:219], v[120:123], v[56:59]
    v_swap_b32 v136, v130
    v_mfma_f32_16x16x32_bf16 v[60:63], v[216:219], v[124:127], v[60:63]
    v_swap_b32 v140, v131
    v_mfma_f32_16x16x32_bf16 v[64:67], v[220:223], v[112:115], v[64:67]
    buffer_load_dwordx4 v[188:191], v251, s[32:35], s70 offen offset:2304 sc1
    v_mfma_f32_16x16x32_bf16 v[68:71], v[220:223], v[116:119], v[68:71]
    v_swap_b32 v137, v134
    v_mfma_f32_16x16x32_bf16 v[72:75], v[220:223], v[120:123], v[72:75]
    v_swap_b32 v141, v135
    v_mfma_f32_16x16x32_bf16 v[76:79], v[220:223], v[124:127], v[76:79]
    v_swap_b32 v142, v139
    s_waitcnt lgkmcnt(0)
    v_mfma_f32_16x16x32_bf16 v[16:19], v[224:227], v[128:131], v[16:19]
    ds_read_b128 v[208:211], v2 offset:16384
    buffer_load_dwordx4 v[192:195], v251, s[32:35], s71 offen offset:0 sc1
    v_mfma_f32_16x16x32_bf16 v[20:23], v[224:227], v[132:135], v[20:23]
    ds_read_b128 v[212:215], v2 offset:17408
    v_mfma_f32_16x16x32_bf16 v[24:27], v[224:227], v[136:139], v[24:27]
    ds_read_b128 v[216:219], v2 offset:18432
    v_mfma_f32_16x16x32_bf16 v[28:31], v[224:227], v[140:143], v[28:31]
    ds_read_b128 v[220:223], v2 offset:19456
    v_mfma_f32_16x16x32_bf16 v[32:35], v[228:231], v[128:131], v[32:35]
    s_waitcnt vmcnt(10)
    v_bitop3_b32 v9, v159, v151, v155 bitop3:0x80
    v_bitop3_b32 v9, v9, v147, 1 bitop3:0x80
    v_mfma_f32_16x16x32_bf16 v[36:39], v[228:231], v[132:135], v[36:39]
    v_cmp_eq_u32 vcc, 0, v9
    buffer_load_dwordx4 v[196:199], v251, s[32:35], s71 offen offset:256 sc1
    v_mfma_f32_16x16x32_bf16 v[40:43], v[228:231], v[136:139], v[40:43]
    v_mfma_f32_16x16x32_bf16 v[44:47], v[228:231], v[140:143], v[44:47]
    s_cbranch_vccnz L_slow_g1b_4
L_back_g1b_4:
    v_mfma_f32_16x16x32_bf16 v[48:51], v[232:235], v[128:131], v[48:51]
    buffer_load_dwordx4 v[200:203], v251, s[32:35], s71 offen offset:2048 sc1
    v_mfma_f32_16x16x32_bf16 v[52:55], v[232:235], v[132:135], v[52:55]
    v_swap_b32 v148, v145
    v_mfma_f32_16x16x32_bf16 v[56:59], v[232:235], v[136:139], v[56:59]
    v_swap_b32 v152, v146
    v_mfma_f32_16x16x32_bf16 v[60:63], v[232:235], v[140:143], v[60:63]
    v_swap_b32 v156, v147
    v_mfma_f32_16x16x32_bf16 v[64:67], v[236:239], v[128:131], v[64:67]
    buffer_load_dwordx4 v[204:207], v251, s[32:35], s71 offen offset:2304 sc1
    v_mfma_f32_16x16x32_bf16 v[68:71], v[236:239], v[132:135], v[68:71]
    v_swap_b32 v153, v150
    v_mfma_f32_16x16x32_bf16 v[72:75], v[236:239], v[136:139], v[72:75]
    v_swap_b32 v157, v151
    v_mfma_f32_16x16x32_bf16 v[76:79], v[236:239], v[140:143], v[76:79]
    v_swap_b32 v158, v155
    s_waitcnt lgkmcnt(0)
    v_mfma_f32_16x16x32_bf16 v[16:19], v[208:211], v[144:147], v[16:19]
    ds_read_b128 v[224:227], v2 offset:20480
    buffer_load_dwordx4 v[80:83], v251, s[32:35], s72 offen offset:0 sc1
    v_mfma_f32_16x16x32_bf16 v[20:23], v[208:211], v[148:151], v[20:23]
    ds_read_b128 v[228:231], v2 offset:21504
    v_mfma_f32_16x16x32_bf16 v[24:27], v[208:211], v[152:155], v[24:27]
    ds_read_b128 v[232:235], v2 offset:22528
    v_mfma_f32_16x16x32_bf16 v[28:31], v[208:211], v[156:159], v[28:31]
    ds_read_b128 v[236:239], v2 offset:23552
    v_mfma_f32_16x16x32_bf16 v[32:35], v[212:215], v[144:147], v[32:35]
    s_waitcnt vmcnt(10)
    v_bitop3_b32 v9, v175, v167, v171 bitop3:0x80
    v_bitop3_b32 v9, v9, v163, 1 bitop3:0x80
    v_mfma_f32_16x16x32_bf16 v[36:39], v[212:215], v[148:151], v[36:39]
    v_cmp_eq_u32 vcc, 0, v9
    buffer_load_dwordx4 v[84:87], v251, s[32:35], s72 offen offset:256 sc1
    v_mfma_f32_16x16x32_bf16 v[40:43], v[212:215], v[152:155], v[40:43]
    v_mfma_f32_16x16x32_bf16 v[44:47], v[212:215], v[156:159], v[44:47]
    s_cbranch_vccnz L_slow_g1b_5
L_back_g1b_5:
    v_mfma_f32_16x16x32_bf16 v[48:51], v[216:219], v[144:147], v[48:51]
    buffer_load_dwordx4 v[88:91], v251, s[32:35], s72 offen offset:2048 sc1
    v_mfma_f32_16x16x32_bf16 v[52:55], v[216:219], v[148:151], v[52:55]
    v_swap_b32 v164, v161
    v_mfma_f32_16x16x32_bf16 v[56:59], v[216:219], v[152:155], v[56:59]
    v_swap_b32 v168, v162
    v_mfma_f32_16x16x32_bf16 v[60:63], v[216:219], v[156:159], v[60:63]
    v_swap_b32 v172, v163
    v_mfma_f32_16x16x32_bf16 v[64:67], v[220:223], v[144:147], v[64:67]
    buffer_load_dwordx4 v[92:95], v251, s[32:35], s72 offen offset:2304 sc1
    v_mfma_f32_16x16x32_bf16 v[68:71], v[220:223], v[148:151], v[68:71]
    v_swap_b32 v169, v166
    v_mfma_f32_16x16x32_bf16 v[72:75], v[220:223], v[152:155], v[72:75]
    v_swap_b32 v173, v167
    v_mfma_f32_16x16x32_bf16 v[76:79], v[220:223], v[156:159], v[76:79]
    v_swap_b32 v174, v171
    s_waitcnt lgkmcnt(0)
    v_mfma_f32_16x16x32_bf16 v[16:19], v[224:227], v[160:163], v[16:19]
    ds_read_b128 v[208:211], v2 offset:24576
    buffer_load_dwordx4 v[96:99], v251, s[32:35], s73 offen offset:0 sc1
    v_mfma_f32_16x16x32_bf16 v[20:23], v[224:227], v[164:167], v[20:23]
    ds_read_b128 v[212:215], v2 offset:25600
    v_mfma_f32_16x16x32_bf16 v[24:27], v[224:227], v[168:171], v[24:27]
    ds_read_b128 v[216:219], v2 offset:26624
    v_mfma_f32_16x16x32_bf16 v[28:31], v[224:227], v[172:175], v[28:31]
    ds_read_b128 v[220:223], v2 offset:27648
    v_mfma_f32_16x16x32_bf16 v[32:35], v[228:231], v[160:163], v[32:35]
    s_waitcnt vmcnt(9)
    v_bitop3_b32 v9, v191, v183, v187 bitop3:0x80
    v_bitop3_b32 v9, v9, v179, 1 bitop3:0x80
    v_mfma_f32_16x16x32_bf16 v[36:39], v[228:231], v[164:167], v[36:39]
    v_cmp_eq_u32 vcc, 0, v9
    buffer_load_dwordx4 v[100:103], v251, s[32:35], s73 offen offset:256 sc1
    v_mfma_f32_16x16x32_bf16 v[40:43], v[228:231], v[168:171], v[40:43]
    v_mfma_f32_16x16x32_bf16 v[44:47], v[228:231], v[172:175], v[44:47]
    s_cbranch_vccnz L_slow_g1b_6
L_back_g1b_6:
    v_mfma_f32_16x16x32_bf16 v[48:51], v[232:235], v[160:163], v[48:51]
    buffer_load_dwordx4 v[104:107], v251, s[32:35], s73 offen offset:2048 sc1
    v_mfma_f32_16x16x32_bf16 v[52:55], v[232:235], v[164:167], v[52:55]
    v_swap_b32 v180, v177
    v_mfma_f32_16x16x32_bf16 v[56:59], v[232:235], v[168:171], v[56:59]
    v_swap_b32 v184, v178
    v_mfma_f32_16x16x32_bf16 v[60:63], v[232:235], v[172:175], v[60:63]
    v_swap_b32 v188, v179
    v_mfma_f32_16x16x32_bf16 v[64:67], v[236:239], v[160:163], v[64:67]
    buffer_load_dwordx4 v[108:111], v251, s[32:35], s73 offen offset:2304 sc1
    v_mfma_f32_16x16x32_bf16 v[68:71], v[236:239], v[164:167], v[68:71]
    v_swap_b32 v185, v182
    v_mfma_f32_16x16x32_bf16 v[72:75], v[236:239], v[168:171], v[72:75]
    v_swap_b32 v189, v183
    v_mfma_f32_16x16x32_bf16 v[76:79], v[236:239], v[172:175], v[76:79]
    v_swap_b32 v190, v187
    s_waitcnt lgkmcnt(0)
    v_mfma_f32_16x16x32_bf16 v[16:19], v[208:211], v[176:179], v[16:19]
    ds_read_b128 v[224:227], v2 offset:28672
    buffer_load_dwordx4 v[112:115], v251, s[32:35], s74 offen offset:0 sc1
    v_mfma_f32_16x16x32_bf16 v[20:23], v[208:211], v[180:183], v[20:23]
    ds_read_b128 v[228:231], v2 offset:29696
    v_mfma_f32_16x16x32_bf16 v[24:27], v[208:211], v[184:187], v[24:27]
    ds_read_b128 v[232:235], v2 offset:30720
    v_mfma_f32_16x16x32_bf16 v[28:31], v[208:211], v[188:191], v[28:31]
    ds_read_b128 v[236:239], v2 offset:31744
    v_mfma_f32_16x16x32_bf16 v[32:35], v[212:215], v[176:179], v[32:35]
    s_waitcnt vmcnt(9)
    v_bitop3_b32 v9, v207, v199, v203 bitop3:0x80
    v_bitop3_b32 v9, v9, v195, 1 bitop3:0x80
    v_mfma_f32_16x16x32_bf16 v[36:39], v[212:215], v[180:183], v[36:39]
    v_cmp_eq_u32 vcc, 0, v9
    buffer_load_dwordx4 v[116:119], v251, s[32:35], s74 offen offset:256 sc1
    v_mfma_f32_16x16x32_bf16 v[40:43], v[212:215], v[184:187], v[40:43]
    v_mfma_f32_16x16x32_bf16 v[44:47], v[212:215], v[188:191], v[44:47]
    s_cbranch_vccnz L_slow_g1b_7
L_back_g1b_7:
    v_mfma_f32_16x16x32_bf16 v[48:51], v[216:219], v[176:179], v[48:51]
    buffer_load_dwordx4 v[120:123], v251, s[32:35], s74 offen offset:2048 sc1
    v_mfma_f32_16x16x32_bf16 v[52:55], v[216:219], v[180:183], v[52:55]
    v_swap_b32 v196, v193
    v_mfma_f32_16x16x32_bf16 v[56:59], v[216:219], v[184:187], v[56:59]
    v_swap_b32 v200, v194
    v_mfma_f32_16x16x32_bf16 v[60:63], v[216:219], v[188:191], v[60:63]
    v_swap_b32 v204, v195
    v_mfma_f32_16x16x32_bf16 v[64:67], v[220:223], v[176:179], v[64:67]
    buffer_load_dwordx4 v[124:127], v251, s[32:35], s74 offen offset:2304 sc1
    v_mfma_f32_16x16x32_bf16 v[68:71], v[220:223], v[180:183], v[68:71]
    v_swap_b32 v201, v198
    v_mfma_f32_16x16x32_bf16 v[72:75], v[220:223], v[184:187], v[72:75]
    v_swap_b32 v205, v199
    v_mfma_f32_16x16x32_bf16 v[76:79], v[220:223], v[188:191], v[76:79]
    v_swap_b32 v206, v203
    s_waitcnt lgkmcnt(0)
    v_mfma_f32_16x16x32_bf16 v[16:19], v[224:227], v[192:195], v[16:19]
    ds_read_b128 v[208:211], v2 offset:32768
    buffer_load_dwordx4 v[128:131], v251, s[32:35], s75 offen offset:0 sc1
    v_mfma_f32_16x16x32_bf16 v[20:23], v[224:227], v[196:199], v[20:23]
    ds_read_b128 v[212:215], v2 offset:33792
    v_mov_b32 v188, 0
    v_mfma_f32_16x16x32_bf16 v[24:27], v[224:227], v[200:203], v[24:27]
    ds_read_b128 v[216:219], v2 offset:34816
    v_mov_b32 v189, 0
    v_mfma_f32_16x16x32_bf16 v[28:31], v[224:227], v[204:207], v[28:31]
    ds_read_b128 v[220:223], v2 offset:35840
    v_mov_b32 v190, 0
    v_mfma_f32_16x16x32_bf16 v[32:35], v[228:231], v[192:195], v[32:35]
    s_waitcnt vmcnt(9)
    v_bitop3_b32 v9, v95, v87, v91 bitop3:0x80
    v_bitop3_b32 v9, v9, v83, 1 bitop3:0x80
    v_mfma_f32_16x16x32_bf16 v[36:39], v[228:231], v[196:199], v[36:39]
    v_cmp_eq_u32 vcc, 0, v9
    buffer_load_dwordx4 v[132:135], v251, s[32:35], s75 offen offset:256 sc1
    v_mfma_f32_16x16x32_bf16 v[40:43], v[228:231], v[200:203], v[40:43]
    v_mov_b32 v191, 0
    v_mfma_f32_16x16x32_bf16 v[44:47], v[228:231], v[204:207], v[44:47]
    s_cbranch_vccnz L_slow_g1b_8
L_back_g1b_8:
    v_mfma_f32_16x16x32_bf16 v[48:51], v[232:235], v[192:195], v[48:51]
    buffer_load_dwordx4 v[136:139], v251, s[32:35], s75 offen offset:2048 sc1
    v_mfma_f32_16x16x32_bf16 v[52:55], v[232:235], v[196:199], v[52:55]
    v_swap_b32 v84, v81
    v_mfma_f32_16x16x32_bf16 v[56:59], v[232:235], v[200:203], v[56:59]
    v_swap_b32 v88, v82
    v_mfma_f32_16x16x32_bf16 v[60:63], v[232:235], v[204:207], v[60:63]
    v_swap_b32 v92, v83
    v_mfma_f32_16x16x32_bf16 v[64:67], v[236:239], v[192:195], v[64:67]
    buffer_load_dwordx4 v[140:143], v251, s[32:35], s75 offen offset:2304 sc1
    v_mfma_f32_16x16x32_bf16 v[68:71], v[236:239], v[196:199], v[68:71]
    v_swap_b32 v89, v86
    v_mfma_f32_16x16x32_bf16 v[72:75], v[236:239], v[200:203], v[72:75]
    v_swap_b32 v93, v87
    v_mfma_f32_16x16x32_bf16 v[76:79], v[236:239], v[204:207], v[76:79]
    v_swap_b32 v94, v91
    s_waitcnt lgkmcnt(0)
    v_mfma_f32_16x16x32_bf16 v[16:19], v[208:211], v[80:83], v[16:19]
    ds_read_b128 v[224:227], v2 offset:36864
    buffer_load_dwordx4 v[144:147], v251, s[32:35], s76 offen offset:0 sc1
    v_mfma_f32_16x16x32_bf16 v[20:23], v[208:211], v[84:87], v[20:23]
    ds_read_b128 v[228:231], v2 offset:37888
    buffer_load_dwordx4 v[176:179], v2, s[28:31], s9 offen offset:0 sc1
    v_mfma_f32_16x16x32_bf16 v[24:27], v[208:211], v[88:91], v[24:27]
    ds_read_b128 v[232:235], v2 offset:38912
    v_mfma_f32_16x16x32_bf16 v[28:31], v[208:211], v[92:95], v[28:31]
    ds_read_b128 v[236:239], v2 offset:39936
    buffer_load_dwordx4 v[180:183], v2, s[28:31], s9 offen offset:1024 sc1
    v_mfma_f32_16x16x32_bf16 v[32:35], v[212:215], v[80:83], v[32:35]
    s_waitcnt vmcnt(11)
    v_bitop3_b32 v9, v111, v103, v107 bitop3:0x80
    v_bitop3_b32 v9, v9, v99, 1 bitop3:0x80
    v_mfma_f32_16x16x32_bf16 v[36:39], v[212:215], v[84:87], v[36:39]
    v_cmp_eq_u32 vcc, 0, v9
    buffer_load_dwordx4 v[148:151], v251, s[32:35], s76 offen offset:256 sc1
    v_mfma_f32_16x16x32_bf16 v[40:43], v[212:215], v[88:91], v[40:43]
    buffer_load_dwordx4 v[184:187], v2, s[28:31], s9 offen offset:2048 sc1
    v_mfma_f32_16x16x32_bf16 v[44:47], v[212:215], v[92:95], v[44:47]
    s_cbranch_vccnz L_slow_g1b_9
L_back_g1b_9:
    v_mfma_f32_16x16x32_bf16 v[48:51], v[216:219], v[80:83], v[48:51]
    buffer_load_dwordx4 v[152:155], v251, s[32:35], s76 offen offset:2048 sc1
    v_mfma_f32_16x16x32_bf16 v[52:55], v[216:219], v[84:87], v[52:55]
    v_swap_b32 v100, v97
    v_mfma_f32_16x16x32_bf16 v[56:59], v[216:219], v[88:91], v[56:59]
    v_swap_b32 v104, v98
    v_mfma_f32_16x16x32_bf16 v[60:63], v[216:219], v[92:95], v[60:63]
    v_swap_b32 v108, v99
    v_mfma_f32_16x16x32_bf16 v[64:67], v[220:223], v[80:83], v[64:67]
    buffer_load_dwordx4 v[156:159], v251, s[32:35], s76 offen offset:2304 sc1
    v_mfma_f32_16x16x32_bf16 v[68:71], v[220:223], v[84:87], v[68:71]
    v_swap_b32 v105, v102
    v_mfma_f32_16x16x32_bf16 v[72:75], v[220:223], v[88:91], v[72:75]
    v_swap_b32 v109, v103
    v_mfma_f32_16x16x32_bf16 v[76:79], v[220:223], v[92:95], v[76:79]
    v_swap_b32 v110, v107
    s_waitcnt lgkmcnt(0)
    v_mfma_f32_16x16x32_bf16 v[16:19], v[224:227], v[96:99], v[16:19]
    ds_read_b128 v[208:211], v2 offset:40960
    buffer_load_dwordx4 v[160:163], v251, s[32:35], s77 offen offset:0 sc1
    v_mfma_f32_16x16x32_bf16 v[20:23], v[224:227], v[100:103], v[20:23]
    ds_read_b128 v[212:215], v2 offset:41984
    v_mfma_f32_16x16x32_bf16 v[24:27], v[224:227], v[104:107], v[24:27]
    ds_read_b128 v[216:219], v2 offset:43008
    v_mfma_f32_16x16x32_bf16 v[28:31], v[224:227], v[108:111], v[28:31]
    ds_read_b128 v[220:223], v2 offset:44032
    v_mfma_f32_16x16x32_bf16 v[32:35], v[228:231], v[96:99], v[32:35]
    s_waitcnt vmcnt(12)
    v_bitop3_b32 v9, v127, v119, v123 bitop3:0x80
    v_bitop3_b32 v9, v9, v115, 1 bitop3:0x80
    v_mfma_f32_16x16x32_bf16 v[36:39], v[228:231], v[100:103], v[36:39]
    v_cmp_eq_u32 vcc, 0, v9
    buffer_load_dwordx4 v[164:167], v251, s[32:35], s77 offen offset:256 sc1
    v_mfma_f32_16x16x32_bf16 v[40:43], v[228:231], v[104:107], v[40:43]
    s_mov_b32 exec_hi, 0
    buffer_load_dwordx4 v[188:191], v2, s[28:31], s9 offen offset:3072 sc1
    s_mov_b64 exec, -1
    v_mfma_f32_16x16x32_bf16 v[44:47], v[228:231], v[108:111], v[44:47]
    s_cbranch_vccnz L_slow_g1b_10
L_back_g1b_10:
    v_mfma_f32_16x16x32_bf16 v[48:51], v[232:235], v[96:99], v[48:51]
    buffer_load_dwordx4 v[168:171], v251, s[32:35], s77 offen offset:2048 sc1
    v_mfma_f32_16x16x32_bf16 v[52:55], v[232:235], v[100:103], v[52:55]
    v_swap_b32 v116, v113
    v_mfma_f32_16x16x32_bf16 v[56:59], v[232:235], v[104:107], v[56:59]
    v_swap_b32 v120, v114
    v_mfma_f32_16x16x32_bf16 v[60:63], v[232:235], v[108:111], v[60:63]
    v_swap_b32 v124, v115
    v_mfma_f32_16x16x32_bf16 v[64:67], v[236:239], v[96:99], v[64:67]
    buffer_load_dwordx4 v[172:175], v251, s[32:35], s77 offen offset:2304 sc1
    v_mfma_f32_16x16x32_bf16 v[68:71], v[236:239], v[100:103], v[68:71]
    v_swap_b32 v121, v118
    v_mfma_f32_16x16x32_bf16 v[72:75], v[236:239], v[104:107], v[72:75]
    v_swap_b32 v125, v119
    v_mfma_f32_16x16x32_bf16 v[76:79], v[236:239], v[108:111], v[76:79]
    v_swap_b32 v126, v123
    s_waitcnt lgkmcnt(0)
    v_mfma_f32_16x16x32_bf16 v[16:19], v[208:211], v[112:115], v[16:19]
    ds_read_b128 v[224:227], v2 offset:45056
    v_mfma_f32_16x16x32_bf16 v[20:23], v[208:211], v[116:119], v[20:23]
    ds_read_b128 v[228:231], v2 offset:46080
    v_mfma_f32_16x16x32_bf16 v[24:27], v[208:211], v[120:123], v[24:27]
    ds_read_b128 v[232:235], v2 offset:47104
    v_mfma_f32_16x16x32_bf16 v[28:31], v[208:211], v[124:127], v[28:31]
    ds_read_b128 v[236:239], v2 offset:48128
    v_mfma_f32_16x16x32_bf16 v[32:35], v[212:215], v[112:115], v[32:35]
    s_waitcnt vmcnt(12)
    v_bitop3_b32 v9, v143, v135, v139 bitop3:0x80
    v_bitop3_b32 v9, v9, v131, 1 bitop3:0x80
    v_mfma_f32_16x16x32_bf16 v[36:39], v[212:215], v[116:119], v[36:39]
    v_cmp_eq_u32 vcc, 0, v9
    v_mfma_f32_16x16x32_bf16 v[40:43], v[212:215], v[120:123], v[40:43]
    v_mfma_f32_16x16x32_bf16 v[44:47], v[212:215], v[124:127], v[44:47]
    s_cbranch_vccnz L_slow_g1b_11
L_back_g1b_11:
    v_mfma_f32_16x16x32_bf16 v[48:51], v[216:219], v[112:115], v[48:51]
    v_mfma_f32_16x16x32_bf16 v[52:55], v[216:219], v[116:119], v[52:55]
    v_swap_b32 v132, v129
    v_mfma_f32_16x16x32_bf16 v[56:59], v[216:219], v[120:123], v[56:59]
    v_swap_b32 v136, v130
    v_mfma_f32_16x16x32_bf16 v[60:63], v[216:219], v[124:127], v[60:63]
    v_swap_b32 v140, v131
    v_mfma_f32_16x16x32_bf16 v[64:67], v[220:223], v[112:115], v[64:67]
    v_mfma_f32_16x16x32_bf16 v[68:71], v[220:223], v[116:119], v[68:71]
    v_swap_b32 v137, v134
    v_mfma_f32_16x16x32_bf16 v[72:75], v[220:223], v[120:123], v[72:75]
    v_swap_b32 v141, v135
    v_mfma_f32_16x16x32_bf16 v[76:79], v[220:223], v[124:127], v[76:79]
    v_swap_b32 v142, v139
    s_waitcnt lgkmcnt(0)
    v_mfma_f32_16x16x32_bf16 v[16:19], v[224:227], v[128:131], v[16:19]
    ds_read_b128 v[208:211], v2 offset:49152
    buffer_load_dwordx4 a[184:187], v6, s[44:47], s91 offen offset:0 sc1
    v_accvgpr_read_b32 v112, a224
    v_accvgpr_read_b32 v113, a225
    v_accvgpr_read_b32 v114, a226
    v_accvgpr_read_b32 v115, a227
    v_accvgpr_read_b32 v116, a228
    v_mfma_f32_16x16x32_bf16 v[20:23], v[224:227], v[132:135], v[20:23]
    ds_read_b128 v[212:215], v2 offset:50176
    v_accvgpr_read_b32 v117, a229
    v_mfma_f32_16x16x32_bf16 v[24:27], v[224:227], v[136:139], v[24:27]
    ds_read_b128 v[216:219], v2 offset:51200
    v_accvgpr_read_b32 v118, a230
    v_mfma_f32_16x16x32_bf16 v[28:31], v[224:227], v[140:143], v[28:31]
    ds_read_b128 v[220:223], v2 offset:52224
    buffer_load_dwordx4 a[188:191], v6, s[44:47], s91 offen offset:1024 sc1
    v_mfma_f32_16x16x32_bf16 v[32:35], v[228:231], v[128:131], v[32:35]
    s_waitcnt vmcnt(7)
    v_bitop3_b32 v9, v159, v151, v155 bitop3:0x80
    v_bitop3_b32 v9, v9, v147, 1 bitop3:0x80
    v_mfma_f32_16x16x32_bf16 v[36:39], v[228:231], v[132:135], v[36:39]
    v_cmp_eq_u32 vcc, 0, v9
    v_accvgpr_read_b32 v119, a231
    v_mfma_f32_16x16x32_bf16 v[40:43], v[228:231], v[136:139], v[40:43]
    buffer_load_dwordx4 a[192:195], v5, s[44:47], s92 offen offset:0 sc1
    v_accvgpr_read_b32 v120, a232
    v_mfma_f32_16x16x32_bf16 v[44:47], v[228:231], v[140:143], v[44:47]
    s_cbranch_vccnz L_slow_g1b_12
L_back_g1b_12:
    v_mfma_f32_16x16x32_bf16 v[48:51], v[232:235], v[128:131], v[48:51]
    buffer_load_dwordx4 a[196:199], v5, s[44:47], s92 offen offset:1024 sc1
    v_accvgpr_read_b32 v121, a233
    v_mfma_f32_16x16x32_bf16 v[52:55], v[232:235], v[132:135], v[52:55]
    v_swap_b32 v148, v145
    v_mfma_f32_16x16x32_bf16 v[56:59], v[232:235], v[136:139], v[56:59]
    v_swap_b32 v152, v146
    v_mfma_f32_16x16x32_bf16 v[60:63], v[232:235], v[140:143], v[60:63]
    v_swap_b32 v156, v147
    v_mfma_f32_16x16x32_bf16 v[64:67], v[236:239], v[128:131], v[64:67]
    buffer_load_dwordx4 a[200:203], v6, s[44:47], s92 offen offset:0 sc1
    v_accvgpr_read_b32 v122, a234
    v_mfma_f32_16x16x32_bf16 v[68:71], v[236:239], v[132:135], v[68:71]
    v_swap_b32 v153, v150
    v_mfma_f32_16x16x32_bf16 v[72:75], v[236:239], v[136:139], v[72:75]
    v_swap_b32 v157, v151
    v_mfma_f32_16x16x32_bf16 v[76:79], v[236:239], v[140:143], v[76:79]
    v_swap_b32 v158, v155
    s_waitcnt lgkmcnt(0)
    v_mfma_f32_16x16x32_bf16 v[16:19], v[208:211], v[144:147], v[16:19]
    ds_read_b128 v[224:227], v2 offset:53248
    buffer_load_dwordx4 a[204:207], v6, s[44:47], s92 offen offset:1024 sc1
    v_add_f32 v192, v176, v180
    v_add_f32 v193, v177, v181
    v_add_f32 v194, v178, v182
    v_add_f32 v195, v179, v183
    s_waitcnt vmcnt(8)
    v_add_f32 v196, v184, v188
    v_add_f32 v197, v185, v189
    v_add_f32 v198, v186, v190
    v_add_f32 v199, v187, v191
    v_add_f32 v192, v192, v196
    v_add_f32 v193, v193, v197
    v_mfma_f32_16x16x32_bf16 v[20:23], v[208:211], v[148:151], v[20:23]
    ds_read_b128 v[228:231], v2 offset:54272
    v_add_f32 v194, v194, v198
    v_mfma_f32_16x16x32_bf16 v[24:27], v[208:211], v[152:155], v[24:27]
    ds_read_b128 v[232:235], v2 offset:55296
    v_add_f32 v195, v195, v199
    v_mfma_f32_16x16x32_bf16 v[28:31], v[208:211], v[156:159], v[28:31]
    ds_read_b128 v[236:239], v2 offset:56320
    buffer_load_dwordx4 a[208:211], v5, s[44:47], s93 offen offset:0 sc1
    v_mfma_f32_16x16x32_bf16 v[32:35], v[212:215], v[144:147], v[32:35]
    s_waitcnt vmcnt(7)
    v_bitop3_b32 v9, v175, v167, v171 bitop3:0x80
    v_bitop3_b32 v9, v9, v163, 1 bitop3:0x80
    v_mfma_f32_16x16x32_bf16 v[36:39], v[212:215], v[148:151], v[36:39]
    v_cmp_eq_u32 vcc, 0, v9
    v_permlane32_swap_b32 v192, v194
    v_mfma_f32_16x16x32_bf16 v[40:43], v[212:215], v[152:155], v[40:43]
    buffer_load_dwordx4 a[212:215], v5, s[44:47], s93 offen offset:1024 sc1
    v_permlane32_swap_b32 v193, v195
    v_mfma_f32_16x16x32_bf16 v[44:47], v[212:215], v[156:159], v[44:47]
    s_cbranch_vccnz L_slow_g1b_13
L_back_g1b_13:
    v_mfma_f32_16x16x32_bf16 v[48:51], v[216:219], v[144:147], v[48:51]
    buffer_load_dwordx4 a[216:219], v6, s[44:47], s93 offen offset:0 sc1
    v_add_f32 v192, v192, v194
    v_mfma_f32_16x16x32_bf16 v[52:55], v[216:219], v[148:151], v[52:55]
    v_swap_b32 v164, v161
    v_mfma_f32_16x16x32_bf16 v[56:59], v[216:219], v[152:155], v[56:59]
    v_swap_b32 v168, v162
    v_mfma_f32_16x16x32_bf16 v[60:63], v[216:219], v[156:159], v[60:63]
    v_swap_b32 v172, v163
    v_mfma_f32_16x16x32_bf16 v[64:67], v[220:223], v[144:147], v[64:67]
    buffer_load_dwordx4 a[220:223], v6, s[44:47], s93 offen offset:1024 sc1
    v_add_f32 v193, v193, v195
    v_mfma_f32_16x16x32_bf16 v[68:71], v[220:223], v[148:151], v[68:71]
    v_swap_b32 v169, v166
    v_mfma_f32_16x16x32_bf16 v[72:75], v[220:223], v[152:155], v[72:75]
    v_swap_b32 v173, v167
    v_mfma_f32_16x16x32_bf16 v[76:79], v[220:223], v[156:159], v[76:79]
    v_swap_b32 v174, v171
    s_waitcnt lgkmcnt(0)
    v_mfma_f32_16x16x32_bf16 v[16:19], v[224:227], v[160:163], v[16:19]
    v_permlane16_swap_b32 v192, v193
    s_mov_b32 s56, 0x409d30fc
    v_mfma_f32_16x16x32_bf16 v[20:23], v[224:227], v[164:167], v[20:23]
    v_add_f32 v192, v192, v193
    v_cmp_u_f32 s[98:99], v192, v192
    s_mov_b32 s57, 0x3eeff558
    v_mfma_f32_16x16x32_bf16 v[24:27], v[224:227], v[168:171], v[24:27]
    s_add_u32 s55, s61, 15114240
    s_add_u32 s59, s61, 15118336
    v_accvgpr_read_b32 v123, a235
    v_mfma_f32_16x16x32_bf16 v[28:31], v[224:227], v[172:175], v[28:31]
    s_cmp_lg_u64 s[98:99], 0
    s_cbranch_scc1 L_slow_g1brs
L_back_g1brs:
    v_mfma_f32_16x16x32_bf16 v[32:35], v[228:231], v[160:163], v[32:35]
    v_mov_b32 v194, 0x3727c5ac
    v_mul_f32 v192, 0x3b124925, v192
    v_mfma_f32_16x16x32_bf16 v[36:39], v[228:231], v[164:167], v[36:39]
    v_add_f32 v193, v192, v194
    v_accvgpr_read_b32 v124, a236
    v_mfma_f32_16x16x32_bf16 v[40:43], v[228:231], v[168:171], v[40:43]
    v_rsq_f32 v193, v193
    v_mfma_f32_16x16x32_bf16 v[44:47], v[228:231], v[172:175], v[44:47]
    v_mul_f32 v192, v192, v193
    v_fma_f32 v192, v192, v193, v194
    v_mfma_f32_16x16x32_bf16 v[48:51], v[232:235], v[160:163], v[48:51]
    v_rsq_f32 v192, v192
    v_mfma_f32_16x16x32_bf16 v[52:55], v[232:235], v[164:167], v[52:55]
    v_mul_f32 v193, 0x3eeff558, v193
    v_mul_f32 v240, v192, v193
    v_mfma_f32_16x16x32_bf16 v[56:59], v[232:235], v[168:171], v[56:59]
    v_mul_f32 v241, v192, v193
    v_accvgpr_read_b32 v125, a237
    v_mfma_f32_16x16x32_bf16 v[60:63], v[232:235], v[172:175], v[60:63]
    v_permlane16_swap_b32 v240, v241
    v_mfma_f32_16x16x32_bf16 v[64:67], v[236:239], v[160:163], v[64:67]
    v_mov_b32 v242, v240
    v_mov_b32 v243, v241
    v_mfma_f32_16x16x32_bf16 v[68:71], v[236:239], v[164:167], v[68:71]
    v_permlane32_swap_b32 v240, v242
    v_mfma_f32_16x16x32_bf16 v[72:75], v[236:239], v[168:171], v[72:75]
    v_permlane32_swap_b32 v241, v243
    v_mfma_f32_16x16x32_bf16 v[76:79], v[236:239], v[172:175], v[76:79]
    v_accvgpr_read_b32 v126, a238
    v_accvgpr_read_b32 v127, a239
    v_pk_fma_f32 v[16:17], v[16:17], v[240:241], v[112:113] op_sel:[0,0,0] op_sel_hi:[1,0,1]
    v_pk_fma_f32 v[18:19], v[18:19], v[240:241], v[114:115] op_sel:[0,0,0] op_sel_hi:[1,0,1]
    v_pk_fma_f32 v[208:209], v[16:17], v[16:17], s[56:57] op_sel_hi:[1,1,0]
    v_pk_fma_f32 v[32:33], v[32:33], v[240:241], v[116:117] op_sel:[0,0,0] op_sel_hi:[1,0,1]
    v_pk_fma_f32 v[210:211], v[18:19], v[18:19], s[56:57] op_sel_hi:[1,1,0]
    v_pk_mul_f32 v[208:209], v[208:209], v[16:17] neg_lo:[1,0] neg_hi:[1,0]
    v_exp_f32 v208, v208
    v_pk_fma_f32 v[34:35], v[34:35], v[240:241], v[118:119] op_sel:[0,0,0] op_sel_hi:[1,0,1]
    v_exp_f32 v209, v209
    v_pk_fma_f32 v[212:213], v[32:33], v[32:33], s[56:57] op_sel_hi:[1,1,0]
    v_pk_mul_f32 v[210:211], v[210:211], v[18:19] neg_lo:[1,0] neg_hi:[1,0]
    v_exp_f32 v210, v210
    v_pk_fma_f32 v[20:21], v[20:21], v[240:241], v[112:113] op_sel:[0,1,0] op_sel_hi:[1,1,1]
    v_exp_f32 v211, v211
    v_pk_fma_f32 v[214:215], v[34:35], v[34:35], s[56:57] op_sel_hi:[1,1,0]
    v_pk_mul_f32 v[212:213], v[212:213], v[32:33] neg_lo:[1,0] neg_hi:[1,0]
    v_exp_f32 v212, v212
    v_pk_fma_f32 v[22:23], v[22:23], v[240:241], v[114:115] op_sel:[0,1,0] op_sel_hi:[1,1,1]
    v_pk_fma_f32 v[208:209], v[208:209], s[56:57], s[56:57] op_sel:[0,1,1] op_sel_hi:[1,1,1]
    v_exp_f32 v213, v213
    v_pk_fma_f32 v[216:217], v[20:21], v[20:21], s[56:57] op_sel_hi:[1,1,0]
    v_pk_mul_f32 v[214:215], v[214:215], v[34:35] neg_lo:[1,0] neg_hi:[1,0]
    v_exp_f32 v214, v214
    v_pk_fma_f32 v[36:37], v[36:37], v[240:241], v[116:117] op_sel:[0,1,0] op_sel_hi:[1,1,1]
    v_pk_fma_f32 v[210:211], v[210:211], s[56:57], s[56:57] op_sel:[0,1,1] op_sel_hi:[1,1,1]
    v_exp_f32 v215, v215
    v_pk_fma_f32 v[218:219], v[22:23], v[22:23], s[56:57] op_sel_hi:[1,1,0]
    v_rcp_f32 v208, v208
    v_pk_mul_f32 v[216:217], v[216:217], v[20:21] neg_lo:[1,0] neg_hi:[1,0]
    v_rcp_f32 v209, v209
    v_exp_f32 v216, v216
    v_pk_fma_f32 v[38:39], v[38:39], v[240:241], v[118:119] op_sel:[0,1,0] op_sel_hi:[1,1,1]
    v_pk_fma_f32 v[212:213], v[212:213], s[56:57], s[56:57] op_sel:[0,1,1] op_sel_hi:[1,1,1]
    v_exp_f32 v217, v217
    v_pk_fma_f32 v[220:221], v[36:37], v[36:37], s[56:57] op_sel_hi:[1,1,0]
    v_rcp_f32 v210, v210
    v_pk_mul_f32 v[218:219], v[218:219], v[22:23] neg_lo:[1,0] neg_hi:[1,0]
    v_rcp_f32 v211, v211
    v_exp_f32 v218, v218
    v_pk_fma_f32 v[24:25], v[24:25], v[242:243], v[112:113] op_sel:[0,0,0] op_sel_hi:[1,0,1]
    v_pk_fma_f32 v[214:215], v[214:215], s[56:57], s[56:57] op_sel:[0,1,1] op_sel_hi:[1,1,1]
    v_exp_f32 v219, v219
    v_pk_fma_f32 v[222:223], v[38:39], v[38:39], s[56:57] op_sel_hi:[1,1,0]
    v_rcp_f32 v212, v212
    v_pk_mul_f32 v[220:221], v[220:221], v[36:37] neg_lo:[1,0] neg_hi:[1,0]
    v_pk_mul_f32 v[208:209], v[208:209], v[16:17]
    v_rcp_f32 v213, v213
    v_exp_f32 v220, v220
    v_pk_fma_f32 v[26:27], v[26:27], v[242:243], v[114:115] op_sel:[0,0,0] op_sel_hi:[1,0,1]
    v_pk_fma_f32 v[216:217], v[216:217], s[56:57], s[56:57] op_sel:[0,1,1] op_sel_hi:[1,1,1]
    v_exp_f32 v221, v221
    v_pk_fma_f32 v[224:225], v[24:25], v[24:25], s[56:57] op_sel_hi:[1,1,0]
    v_rcp_f32 v214, v214
    v_pk_mul_f32 v[222:223], v[222:223], v[38:39] neg_lo:[1,0] neg_hi:[1,0]
    v_pk_mul_f32 v[210:211], v[210:211], v[18:19]
    v_rcp_f32 v215, v215
    v_cvt_pk_bf16_f32 v208, v208, v209
    v_exp_f32 v222, v222
    v_pk_fma_f32 v[40:41], v[40:41], v[242:243], v[116:117] op_sel:[0,0,0] op_sel_hi:[1,0,1]
    v_pk_fma_f32 v[218:219], v[218:219], s[56:57], s[56:57] op_sel:[0,1,1] op_sel_hi:[1,1,1]
    v_exp_f32 v223, v223
    v_pk_fma_f32 v[226:227], v[26:27], v[26:27], s[56:57] op_sel_hi:[1,1,0]
    v_rcp_f32 v216, v216
    v_pk_mul_f32 v[224:225], v[224:225], v[24:25] neg_lo:[1,0] neg_hi:[1,0]
    v_pk_mul_f32 v[212:213], v[212:213], v[32:33]
    v_rcp_f32 v217, v217
    v_cvt_pk_bf16_f32 v209, v210, v211
    v_or_b32 v208, 1, v208
    v_exp_f32 v224, v224
    v_pk_fma_f32 v[42:43], v[42:43], v[242:243], v[118:119] op_sel:[0,0,0] op_sel_hi:[1,0,1]
    v_pk_fma_f32 v[220:221], v[220:221], s[56:57], s[56:57] op_sel:[0,1,1] op_sel_hi:[1,1,1]
    v_exp_f32 v225, v225
    v_pk_fma_f32 v[228:229], v[40:41], v[40:41], s[56:57] op_sel_hi:[1,1,0]
    v_rcp_f32 v218, v218
    v_pk_mul_f32 v[226:227], v[226:227], v[26:27] neg_lo:[1,0] neg_hi:[1,0]
    v_pk_mul_f32 v[214:215], v[214:215], v[34:35]
    v_rcp_f32 v219, v219
    v_cvt_pk_bf16_f32 v210, v212, v213
    v_exp_f32 v226, v226
    v_pk_fma_f32 v[28:29], v[28:29], v[242:243], v[112:113] op_sel:[0,1,0] op_sel_hi:[1,1,1]
    v_pk_fma_f32 v[222:223], v[222:223], s[56:57], s[56:57] op_sel:[0,1,1] op_sel_hi:[1,1,1]
    v_exp_f32 v227, v227
    v_pk_fma_f32 v[230:231], v[42:43], v[42:43], s[56:57] op_sel_hi:[1,1,0]
    v_rcp_f32 v220, v220
    v_pk_mul_f32 v[228:229], v[228:229], v[40:41] neg_lo:[1,0] neg_hi:[1,0]
    v_pk_mul_f32 v[216:217], v[216:217], v[20:21]
    v_rcp_f32 v221, v221
    v_cvt_pk_bf16_f32 v211, v214, v215
    v_exp_f32 v228, v228
    v_pk_fma_f32 v[30:31], v[30:31], v[242:243], v[114:115] op_sel:[0,1,0] op_sel_hi:[1,1,1]
    v_pk_fma_f32 v[224:225], v[224:225], s[56:57], s[56:57] op_sel:[0,1,1] op_sel_hi:[1,1,1]
    v_exp_f32 v229, v229
    v_pk_fma_f32 v[232:233], v[28:29], v[28:29], s[56:57] op_sel_hi:[1,1,0]
    v_rcp_f32 v222, v222
    v_pk_mul_f32 v[230:231], v[230:231], v[42:43] neg_lo:[1,0] neg_hi:[1,0]
    v_pk_mul_f32 v[218:219], v[218:219], v[22:23]
    v_rcp_f32 v223, v223
    v_cvt_pk_bf16_f32 v212, v216, v217
    v_exp_f32 v230, v230
    v_pk_fma_f32 v[44:45], v[44:45], v[242:243], v[116:117] op_sel:[0,1,0] op_sel_hi:[1,1,1]
    v_pk_fma_f32 v[226:227], v[226:227], s[56:57], s[56:57] op_sel:[0,1,1] op_sel_hi:[1,1,1]
    v_exp_f32 v231, v231
    v_pk_fma_f32 v[234:235], v[30:31], v[30:31], s[56:57] op_sel_hi:[1,1,0]
    v_rcp_f32 v224, v224
    v_pk_mul_f32 v[232:233], v[232:233], v[28:29] neg_lo:[1,0] neg_hi:[1,0]
    v_pk_mul_f32 v[220:221], v[220:221], v[36:37]
    v_rcp_f32 v225, v225
    v_cvt_pk_bf16_f32 v213, v218, v219
    v_or_b32 v212, 1, v212
    v_exp_f32 v232, v232
    v_pk_fma_f32 v[46:47], v[46:47], v[242:243], v[118:119] op_sel:[0,1,0] op_sel_hi:[1,1,1]
    v_pk_fma_f32 v[228:229], v[228:229], s[56:57], s[56:57] op_sel:[0,1,1] op_sel_hi:[1,1,1]
    v_exp_f32 v233, v233
    v_pk_fma_f32 v[236:237], v[44:45], v[44:45], s[56:57] op_sel_hi:[1,1,0]
    v_rcp_f32 v226, v226
    v_pk_mul_f32 v[234:235], v[234:235], v[30:31] neg_lo:[1,0] neg_hi:[1,0]
    v_pk_mul_f32 v[222:223], v[222:223], v[38:39]
    v_rcp_f32 v227, v227
    v_cvt_pk_bf16_f32 v214, v220, v221
    v_exp_f32 v234, v234
    v_pk_fma_f32 v[56:57], v[56:57], v[242:243], v[120:121] op_sel:[0,0,0] op_sel_hi:[1,0,1]
    v_pk_fma_f32 v[230:231], v[230:231], s[56:57], s[56:57] op_sel:[0,1,1] op_sel_hi:[1,1,1]
    v_exp_f32 v235, v235
    v_pk_fma_f32 v[238:239], v[46:47], v[46:47], s[56:57] op_sel_hi:[1,1,0]
    v_rcp_f32 v228, v228
    v_pk_mul_f32 v[236:237], v[236:237], v[44:45] neg_lo:[1,0] neg_hi:[1,0]
    v_pk_mul_f32 v[224:225], v[224:225], v[24:25]
    v_rcp_f32 v229, v229
    v_cvt_pk_bf16_f32 v215, v222, v223
    s_cmp_lg_u32 s10, 0
    s_cbranch_scc1 L_alt_g1bh00
    buffer_store_dwordx4 v[208:211], v2, s[28:31], s55 offen offset:0 nt
    buffer_store_dwordx4 v[212:215], v2, s[28:31], s55 offen offset:1024 nt
L_ret_g1bh00:
    v_exp_f32 v236, v236
    v_pk_fma_f32 v[58:59], v[58:59], v[242:243], v[122:123] op_sel:[0,0,0] op_sel_hi:[1,0,1]
    v_pk_fma_f32 v[232:233], v[232:233], s[56:57], s[56:57] op_sel:[0,1,1] op_sel_hi:[1,1,1]
    v_exp_f32 v237, v237
    v_pk_fma_f32 v[208:209], v[56:57], v[56:57], s[56:57] op_sel_hi:[1,1,0]
    v_rcp_f32 v230, v230
    v_pk_mul_f32 v[238:239], v[238:239], v[46:47] neg_lo:[1,0] neg_hi:[1,0]
    v_pk_mul_f32 v[226:227], v[226:227], v[26:27]
    v_rcp_f32 v231, v231
    v_cvt_pk_bf16_f32 v224, v224, v225
    v_exp_f32 v238, v238
    v_pk_fma_f32 v[72:73], v[72:73], v[242:243], v[124:125] op_sel:[0,0,0] op_sel_hi:[1,0,1]
    v_pk_fma_f32 v[234:235], v[234:235], s[56:57], s[56:57] op_sel:[0,1,1] op_sel_hi:[1,1,1]
    v_exp_f32 v239, v239
    v_pk_fma_f32 v[210:211], v[58:59], v[58:59], s[56:57] op_sel_hi:[1,1,0]
    v_rcp_f32 v232, v232
    v_pk_mul_f32 v[208:209], v[208:209], v[56:57] neg_lo:[1,0] neg_hi:[1,0]
    v_pk_mul_f32 v[228:229], v[228:229], v[40:41]
    v_rcp_f32 v233, v233
    v_cvt_pk_bf16_f32 v225, v226, v227
    v_or_b32 v224, 1, v224
    v_exp_f32 v208, v208
    v_pk_fma_f32 v[74:75], v[74:75], v[242:243], v[126:127] op_sel:[0,0,0] op_sel_hi:[1,0,1]
    v_pk_fma_f32 v[236:237], v[236:237], s[56:57], s[56:57] op_sel:[0,1,1] op_sel_hi:[1,1,1]
    v_exp_f32 v209, v209
    v_pk_fma_f32 v[212:213], v[72:73], v[72:73], s[56:57] op_sel_hi:[1,1,0]
    v_rcp_f32 v234, v234
    v_pk_mul_f32 v[210:211], v[210:211], v[58:59] neg_lo:[1,0] neg_hi:[1,0]
    v_pk_mul_f32 v[230:231], v[230:231], v[42:43]
    v_rcp_f32 v235, v235
    v_cvt_pk_bf16_f32 v226, v228, v229
    v_exp_f32 v210, v210
    v_pk_fma_f32 v[60:61], v[60:61], v[242:243], v[120:121] op_sel:[0,1,0] op_sel_hi:[1,1,1]
    v_pk_fma_f32 v[238:239], v[238:239], s[56:57], s[56:57] op_sel:[0,1,1] op_sel_hi:[1,1,1]
    v_exp_f32 v211, v211
    v_pk_fma_f32 v[214:215], v[74:75], v[74:75], s[56:57] op_sel_hi:[1,1,0]
    v_rcp_f32 v236, v236
    v_pk_mul_f32 v[212:213], v[212:213], v[72:73] neg_lo:[1,0] neg_hi:[1,0]
    v_pk_mul_f32 v[232:233], v[232:233], v[28:29]
    v_rcp_f32 v237, v237
    v_cvt_pk_bf16_f32 v227, v230, v231
    v_exp_f32 v212, v212
    v_pk_fma_f32 v[62:63], v[62:63], v[242:243], v[122:123] op_sel:[0,1,0] op_sel_hi:[1,1,1]
    v_pk_fma_f32 v[208:209], v[208:209], s[56:57], s[56:57] op_sel:[0,1,1] op_sel_hi:[1,1,1]
    v_exp_f32 v213, v213
    v_pk_fma_f32 v[216:217], v[60:61], v[60:61], s[56:57] op_sel_hi:[1,1,0]
    v_rcp_f32 v238, v238
    v_pk_mul_f32 v[214:215], v[214:215], v[74:75] neg_lo:[1,0] neg_hi:[1,0]
    v_pk_mul_f32 v[234:235], v[234:235], v[30:31]
    v_rcp_f32 v239, v239
    v_cvt_pk_bf16_f32 v228, v232, v233
    v_exp_f32 v214, v214
    v_pk_fma_f32 v[76:77], v[76:77], v[242:243], v[124:125] op_sel:[0,1,0] op_sel_hi:[1,1,1]
    v_pk_fma_f32 v[210:211], v[210:211], s[56:57], s[56:57] op_sel:[0,1,1] op_sel_hi:[1,1,1]
    v_exp_f32 v215, v215
    v_pk_fma_f32 v[218:219], v[62:63], v[62:63], s[56:57] op_sel_hi:[1,1,0]
    v_rcp_f32 v208, v208
    v_pk_mul_f32 v[216:217], v[216:217], v[60:61] neg_lo:[1,0] neg_hi:[1,0]
    v_pk_mul_f32 v[236:237], v[236:237], v[44:45]
    v_rcp_f32 v209, v209
    v_cvt_pk_bf16_f32 v229, v234, v235
    v_or_b32 v228, 1, v228
    v_exp_f32 v216, v216
    v_pk_fma_f32 v[78:79], v[78:79], v[242:243], v[126:127] op_sel:[0,1,0] op_sel_hi:[1,1,1]
    v_pk_fma_f32 v[212:213], v[212:213], s[56:57], s[56:57] op_sel:[0,1,1] op_sel_hi:[1,1,1]
    v_exp_f32 v217, v217
    v_pk_fma_f32 v[220:221], v[76:77], v[76:77], s[56:57] op_sel_hi:[1,1,0]
    v_rcp_f32 v210, v210
    v_pk_mul_f32 v[218:219], v[218:219], v[62:63] neg_lo:[1,0] neg_hi:[1,0]
    v_pk_mul_f32 v[238:239], v[238:239], v[46:47]
    v_rcp_f32 v211, v211
    v_cvt_pk_bf16_f32 v230, v236, v237
    v_exp_f32 v218, v218
    v_pk_fma_f32 v[128:129], v[48:49], v[240:241], v[120:121] op_sel:[0,0,0] op_sel_hi:[1,0,1]
    v_pk_fma_f32 v[214:215], v[214:215], s[56:57], s[56:57] op_sel:[0,1,1] op_sel_hi:[1,1,1]
    v_exp_f32 v219, v219
    v_pk_fma_f32 v[222:223], v[78:79], v[78:79], s[56:57] op_sel_hi:[1,1,0]
    v_rcp_f32 v212, v212
    v_pk_mul_f32 v[220:221], v[220:221], v[76:77] neg_lo:[1,0] neg_hi:[1,0]
    v_pk_mul_f32 v[208:209], v[208:209], v[56:57]
    v_rcp_f32 v213, v213
    v_cvt_pk_bf16_f32 v231, v238, v239
    s_cmp_lg_u32 s10, 0
    s_cbranch_scc1 L_alt_g1bh01
    buffer_store_dwordx4 v[224:227], v2, s[28:31], s55 offen offset:2048 nt
    buffer_store_dwordx4 v[228:231], v2, s[28:31], s55 offen offset:3072 nt
L_ret_g1bh01:
    v_exp_f32 v220, v220
    v_pk_fma_f32 v[130:131], v[50:51], v[240:241], v[122:123] op_sel:[0,0,0] op_sel_hi:[1,0,1]
    v_pk_fma_f32 v[216:217], v[216:217], s[56:57], s[56:57] op_sel:[0,1,1] op_sel_hi:[1,1,1]
    v_exp_f32 v221, v221
    v_pk_fma_f32 v[224:225], v[128:129], v[128:129], s[56:57] op_sel_hi:[1,1,0]
    v_rcp_f32 v214, v214
    v_pk_mul_f32 v[222:223], v[222:223], v[78:79] neg_lo:[1,0] neg_hi:[1,0]
    v_pk_mul_f32 v[210:211], v[210:211], v[58:59]
    v_rcp_f32 v215, v215
    v_cvt_pk_bf16_f32 v208, v208, v209
    v_exp_f32 v222, v222
    v_pk_fma_f32 v[132:133], v[64:65], v[240:241], v[124:125] op_sel:[0,0,0] op_sel_hi:[1,0,1]
    v_pk_fma_f32 v[218:219], v[218:219], s[56:57], s[56:57] op_sel:[0,1,1] op_sel_hi:[1,1,1]
    v_exp_f32 v223, v223
    v_pk_fma_f32 v[226:227], v[130:131], v[130:131], s[56:57] op_sel_hi:[1,1,0]
    v_rcp_f32 v216, v216
    v_pk_mul_f32 v[224:225], v[224:225], v[128:129] neg_lo:[1,0] neg_hi:[1,0]
    v_pk_mul_f32 v[212:213], v[212:213], v[72:73]
    v_rcp_f32 v217, v217
    v_cvt_pk_bf16_f32 v209, v210, v211
    v_or_b32 v208, 1, v208
    v_exp_f32 v224, v224
    v_pk_fma_f32 v[134:135], v[66:67], v[240:241], v[126:127] op_sel:[0,0,0] op_sel_hi:[1,0,1]
    v_pk_fma_f32 v[220:221], v[220:221], s[56:57], s[56:57] op_sel:[0,1,1] op_sel_hi:[1,1,1]
    v_exp_f32 v225, v225
    v_pk_fma_f32 v[228:229], v[132:133], v[132:133], s[56:57] op_sel_hi:[1,1,0]
    v_rcp_f32 v218, v218
    v_pk_mul_f32 v[226:227], v[226:227], v[130:131] neg_lo:[1,0] neg_hi:[1,0]
    v_pk_mul_f32 v[214:215], v[214:215], v[74:75]
    v_rcp_f32 v219, v219
    v_cvt_pk_bf16_f32 v210, v212, v213
    v_exp_f32 v226, v226
    v_pk_fma_f32 v[136:137], v[52:53], v[240:241], v[120:121] op_sel:[0,1,0] op_sel_hi:[1,1,1]
    v_pk_fma_f32 v[222:223], v[222:223], s[56:57], s[56:57] op_sel:[0,1,1] op_sel_hi:[1,1,1]
    v_exp_f32 v227, v227
    v_pk_fma_f32 v[230:231], v[134:135], v[134:135], s[56:57] op_sel_hi:[1,1,0]
    v_rcp_f32 v220, v220
    v_pk_mul_f32 v[228:229], v[228:229], v[132:133] neg_lo:[1,0] neg_hi:[1,0]
    v_pk_mul_f32 v[216:217], v[216:217], v[60:61]
    v_rcp_f32 v221, v221
    v_cvt_pk_bf16_f32 v211, v214, v215
    v_exp_f32 v228, v228
    buffer_load_dwordx4 v[144:147], v7, s[40:43], s80 offen offset:0 sc1 nt
    v_pk_fma_f32 v[138:139], v[54:55], v[240:241], v[122:123] op_sel:[0,1,0] op_sel_hi:[1,1,1]
    v_pk_fma_f32 v[224:225], v[224:225], s[56:57], s[56:57] op_sel:[0,1,1] op_sel_hi:[1,1,1]
    v_exp_f32 v229, v229
    v_pk_fma_f32 v[232:233], v[136:137], v[136:137], s[56:57] op_sel_hi:[1,1,0]
    buffer_load_dwordx4 v[148:151], v8, s[40:43], s80 offen offset:0 sc1 nt
    v_rcp_f32 v222, v222
    v_pk_mul_f32 v[230:231], v[230:231], v[134:135] neg_lo:[1,0] neg_hi:[1,0]
    v_pk_mul_f32 v[218:219], v[218:219], v[62:63]
    v_rcp_f32 v223, v223
    v_cvt_pk_bf16_f32 v212, v216, v217
    buffer_load_dwordx4 v[152:155], v7, s[40:43], s81 offen offset:0 sc1 nt
    v_exp_f32 v230, v230
    v_pk_fma_f32 v[140:141], v[68:69], v[240:241], v[124:125] op_sel:[0,1,0] op_sel_hi:[1,1,1]
    v_pk_fma_f32 v[226:227], v[226:227], s[56:57], s[56:57] op_sel:[0,1,1] op_sel_hi:[1,1,1]
    v_exp_f32 v231, v231
    v_pk_fma_f32 v[234:235], v[138:139], v[138:139], s[56:57] op_sel_hi:[1,1,0]
    buffer_load_dwordx4 v[156:159], v8, s[40:43], s81 offen offset:0 sc1 nt
    v_rcp_f32 v224, v224
    v_pk_mul_f32 v[232:233], v[232:233], v[136:137] neg_lo:[1,0] neg_hi:[1,0]
    v_pk_mul_f32 v[220:221], v[220:221], v[76:77]
    v_rcp_f32 v225, v225
    v_cvt_pk_bf16_f32 v213, v218, v219
    buffer_load_dwordx4 v[160:163], v7, s[40:43], s82 offen offset:0 sc1 nt
    v_or_b32 v212, 1, v212
    v_exp_f32 v232, v232
    v_pk_fma_f32 v[142:143], v[70:71], v[240:241], v[126:127] op_sel:[0,1,0] op_sel_hi:[1,1,1]
    v_pk_fma_f32 v[228:229], v[228:229], s[56:57], s[56:57] op_sel:[0,1,1] op_sel_hi:[1,1,1]
    v_exp_f32 v233, v233
    buffer_load_dwordx4 v[164:167], v8, s[40:43], s82 offen offset:0 sc1 nt
    v_pk_fma_f32 v[236:237], v[140:141], v[140:141], s[56:57] op_sel_hi:[1,1,0]
    v_rcp_f32 v226, v226
    v_pk_mul_f32 v[234:235], v[234:235], v[138:139] neg_lo:[1,0] neg_hi:[1,0]
    v_pk_mul_f32 v[222:223], v[222:223], v[78:79]
    v_rcp_f32 v227, v227
    buffer_load_dwordx4 v[168:171], v7, s[40:43], s83 offen offset:0 sc1 nt
    v_cvt_pk_bf16_f32 v214, v220, v221
    v_exp_f32 v234, v234
    v_pk_fma_f32 v[230:231], v[230:231], s[56:57], s[56:57] op_sel:[0,1,1] op_sel_hi:[1,1,1]
    v_exp_f32 v235, v235
    v_pk_fma_f32 v[238:239], v[142:143], v[142:143], s[56:57] op_sel_hi:[1,1,0]
    buffer_load_dwordx4 v[172:175], v8, s[40:43], s83 offen offset:0 sc1 nt
    v_rcp_f32 v228, v228
    v_pk_mul_f32 v[236:237], v[236:237], v[140:141] neg_lo:[1,0] neg_hi:[1,0]
    v_rcp_f32 v229, v229
    v_cvt_pk_bf16_f32 v215, v222, v223
    s_cmp_lg_u32 s10, 0
    s_cbranch_scc1 L_alt_g1bh11
    buffer_store_dwordx4 v[208:211], v2, s[28:31], s59 offen offset:2048 nt
    buffer_store_dwordx4 v[212:215], v2, s[28:31], s59 offen offset:3072 nt
L_ret_g1bh11:
    buffer_load_dwordx4 v[176:179], v7, s[40:43], s84 offen offset:0 sc1 nt
    v_exp_f32 v236, v236
    v_pk_fma_f32 v[232:233], v[232:233], s[56:57], s[56:57] op_sel:[0,1,1] op_sel_hi:[1,1,1]
    v_exp_f32 v237, v237
    v_rcp_f32 v230, v230
    v_pk_mul_f32 v[238:239], v[238:239], v[142:143] neg_lo:[1,0] neg_hi:[1,0]
    buffer_load_dwordx4 v[180:183], v8, s[40:43], s84 offen offset:0 sc1 nt
    v_rcp_f32 v231, v231
    v_exp_f32 v238, v238
    v_pk_fma_f32 v[234:235], v[234:235], s[56:57], s[56:57] op_sel:[0,1,1] op_sel_hi:[1,1,1]
    v_exp_f32 v239, v239
    v_rcp_f32 v232, v232
    buffer_load_dwordx4 v[184:187], v7, s[40:43], s85 offen offset:0 sc1 nt
    v_rcp_f32 v233, v233
    v_pk_fma_f32 v[236:237], v[236:237], s[56:57], s[56:57] op_sel:[0,1,1] op_sel_hi:[1,1,1]
    v_rcp_f32 v234, v234
    v_rcp_f32 v235, v235
    v_pk_fma_f32 v[238:239], v[238:239], s[56:57], s[56:57] op_sel:[0,1,1] op_sel_hi:[1,1,1]
    buffer_load_dwordx4 v[188:191], v8, s[40:43], s85 offen offset:0 sc1 nt
    v_rcp_f32 v236, v236
    v_rcp_f32 v237, v237
    v_rcp_f32 v238, v238
    v_rcp_f32 v239, v239
    s_waitcnt vmcnt(10)
    v_bitop3_b32 v9, v156, v148, v152 bitop3:0x80
    v_bitop3_b32 v9, v9, v144, 1 bitop3:0x80
    v_cmp_eq_u32 vcc, 0, v9
    s_cbranch_vccnz L_slow_g2b_0
L_back_g2b_0:
    v_mfma_f32_16x16x32_bf16 v[16:19], a[0:3], v[144:147], 0
    buffer_load_dwordx4 v[192:195], v7, s[40:43], s86 offen offset:0 sc1 nt
    v_mul_f32 v224, v224, v128
    v_mfma_f32_16x16x32_bf16 v[20:23], a[0:3], v[148:151], 0
    v_mul_f32 v225, v225, v129
    v_mul_f32 v226, v226, v130
    v_mfma_f32_16x16x32_bf16 v[32:35], a[4:7], v[144:147], 0
    buffer_load_dwordx4 v[196:199], v8, s[40:43], s86 offen offset:0 sc1 nt
    v_mul_f32 v227, v227, v131
    v_mfma_f32_16x16x32_bf16 v[36:39], a[4:7], v[148:151], 0
    v_mul_f32 v228, v228, v132
    v_mul_f32 v229, v229, v133
    v_mfma_f32_16x16x32_bf16 v[48:51], a[8:11], v[144:147], 0
    buffer_load_dwordx4 v[200:203], v7, s[40:43], s80 offen offset:2048 sc1 nt
    v_cvt_pk_bf16_f32 v224, v224, v225
    v_mfma_f32_16x16x32_bf16 v[52:55], a[8:11], v[148:151], 0
    v_mul_f32 v230, v230, v134
    v_mul_f32 v231, v231, v135
    v_mfma_f32_16x16x32_bf16 v[64:67], a[12:15], v[144:147], 0
    buffer_load_dwordx4 v[204:207], v8, s[40:43], s80 offen offset:2048 sc1 nt
    v_cvt_pk_bf16_f32 v225, v226, v227
    v_mfma_f32_16x16x32_bf16 v[68:71], a[12:15], v[148:151], 0
    v_mul_f32 v232, v232, v136
    v_mul_f32 v233, v233, v137
    v_mfma_f32_16x16x32_bf16 v[16:19], a[16:19], v[152:155], v[16:19]
    buffer_load_dwordx4 v[80:83], v7, s[40:43], s81 offen offset:2048 sc1 nt
    v_cvt_pk_bf16_f32 v226, v228, v229
    v_mfma_f32_16x16x32_bf16 v[20:23], a[16:19], v[156:159], v[20:23]
    v_mul_f32 v234, v234, v138
    v_mul_f32 v235, v235, v139
    v_mfma_f32_16x16x32_bf16 v[32:35], a[20:23], v[152:155], v[32:35]
    buffer_load_dwordx4 v[84:87], v8, s[40:43], s81 offen offset:2048 sc1 nt
    v_cvt_pk_bf16_f32 v227, v230, v231
    v_mfma_f32_16x16x32_bf16 v[36:39], a[20:23], v[156:159], v[36:39]
    v_or_b32 v224, 1, v224
    v_mul_f32 v236, v236, v140
    v_mfma_f32_16x16x32_bf16 v[48:51], a[24:27], v[152:155], v[48:51]
    s_waitcnt vmcnt(12)
    v_bitop3_b32 v9, v172, v164, v168 bitop3:0x80
    v_bitop3_b32 v9, v9, v160, 1 bitop3:0x80
    v_mfma_f32_16x16x32_bf16 v[52:55], a[24:27], v[156:159], v[52:55]
    v_cmp_eq_u32 vcc, 0, v9
    buffer_load_dwordx4 v[88:91], v7, s[40:43], s82 offen offset:2048 sc1 nt
    v_mfma_f32_16x16x32_bf16 v[64:67], a[28:31], v[152:155], v[64:67]
    buffer_load_dwordx4 v[92:95], v8, s[40:43], s82 offen offset:2048 sc1 nt
    v_mul_f32 v237, v237, v141
    v_mfma_f32_16x16x32_bf16 v[68:71], a[28:31], v[156:159], v[68:71]
    s_cbranch_vccnz L_slow_g2b_1
L_back_g2b_1:
    v_mfma_f32_16x16x32_bf16 v[16:19], a[32:35], v[160:163], v[16:19]
    v_cvt_pk_bf16_f32 v228, v232, v233
    v_mul_f32 v238, v238, v142
    v_mfma_f32_16x16x32_bf16 v[20:23], a[32:35], v[164:167], v[20:23]
    buffer_load_dwordx4 v[96:99], v7, s[40:43], s83 offen offset:2048 sc1 nt
    v_mul_f32 v239, v239, v143
    v_mfma_f32_16x16x32_bf16 v[32:35], a[36:39], v[160:163], v[32:35]
    v_cvt_pk_bf16_f32 v229, v234, v235
    v_or_b32 v228, 1, v228
    v_mfma_f32_16x16x32_bf16 v[36:39], a[36:39], v[164:167], v[36:39]
    v_cvt_pk_bf16_f32 v230, v236, v237
    v_mfma_f32_16x16x32_bf16 v[48:51], a[40:43], v[160:163], v[48:51]
    v_cvt_pk_bf16_f32 v231, v238, v239
    v_mfma_f32_16x16x32_bf16 v[52:55], a[40:43], v[164:167], v[52:55]
    buffer_load_dwordx4 v[100:103], v8, s[40:43], s83 offen offset:2048 sc1 nt
    v_mfma_f32_16x16x32_bf16 v[64:67], a[44:47], v[160:163], v[64:67]
    s_cmp_lg_u32 s10, 0
    s_cbranch_scc1 L_alt_g1bh10
    buffer_store_dwordx4 v[224:227], v2, s[28:31], s59 offen offset:0 nt
    buffer_store_dwordx4 v[228:231], v2, s[28:31], s59 offen offset:1024 nt
L_ret_g1bh10:
    v_mfma_f32_16x16x32_bf16 v[68:71], a[44:47], v[164:167], v[68:71]
    v_mfma_f32_16x16x32_bf16 v[16:19], a[48:51], v[168:171], v[16:19]
    v_mfma_f32_16x16x32_bf16 v[20:23], a[48:51], v[172:175], v[20:23]
    buffer_load_dwordx4 v[104:107], v7, s[40:43], s84 offen offset:2048 sc1 nt
    v_mfma_f32_16x16x32_bf16 v[32:35], a[52:55], v[168:171], v[32:35]
    v_mfma_f32_16x16x32_bf16 v[36:39], a[52:55], v[172:175], v[36:39]
    v_mfma_f32_16x16x32_bf16 v[48:51], a[56:59], v[168:171], v[48:51]
    s_waitcnt vmcnt(13)
    v_bitop3_b32 v9, v188, v180, v184 bitop3:0x80
    v_bitop3_b32 v9, v9, v176, 1 bitop3:0x80
    v_mfma_f32_16x16x32_bf16 v[52:55], a[56:59], v[172:175], v[52:55]
    v_cmp_eq_u32 vcc, 0, v9
    buffer_load_dwordx4 v[108:111], v8, s[40:43], s84 offen offset:2048 sc1 nt
    v_mfma_f32_16x16x32_bf16 v[64:67], a[60:63], v[168:171], v[64:67]
    v_mfma_f32_16x16x32_bf16 v[68:71], a[60:63], v[172:175], v[68:71]
    s_cbranch_vccnz L_slow_g2b_2
L_back_g2b_2:
    v_mfma_f32_16x16x32_bf16 v[16:19], a[64:67], v[176:179], v[16:19]
    v_mfma_f32_16x16x32_bf16 v[20:23], a[64:67], v[180:183], v[20:23]
    buffer_load_dwordx4 v[144:147], v7, s[40:43], s85 offen offset:2048 sc1 nt
    v_mfma_f32_16x16x32_bf16 v[32:35], a[68:71], v[176:179], v[32:35]
    v_mfma_f32_16x16x32_bf16 v[36:39], a[68:71], v[180:183], v[36:39]
    v_mfma_f32_16x16x32_bf16 v[48:51], a[72:75], v[176:179], v[48:51]
    v_mfma_f32_16x16x32_bf16 v[52:55], a[72:75], v[180:183], v[52:55]
    buffer_load_dwordx4 v[148:151], v8, s[40:43], s85 offen offset:2048 sc1 nt
    v_mfma_f32_16x16x32_bf16 v[64:67], a[76:79], v[176:179], v[64:67]
    v_mfma_f32_16x16x32_bf16 v[68:71], a[76:79], v[180:183], v[68:71]
    v_mfma_f32_16x16x32_bf16 v[16:19], a[80:83], v[184:187], v[16:19]
    v_mfma_f32_16x16x32_bf16 v[20:23], a[80:83], v[188:191], v[20:23]
    buffer_load_dwordx4 v[152:155], v7, s[40:43], s86 offen offset:2048 sc1 nt
    v_mfma_f32_16x16x32_bf16 v[32:35], a[84:87], v[184:187], v[32:35]
    v_mfma_f32_16x16x32_bf16 v[36:39], a[84:87], v[188:191], v[36:39]
    v_mfma_f32_16x16x32_bf16 v[48:51], a[88:91], v[184:187], v[48:51]
    s_waitcnt vmcnt(13)
    v_bitop3_b32 v9, v204, v196, v200 bitop3:0x80
    v_bitop3_b32 v9, v9, v192, 1 bitop3:0x80
    v_mfma_f32_16x16x32_bf16 v[52:55], a[88:91], v[188:191], v[52:55]
    v_cmp_eq_u32 vcc, 0, v9
    buffer_load_dwordx4 v[156:159], v8, s[40:43], s86 offen offset:2048 sc1 nt
    v_mfma_f32_16x16x32_bf16 v[64:67], a[92:95], v[184:187], v[64:67]
    v_mfma_f32_16x16x32_bf16 v[68:71], a[92:95], v[188:191], v[68:71]
    s_cbranch_vccnz L_slow_g2b_3
L_back_g2b_3:
    v_mfma_f32_16x16x32_bf16 v[16:19], a[96:99], v[192:195], v[16:19]
    v_mfma_f32_16x16x32_bf16 v[20:23], a[96:99], v[196:199], v[20:23]
    buffer_load_dwordx4 v[160:163], v7, s[40:43], s87 offen offset:2048 sc1 nt
    v_mfma_f32_16x16x32_bf16 v[32:35], a[100:103], v[192:195], v[32:35]
    v_mfma_f32_16x16x32_bf16 v[36:39], a[100:103], v[196:199], v[36:39]
    v_mfma_f32_16x16x32_bf16 v[48:51], a[104:107], v[192:195], v[48:51]
    v_mfma_f32_16x16x32_bf16 v[52:55], a[104:107], v[196:199], v[52:55]
    buffer_load_dwordx4 v[164:167], v8, s[40:43], s87 offen offset:2048 sc1 nt
    v_mfma_f32_16x16x32_bf16 v[64:67], a[108:111], v[192:195], v[64:67]
    v_mfma_f32_16x16x32_bf16 v[68:71], a[108:111], v[196:199], v[68:71]
    v_mfma_f32_16x16x32_bf16 v[24:27], a[0:3], v[200:203], 0
    v_mfma_f32_16x16x32_bf16 v[28:31], a[0:3], v[204:207], 0
    buffer_load_dwordx4 v[168:171], v7, s[40:43], s88 offen offset:2048 sc1 nt
    v_mfma_f32_16x16x32_bf16 v[40:43], a[4:7], v[200:203], 0
    v_mfma_f32_16x16x32_bf16 v[44:47], a[4:7], v[204:207], 0
    v_mfma_f32_16x16x32_bf16 v[56:59], a[8:11], v[200:203], 0
    s_waitcnt vmcnt(13)
    v_bitop3_b32 v9, v92, v84, v88 bitop3:0x80
    v_bitop3_b32 v9, v9, v80, 1 bitop3:0x80
    v_mfma_f32_16x16x32_bf16 v[60:63], a[8:11], v[204:207], 0
    v_cmp_eq_u32 vcc, 0, v9
    buffer_load_dwordx4 v[172:175], v8, s[40:43], s88 offen offset:2048 sc1 nt
    v_mfma_f32_16x16x32_bf16 v[72:75], a[12:15], v[200:203], 0
    v_mfma_f32_16x16x32_bf16 v[76:79], a[12:15], v[204:207], 0
    s_cbranch_vccnz L_slow_g2b_4
L_back_g2b_4:
    v_mfma_f32_16x16x32_bf16 v[24:27], a[16:19], v[80:83], v[24:27]
    v_mfma_f32_16x16x32_bf16 v[28:31], a[16:19], v[84:87], v[28:31]
    buffer_load_dwordx4 v[176:179], v7, s[40:43], s89 offen offset:2048 sc1 nt
    v_mfma_f32_16x16x32_bf16 v[40:43], a[20:23], v[80:83], v[40:43]
    v_mfma_f32_16x16x32_bf16 v[44:47], a[20:23], v[84:87], v[44:47]
    v_mfma_f32_16x16x32_bf16 v[56:59], a[24:27], v[80:83], v[56:59]
    v_mfma_f32_16x16x32_bf16 v[60:63], a[24:27], v[84:87], v[60:63]
    buffer_load_dwordx4 v[180:183], v8, s[40:43], s89 offen offset:2048 sc1 nt
    v_mfma_f32_16x16x32_bf16 v[72:75], a[28:31], v[80:83], v[72:75]
    v_mfma_f32_16x16x32_bf16 v[76:79], a[28:31], v[84:87], v[76:79]
    v_mfma_f32_16x16x32_bf16 v[24:27], a[32:35], v[88:91], v[24:27]
    v_mfma_f32_16x16x32_bf16 v[28:31], a[32:35], v[92:95], v[28:31]
    buffer_load_dwordx4 v[184:187], v7, s[40:43], s90 offen offset:2048 sc1 nt
    v_mfma_f32_16x16x32_bf16 v[40:43], a[36:39], v[88:91], v[40:43]
    v_mfma_f32_16x16x32_bf16 v[44:47], a[36:39], v[92:95], v[44:47]
    v_mfma_f32_16x16x32_bf16 v[56:59], a[40:43], v[88:91], v[56:59]
    s_waitcnt vmcnt(11)
    v_bitop3_b32 v9, v108, v100, v104 bitop3:0x80
    v_bitop3_b32 v9, v9, v96, 1 bitop3:0x80
    v_mfma_f32_16x16x32_bf16 v[60:63], a[40:43], v[92:95], v[60:63]
    v_cmp_eq_u32 vcc, 0, v9
    buffer_load_dwordx4 v[188:191], v8, s[40:43], s90 offen offset:2048 sc1 nt
    v_mfma_f32_16x16x32_bf16 v[72:75], a[44:47], v[88:91], v[72:75]
    v_mfma_f32_16x16x32_bf16 v[76:79], a[44:47], v[92:95], v[76:79]
    s_cbranch_vccnz L_slow_g2b_5
L_back_g2b_5:
    v_mfma_f32_16x16x32_bf16 v[24:27], a[48:51], v[96:99], v[24:27]
    v_mfma_f32_16x16x32_bf16 v[28:31], a[48:51], v[100:103], v[28:31]
    buffer_load_dwordx4 v[192:195], v7, s[40:43], s91 offen offset:2048 sc1 nt
    v_mfma_f32_16x16x32_bf16 v[40:43], a[52:55], v[96:99], v[40:43]
    s_mov_b32 s79, 14455808
    buffer_load_dwordx2 v[252:253], v254, s[28:31], s79 offen sc1
    v_mfma_f32_16x16x32_bf16 v[44:47], a[52:55], v[100:103], v[44:47]
    v_mfma_f32_16x16x32_bf16 v[56:59], a[56:59], v[96:99], v[56:59]
    v_mfma_f32_16x16x32_bf16 v[60:63], a[56:59], v[100:103], v[60:63]
    buffer_load_dwordx4 v[196:199], v8, s[40:43], s91 offen offset:2048 sc1 nt
    v_mfma_f32_16x16x32_bf16 v[72:75], a[60:63], v[96:99], v[72:75]
    v_mfma_f32_16x16x32_bf16 v[76:79], a[60:63], v[100:103], v[76:79]
    v_mfma_f32_16x16x32_bf16 v[24:27], a[64:67], v[104:107], v[24:27]
    v_mfma_f32_16x16x32_bf16 v[28:31], a[64:67], v[108:111], v[28:31]
    buffer_load_dwordx4 v[200:203], v7, s[40:43], s92 offen offset:2048 sc1 nt
    v_mfma_f32_16x16x32_bf16 v[40:43], a[68:71], v[104:107], v[40:43]
    v_mfma_f32_16x16x32_bf16 v[44:47], a[68:71], v[108:111], v[44:47]
    v_mfma_f32_16x16x32_bf16 v[56:59], a[72:75], v[104:107], v[56:59]
    s_waitcnt vmcnt(12)
    v_bitop3_b32 v9, v156, v148, v152 bitop3:0x80
    v_bitop3_b32 v9, v9, v144, 1 bitop3:0x80
    v_mfma_f32_16x16x32_bf16 v[60:63], a[72:75], v[108:111], v[60:63]
    v_cmp_eq_u32 vcc, 0, v9
    buffer_load_dwordx4 v[204:207], v8, s[40:43], s92 offen offset:2048 sc1 nt
    v_mfma_f32_16x16x32_bf16 v[72:75], a[76:79], v[104:107], v[72:75]
    v_mfma_f32_16x16x32_bf16 v[76:79], a[76:79], v[108:111], v[76:79]
    s_cbranch_vccnz L_slow_g2b_6
L_back_g2b_6:
    v_mfma_f32_16x16x32_bf16 v[24:27], a[80:83], v[144:147], v[24:27]
    v_mfma_f32_16x16x32_bf16 v[28:31], a[80:83], v[148:151], v[28:31]
    buffer_load_dwordx4 v[80:83], v7, s[40:43], s93 offen offset:2048 sc1 nt
    v_mfma_f32_16x16x32_bf16 v[40:43], a[84:87], v[144:147], v[40:43]
    v_mfma_f32_16x16x32_bf16 v[44:47], a[84:87], v[148:151], v[44:47]
    v_mfma_f32_16x16x32_bf16 v[56:59], a[88:91], v[144:147], v[56:59]
    v_mfma_f32_16x16x32_bf16 v[60:63], a[88:91], v[148:151], v[60:63]
    buffer_load_dwordx4 v[84:87], v8, s[40:43], s93 offen offset:2048 sc1 nt
    v_mfma_f32_16x16x32_bf16 v[72:75], a[92:95], v[144:147], v[72:75]
    v_mfma_f32_16x16x32_bf16 v[76:79], a[92:95], v[148:151], v[76:79]
    v_mfma_f32_16x16x32_bf16 v[24:27], a[96:99], v[152:155], v[24:27]
    v_mfma_f32_16x16x32_bf16 v[28:31], a[96:99], v[156:159], v[28:31]
    buffer_load_dwordx4 v[88:91], v7, s[40:43], s87 offen offset:0 sc1 nt
    v_mfma_f32_16x16x32_bf16 v[40:43], a[100:103], v[152:155], v[40:43]
    v_mfma_f32_16x16x32_bf16 v[44:47], a[100:103], v[156:159], v[44:47]
    v_mfma_f32_16x16x32_bf16 v[56:59], a[104:107], v[152:155], v[56:59]
    s_waitcnt vmcnt(12)
    v_bitop3_b32 v9, v172, v164, v168 bitop3:0x80
    v_bitop3_b32 v9, v9, v160, 1 bitop3:0x80
    v_mfma_f32_16x16x32_bf16 v[60:63], a[104:107], v[156:159], v[60:63]
    v_cmp_eq_u32 vcc, 0, v9
    buffer_load_dwordx4 v[92:95], v8, s[40:43], s87 offen offset:0 sc1 nt
    v_mfma_f32_16x16x32_bf16 v[72:75], a[108:111], v[152:155], v[72:75]
    v_mfma_f32_16x16x32_bf16 v[76:79], a[108:111], v[156:159], v[76:79]
    s_cbranch_vccnz L_slow_g2b_7
L_back_g2b_7:
    v_mfma_f32_16x16x32_bf16 v[24:27], a[112:115], v[160:163], v[24:27]
    v_mfma_f32_16x16x32_bf16 v[28:31], a[112:115], v[164:167], v[28:31]
    buffer_load_dwordx4 v[96:99], v7, s[40:43], s88 offen offset:0 sc1 nt
    v_mfma_f32_16x16x32_bf16 v[40:43], a[116:119], v[160:163], v[40:43]
    s_mul_i32 s58, s48, 7
    s_add_u32 s58, s58, s49
    s_and_b32 s60, s26, 1
    v_mfma_f32_16x16x32_bf16 v[44:47], a[116:119], v[164:167], v[44:47]
    s_lshl2_add_u32 s58, s58, s60
    s_lshl_b32 s58, s58, 12
    s_add_u32 s58, s58, 5865472
    v_mfma_f32_16x16x32_bf16 v[56:59], a[120:123], v[160:163], v[56:59]
    s_add_u32 s60, s58, 8192
    v_mfma_f32_16x16x32_bf16 v[60:63], a[120:123], v[164:167], v[60:63]
    buffer_load_dwordx4 v[100:103], v8, s[40:43], s88 offen offset:0 sc1 nt
    v_mfma_f32_16x16x32_bf16 v[72:75], a[124:127], v[160:163], v[72:75]
    v_mfma_f32_16x16x32_bf16 v[76:79], a[124:127], v[164:167], v[76:79]
    v_mfma_f32_16x16x32_bf16 v[24:27], a[128:131], v[168:171], v[24:27]
    v_mfma_f32_16x16x32_bf16 v[28:31], a[128:131], v[172:175], v[28:31]
    buffer_load_dwordx4 v[104:107], v7, s[40:43], s89 offen offset:0 sc1 nt
    v_mfma_f32_16x16x32_bf16 v[40:43], a[132:135], v[168:171], v[40:43]
    v_mfma_f32_16x16x32_bf16 v[44:47], a[132:135], v[172:175], v[44:47]
    v_mfma_f32_16x16x32_bf16 v[56:59], a[136:139], v[168:171], v[56:59]
    s_waitcnt vmcnt(12)
    v_bitop3_b32 v9, v188, v180, v184 bitop3:0x80
    v_bitop3_b32 v9, v9, v176, 1 bitop3:0x80
    v_mfma_f32_16x16x32_bf16 v[60:63], a[136:139], v[172:175], v[60:63]
    v_cmp_eq_u32 vcc, 0, v9
    buffer_load_dwordx4 v[108:111], v8, s[40:43], s89 offen offset:0 sc1 nt
    v_mfma_f32_16x16x32_bf16 v[72:75], a[140:143], v[168:171], v[72:75]
    v_mfma_f32_16x16x32_bf16 v[76:79], a[140:143], v[172:175], v[76:79]
    s_cbranch_vccnz L_slow_g2b_8
L_back_g2b_8:
    v_mfma_f32_16x16x32_bf16 v[24:27], a[144:147], v[176:179], v[24:27]
    v_mfma_f32_16x16x32_bf16 v[28:31], a[144:147], v[180:183], v[28:31]
    buffer_load_dwordx4 v[144:147], v7, s[40:43], s90 offen offset:0 sc1 nt
    v_mfma_f32_16x16x32_bf16 v[40:43], a[148:151], v[176:179], v[40:43]
    s_waitcnt vmcnt(12)
    v_cmp_ne_u64 s[98:99], s[12:13], v[252:253]
    v_mfma_f32_16x16x32_bf16 v[44:47], a[148:151], v[180:183], v[44:47]
    v_mfma_f32_16x16x32_bf16 v[56:59], a[152:155], v[176:179], v[56:59]
    s_cmp_lg_u64 s[98:99], 0
    s_cbranch_scc1 L_slow_hb
L_back_hb:
    v_mfma_f32_16x16x32_bf16 v[60:63], a[152:155], v[180:183], v[60:63]
    buffer_load_dwordx4 v[148:151], v8, s[40:43], s90 offen offset:0 sc1 nt
    v_mfma_f32_16x16x32_bf16 v[72:75], a[156:159], v[176:179], v[72:75]
    v_mfma_f32_16x16x32_bf16 v[76:79], a[156:159], v[180:183], v[76:79]
    v_mfma_f32_16x16x32_bf16 v[24:27], a[160:163], v[184:187], v[24:27]
    v_mfma_f32_16x16x32_bf16 v[28:31], a[160:163], v[188:191], v[28:31]
    buffer_load_dwordx4 v[152:155], v7, s[40:43], s91 offen offset:0 sc1 nt
    v_mfma_f32_16x16x32_bf16 v[40:43], a[164:167], v[184:187], v[40:43]
    v_mfma_f32_16x16x32_bf16 v[44:47], a[164:167], v[188:191], v[44:47]
    v_mfma_f32_16x16x32_bf16 v[56:59], a[168:171], v[184:187], v[56:59]
    s_waitcnt vmcnt(11)
    v_bitop3_b32 v9, v204, v196, v200 bitop3:0x80
    v_bitop3_b32 v9, v9, v192, 1 bitop3:0x80
    v_mfma_f32_16x16x32_bf16 v[60:63], a[168:171], v[188:191], v[60:63]
    v_cmp_eq_u32 vcc, 0, v9
    buffer_load_dwordx4 v[156:159], v8, s[40:43], s91 offen offset:0 sc1 nt
    v_mfma_f32_16x16x32_bf16 v[72:75], a[172:175], v[184:187], v[72:75]
    v_mfma_f32_16x16x32_bf16 v[76:79], a[172:175], v[188:191], v[76:79]
    s_cbranch_vccnz L_slow_g2b_9
L_back_g2b_9:
    v_mfma_f32_16x16x32_bf16 v[24:27], a[176:179], v[192:195], v[24:27]
    v_add_u32 v180, 57344, v2
    v_mul_u32_u24 v176, 12288, v1
    v_mfma_f32_16x16x32_bf16 v[28:31], a[176:179], v[196:199], v[28:31]
    buffer_load_dwordx4 v[160:163], v7, s[40:43], s92 offen offset:0 sc1 nt
    v_add_u32 v176, v176, v180
    v_mfma_f32_16x16x32_bf16 v[40:43], a[180:183], v[192:195], v[40:43]
    v_xor_b32 v177, 1, v1
    v_mul_u32_u24 v177, 12288, v177
    v_mfma_f32_16x16x32_bf16 v[44:47], a[180:183], v[196:199], v[44:47]
    v_add_u32 v177, v177, v180
    v_xor_b32 v178, 2, v1
    v_mfma_f32_16x16x32_bf16 v[56:59], a[184:187], v[192:195], v[56:59]
    v_mul_u32_u24 v178, 12288, v178
    v_add_u32 v178, v178, v180
    v_mfma_f32_16x16x32_bf16 v[60:63], a[184:187], v[196:199], v[60:63]
    buffer_load_dwordx4 v[164:167], v8, s[40:43], s92 offen offset:0 sc1 nt
    v_xor_b32 v179, 3, v1
    v_mfma_f32_16x16x32_bf16 v[72:75], a[188:191], v[192:195], v[72:75]
    v_mul_u32_u24 v179, 12288, v179
    v_add_u32 v179, v179, v180
    v_mfma_f32_16x16x32_bf16 v[76:79], a[188:191], v[196:199], v[76:79]
    buffer_load_dwordx4 v[208:211], v5, s[28:31], s58 offen offset:0 sc1
    v_mfma_f32_16x16x32_bf16 v[24:27], a[192:195], v[200:203], v[24:27]
    v_mfma_f32_16x16x32_bf16 v[28:31], a[192:195], v[204:207], v[28:31]
    buffer_load_dwordx4 v[168:171], v7, s[40:43], s93 offen offset:0 sc1 nt
    buffer_load_dwordx4 v[212:215], v5, s[28:31], s58 offen offset:1024 sc1
    v_mfma_f32_16x16x32_bf16 v[40:43], a[196:199], v[200:203], v[40:43]
    v_mfma_f32_16x16x32_bf16 v[44:47], a[196:199], v[204:207], v[44:47]
    buffer_load_dwordx4 v[216:219], v5, s[28:31], s60 offen offset:0 sc1
    v_mfma_f32_16x16x32_bf16 v[56:59], a[200:203], v[200:203], v[56:59]
    s_waitcnt vmcnt(14)
    v_bitop3_b32 v9, v92, v84, v88 bitop3:0x80
    v_bitop3_b32 v9, v9, v80, 1 bitop3:0x80
    v_mfma_f32_16x16x32_bf16 v[60:63], a[200:203], v[204:207], v[60:63]
    v_cmp_eq_u32 vcc, 0, v9
    buffer_load_dwordx4 v[172:175], v8, s[40:43], s93 offen offset:0 sc1 nt
    v_mfma_f32_16x16x32_bf16 v[72:75], a[204:207], v[200:203], v[72:75]
    buffer_load_dwordx4 v[220:223], v5, s[28:31], s60 offen offset:1024 sc1
    v_mfma_f32_16x16x32_bf16 v[76:79], a[204:207], v[204:207], v[76:79]
    s_cbranch_vccnz L_slow_g2b_10
L_back_g2b_10:
    v_mfma_f32_16x16x32_bf16 v[28:31], a[208:211], v[84:87], v[28:31]
    v_mfma_f32_16x16x32_bf16 v[44:47], a[212:215], v[84:87], v[44:47]
    v_mfma_f32_16x16x32_bf16 v[56:59], a[216:219], v[80:83], v[56:59]
    v_mfma_f32_16x16x32_bf16 v[60:63], a[216:219], v[84:87], v[60:63]
    v_mfma_f32_16x16x32_bf16 v[72:75], a[220:223], v[80:83], v[72:75]
    v_mfma_f32_16x16x32_bf16 v[76:79], a[220:223], v[84:87], v[76:79]
    v_mfma_f32_16x16x32_bf16 v[24:27], a[208:211], v[80:83], v[24:27]
    s_nop 1
    ds_write_b128 v177, v[28:31] offset:2048
    v_mfma_f32_16x16x32_bf16 v[40:43], a[212:215], v[80:83], v[40:43]
    ds_write_b128 v177, v[44:47] offset:3072
    v_mfma_f32_16x16x32_bf16 v[16:19], a[112:115], v[88:91], v[16:19]
    ds_write_b128 v178, v[56:59] offset:6144
    v_mfma_f32_16x16x32_bf16 v[20:23], a[112:115], v[92:95], v[20:23]
    ds_write_b128 v179, v[60:63] offset:10240
    v_mfma_f32_16x16x32_bf16 v[32:35], a[116:119], v[88:91], v[32:35]
    ds_write_b128 v178, v[72:75] offset:7168
    v_mfma_f32_16x16x32_bf16 v[36:39], a[116:119], v[92:95], v[36:39]
    ds_write_b128 v179, v[76:79] offset:11264
    v_mfma_f32_16x16x32_bf16 v[48:51], a[120:123], v[88:91], v[48:51]
    s_waitcnt vmcnt(12)
    v_bitop3_b32 v9, v108, v100, v104 bitop3:0x80
    v_bitop3_b32 v9, v9, v96, 1 bitop3:0x80
    v_mfma_f32_16x16x32_bf16 v[52:55], a[120:123], v[92:95], v[52:55]
    v_cmp_eq_u32 vcc, 0, v9
    v_mfma_f32_16x16x32_bf16 v[64:67], a[124:127], v[88:91], v[64:67]
    v_mfma_f32_16x16x32_bf16 v[68:71], a[124:127], v[92:95], v[68:71]
    s_cbranch_vccnz L_slow_g2b_11
L_back_g2b_11:
    v_mfma_f32_16x16x32_bf16 v[16:19], a[128:131], v[96:99], v[16:19]
    s_lshr_b32 s55, s48, 3
    s_lshl_b32 s55, s55, 9
    s_and_b32 s59, s48, 4
    s_lshl_b32 s59, s59, 2
    s_add_u32 s55, s55, s59
    s_and_b32 s59, s48, 3
    s_lshl_b32 s59, s59, 7
    s_add_u32 s55, s55, s59
    v_mfma_f32_16x16x32_bf16 v[20:23], a[128:131], v[100:103], v[20:23]
    s_and_b32 s59, s26, 1
    s_lshl_b32 s59, s59, 5
    s_add_u32 s55, s55, s59
    v_mfma_f32_16x16x32_bf16 v[32:35], a[132:135], v[96:99], v[32:35]
    s_waitcnt lgkmcnt(0)
    s_barrier
    s_mul_i32 s55, s55, 896
    s_lshl_b32 s59, s49, 7
    v_mfma_f32_16x16x32_bf16 v[36:39], a[132:135], v[100:103], v[36:39]
    ds_read_b128 v[28:31], v176 offset:2048
    s_add_u32 s55, s55, s59
    s_and_b32 s59, s26, 2
    v_mfma_f32_16x16x32_bf16 v[48:51], a[136:139], v[96:99], v[48:51]
    ds_read_b128 v[44:47], v176 offset:3072
    s_lshl3_add_u32 s55, s59, s55
    s_add_u32 s62, s55, 57344
    v_mfma_f32_16x16x32_bf16 v[52:55], a[136:139], v[100:103], v[52:55]
    ds_read_b128 v[56:59], v176 offset:6144
    v_mfma_f32_16x16x32_bf16 v[64:67], a[140:143], v[96:99], v[64:67]
    ds_read_b128 v[60:63], v176 offset:7168
    v_mfma_f32_16x16x32_bf16 v[68:71], a[140:143], v[100:103], v[68:71]
    ds_read_b128 v[72:75], v176 offset:10240
    v_mfma_f32_16x16x32_bf16 v[16:19], a[144:147], v[104:107], v[16:19]
    ds_read_b128 v[76:79], v176 offset:11264
    v_mfma_f32_16x16x32_bf16 v[20:23], a[144:147], v[108:111], v[20:23]
    s_mov_b32 s36, s20
    s_mov_b32 s37, s21
    s_mov_b32 s38, 1835008
    s_mov_b32 s39, 0x20000
    v_mfma_f32_16x16x32_bf16 v[32:35], a[148:151], v[104:107], v[32:35]
    v_mul_u32_u24 v13, 896, v3
    v_lshl_add_u32 v13, v4, 5, v13
    v_mfma_f32_16x16x32_bf16 v[36:39], a[148:151], v[108:111], v[36:39]
    s_waitcnt lgkmcnt(5)
    v_add_f32 v24, v24, v28
    v_add_f32 v25, v25, v29
    v_mfma_f32_16x16x32_bf16 v[48:51], a[152:155], v[104:107], v[48:51]
    s_waitcnt vmcnt(8)
    v_bitop3_b32 v9, v156, v148, v152 bitop3:0x80
    v_bitop3_b32 v9, v9, v144, 1 bitop3:0x80
    v_mfma_f32_16x16x32_bf16 v[52:55], a[152:155], v[108:111], v[52:55]
    v_cmp_eq_u32 vcc, 0, v9
    v_add_f32 v26, v26, v30
    v_mfma_f32_16x16x32_bf16 v[64:67], a[156:159], v[104:107], v[64:67]
    v_add_f32 v27, v27, v31
    s_waitcnt lgkmcnt(4)
    v_add_f32 v40, v40, v44
    v_mfma_f32_16x16x32_bf16 v[68:71], a[156:159], v[108:111], v[68:71]
    s_cbranch_vccnz L_slow_g2b_12
L_back_g2b_12:
    v_mfma_f32_16x16x32_bf16 v[16:19], a[160:163], v[144:147], v[16:19]
    v_add_f32 v41, v41, v45
    v_add_f32 v42, v42, v46
    v_mfma_f32_16x16x32_bf16 v[20:23], a[160:163], v[148:151], v[20:23]
    v_add_f32 v43, v43, v47
    s_waitcnt lgkmcnt(3)
    v_add_f32 v24, v24, v56
    v_mfma_f32_16x16x32_bf16 v[32:35], a[164:167], v[144:147], v[32:35]
    v_add_f32 v25, v25, v57
    v_add_f32 v26, v26, v58
    v_mfma_f32_16x16x32_bf16 v[36:39], a[164:167], v[148:151], v[36:39]
    v_add_f32 v27, v27, v59
    s_waitcnt lgkmcnt(2)
    v_add_f32 v40, v40, v60
    v_mfma_f32_16x16x32_bf16 v[48:51], a[168:171], v[144:147], v[48:51]
    v_add_f32 v41, v41, v61
    v_add_f32 v42, v42, v62
    v_mfma_f32_16x16x32_bf16 v[52:55], a[168:171], v[148:151], v[52:55]
    v_add_f32 v43, v43, v63
    s_waitcnt lgkmcnt(1)
    v_add_f32 v24, v24, v72
    v_mfma_f32_16x16x32_bf16 v[64:67], a[172:175], v[144:147], v[64:67]
    s_waitcnt vmcnt(0)
    v_max3_u32 v10, v220, v212, v216
    v_max_u32 v10, v10, v208
    v_mfma_f32_16x16x32_bf16 v[68:71], a[172:175], v[148:151], v[68:71]
    v_cmp_eq_u32 s[98:99], -1, v10
    v_add_f32 v25, v25, v73
    v_mfma_f32_16x16x32_bf16 v[16:19], a[176:179], v[152:155], v[16:19]
    v_add_f32 v26, v26, v74
    v_add_f32 v27, v27, v75
    v_mfma_f32_16x16x32_bf16 v[20:23], a[176:179], v[156:159], v[20:23]
    s_cmp_lg_u64 s[98:99], 0
    s_cbranch_scc1 L_slow_rf
L_back_rf:
    v_mfma_f32_16x16x32_bf16 v[32:35], a[180:183], v[152:155], v[32:35]
    s_waitcnt lgkmcnt(0)
    v_add_f32 v40, v40, v76
    v_add_f32 v41, v41, v77
    v_mfma_f32_16x16x32_bf16 v[36:39], a[180:183], v[156:159], v[36:39]
    v_add_f32 v42, v42, v78
    v_add_f32 v43, v43, v79
    v_mfma_f32_16x16x32_bf16 v[48:51], a[184:187], v[152:155], v[48:51]
    v_bitop3_b32 v9, v172, v164, v168 bitop3:0x80
    v_bitop3_b32 v9, v9, v160, 1 bitop3:0x80
    v_mfma_f32_16x16x32_bf16 v[52:55], a[184:187], v[156:159], v[52:55]
    v_cmp_eq_u32 vcc, 0, v9
    v_mfma_f32_16x16x32_bf16 v[64:67], a[188:191], v[152:155], v[64:67]
    v_mfma_f32_16x16x32_bf16 v[68:71], a[188:191], v[156:159], v[68:71]
    s_cbranch_vccnz L_slow_g2b_13
L_back_g2b_13:
    v_add_f32 v24, v24, v216
    v_mfma_f32_16x16x32_bf16 v[20:23], a[192:195], v[164:167], v[20:23]
    v_add_f32 v25, v25, v217
    v_add_f32 v26, v26, v218
    v_mfma_f32_16x16x32_bf16 v[36:39], a[196:199], v[164:167], v[36:39]
    v_add_f32 v27, v27, v219
    v_add_f32 v40, v40, v220
    v_mfma_f32_16x16x32_bf16 v[48:51], a[200:203], v[160:163], v[48:51]
    v_add_f32 v41, v41, v221
    v_add_f32 v42, v42, v222
    v_mfma_f32_16x16x32_bf16 v[20:23], a[208:211], v[172:175], v[20:23]
    v_add_f32 v16, v16, v208
    v_add_f32 v17, v17, v209
    v_mfma_f32_16x16x32_bf16 v[36:39], a[212:215], v[172:175], v[36:39]
    v_add_f32 v18, v18, v210
    v_add_f32 v19, v19, v211
    v_mfma_f32_16x16x32_bf16 v[48:51], a[216:219], v[168:171], v[48:51]
    v_add_f32 v32, v32, v212
    v_add_f32 v33, v33, v213
    v_mfma_f32_16x16x32_bf16 v[52:55], a[200:203], v[164:167], v[52:55]
    ds_write_b128 v177, v[20:23] offset:0
    v_add_f32 v34, v34, v214
    v_mfma_f32_16x16x32_bf16 v[64:67], a[204:207], v[160:163], v[64:67]
    v_add_f32 v35, v35, v215
    v_add_f32 v43, v43, v223
    v_mfma_f32_16x16x32_bf16 v[68:71], a[204:207], v[164:167], v[68:71]
    ds_write_b128 v177, v[36:39] offset:1024
    v_cvt_pk_bf16_f32 v84, v24, v25
    v_mfma_f32_16x16x32_bf16 v[52:55], a[216:219], v[172:175], v[52:55]
    v_cvt_pk_bf16_f32 v85, v26, v27
    v_cvt_pk_bf16_f32 v86, v40, v41
    v_mfma_f32_16x16x32_bf16 v[64:67], a[220:223], v[168:171], v[64:67]
    ds_write_b128 v178, v[48:51] offset:4096
    v_cvt_pk_bf16_f32 v87, v42, v43
    v_mfma_f32_16x16x32_bf16 v[68:71], a[220:223], v[172:175], v[68:71]
    buffer_store_dwordx4 v[84:87], v13, s[36:39], s62 offen nt
    v_mfma_f32_16x16x32_bf16 v[16:19], a[192:195], v[160:163], v[16:19]
    ds_write_b128 v179, v[52:55] offset:8192
    v_mfma_f32_16x16x32_bf16 v[32:35], a[196:199], v[160:163], v[32:35]
    s_nop 0
    ds_write_b128 v178, v[64:67] offset:5120
    v_mfma_f32_16x16x32_bf16 v[16:19], a[208:211], v[168:171], v[16:19]
    s_nop 0
    ds_write_b128 v179, v[68:71] offset:9216
    v_mfma_f32_16x16x32_bf16 v[32:35], a[212:215], v[168:171], v[32:35]
    s_waitcnt lgkmcnt(0)
    s_barrier
    ds_read_b128 v[96:99], v176 offset:0
    ds_read_b128 v[112:115], v176 offset:4096
    ds_read_b128 v[128:131], v176 offset:8192
    ds_read_b128 v[100:103], v176 offset:1024
    ds_read_b128 v[116:119], v176 offset:5120
    ds_read_b128 v[132:135], v176 offset:9216
    s_waitcnt lgkmcnt(5)
    v_pk_add_f32 v[16:17], v[16:17], v[96:97]
    v_pk_add_f32 v[18:19], v[18:19], v[98:99]
    s_waitcnt lgkmcnt(3)
    v_pk_add_f32 v[112:113], v[112:113], v[128:129]
    v_pk_add_f32 v[114:115], v[114:115], v[130:131]
    v_pk_add_f32 v[16:17], v[16:17], v[112:113]
    v_pk_add_f32 v[18:19], v[18:19], v[114:115]
    v_cvt_pk_bf16_f32 v80, v16, v17
    v_cvt_pk_bf16_f32 v81, v18, v19
    s_waitcnt lgkmcnt(2)
    v_pk_add_f32 v[32:33], v[32:33], v[100:101]
    v_pk_add_f32 v[34:35], v[34:35], v[102:103]
    s_waitcnt lgkmcnt(0)
    v_pk_add_f32 v[116:117], v[116:117], v[132:133]
    v_pk_add_f32 v[118:119], v[118:119], v[134:135]
    v_pk_add_f32 v[32:33], v[32:33], v[116:117]
    v_pk_add_f32 v[34:35], v[34:35], v[118:119]
    v_cvt_pk_bf16_f32 v82, v32, v33
    v_cvt_pk_bf16_f32 v83, v34, v35
    buffer_store_dwordx4 v[80:83], v13, s[36:39], s55 offen nt
    s_endpgm
L_helper:
    s_sub_u32 s48, s2, 224
    s_mul_i32 s53, s50, 200704
    s_add_u32 s40, s16, s53
    s_addc_u32 s41, s17, 0
    s_mov_b32 s42, 200704
    s_mov_b32 s43, 0x20000
    s_mul_i32 s54, s11, 7
    s_add_u32 s54, s54, 28672
    s_cmp_eq_u32 s54, 200704
    s_cselect_b32 s54, 0, s54
    s_add_u32 m0, s9, 73728
    s_add_u32 s53, s54, s80
    buffer_load_dwordx4 v173, s[40:43], s53 offen lds
    v_mov_b32 v168, -1
    v_mov_b32 v169, -1
    v_mov_b32 v170, -1
    v_mov_b32 v171, -1
    s_lshr_b32 s78, s78, 4
    s_add_u32 m0, s9, 77824
    s_add_u32 s53, s54, s81
    buffer_load_dwordx4 v173, s[40:43], s53 offen lds
    s_add_u32 s78, s78, 5505024
    s_mov_b64 exec, 0xffff
    buffer_store_dwordx4 v[168:171], v2, s[68:71], s78 offen sc1
    s_mov_b64 exec, -1
    s_mov_b32 s28, s24
    s_mov_b32 s29, s25
    s_mov_b32 s30, 268435456
    s_mov_b32 s31, 0x20000
    s_getreg_b32 s60, hwreg(HW_REG_XCC_ID, 0, 4)
    s_lshl_b32 s96, s2, 7
    s_add_u32 m0, s9, 81920
    s_add_u32 s53, s54, s82
    buffer_load_dwordx4 v173, s[40:43], s53 offen lds
    s_lshl_b32 s58, s26, 5
    s_add_u32 s96, s96, s58
    s_add_u32 s96, s96, 14389248
    v_readfirstlane_b32 s12, v12
    v_readfirstlane_b32 s13, v13
    s_add_u32 m0, s9, 86016
    s_add_u32 s53, s54, s83
    buffer_load_dwordx4 v173, s[40:43], s53 offen lds
    v_mov_b32 v14, s60
    v_add_u32 v5, 73728, v244
    v_add_u32 v6, 131072, v244
    s_lshr_b32 s57, s88, 1
    s_lshl_b32 s57, s57, 3
    s_add_u32 m0, s9, 90112
    s_add_u32 s53, s54, s84
    buffer_load_dwordx4 v173, s[40:43], s53 offen lds
    s_add_u32 s57, s57, s50
    s_mul_i32 s57, s57, 14
    s_and_b32 s56, s88, 1
    s_add_u32 s57, s57, s56
    s_lshl_b32 s57, s57, 11
    s_add_u32 m0, s9, 94208
    s_add_u32 s53, s54, s85
    buffer_load_dwordx4 v173, s[40:43], s53 offen lds
    s_add_u32 s57, s57, 11141120
    s_add_u32 s55, s57, s11
    s_add_u32 s56, s57, 28672
    s_lshl_b32 s97, s51, 2
    s_add_u32 s97, s97, s26
    s_add_u32 m0, s9, 98304
    s_add_u32 s53, s54, s86
    buffer_load_dwordx4 v173, s[40:43], s53 offen lds
    s_and_b32 s97, s97, 15
    s_lshl_b32 s97, s97, 3
    s_add_u32 s97, s97, s50
    s_lshl_b32 s97, s97, 5
    s_add_u32 s97, s97, 14422016
    s_waitcnt vmcnt(14)
    s_barrier
    ds_read_b128 a[0:3], v244 offset:28672
    ds_read_b128 a[4:7], v244 offset:29696
    ds_read_b128 a[8:11], v244 offset:30720
    ds_read_b128 a[12:15], v244 offset:31744
    ds_read_b128 a[16:19], v244 offset:32768
    ds_read_b128 a[20:23], v244 offset:33792
    s_waitcnt lgkmcnt(5)
    v_mfma_f32_16x16x32_bf16 v[128:131], a[0:3], v[16:19], 0
    ds_read_b128 a[24:27], v244 offset:34816
    s_waitcnt lgkmcnt(5)
    v_mfma_f32_16x16x32_bf16 v[132:135], a[4:7], v[16:19], 0
    ds_read_b128 a[28:31], v244 offset:35840
    v_mfma_f32_16x16x32_bf16 v[136:139], a[0:3], v[72:75], 0
    s_add_u32 s54, s54, 28672
    s_cmp_eq_u32 s54, 200704
    s_cselect_b32 s54, 0, s54
    s_add_u32 m0, s9, 102400
    s_add_u32 s53, s54, s80
    buffer_load_dwordx4 v173, s[40:43], s53 offen lds
    v_mfma_f32_16x16x32_bf16 v[140:143], a[4:7], v[72:75], 0
    s_waitcnt lgkmcnt(5)
    v_mfma_f32_16x16x32_bf16 v[128:131], a[8:11], v[20:23], v[128:131]
    ds_read_b128 a[32:35], v244 offset:36864
    s_waitcnt lgkmcnt(5)
    v_mfma_f32_16x16x32_bf16 v[132:135], a[12:15], v[20:23], v[132:135]
    ds_read_b128 a[36:39], v244 offset:37888
    v_mfma_f32_16x16x32_bf16 v[136:139], a[8:11], v[76:79], v[136:139]
    s_add_u32 m0, s9, 106496
    s_add_u32 s53, s54, s81
    buffer_load_dwordx4 v173, s[40:43], s53 offen lds
    v_mfma_f32_16x16x32_bf16 v[140:143], a[12:15], v[76:79], v[140:143]
    s_waitcnt lgkmcnt(5)
    v_mfma_f32_16x16x32_bf16 v[128:131], a[16:19], v[24:27], v[128:131]
    ds_read_b128 a[0:3], v244 offset:38912
    s_waitcnt lgkmcnt(5)
    v_mfma_f32_16x16x32_bf16 v[132:135], a[20:23], v[24:27], v[132:135]
    ds_read_b128 a[4:7], v244 offset:39936
    v_mfma_f32_16x16x32_bf16 v[136:139], a[16:19], v[80:83], v[136:139]
    s_add_u32 m0, s9, 110592
    s_add_u32 s53, s54, s82
    buffer_load_dwordx4 v173, s[40:43], s53 offen lds
    v_mfma_f32_16x16x32_bf16 v[140:143], a[20:23], v[80:83], v[140:143]
    s_waitcnt lgkmcnt(5)
    v_mfma_f32_16x16x32_bf16 v[128:131], a[24:27], v[28:31], v[128:131]
    ds_read_b128 a[8:11], v244 offset:40960
    s_waitcnt lgkmcnt(5)
    v_mfma_f32_16x16x32_bf16 v[132:135], a[28:31], v[28:31], v[132:135]
    ds_read_b128 a[12:15], v244 offset:41984
    v_mfma_f32_16x16x32_bf16 v[136:139], a[24:27], v[84:87], v[136:139]
    s_add_u32 m0, s9, 114688
    s_add_u32 s53, s54, s83
    buffer_load_dwordx4 v173, s[40:43], s53 offen lds
    v_mfma_f32_16x16x32_bf16 v[140:143], a[28:31], v[84:87], v[140:143]
    s_waitcnt lgkmcnt(5)
    v_mfma_f32_16x16x32_bf16 v[128:131], a[32:35], v[32:35], v[128:131]
    ds_read_b128 a[16:19], v244 offset:43008
    s_waitcnt lgkmcnt(5)
    v_mfma_f32_16x16x32_bf16 v[132:135], a[36:39], v[32:35], v[132:135]
    ds_read_b128 a[20:23], v244 offset:44032
    v_mfma_f32_16x16x32_bf16 v[136:139], a[32:35], v[88:91], v[136:139]
    s_add_u32 m0, s9, 118784
    s_add_u32 s53, s54, s84
    buffer_load_dwordx4 v173, s[40:43], s53 offen lds
    v_mfma_f32_16x16x32_bf16 v[140:143], a[36:39], v[88:91], v[140:143]
    s_waitcnt lgkmcnt(5)
    v_mfma_f32_16x16x32_bf16 v[128:131], a[0:3], v[36:39], v[128:131]
    ds_read_b128 a[24:27], v244 offset:45056
    s_waitcnt lgkmcnt(5)
    v_mfma_f32_16x16x32_bf16 v[132:135], a[4:7], v[36:39], v[132:135]
    ds_read_b128 a[28:31], v244 offset:46080
    v_mfma_f32_16x16x32_bf16 v[136:139], a[0:3], v[92:95], v[136:139]
    s_add_u32 m0, s9, 122880
    s_add_u32 s53, s54, s85
    buffer_load_dwordx4 v173, s[40:43], s53 offen lds
    v_mfma_f32_16x16x32_bf16 v[140:143], a[4:7], v[92:95], v[140:143]
    s_waitcnt lgkmcnt(5)
    v_mfma_f32_16x16x32_bf16 v[128:131], a[8:11], v[40:43], v[128:131]
    ds_read_b128 a[32:35], v244 offset:47104
    s_waitcnt lgkmcnt(5)
    v_mfma_f32_16x16x32_bf16 v[132:135], a[12:15], v[40:43], v[132:135]
    ds_read_b128 a[36:39], v244 offset:48128
    v_mfma_f32_16x16x32_bf16 v[136:139], a[8:11], v[96:99], v[136:139]
    s_add_u32 m0, s9, 126976
    s_add_u32 s53, s54, s86
    buffer_load_dwordx4 v173, s[40:43], s53 offen lds
    v_mfma_f32_16x16x32_bf16 v[140:143], a[12:15], v[96:99], v[140:143]
    s_waitcnt lgkmcnt(5)
    v_mfma_f32_16x16x32_bf16 v[128:131], a[16:19], v[44:47], v[128:131]
    ds_read_b128 a[0:3], v244 offset:49152
    s_waitcnt lgkmcnt(5)
    v_mfma_f32_16x16x32_bf16 v[132:135], a[20:23], v[44:47], v[132:135]
    ds_read_b128 a[4:7], v244 offset:50176
    v_mfma_f32_16x16x32_bf16 v[136:139], a[16:19], v[100:103], v[136:139]
    s_add_u32 s54, s54, 28672
    s_cmp_eq_u32 s54, 200704
    s_cselect_b32 s54, 0, s54
    s_add_u32 m0, s9, 0
    s_add_u32 s53, s54, s80
    buffer_load_dwordx4 v173, s[40:43], s53 offen lds
    v_mfma_f32_16x16x32_bf16 v[140:143], a[20:23], v[100:103], v[140:143]
    s_waitcnt lgkmcnt(5)
    v_mfma_f32_16x16x32_bf16 v[128:131], a[24:27], v[48:51], v[128:131]
    ds_read_b128 a[8:11], v244 offset:51200
    s_waitcnt lgkmcnt(5)
    v_mfma_f32_16x16x32_bf16 v[132:135], a[28:31], v[48:51], v[132:135]
    ds_read_b128 a[12:15], v244 offset:52224
    v_mfma_f32_16x16x32_bf16 v[136:139], a[24:27], v[104:107], v[136:139]
    s_add_u32 m0, s9, 4096
    s_add_u32 s53, s54, s81
    buffer_load_dwordx4 v173, s[40:43], s53 offen lds
    v_mfma_f32_16x16x32_bf16 v[140:143], a[28:31], v[104:107], v[140:143]
    s_waitcnt lgkmcnt(5)
    v_mfma_f32_16x16x32_bf16 v[128:131], a[32:35], v[52:55], v[128:131]
    ds_read_b128 a[16:19], v244 offset:53248
    s_waitcnt lgkmcnt(5)
    v_mfma_f32_16x16x32_bf16 v[132:135], a[36:39], v[52:55], v[132:135]
    ds_read_b128 a[20:23], v244 offset:54272
    v_mfma_f32_16x16x32_bf16 v[136:139], a[32:35], v[108:111], v[136:139]
    s_add_u32 m0, s9, 8192
    s_add_u32 s53, s54, s82
    buffer_load_dwordx4 v173, s[40:43], s53 offen lds
    v_mfma_f32_16x16x32_bf16 v[140:143], a[36:39], v[108:111], v[140:143]
    s_waitcnt lgkmcnt(5)
    v_mfma_f32_16x16x32_bf16 v[128:131], a[0:3], v[56:59], v[128:131]
    ds_read_b128 a[24:27], v244 offset:55296
    s_waitcnt lgkmcnt(5)
    v_mfma_f32_16x16x32_bf16 v[132:135], a[4:7], v[56:59], v[132:135]
    ds_read_b128 a[28:31], v244 offset:56320
    v_mfma_f32_16x16x32_bf16 v[136:139], a[0:3], v[112:115], v[136:139]
    s_add_u32 m0, s9, 12288
    s_add_u32 s53, s54, s83
    buffer_load_dwordx4 v173, s[40:43], s53 offen lds
    v_mfma_f32_16x16x32_bf16 v[140:143], a[4:7], v[112:115], v[140:143]
    s_waitcnt lgkmcnt(5)
    v_mfma_f32_16x16x32_bf16 v[128:131], a[8:11], v[60:63], v[128:131]
    s_waitcnt vmcnt(11)
    s_barrier
    ds_read_b128 a[32:35], v5 offset:0
    s_waitcnt lgkmcnt(5)
    v_mfma_f32_16x16x32_bf16 v[132:135], a[12:15], v[60:63], v[132:135]
    ds_read_b128 a[36:39], v5 offset:1024
    v_mfma_f32_16x16x32_bf16 v[136:139], a[8:11], v[116:119], v[136:139]
    s_add_u32 m0, s9, 16384
    s_add_u32 s53, s54, s84
    buffer_load_dwordx4 v173, s[40:43], s53 offen lds
    v_mfma_f32_16x16x32_bf16 v[140:143], a[12:15], v[116:119], v[140:143]
    s_waitcnt lgkmcnt(5)
    v_mfma_f32_16x16x32_bf16 v[128:131], a[16:19], v[64:67], v[128:131]
    ds_read_b128 a[0:3], v5 offset:2048
    s_waitcnt lgkmcnt(5)
    v_mfma_f32_16x16x32_bf16 v[132:135], a[20:23], v[64:67], v[132:135]
    ds_read_b128 a[4:7], v5 offset:3072
    v_mfma_f32_16x16x32_bf16 v[136:139], a[16:19], v[120:123], v[136:139]
    s_add_u32 m0, s9, 20480
    s_add_u32 s53, s54, s85
    buffer_load_dwordx4 v173, s[40:43], s53 offen lds
    v_mfma_f32_16x16x32_bf16 v[140:143], a[20:23], v[120:123], v[140:143]
    s_waitcnt lgkmcnt(5)
    v_mfma_f32_16x16x32_bf16 v[128:131], a[24:27], v[68:71], v[128:131]
    ds_read_b128 a[8:11], v5 offset:4096
    s_waitcnt lgkmcnt(5)
    v_mfma_f32_16x16x32_bf16 v[132:135], a[28:31], v[68:71], v[132:135]
    ds_read_b128 a[12:15], v5 offset:5120
    v_mfma_f32_16x16x32_bf16 v[136:139], a[24:27], v[124:127], v[136:139]
    s_add_u32 m0, s9, 24576
    s_add_u32 s53, s54, s86
    buffer_load_dwordx4 v173, s[40:43], s53 offen lds
    v_mfma_f32_16x16x32_bf16 v[140:143], a[28:31], v[124:127], v[140:143]
    s_waitcnt lgkmcnt(5)
    v_mfma_f32_16x16x32_bf16 v[144:147], a[32:35], v[16:19], 0
    ds_read_b128 a[16:19], v5 offset:6144
    s_waitcnt lgkmcnt(5)
    v_mfma_f32_16x16x32_bf16 v[148:151], a[36:39], v[16:19], 0
    ds_read_b128 a[20:23], v5 offset:7168
    v_mfma_f32_16x16x32_bf16 v[152:155], a[32:35], v[72:75], 0
    v_mfma_f32_16x16x32_bf16 v[156:159], a[36:39], v[72:75], 0
    s_waitcnt lgkmcnt(5)
    v_mfma_f32_16x16x32_bf16 v[144:147], a[0:3], v[20:23], v[144:147]
    ds_read_b128 a[24:27], v5 offset:8192
    s_waitcnt lgkmcnt(5)
    v_mfma_f32_16x16x32_bf16 v[148:151], a[4:7], v[20:23], v[148:151]
    ds_read_b128 a[28:31], v5 offset:9216
    v_mfma_f32_16x16x32_bf16 v[152:155], a[0:3], v[76:79], v[152:155]
    s_add_u32 s54, s54, 28672
    s_cmp_eq_u32 s54, 200704
    s_cselect_b32 s54, 0, s54
    s_add_u32 m0, s9, 131072
    s_add_u32 s53, s54, s80
    buffer_load_dwordx4 v173, s[40:43], s53 offen lds
    v_cvt_pk_bf16_f32 v160, v128, v129
    v_cvt_pk_bf16_f32 v161, v130, v131
    v_mfma_f32_16x16x32_bf16 v[156:159], a[4:7], v[76:79], v[156:159]
    v_cvt_pk_bf16_f32 v162, v132, v133
    v_cvt_pk_bf16_f32 v163, v134, v135
    s_waitcnt lgkmcnt(5)
    v_mfma_f32_16x16x32_bf16 v[144:147], a[8:11], v[24:27], v[144:147]
    ds_read_b128 a[32:35], v5 offset:10240
    s_waitcnt lgkmcnt(5)
    v_mfma_f32_16x16x32_bf16 v[148:151], a[12:15], v[24:27], v[148:151]
    ds_read_b128 a[36:39], v5 offset:11264
    v_mfma_f32_16x16x32_bf16 v[152:155], a[8:11], v[80:83], v[152:155]
    v_cvt_pk_bf16_f32 v164, v136, v137
    v_cvt_pk_bf16_f32 v165, v138, v139
    v_mfma_f32_16x16x32_bf16 v[156:159], a[12:15], v[80:83], v[156:159]
    v_cvt_pk_bf16_f32 v166, v140, v141
    v_cvt_pk_bf16_f32 v167, v142, v143
    s_waitcnt lgkmcnt(5)
    v_mfma_f32_16x16x32_bf16 v[144:147], a[16:19], v[28:31], v[144:147]
    ds_read_b128 a[0:3], v5 offset:12288
    s_waitcnt lgkmcnt(5)
    v_mfma_f32_16x16x32_bf16 v[148:151], a[20:23], v[28:31], v[148:151]
    ds_read_b128 a[4:7], v5 offset:13312
    v_mfma_f32_16x16x32_bf16 v[152:155], a[16:19], v[84:87], v[152:155]
    s_add_u32 m0, s9, 135168
    s_add_u32 s53, s54, s81
    buffer_load_dwordx4 v173, s[40:43], s53 offen lds
    buffer_store_dwordx4 v[160:163], v2, s[68:71], s55 offen offset:0 sc1
    buffer_store_dwordx4 v[164:167], v2, s[68:71], s55 offen offset:1024 sc1
    v_mfma_f32_16x16x32_bf16 v[156:159], a[20:23], v[84:87], v[156:159]
    s_add_u32 s55, s55, 4096
    s_cmp_eq_u32 s55, s56
    s_cselect_b32 s55, s57, s55
    s_waitcnt lgkmcnt(5)
    v_mfma_f32_16x16x32_bf16 v[144:147], a[24:27], v[32:35], v[144:147]
    ds_read_b128 a[8:11], v5 offset:14336
    s_waitcnt lgkmcnt(5)
    v_mfma_f32_16x16x32_bf16 v[148:151], a[28:31], v[32:35], v[148:151]
    ds_read_b128 a[12:15], v5 offset:15360
    v_mfma_f32_16x16x32_bf16 v[152:155], a[24:27], v[88:91], v[152:155]
    v_mfma_f32_16x16x32_bf16 v[156:159], a[28:31], v[88:91], v[156:159]
    s_waitcnt lgkmcnt(5)
    v_mfma_f32_16x16x32_bf16 v[144:147], a[32:35], v[36:39], v[144:147]
    ds_read_b128 a[16:19], v5 offset:16384
    s_waitcnt lgkmcnt(5)
    v_mfma_f32_16x16x32_bf16 v[148:151], a[36:39], v[36:39], v[148:151]
    ds_read_b128 a[20:23], v5 offset:17408
    v_mfma_f32_16x16x32_bf16 v[152:155], a[32:35], v[92:95], v[152:155]
    s_add_u32 m0, s9, 139264
    s_add_u32 s53, s54, s82
    buffer_load_dwordx4 v173, s[40:43], s53 offen lds
    v_mfma_f32_16x16x32_bf16 v[156:159], a[36:39], v[92:95], v[156:159]
    s_waitcnt lgkmcnt(5)
    v_mfma_f32_16x16x32_bf16 v[144:147], a[0:3], v[40:43], v[144:147]
    ds_read_b128 a[24:27], v5 offset:18432
    s_waitcnt lgkmcnt(5)
    v_mfma_f32_16x16x32_bf16 v[148:151], a[4:7], v[40:43], v[148:151]
    ds_read_b128 a[28:31], v5 offset:19456
    v_mfma_f32_16x16x32_bf16 v[152:155], a[0:3], v[96:99], v[152:155]
    v_mfma_f32_16x16x32_bf16 v[156:159], a[4:7], v[96:99], v[156:159]
    s_mov_b64 exec, 1
    buffer_store_dwordx3 v[12:14], off, s[28:31], s96 offset:0 sc1
    s_mov_b64 exec, -1
    s_waitcnt lgkmcnt(5)
    v_mfma_f32_16x16x32_bf16 v[144:147], a[8:11], v[44:47], v[144:147]
    ds_read_b128 a[32:35], v5 offset:20480
    s_waitcnt lgkmcnt(5)
    v_mfma_f32_16x16x32_bf16 v[148:151], a[12:15], v[44:47], v[148:151]
    ds_read_b128 a[36:39], v5 offset:21504
    v_mfma_f32_16x16x32_bf16 v[152:155], a[8:11], v[100:103], v[152:155]
    s_add_u32 m0, s9, 143360
    s_add_u32 s53, s54, s83
    buffer_load_dwordx4 v173, s[40:43], s53 offen lds
    v_mfma_f32_16x16x32_bf16 v[156:159], a[12:15], v[100:103], v[156:159]
    s_waitcnt lgkmcnt(5)
    v_mfma_f32_16x16x32_bf16 v[144:147], a[16:19], v[48:51], v[144:147]
    ds_read_b128 a[0:3], v5 offset:22528
    s_waitcnt lgkmcnt(5)
    v_mfma_f32_16x16x32_bf16 v[148:151], a[20:23], v[48:51], v[148:151]
    ds_read_b128 a[4:7], v5 offset:23552
    v_mfma_f32_16x16x32_bf16 v[152:155], a[16:19], v[104:107], v[152:155]
    v_mfma_f32_16x16x32_bf16 v[156:159], a[20:23], v[104:107], v[156:159]
    s_waitcnt lgkmcnt(5)
    v_mfma_f32_16x16x32_bf16 v[144:147], a[24:27], v[52:55], v[144:147]
    ds_read_b128 a[8:11], v5 offset:24576
    s_waitcnt lgkmcnt(5)
    v_mfma_f32_16x16x32_bf16 v[148:151], a[28:31], v[52:55], v[148:151]
    ds_read_b128 a[12:15], v5 offset:25600
    v_mfma_f32_16x16x32_bf16 v[152:155], a[24:27], v[108:111], v[152:155]
    s_add_u32 m0, s9, 147456
    s_add_u32 s53, s54, s84
    buffer_load_dwordx4 v173, s[40:43], s53 offen lds
    v_mfma_f32_16x16x32_bf16 v[156:159], a[28:31], v[108:111], v[156:159]
    s_waitcnt lgkmcnt(5)
    v_mfma_f32_16x16x32_bf16 v[144:147], a[32:35], v[56:59], v[144:147]
    ds_read_b128 a[16:19], v5 offset:26624
    s_waitcnt lgkmcnt(5)
    v_mfma_f32_16x16x32_bf16 v[148:151], a[36:39], v[56:59], v[148:151]
    ds_read_b128 a[20:23], v5 offset:27648
    v_mfma_f32_16x16x32_bf16 v[152:155], a[32:35], v[112:115], v[152:155]
    v_mfma_f32_16x16x32_bf16 v[156:159], a[36:39], v[112:115], v[156:159]
    s_waitcnt lgkmcnt(5)
    v_mfma_f32_16x16x32_bf16 v[144:147], a[0:3], v[60:63], v[144:147]
    s_waitcnt vmcnt(15)
    s_barrier
    ds_read_b128 a[24:27], v5 offset:28672
    s_waitcnt lgkmcnt(5)
    v_mfma_f32_16x16x32_bf16 v[148:151], a[4:7], v[60:63], v[148:151]
    ds_read_b128 a[28:31], v5 offset:29696
    v_mfma_f32_16x16x32_bf16 v[152:155], a[0:3], v[116:119], v[152:155]
    s_add_u32 m0, s9, 151552
    s_add_u32 s53, s54, s85
    buffer_load_dwordx4 v173, s[40:43], s53 offen lds
    v_mfma_f32_16x16x32_bf16 v[156:159], a[4:7], v[116:119], v[156:159]
    s_waitcnt lgkmcnt(5)
    v_mfma_f32_16x16x32_bf16 v[144:147], a[8:11], v[64:67], v[144:147]
    ds_read_b128 a[32:35], v5 offset:30720
    s_waitcnt lgkmcnt(5)
    v_mfma_f32_16x16x32_bf16 v[148:151], a[12:15], v[64:67], v[148:151]
    ds_read_b128 a[36:39], v5 offset:31744
    v_mfma_f32_16x16x32_bf16 v[152:155], a[8:11], v[120:123], v[152:155]
    v_mfma_f32_16x16x32_bf16 v[156:159], a[12:15], v[120:123], v[156:159]
    s_waitcnt lgkmcnt(5)
    v_mfma_f32_16x16x32_bf16 v[144:147], a[16:19], v[68:71], v[144:147]
    ds_read_b128 a[0:3], v5 offset:32768
    s_waitcnt lgkmcnt(5)
    v_mfma_f32_16x16x32_bf16 v[148:151], a[20:23], v[68:71], v[148:151]
    ds_read_b128 a[4:7], v5 offset:33792
    v_mfma_f32_16x16x32_bf16 v[152:155], a[16:19], v[124:127], v[152:155]
    s_add_u32 m0, s9, 155648
    s_add_u32 s53, s54, s86
    buffer_load_dwordx4 v173, s[40:43], s53 offen lds
    v_mfma_f32_16x16x32_bf16 v[156:159], a[20:23], v[124:127], v[156:159]
    s_waitcnt lgkmcnt(5)
    v_mfma_f32_16x16x32_bf16 v[128:131], a[24:27], v[16:19], 0
    ds_read_b128 a[8:11], v5 offset:34816
    s_waitcnt lgkmcnt(5)
    v_mfma_f32_16x16x32_bf16 v[132:135], a[28:31], v[16:19], 0
    ds_read_b128 a[12:15], v5 offset:35840
    v_mfma_f32_16x16x32_bf16 v[136:139], a[24:27], v[72:75], 0
    v_mfma_f32_16x16x32_bf16 v[140:143], a[28:31], v[72:75], 0
    s_waitcnt lgkmcnt(5)
    v_mfma_f32_16x16x32_bf16 v[128:131], a[32:35], v[20:23], v[128:131]
    ds_read_b128 a[16:19], v5 offset:36864
    s_waitcnt lgkmcnt(5)
    v_mfma_f32_16x16x32_bf16 v[132:135], a[36:39], v[20:23], v[132:135]
    ds_read_b128 a[20:23], v5 offset:37888
    v_mfma_f32_16x16x32_bf16 v[136:139], a[32:35], v[76:79], v[136:139]
    s_add_u32 s54, s54, 28672
    s_cmp_eq_u32 s54, 200704
    s_cselect_b32 s54, 0, s54
    s_add_u32 m0, s9, 28672
    s_add_u32 s53, s54, s80
    buffer_load_dwordx4 v173, s[40:43], s53 offen lds
    v_cvt_pk_bf16_f32 v160, v144, v145
    v_cvt_pk_bf16_f32 v161, v146, v147
    v_mfma_f32_16x16x32_bf16 v[140:143], a[36:39], v[76:79], v[140:143]
    v_cvt_pk_bf16_f32 v162, v148, v149
    v_cvt_pk_bf16_f32 v163, v150, v151
    s_waitcnt lgkmcnt(5)
    v_mfma_f32_16x16x32_bf16 v[128:131], a[0:3], v[24:27], v[128:131]
    ds_read_b128 a[24:27], v5 offset:38912
    s_waitcnt lgkmcnt(5)
    v_mfma_f32_16x16x32_bf16 v[132:135], a[4:7], v[24:27], v[132:135]
    ds_read_b128 a[28:31], v5 offset:39936
    v_mfma_f32_16x16x32_bf16 v[136:139], a[0:3], v[80:83], v[136:139]
    v_cvt_pk_bf16_f32 v164, v152, v153
    v_cvt_pk_bf16_f32 v165, v154, v155
    v_mfma_f32_16x16x32_bf16 v[140:143], a[4:7], v[80:83], v[140:143]
    v_cvt_pk_bf16_f32 v166, v156, v157
    v_cvt_pk_bf16_f32 v167, v158, v159
    s_waitcnt lgkmcnt(5)
    v_mfma_f32_16x16x32_bf16 v[128:131], a[8:11], v[28:31], v[128:131]
    ds_read_b128 a[32:35], v5 offset:40960
    s_waitcnt lgkmcnt(5)
    v_mfma_f32_16x16x32_bf16 v[132:135], a[12:15], v[28:31], v[132:135]
    ds_read_b128 a[36:39], v5 offset:41984
    v_mfma_f32_16x16x32_bf16 v[136:139], a[8:11], v[84:87], v[136:139]
    s_add_u32 m0, s9, 32768
    s_add_u32 s53, s54, s81
    buffer_load_dwordx4 v173, s[40:43], s53 offen lds
    buffer_store_dwordx4 v[160:163], v2, s[68:71], s55 offen offset:0 sc1
    buffer_store_dwordx4 v[164:167], v2, s[68:71], s55 offen offset:1024 sc1
    v_mfma_f32_16x16x32_bf16 v[140:143], a[12:15], v[84:87], v[140:143]
    s_add_u32 s55, s55, 4096
    s_cmp_eq_u32 s55, s56
    s_cselect_b32 s55, s57, s55
    s_waitcnt lgkmcnt(5)
    v_mfma_f32_16x16x32_bf16 v[128:131], a[16:19], v[32:35], v[128:131]
    ds_read_b128 a[0:3], v5 offset:43008
    s_waitcnt lgkmcnt(5)
    v_mfma_f32_16x16x32_bf16 v[132:135], a[20:23], v[32:35], v[132:135]
    ds_read_b128 a[4:7], v5 offset:44032
    v_mfma_f32_16x16x32_bf16 v[136:139], a[16:19], v[88:91], v[136:139]
    v_mfma_f32_16x16x32_bf16 v[140:143], a[20:23], v[88:91], v[140:143]
    s_waitcnt lgkmcnt(5)
    v_mfma_f32_16x16x32_bf16 v[128:131], a[24:27], v[36:39], v[128:131]
    ds_read_b128 a[8:11], v5 offset:45056
    s_waitcnt lgkmcnt(5)
    v_mfma_f32_16x16x32_bf16 v[132:135], a[28:31], v[36:39], v[132:135]
    ds_read_b128 a[12:15], v5 offset:46080
    v_mfma_f32_16x16x32_bf16 v[136:139], a[24:27], v[92:95], v[136:139]
    s_add_u32 m0, s9, 36864
    s_add_u32 s53, s54, s82
    buffer_load_dwordx4 v173, s[40:43], s53 offen lds
    v_mfma_f32_16x16x32_bf16 v[140:143], a[28:31], v[92:95], v[140:143]
    s_waitcnt lgkmcnt(5)
    v_mfma_f32_16x16x32_bf16 v[128:131], a[32:35], v[40:43], v[128:131]
    ds_read_b128 a[16:19], v5 offset:47104
    s_waitcnt lgkmcnt(5)
    v_mfma_f32_16x16x32_bf16 v[132:135], a[36:39], v[40:43], v[132:135]
    ds_read_b128 a[20:23], v5 offset:48128
    v_mfma_f32_16x16x32_bf16 v[136:139], a[32:35], v[96:99], v[136:139]
    v_mfma_f32_16x16x32_bf16 v[140:143], a[36:39], v[96:99], v[140:143]
    s_waitcnt lgkmcnt(5)
    v_mfma_f32_16x16x32_bf16 v[128:131], a[0:3], v[44:47], v[128:131]
    ds_read_b128 a[24:27], v5 offset:49152
    s_waitcnt lgkmcnt(5)
    v_mfma_f32_16x16x32_bf16 v[132:135], a[4:7], v[44:47], v[132:135]
    ds_read_b128 a[28:31], v5 offset:50176
    v_mfma_f32_16x16x32_bf16 v[136:139], a[0:3], v[100:103], v[136:139]
    s_add_u32 m0, s9, 40960
    s_add_u32 s53, s54, s83
    buffer_load_dwordx4 v173, s[40:43], s53 offen lds
    v_mfma_f32_16x16x32_bf16 v[140:143], a[4:7], v[100:103], v[140:143]
    s_waitcnt lgkmcnt(5)
    v_mfma_f32_16x16x32_bf16 v[128:131], a[8:11], v[48:51], v[128:131]
    ds_read_b128 a[32:35], v5 offset:51200
    s_waitcnt lgkmcnt(5)
    v_mfma_f32_16x16x32_bf16 v[132:135], a[12:15], v[48:51], v[132:135]
    ds_read_b128 a[36:39], v5 offset:52224
    v_mfma_f32_16x16x32_bf16 v[136:139], a[8:11], v[104:107], v[136:139]
    v_mfma_f32_16x16x32_bf16 v[140:143], a[12:15], v[104:107], v[140:143]
    s_waitcnt lgkmcnt(5)
    v_mfma_f32_16x16x32_bf16 v[128:131], a[16:19], v[52:55], v[128:131]
    ds_read_b128 a[0:3], v5 offset:53248
    s_waitcnt lgkmcnt(5)
    v_mfma_f32_16x16x32_bf16 v[132:135], a[20:23], v[52:55], v[132:135]
    ds_read_b128 a[4:7], v5 offset:54272
    v_mfma_f32_16x16x32_bf16 v[136:139], a[16:19], v[108:111], v[136:139]
    s_add_u32 m0, s9, 45056
    s_add_u32 s53, s54, s84
    buffer_load_dwordx4 v173, s[40:43], s53 offen lds
    v_mfma_f32_16x16x32_bf16 v[140:143], a[20:23], v[108:111], v[140:143]
    s_waitcnt lgkmcnt(5)
    v_mfma_f32_16x16x32_bf16 v[128:131], a[24:27], v[56:59], v[128:131]
    ds_read_b128 a[8:11], v5 offset:55296
    s_waitcnt lgkmcnt(5)
    v_mfma_f32_16x16x32_bf16 v[132:135], a[28:31], v[56:59], v[132:135]
    ds_read_b128 a[12:15], v5 offset:56320
    v_mfma_f32_16x16x32_bf16 v[136:139], a[24:27], v[112:115], v[136:139]
    v_mfma_f32_16x16x32_bf16 v[140:143], a[28:31], v[112:115], v[140:143]
    s_waitcnt lgkmcnt(5)
    v_mfma_f32_16x16x32_bf16 v[128:131], a[32:35], v[60:63], v[128:131]
    s_waitcnt vmcnt(17)
    s_barrier
    ds_read_b128 a[16:19], v244 offset:0
    s_waitcnt lgkmcnt(5)
    v_mfma_f32_16x16x32_bf16 v[132:135], a[36:39], v[60:63], v[132:135]
    ds_read_b128 a[20:23], v244 offset:1024
    v_mfma_f32_16x16x32_bf16 v[136:139], a[32:35], v[116:119], v[136:139]
    s_add_u32 m0, s9, 49152
    s_add_u32 s53, s54, s85
    buffer_load_dwordx4 v173, s[40:43], s53 offen lds
    v_mfma_f32_16x16x32_bf16 v[140:143], a[36:39], v[116:119], v[140:143]
    s_waitcnt lgkmcnt(5)
    v_mfma_f32_16x16x32_bf16 v[128:131], a[0:3], v[64:67], v[128:131]
    ds_read_b128 a[24:27], v244 offset:2048
    s_waitcnt lgkmcnt(5)
    v_mfma_f32_16x16x32_bf16 v[132:135], a[4:7], v[64:67], v[132:135]
    ds_read_b128 a[28:31], v244 offset:3072
    v_mfma_f32_16x16x32_bf16 v[136:139], a[0:3], v[120:123], v[136:139]
    v_mfma_f32_16x16x32_bf16 v[140:143], a[4:7], v[120:123], v[140:143]
    s_waitcnt lgkmcnt(5)
    v_mfma_f32_16x16x32_bf16 v[128:131], a[8:11], v[68:71], v[128:131]
    ds_read_b128 a[32:35], v244 offset:4096
    s_waitcnt lgkmcnt(5)
    v_mfma_f32_16x16x32_bf16 v[132:135], a[12:15], v[68:71], v[132:135]
    ds_read_b128 a[36:39], v244 offset:5120
    v_mfma_f32_16x16x32_bf16 v[136:139], a[8:11], v[124:127], v[136:139]
    s_add_u32 m0, s9, 53248
    s_add_u32 s53, s54, s86
    buffer_load_dwordx4 v173, s[40:43], s53 offen lds
    v_mfma_f32_16x16x32_bf16 v[140:143], a[12:15], v[124:127], v[140:143]
    s_waitcnt lgkmcnt(5)
    v_mfma_f32_16x16x32_bf16 v[144:147], a[16:19], v[16:19], 0
    ds_read_b128 a[0:3], v244 offset:6144
    s_waitcnt lgkmcnt(5)
    v_mfma_f32_16x16x32_bf16 v[148:151], a[20:23], v[16:19], 0
    ds_read_b128 a[4:7], v244 offset:7168
    v_mfma_f32_16x16x32_bf16 v[152:155], a[16:19], v[72:75], 0
    v_mfma_f32_16x16x32_bf16 v[156:159], a[20:23], v[72:75], 0
    s_waitcnt lgkmcnt(5)
    v_mfma_f32_16x16x32_bf16 v[144:147], a[24:27], v[20:23], v[144:147]
    ds_read_b128 a[8:11], v244 offset:8192
    s_waitcnt lgkmcnt(5)
    v_mfma_f32_16x16x32_bf16 v[148:151], a[28:31], v[20:23], v[148:151]
    ds_read_b128 a[12:15], v244 offset:9216
    v_mfma_f32_16x16x32_bf16 v[152:155], a[24:27], v[76:79], v[152:155]
    s_add_u32 s54, s54, 28672
    s_cmp_eq_u32 s54, 200704
    s_cselect_b32 s54, 0, s54
    s_add_u32 m0, s9, 73728
    s_add_u32 s53, s54, s80
    buffer_load_dwordx4 v173, s[40:43], s53 offen lds
    v_cvt_pk_bf16_f32 v160, v128, v129
    v_cvt_pk_bf16_f32 v161, v130, v131
    v_mfma_f32_16x16x32_bf16 v[156:159], a[28:31], v[76:79], v[156:159]
    v_cvt_pk_bf16_f32 v162, v132, v133
    v_cvt_pk_bf16_f32 v163, v134, v135
    s_waitcnt lgkmcnt(5)
    v_mfma_f32_16x16x32_bf16 v[144:147], a[32:35], v[24:27], v[144:147]
    ds_read_b128 a[16:19], v244 offset:10240
    s_waitcnt lgkmcnt(5)
    v_mfma_f32_16x16x32_bf16 v[148:151], a[36:39], v[24:27], v[148:151]
    ds_read_b128 a[20:23], v244 offset:11264
    v_mfma_f32_16x16x32_bf16 v[152:155], a[32:35], v[80:83], v[152:155]
    v_cvt_pk_bf16_f32 v164, v136, v137
    v_cvt_pk_bf16_f32 v165, v138, v139
    v_mfma_f32_16x16x32_bf16 v[156:159], a[36:39], v[80:83], v[156:159]
    v_cvt_pk_bf16_f32 v166, v140, v141
    v_cvt_pk_bf16_f32 v167, v142, v143
    s_waitcnt lgkmcnt(5)
    v_mfma_f32_16x16x32_bf16 v[144:147], a[0:3], v[28:31], v[144:147]
    ds_read_b128 a[24:27], v244 offset:12288
    s_waitcnt lgkmcnt(5)
    v_mfma_f32_16x16x32_bf16 v[148:151], a[4:7], v[28:31], v[148:151]
    ds_read_b128 a[28:31], v244 offset:13312
    v_mfma_f32_16x16x32_bf16 v[152:155], a[0:3], v[84:87], v[152:155]
    s_add_u32 m0, s9, 77824
    s_add_u32 s53, s54, s81
    buffer_load_dwordx4 v173, s[40:43], s53 offen lds
    buffer_store_dwordx4 v[160:163], v2, s[68:71], s55 offen offset:0 sc1
    buffer_store_dwordx4 v[164:167], v2, s[68:71], s55 offen offset:1024 sc1
    v_mfma_f32_16x16x32_bf16 v[156:159], a[4:7], v[84:87], v[156:159]
    s_add_u32 s55, s55, 4096
    s_cmp_eq_u32 s55, s56
    s_cselect_b32 s55, s57, s55
    s_waitcnt lgkmcnt(5)
    v_mfma_f32_16x16x32_bf16 v[144:147], a[8:11], v[32:35], v[144:147]
    ds_read_b128 a[32:35], v244 offset:14336
    s_waitcnt lgkmcnt(5)
    v_mfma_f32_16x16x32_bf16 v[148:151], a[12:15], v[32:35], v[148:151]
    ds_read_b128 a[36:39], v244 offset:15360
    v_mfma_f32_16x16x32_bf16 v[152:155], a[8:11], v[88:91], v[152:155]
    v_mfma_f32_16x16x32_bf16 v[156:159], a[12:15], v[88:91], v[156:159]
    s_waitcnt lgkmcnt(5)
    v_mfma_f32_16x16x32_bf16 v[144:147], a[16:19], v[36:39], v[144:147]
    ds_read_b128 a[0:3], v244 offset:16384
    s_waitcnt lgkmcnt(5)
    v_mfma_f32_16x16x32_bf16 v[148:151], a[20:23], v[36:39], v[148:151]
    ds_read_b128 a[4:7], v244 offset:17408
    v_mfma_f32_16x16x32_bf16 v[152:155], a[16:19], v[92:95], v[152:155]
    s_add_u32 m0, s9, 81920
    s_add_u32 s53, s54, s82
    buffer_load_dwordx4 v173, s[40:43], s53 offen lds
    v_mfma_f32_16x16x32_bf16 v[156:159], a[20:23], v[92:95], v[156:159]
    s_waitcnt lgkmcnt(5)
    v_mfma_f32_16x16x32_bf16 v[144:147], a[24:27], v[40:43], v[144:147]
    ds_read_b128 a[8:11], v244 offset:18432
    s_waitcnt lgkmcnt(5)
    v_mfma_f32_16x16x32_bf16 v[148:151], a[28:31], v[40:43], v[148:151]
    ds_read_b128 a[12:15], v244 offset:19456
    v_mfma_f32_16x16x32_bf16 v[152:155], a[24:27], v[96:99], v[152:155]
    v_mfma_f32_16x16x32_bf16 v[156:159], a[28:31], v[96:99], v[156:159]
    s_waitcnt lgkmcnt(5)
    v_mfma_f32_16x16x32_bf16 v[144:147], a[32:35], v[44:47], v[144:147]
    ds_read_b128 a[16:19], v244 offset:20480
    s_waitcnt lgkmcnt(5)
    v_mfma_f32_16x16x32_bf16 v[148:151], a[36:39], v[44:47], v[148:151]
    ds_read_b128 a[20:23], v244 offset:21504
    v_mfma_f32_16x16x32_bf16 v[152:155], a[32:35], v[100:103], v[152:155]
    s_add_u32 m0, s9, 86016
    s_add_u32 s53, s54, s83
    buffer_load_dwordx4 v173, s[40:43], s53 offen lds
    v_mfma_f32_16x16x32_bf16 v[156:159], a[36:39], v[100:103], v[156:159]
    s_waitcnt lgkmcnt(5)
    v_mfma_f32_16x16x32_bf16 v[144:147], a[0:3], v[48:51], v[144:147]
    ds_read_b128 a[24:27], v244 offset:22528
    s_waitcnt lgkmcnt(5)
    v_mfma_f32_16x16x32_bf16 v[148:151], a[4:7], v[48:51], v[148:151]
    ds_read_b128 a[28:31], v244 offset:23552
    v_mfma_f32_16x16x32_bf16 v[152:155], a[0:3], v[104:107], v[152:155]
    v_mfma_f32_16x16x32_bf16 v[156:159], a[4:7], v[104:107], v[156:159]
    s_waitcnt lgkmcnt(5)
    v_mfma_f32_16x16x32_bf16 v[144:147], a[8:11], v[52:55], v[144:147]
    ds_read_b128 a[32:35], v244 offset:24576
    s_waitcnt lgkmcnt(5)
    v_mfma_f32_16x16x32_bf16 v[148:151], a[12:15], v[52:55], v[148:151]
    ds_read_b128 a[36:39], v244 offset:25600
    v_mfma_f32_16x16x32_bf16 v[152:155], a[8:11], v[108:111], v[152:155]
    s_add_u32 m0, s9, 90112
    s_add_u32 s53, s54, s84
    buffer_load_dwordx4 v173, s[40:43], s53 offen lds
    v_mfma_f32_16x16x32_bf16 v[156:159], a[12:15], v[108:111], v[156:159]
    s_waitcnt lgkmcnt(5)
    v_mfma_f32_16x16x32_bf16 v[144:147], a[16:19], v[56:59], v[144:147]
    ds_read_b128 a[0:3], v244 offset:26624
    s_waitcnt lgkmcnt(5)
    v_mfma_f32_16x16x32_bf16 v[148:151], a[20:23], v[56:59], v[148:151]
    ds_read_b128 a[4:7], v244 offset:27648
    v_mfma_f32_16x16x32_bf16 v[152:155], a[16:19], v[112:115], v[152:155]
    v_mfma_f32_16x16x32_bf16 v[156:159], a[20:23], v[112:115], v[156:159]
    s_waitcnt lgkmcnt(5)
    v_mfma_f32_16x16x32_bf16 v[144:147], a[24:27], v[60:63], v[144:147]
    s_waitcnt vmcnt(16)
    s_barrier
    ds_read_b128 a[8:11], v6 offset:0
    s_waitcnt lgkmcnt(5)
    v_mfma_f32_16x16x32_bf16 v[148:151], a[28:31], v[60:63], v[148:151]
    ds_read_b128 a[12:15], v6 offset:1024
    v_mfma_f32_16x16x32_bf16 v[152:155], a[24:27], v[116:119], v[152:155]
    s_add_u32 m0, s9, 94208
    s_add_u32 s53, s54, s85
    buffer_load_dwordx4 v173, s[40:43], s53 offen lds
    v_mfma_f32_16x16x32_bf16 v[156:159], a[28:31], v[116:119], v[156:159]
    s_waitcnt lgkmcnt(5)
    v_mfma_f32_16x16x32_bf16 v[144:147], a[32:35], v[64:67], v[144:147]
    ds_read_b128 a[16:19], v6 offset:2048
    s_waitcnt lgkmcnt(5)
    v_mfma_f32_16x16x32_bf16 v[148:151], a[36:39], v[64:67], v[148:151]
    ds_read_b128 a[20:23], v6 offset:3072
    v_mfma_f32_16x16x32_bf16 v[152:155], a[32:35], v[120:123], v[152:155]
    v_mfma_f32_16x16x32_bf16 v[156:159], a[36:39], v[120:123], v[156:159]
    s_waitcnt lgkmcnt(5)
    v_mfma_f32_16x16x32_bf16 v[144:147], a[0:3], v[68:71], v[144:147]
    ds_read_b128 a[24:27], v6 offset:4096
    s_waitcnt lgkmcnt(5)
    v_mfma_f32_16x16x32_bf16 v[148:151], a[4:7], v[68:71], v[148:151]
    ds_read_b128 a[28:31], v6 offset:5120
    v_mfma_f32_16x16x32_bf16 v[152:155], a[0:3], v[124:127], v[152:155]
    s_add_u32 m0, s9, 98304
    s_add_u32 s53, s54, s86
    buffer_load_dwordx4 v173, s[40:43], s53 offen lds
    v_mfma_f32_16x16x32_bf16 v[156:159], a[4:7], v[124:127], v[156:159]
    s_waitcnt lgkmcnt(5)
    v_mfma_f32_16x16x32_bf16 v[128:131], a[8:11], v[16:19], 0
    ds_read_b128 a[32:35], v6 offset:6144
    s_waitcnt lgkmcnt(5)
    v_mfma_f32_16x16x32_bf16 v[132:135], a[12:15], v[16:19], 0
    ds_read_b128 a[36:39], v6 offset:7168
    v_mfma_f32_16x16x32_bf16 v[136:139], a[8:11], v[72:75], 0
    v_mfma_f32_16x16x32_bf16 v[140:143], a[12:15], v[72:75], 0
    s_waitcnt lgkmcnt(5)
    v_mfma_f32_16x16x32_bf16 v[128:131], a[16:19], v[20:23], v[128:131]
    ds_read_b128 a[0:3], v6 offset:8192
    s_waitcnt lgkmcnt(5)
    v_mfma_f32_16x16x32_bf16 v[132:135], a[20:23], v[20:23], v[132:135]
    ds_read_b128 a[4:7], v6 offset:9216
    v_mfma_f32_16x16x32_bf16 v[136:139], a[16:19], v[76:79], v[136:139]
    v_cvt_pk_bf16_f32 v160, v144, v145
    v_cvt_pk_bf16_f32 v161, v146, v147
    v_mfma_f32_16x16x32_bf16 v[140:143], a[20:23], v[76:79], v[140:143]
    v_cvt_pk_bf16_f32 v162, v148, v149
    v_cvt_pk_bf16_f32 v163, v150, v151
    s_waitcnt lgkmcnt(5)
    v_mfma_f32_16x16x32_bf16 v[128:131], a[24:27], v[24:27], v[128:131]
    ds_read_b128 a[8:11], v6 offset:10240
    s_waitcnt lgkmcnt(5)
    v_mfma_f32_16x16x32_bf16 v[132:135], a[28:31], v[24:27], v[132:135]
    ds_read_b128 a[12:15], v6 offset:11264
    v_mfma_f32_16x16x32_bf16 v[136:139], a[24:27], v[80:83], v[136:139]
    v_cvt_pk_bf16_f32 v164, v152, v153
    v_cvt_pk_bf16_f32 v165, v154, v155
    v_mfma_f32_16x16x32_bf16 v[140:143], a[28:31], v[80:83], v[140:143]
    v_cvt_pk_bf16_f32 v166, v156, v157
    v_cvt_pk_bf16_f32 v167, v158, v159
    s_waitcnt lgkmcnt(5)
    v_mfma_f32_16x16x32_bf16 v[128:131], a[32:35], v[28:31], v[128:131]
    ds_read_b128 a[16:19], v6 offset:12288
    s_waitcnt lgkmcnt(5)
    v_mfma_f32_16x16x32_bf16 v[132:135], a[36:39], v[28:31], v[132:135]
    ds_read_b128 a[20:23], v6 offset:13312
    v_mfma_f32_16x16x32_bf16 v[136:139], a[32:35], v[84:87], v[136:139]
    buffer_store_dwordx4 v[160:163], v2, s[68:71], s55 offen offset:0 sc1
    buffer_store_dwordx4 v[164:167], v2, s[68:71], s55 offen offset:1024 sc1
    v_mfma_f32_16x16x32_bf16 v[140:143], a[36:39], v[84:87], v[140:143]
    s_add_u32 s55, s55, 4096
    s_cmp_eq_u32 s55, s56
    s_cselect_b32 s55, s57, s55
    s_waitcnt lgkmcnt(5)
    v_mfma_f32_16x16x32_bf16 v[128:131], a[0:3], v[32:35], v[128:131]
    ds_read_b128 a[24:27], v6 offset:14336
    s_waitcnt lgkmcnt(5)
    v_mfma_f32_16x16x32_bf16 v[132:135], a[4:7], v[32:35], v[132:135]
    ds_read_b128 a[28:31], v6 offset:15360
    v_mfma_f32_16x16x32_bf16 v[136:139], a[0:3], v[88:91], v[136:139]
    v_mfma_f32_16x16x32_bf16 v[140:143], a[4:7], v[88:91], v[140:143]
    s_waitcnt lgkmcnt(5)
    v_mfma_f32_16x16x32_bf16 v[128:131], a[8:11], v[36:39], v[128:131]
    ds_read_b128 a[32:35], v6 offset:16384
    s_waitcnt lgkmcnt(5)
    v_mfma_f32_16x16x32_bf16 v[132:135], a[12:15], v[36:39], v[132:135]
    ds_read_b128 a[36:39], v6 offset:17408
    v_mfma_f32_16x16x32_bf16 v[136:139], a[8:11], v[92:95], v[136:139]
    v_mfma_f32_16x16x32_bf16 v[140:143], a[12:15], v[92:95], v[140:143]
    s_waitcnt lgkmcnt(5)
    v_mfma_f32_16x16x32_bf16 v[128:131], a[16:19], v[40:43], v[128:131]
    ds_read_b128 a[0:3], v6 offset:18432
    s_waitcnt lgkmcnt(5)
    v_mfma_f32_16x16x32_bf16 v[132:135], a[20:23], v[40:43], v[132:135]
    ds_read_b128 a[4:7], v6 offset:19456
    v_mfma_f32_16x16x32_bf16 v[136:139], a[16:19], v[96:99], v[136:139]
    v_mfma_f32_16x16x32_bf16 v[140:143], a[20:23], v[96:99], v[140:143]
    s_waitcnt lgkmcnt(5)
    v_mfma_f32_16x16x32_bf16 v[128:131], a[24:27], v[44:47], v[128:131]
    ds_read_b128 a[8:11], v6 offset:20480
    s_waitcnt lgkmcnt(5)
    v_mfma_f32_16x16x32_bf16 v[132:135], a[28:31], v[44:47], v[132:135]
    ds_read_b128 a[12:15], v6 offset:21504
    v_mfma_f32_16x16x32_bf16 v[136:139], a[24:27], v[100:103], v[136:139]
    v_mfma_f32_16x16x32_bf16 v[140:143], a[28:31], v[100:103], v[140:143]
    s_waitcnt lgkmcnt(5)
    v_mfma_f32_16x16x32_bf16 v[128:131], a[32:35], v[48:51], v[128:131]
    ds_read_b128 a[16:19], v6 offset:22528
    s_waitcnt lgkmcnt(5)
    v_mfma_f32_16x16x32_bf16 v[132:135], a[36:39], v[48:51], v[132:135]
    ds_read_b128 a[20:23], v6 offset:23552
    v_mfma_f32_16x16x32_bf16 v[136:139], a[32:35], v[104:107], v[136:139]
    v_mfma_f32_16x16x32_bf16 v[140:143], a[36:39], v[104:107], v[140:143]
    s_waitcnt lgkmcnt(5)
    v_mfma_f32_16x16x32_bf16 v[128:131], a[0:3], v[52:55], v[128:131]
    ds_read_b128 a[24:27], v6 offset:24576
    s_waitcnt lgkmcnt(5)
    v_mfma_f32_16x16x32_bf16 v[132:135], a[4:7], v[52:55], v[132:135]
    ds_read_b128 a[28:31], v6 offset:25600
    v_mfma_f32_16x16x32_bf16 v[136:139], a[0:3], v[108:111], v[136:139]
    v_mfma_f32_16x16x32_bf16 v[140:143], a[4:7], v[108:111], v[140:143]
    s_waitcnt lgkmcnt(5)
    v_mfma_f32_16x16x32_bf16 v[128:131], a[8:11], v[56:59], v[128:131]
    ds_read_b128 a[32:35], v6 offset:26624
    s_waitcnt lgkmcnt(5)
    v_mfma_f32_16x16x32_bf16 v[132:135], a[12:15], v[56:59], v[132:135]
    ds_read_b128 a[36:39], v6 offset:27648
    v_mfma_f32_16x16x32_bf16 v[136:139], a[8:11], v[112:115], v[136:139]
    v_mfma_f32_16x16x32_bf16 v[140:143], a[12:15], v[112:115], v[140:143]
    s_waitcnt lgkmcnt(5)
    v_mfma_f32_16x16x32_bf16 v[128:131], a[16:19], v[60:63], v[128:131]
    s_waitcnt vmcnt(11)
    s_barrier
    ds_read_b128 a[0:3], v244 offset:28672
    s_waitcnt lgkmcnt(5)
    v_mfma_f32_16x16x32_bf16 v[132:135], a[20:23], v[60:63], v[132:135]
    ds_read_b128 a[4:7], v244 offset:29696
    v_mfma_f32_16x16x32_bf16 v[136:139], a[16:19], v[116:119], v[136:139]
    v_mfma_f32_16x16x32_bf16 v[140:143], a[20:23], v[116:119], v[140:143]
    s_waitcnt lgkmcnt(5)
    v_mfma_f32_16x16x32_bf16 v[128:131], a[24:27], v[64:67], v[128:131]
    ds_read_b128 a[8:11], v244 offset:30720
    s_waitcnt lgkmcnt(5)
    v_mfma_f32_16x16x32_bf16 v[132:135], a[28:31], v[64:67], v[132:135]
    ds_read_b128 a[12:15], v244 offset:31744
    v_mfma_f32_16x16x32_bf16 v[136:139], a[24:27], v[120:123], v[136:139]
    v_mfma_f32_16x16x32_bf16 v[140:143], a[28:31], v[120:123], v[140:143]
    s_waitcnt lgkmcnt(5)
    v_mfma_f32_16x16x32_bf16 v[128:131], a[32:35], v[68:71], v[128:131]
    ds_read_b128 a[16:19], v244 offset:32768
    s_waitcnt lgkmcnt(5)
    v_mfma_f32_16x16x32_bf16 v[132:135], a[36:39], v[68:71], v[132:135]
    ds_read_b128 a[20:23], v244 offset:33792
    v_mfma_f32_16x16x32_bf16 v[136:139], a[32:35], v[124:127], v[136:139]
    v_mfma_f32_16x16x32_bf16 v[140:143], a[36:39], v[124:127], v[140:143]
    s_waitcnt lgkmcnt(5)
    v_mfma_f32_16x16x32_bf16 v[144:147], a[0:3], v[16:19], 0
    ds_read_b128 a[24:27], v244 offset:34816
    s_waitcnt lgkmcnt(5)
    v_mfma_f32_16x16x32_bf16 v[148:151], a[4:7], v[16:19], 0
    ds_read_b128 a[28:31], v244 offset:35840
    v_mfma_f32_16x16x32_bf16 v[152:155], a[0:3], v[72:75], 0
    v_mfma_f32_16x16x32_bf16 v[156:159], a[4:7], v[72:75], 0
    s_waitcnt lgkmcnt(5)
    v_mfma_f32_16x16x32_bf16 v[144:147], a[8:11], v[20:23], v[144:147]
    ds_read_b128 a[32:35], v244 offset:36864
    s_waitcnt lgkmcnt(5)
    v_mfma_f32_16x16x32_bf16 v[148:151], a[12:15], v[20:23], v[148:151]
    ds_read_b128 a[36:39], v244 offset:37888
    v_mfma_f32_16x16x32_bf16 v[152:155], a[8:11], v[76:79], v[152:155]
    v_cvt_pk_bf16_f32 v160, v128, v129
    v_cvt_pk_bf16_f32 v161, v130, v131
    v_mfma_f32_16x16x32_bf16 v[156:159], a[12:15], v[76:79], v[156:159]
    v_cvt_pk_bf16_f32 v162, v132, v133
    v_cvt_pk_bf16_f32 v163, v134, v135
    s_waitcnt lgkmcnt(5)
    v_mfma_f32_16x16x32_bf16 v[144:147], a[16:19], v[24:27], v[144:147]
    ds_read_b128 a[0:3], v244 offset:38912
    s_waitcnt lgkmcnt(5)
    v_mfma_f32_16x16x32_bf16 v[148:151], a[20:23], v[24:27], v[148:151]
    ds_read_b128 a[4:7], v244 offset:39936
    v_mfma_f32_16x16x32_bf16 v[152:155], a[16:19], v[80:83], v[152:155]
    v_cvt_pk_bf16_f32 v164, v136, v137
    v_cvt_pk_bf16_f32 v165, v138, v139
    v_mfma_f32_16x16x32_bf16 v[156:159], a[20:23], v[80:83], v[156:159]
    v_cvt_pk_bf16_f32 v166, v140, v141
    v_cvt_pk_bf16_f32 v167, v142, v143
    s_waitcnt lgkmcnt(5)
    v_mfma_f32_16x16x32_bf16 v[144:147], a[24:27], v[28:31], v[144:147]
    ds_read_b128 a[8:11], v244 offset:40960
    s_waitcnt lgkmcnt(5)
    v_mfma_f32_16x16x32_bf16 v[148:151], a[28:31], v[28:31], v[148:151]
    ds_read_b128 a[12:15], v244 offset:41984
    v_mfma_f32_16x16x32_bf16 v[152:155], a[24:27], v[84:87], v[152:155]
    buffer_store_dwordx4 v[160:163], v2, s[68:71], s55 offen offset:0 sc1
    buffer_store_dwordx4 v[164:167], v2, s[68:71], s55 offen offset:1024 sc1
    v_mfma_f32_16x16x32_bf16 v[156:159], a[28:31], v[84:87], v[156:159]
    s_add_u32 s55, s55, 4096
    s_cmp_eq_u32 s55, s56
    s_cselect_b32 s55, s57, s55
    s_waitcnt lgkmcnt(5)
    v_mfma_f32_16x16x32_bf16 v[144:147], a[32:35], v[32:35], v[144:147]
    ds_read_b128 a[16:19], v244 offset:43008
    s_waitcnt lgkmcnt(5)
    v_mfma_f32_16x16x32_bf16 v[148:151], a[36:39], v[32:35], v[148:151]
    ds_read_b128 a[20:23], v244 offset:44032
    v_mfma_f32_16x16x32_bf16 v[152:155], a[32:35], v[88:91], v[152:155]
    v_mfma_f32_16x16x32_bf16 v[156:159], a[36:39], v[88:91], v[156:159]
    s_waitcnt lgkmcnt(5)
    v_mfma_f32_16x16x32_bf16 v[144:147], a[0:3], v[36:39], v[144:147]
    ds_read_b128 a[24:27], v244 offset:45056
    s_waitcnt lgkmcnt(5)
    v_mfma_f32_16x16x32_bf16 v[148:151], a[4:7], v[36:39], v[148:151]
    ds_read_b128 a[28:31], v244 offset:46080
    v_mfma_f32_16x16x32_bf16 v[152:155], a[0:3], v[92:95], v[152:155]
    v_mfma_f32_16x16x32_bf16 v[156:159], a[4:7], v[92:95], v[156:159]
    s_waitcnt lgkmcnt(5)
    v_mfma_f32_16x16x32_bf16 v[144:147], a[8:11], v[40:43], v[144:147]
    ds_read_b128 a[32:35], v244 offset:47104
    s_waitcnt lgkmcnt(5)
    v_mfma_f32_16x16x32_bf16 v[148:151], a[12:15], v[40:43], v[148:151]
    ds_read_b128 a[36:39], v244 offset:48128
    v_mfma_f32_16x16x32_bf16 v[152:155], a[8:11], v[96:99], v[152:155]
    v_mfma_f32_16x16x32_bf16 v[156:159], a[12:15], v[96:99], v[156:159]
    s_waitcnt lgkmcnt(5)
    v_mfma_f32_16x16x32_bf16 v[144:147], a[16:19], v[44:47], v[144:147]
    ds_read_b128 a[0:3], v244 offset:49152
    s_waitcnt lgkmcnt(5)
    v_mfma_f32_16x16x32_bf16 v[148:151], a[20:23], v[44:47], v[148:151]
    ds_read_b128 a[4:7], v244 offset:50176
    v_mfma_f32_16x16x32_bf16 v[152:155], a[16:19], v[100:103], v[152:155]
    v_mfma_f32_16x16x32_bf16 v[156:159], a[20:23], v[100:103], v[156:159]
    s_waitcnt lgkmcnt(5)
    v_mfma_f32_16x16x32_bf16 v[144:147], a[24:27], v[48:51], v[144:147]
    ds_read_b128 a[8:11], v244 offset:51200
    s_waitcnt lgkmcnt(5)
    v_mfma_f32_16x16x32_bf16 v[148:151], a[28:31], v[48:51], v[148:151]
    ds_read_b128 a[12:15], v244 offset:52224
    v_mfma_f32_16x16x32_bf16 v[152:155], a[24:27], v[104:107], v[152:155]
    v_mfma_f32_16x16x32_bf16 v[156:159], a[28:31], v[104:107], v[156:159]
    s_waitcnt lgkmcnt(5)
    v_mfma_f32_16x16x32_bf16 v[144:147], a[32:35], v[52:55], v[144:147]
    ds_read_b128 a[16:19], v244 offset:53248
    s_waitcnt lgkmcnt(5)
    v_mfma_f32_16x16x32_bf16 v[148:151], a[36:39], v[52:55], v[148:151]
    ds_read_b128 a[20:23], v244 offset:54272
    v_mfma_f32_16x16x32_bf16 v[152:155], a[32:35], v[108:111], v[152:155]
    v_mfma_f32_16x16x32_bf16 v[156:159], a[36:39], v[108:111], v[156:159]
    s_waitcnt lgkmcnt(5)
    v_mfma_f32_16x16x32_bf16 v[144:147], a[0:3], v[56:59], v[144:147]
    ds_read_b128 a[24:27], v244 offset:55296
    s_waitcnt lgkmcnt(5)
    v_mfma_f32_16x16x32_bf16 v[148:151], a[4:7], v[56:59], v[148:151]
    ds_read_b128 a[28:31], v244 offset:56320
    v_mfma_f32_16x16x32_bf16 v[152:155], a[0:3], v[112:115], v[152:155]
    v_mfma_f32_16x16x32_bf16 v[156:159], a[4:7], v[112:115], v[156:159]
    s_waitcnt lgkmcnt(5)
    v_mfma_f32_16x16x32_bf16 v[144:147], a[8:11], v[60:63], v[144:147]
    s_waitcnt vmcnt(4)
    s_barrier
    ds_read_b128 a[32:35], v5 offset:0
    s_waitcnt lgkmcnt(5)
    v_mfma_f32_16x16x32_bf16 v[148:151], a[12:15], v[60:63], v[148:151]
    ds_read_b128 a[36:39], v5 offset:1024
    v_mfma_f32_16x16x32_bf16 v[152:155], a[8:11], v[116:119], v[152:155]
    v_mfma_f32_16x16x32_bf16 v[156:159], a[12:15], v[116:119], v[156:159]
    s_waitcnt lgkmcnt(5)
    v_mfma_f32_16x16x32_bf16 v[144:147], a[16:19], v[64:67], v[144:147]
    ds_read_b128 a[0:3], v5 offset:2048
    s_waitcnt lgkmcnt(5)
    v_mfma_f32_16x16x32_bf16 v[148:151], a[20:23], v[64:67], v[148:151]
    ds_read_b128 a[4:7], v5 offset:3072
    v_mfma_f32_16x16x32_bf16 v[152:155], a[16:19], v[120:123], v[152:155]
    v_mfma_f32_16x16x32_bf16 v[156:159], a[20:23], v[120:123], v[156:159]
    s_waitcnt lgkmcnt(5)
    v_mfma_f32_16x16x32_bf16 v[144:147], a[24:27], v[68:71], v[144:147]
    ds_read_b128 a[8:11], v5 offset:4096
    s_waitcnt lgkmcnt(5)
    v_mfma_f32_16x16x32_bf16 v[148:151], a[28:31], v[68:71], v[148:151]
    ds_read_b128 a[12:15], v5 offset:5120
    v_mfma_f32_16x16x32_bf16 v[152:155], a[24:27], v[124:127], v[152:155]
    v_mfma_f32_16x16x32_bf16 v[156:159], a[28:31], v[124:127], v[156:159]
    s_waitcnt lgkmcnt(5)
    v_mfma_f32_16x16x32_bf16 v[128:131], a[32:35], v[16:19], 0
    ds_read_b128 a[16:19], v5 offset:6144
    s_waitcnt lgkmcnt(5)
    v_mfma_f32_16x16x32_bf16 v[132:135], a[36:39], v[16:19], 0
    ds_read_b128 a[20:23], v5 offset:7168
    v_mfma_f32_16x16x32_bf16 v[136:139], a[32:35], v[72:75], 0
    v_mfma_f32_16x16x32_bf16 v[140:143], a[36:39], v[72:75], 0
    s_waitcnt lgkmcnt(5)
    v_mfma_f32_16x16x32_bf16 v[128:131], a[0:3], v[20:23], v[128:131]
    ds_read_b128 a[24:27], v5 offset:8192
    s_waitcnt lgkmcnt(5)
    v_mfma_f32_16x16x32_bf16 v[132:135], a[4:7], v[20:23], v[132:135]
    ds_read_b128 a[28:31], v5 offset:9216
    v_mfma_f32_16x16x32_bf16 v[136:139], a[0:3], v[76:79], v[136:139]
    v_cvt_pk_bf16_f32 v160, v144, v145
    v_cvt_pk_bf16_f32 v161, v146, v147
    v_mfma_f32_16x16x32_bf16 v[140:143], a[4:7], v[76:79], v[140:143]
    v_cvt_pk_bf16_f32 v162, v148, v149
    v_cvt_pk_bf16_f32 v163, v150, v151
    s_waitcnt lgkmcnt(5)
    v_mfma_f32_16x16x32_bf16 v[128:131], a[8:11], v[24:27], v[128:131]
    ds_read_b128 a[32:35], v5 offset:10240
    s_waitcnt lgkmcnt(5)
    v_mfma_f32_16x16x32_bf16 v[132:135], a[12:15], v[24:27], v[132:135]
    ds_read_b128 a[36:39], v5 offset:11264
    v_mfma_f32_16x16x32_bf16 v[136:139], a[8:11], v[80:83], v[136:139]
    v_cvt_pk_bf16_f32 v164, v152, v153
    v_cvt_pk_bf16_f32 v165, v154, v155
    v_mfma_f32_16x16x32_bf16 v[140:143], a[12:15], v[80:83], v[140:143]
    v_cvt_pk_bf16_f32 v166, v156, v157
    v_cvt_pk_bf16_f32 v167, v158, v159
    s_waitcnt lgkmcnt(5)
    v_mfma_f32_16x16x32_bf16 v[128:131], a[16:19], v[28:31], v[128:131]
    ds_read_b128 a[0:3], v5 offset:12288
    s_waitcnt lgkmcnt(5)
    v_mfma_f32_16x16x32_bf16 v[132:135], a[20:23], v[28:31], v[132:135]
    ds_read_b128 a[4:7], v5 offset:13312
    v_mfma_f32_16x16x32_bf16 v[136:139], a[16:19], v[84:87], v[136:139]
    buffer_store_dwordx4 v[160:163], v2, s[68:71], s55 offen offset:0 sc1
    buffer_store_dwordx4 v[164:167], v2, s[68:71], s55 offen offset:1024 sc1
    v_mfma_f32_16x16x32_bf16 v[140:143], a[20:23], v[84:87], v[140:143]
    s_add_u32 s55, s55, 4096
    s_cmp_eq_u32 s55, s56
    s_cselect_b32 s55, s57, s55
    s_waitcnt lgkmcnt(5)
    v_mfma_f32_16x16x32_bf16 v[128:131], a[24:27], v[32:35], v[128:131]
    ds_read_b128 a[8:11], v5 offset:14336
    s_waitcnt lgkmcnt(5)
    v_mfma_f32_16x16x32_bf16 v[132:135], a[28:31], v[32:35], v[132:135]
    ds_read_b128 a[12:15], v5 offset:15360
    v_mfma_f32_16x16x32_bf16 v[136:139], a[24:27], v[88:91], v[136:139]
    v_mfma_f32_16x16x32_bf16 v[140:143], a[28:31], v[88:91], v[140:143]
    s_waitcnt lgkmcnt(5)
    v_mfma_f32_16x16x32_bf16 v[128:131], a[32:35], v[36:39], v[128:131]
    ds_read_b128 a[16:19], v5 offset:16384
    s_waitcnt lgkmcnt(5)
    v_mfma_f32_16x16x32_bf16 v[132:135], a[36:39], v[36:39], v[132:135]
    ds_read_b128 a[20:23], v5 offset:17408
    v_mfma_f32_16x16x32_bf16 v[136:139], a[32:35], v[92:95], v[136:139]
    v_mfma_f32_16x16x32_bf16 v[140:143], a[36:39], v[92:95], v[140:143]
    s_waitcnt lgkmcnt(5)
    v_mfma_f32_16x16x32_bf16 v[128:131], a[0:3], v[40:43], v[128:131]
    ds_read_b128 a[24:27], v5 offset:18432
    s_waitcnt lgkmcnt(5)
    v_mfma_f32_16x16x32_bf16 v[132:135], a[4:7], v[40:43], v[132:135]
    ds_read_b128 a[28:31], v5 offset:19456
    v_mfma_f32_16x16x32_bf16 v[136:139], a[0:3], v[96:99], v[136:139]
    v_mfma_f32_16x16x32_bf16 v[140:143], a[4:7], v[96:99], v[140:143]
    s_waitcnt lgkmcnt(5)
    v_mfma_f32_16x16x32_bf16 v[128:131], a[8:11], v[44:47], v[128:131]
    ds_read_b128 a[32:35], v5 offset:20480
    s_waitcnt lgkmcnt(5)
    v_mfma_f32_16x16x32_bf16 v[132:135], a[12:15], v[44:47], v[132:135]
    ds_read_b128 a[36:39], v5 offset:21504
    v_mfma_f32_16x16x32_bf16 v[136:139], a[8:11], v[100:103], v[136:139]
    v_mfma_f32_16x16x32_bf16 v[140:143], a[12:15], v[100:103], v[140:143]
    s_waitcnt lgkmcnt(5)
    v_mfma_f32_16x16x32_bf16 v[128:131], a[16:19], v[48:51], v[128:131]
    ds_read_b128 a[0:3], v5 offset:22528
    s_waitcnt lgkmcnt(5)
    v_mfma_f32_16x16x32_bf16 v[132:135], a[20:23], v[48:51], v[132:135]
    ds_read_b128 a[4:7], v5 offset:23552
    v_mfma_f32_16x16x32_bf16 v[136:139], a[16:19], v[104:107], v[136:139]
    v_mfma_f32_16x16x32_bf16 v[140:143], a[20:23], v[104:107], v[140:143]
    s_waitcnt lgkmcnt(5)
    v_mfma_f32_16x16x32_bf16 v[128:131], a[24:27], v[52:55], v[128:131]
    ds_read_b128 a[8:11], v5 offset:24576
    s_waitcnt lgkmcnt(5)
    v_mfma_f32_16x16x32_bf16 v[132:135], a[28:31], v[52:55], v[132:135]
    ds_read_b128 a[12:15], v5 offset:25600
    v_mfma_f32_16x16x32_bf16 v[136:139], a[24:27], v[108:111], v[136:139]
    v_mfma_f32_16x16x32_bf16 v[140:143], a[28:31], v[108:111], v[140:143]
    s_waitcnt lgkmcnt(5)
    v_mfma_f32_16x16x32_bf16 v[128:131], a[32:35], v[56:59], v[128:131]
    ds_read_b128 a[16:19], v5 offset:26624
    s_waitcnt lgkmcnt(5)
    v_mfma_f32_16x16x32_bf16 v[132:135], a[36:39], v[56:59], v[132:135]
    ds_read_b128 a[20:23], v5 offset:27648
    v_mfma_f32_16x16x32_bf16 v[136:139], a[32:35], v[112:115], v[136:139]
    v_mfma_f32_16x16x32_bf16 v[140:143], a[36:39], v[112:115], v[140:143]
    s_waitcnt lgkmcnt(5)
    v_mfma_f32_16x16x32_bf16 v[128:131], a[0:3], v[60:63], v[128:131]
    s_waitcnt lgkmcnt(4)
    v_mfma_f32_16x16x32_bf16 v[132:135], a[4:7], v[60:63], v[132:135]
    v_mfma_f32_16x16x32_bf16 v[136:139], a[0:3], v[116:119], v[136:139]
    v_mfma_f32_16x16x32_bf16 v[140:143], a[4:7], v[116:119], v[140:143]
    s_waitcnt lgkmcnt(3)
    v_mfma_f32_16x16x32_bf16 v[128:131], a[8:11], v[64:67], v[128:131]
    s_waitcnt lgkmcnt(2)
    v_mfma_f32_16x16x32_bf16 v[132:135], a[12:15], v[64:67], v[132:135]
    v_mfma_f32_16x16x32_bf16 v[136:139], a[8:11], v[120:123], v[136:139]
    v_mfma_f32_16x16x32_bf16 v[140:143], a[12:15], v[120:123], v[140:143]
    s_waitcnt lgkmcnt(1)
    v_mfma_f32_16x16x32_bf16 v[128:131], a[16:19], v[68:71], v[128:131]
    s_waitcnt lgkmcnt(0)
    v_mfma_f32_16x16x32_bf16 v[132:135], a[20:23], v[68:71], v[132:135]
    v_mfma_f32_16x16x32_bf16 v[136:139], a[16:19], v[124:127], v[136:139]
    v_mfma_f32_16x16x32_bf16 v[140:143], a[20:23], v[124:127], v[140:143]
    s_nop 3
    v_cvt_pk_bf16_f32 v160, v128, v129
    v_cvt_pk_bf16_f32 v161, v130, v131
    v_cvt_pk_bf16_f32 v162, v132, v133
    v_cvt_pk_bf16_f32 v163, v134, v135
    v_cvt_pk_bf16_f32 v164, v136, v137
    v_cvt_pk_bf16_f32 v165, v138, v139
    v_cvt_pk_bf16_f32 v166, v140, v141
    v_cvt_pk_bf16_f32 v167, v142, v143
    buffer_store_dwordx4 v[160:163], v2, s[68:71], s55 offen offset:0 sc1
    buffer_store_dwordx4 v[164:167], v2, s[68:71], s55 offen offset:1024 sc1
    s_add_u32 s55, s55, 4096
    s_cmp_eq_u32 s55, s56
    s_cselect_b32 s55, s57, s55
    s_waitcnt vmcnt(0)
    s_mov_b64 exec, 1
    buffer_store_dwordx2 v[12:13], off, s[28:31], s97 offset:0 sc1
    s_mov_b64 exec, -1
    s_lshl_b32 s59, s48, 2
    s_add_u32 s59, s59, s26
    s_lshl_b32 s96, s48, 5
    s_add_u32 s96, s96, 14454784
    s_mov_b32 s36, s18
    s_mov_b32 s37, s19
    s_mov_b32 s38, 896
    s_mov_b32 s39, 0x20000
    v_lshlrev_b32 v10, 4, v4
    buffer_load_dwordx4 v[192:195], v10, s[36:39], s80 offen offset:0
    buffer_load_dwordx4 v[196:199], v10, s[36:39], s80 offen offset:64
    buffer_load_dwordx4 v[200:203], v10, s[36:39], s81 offen offset:0
    buffer_load_dwordx4 v[204:207], v10, s[36:39], s81 offen offset:64
    buffer_load_dwordx4 v[208:211], v10, s[36:39], s82 offen offset:0
    buffer_load_dwordx4 v[212:215], v10, s[36:39], s82 offen offset:64
    buffer_load_dwordx4 v[216:219], v10, s[36:39], s83 offen offset:0
    buffer_load_dwordx4 v[220:223], v10, s[36:39], s83 offen offset:64
    buffer_load_dwordx4 v[224:227], v10, s[36:39], s84 offen offset:0
    buffer_load_dwordx4 v[228:231], v10, s[36:39], s84 offen offset:64
    buffer_load_dwordx4 v[232:235], v10, s[36:39], s85 offen offset:0
    buffer_load_dwordx4 v[236:239], v10, s[36:39], s85 offen offset:64
    buffer_load_dwordx4 v[240:243], v10, s[36:39], s86 offen offset:0
    buffer_load_dwordx4 v[244:247], v10, s[36:39], s86 offen offset:64
    s_add_u32 s44, s24, 14352384
    s_addc_u32 s45, s25, 0
    s_mov_b32 s46, 1792
    s_mov_b32 s47, 0x20000
    s_cmp_eq_u32 s87, 56
    s_cselect_b32 s46, s93, 0
    s_min_u32 s46, s46, 1792
    s_lshl_b32 s58, s88, 7
    v_lshlrev_b32 v11, 2, v3
    v_lshl_add_u32 v11, v4, 12, v11
    s_waitcnt vmcnt(13)
    v_mfma_f32_16x16x32_bf16 v[128:131], v[192:195], v[16:19], 0
    v_mfma_f32_16x16x32_bf16 v[132:135], v[192:195], v[72:75], 0
    s_waitcnt vmcnt(12)
    v_mfma_f32_16x16x32_bf16 v[128:131], v[196:199], v[20:23], v[128:131]
    v_mfma_f32_16x16x32_bf16 v[132:135], v[196:199], v[76:79], v[132:135]
    s_waitcnt vmcnt(11)
    v_mfma_f32_16x16x32_bf16 v[128:131], v[200:203], v[24:27], v[128:131]
    v_mfma_f32_16x16x32_bf16 v[132:135], v[200:203], v[80:83], v[132:135]
    s_waitcnt vmcnt(10)
    v_mfma_f32_16x16x32_bf16 v[128:131], v[204:207], v[28:31], v[128:131]
    v_mfma_f32_16x16x32_bf16 v[132:135], v[204:207], v[84:87], v[132:135]
    s_waitcnt vmcnt(9)
    v_mfma_f32_16x16x32_bf16 v[128:131], v[208:211], v[32:35], v[128:131]
    v_mfma_f32_16x16x32_bf16 v[132:135], v[208:211], v[88:91], v[132:135]
    s_waitcnt vmcnt(8)
    v_mfma_f32_16x16x32_bf16 v[128:131], v[212:215], v[36:39], v[128:131]
    v_mfma_f32_16x16x32_bf16 v[132:135], v[212:215], v[92:95], v[132:135]
    s_waitcnt vmcnt(7)
    v_mfma_f32_16x16x32_bf16 v[128:131], v[216:219], v[40:43], v[128:131]
    v_mfma_f32_16x16x32_bf16 v[132:135], v[216:219], v[96:99], v[132:135]
    s_waitcnt vmcnt(6)
    v_mfma_f32_16x16x32_bf16 v[128:131], v[220:223], v[44:47], v[128:131]
    v_mfma_f32_16x16x32_bf16 v[132:135], v[220:223], v[100:103], v[132:135]
    s_waitcnt vmcnt(5)
    v_mfma_f32_16x16x32_bf16 v[128:131], v[224:227], v[48:51], v[128:131]
    v_mfma_f32_16x16x32_bf16 v[132:135], v[224:227], v[104:107], v[132:135]
    s_waitcnt vmcnt(4)
    v_mfma_f32_16x16x32_bf16 v[128:131], v[228:231], v[52:55], v[128:131]
    v_mfma_f32_16x16x32_bf16 v[132:135], v[228:231], v[108:111], v[132:135]
    s_waitcnt vmcnt(3)
    v_mfma_f32_16x16x32_bf16 v[128:131], v[232:235], v[56:59], v[128:131]
    v_mfma_f32_16x16x32_bf16 v[132:135], v[232:235], v[112:115], v[132:135]
    s_waitcnt vmcnt(2)
    v_mfma_f32_16x16x32_bf16 v[128:131], v[236:239], v[60:63], v[128:131]
    v_mfma_f32_16x16x32_bf16 v[132:135], v[236:239], v[116:119], v[132:135]
    s_waitcnt vmcnt(1)
    v_mfma_f32_16x16x32_bf16 v[128:131], v[240:243], v[64:67], v[128:131]
    v_mfma_f32_16x16x32_bf16 v[132:135], v[240:243], v[120:123], v[132:135]
    s_waitcnt vmcnt(0)
    v_mfma_f32_16x16x32_bf16 v[128:131], v[244:247], v[68:71], v[128:131]
    v_mfma_f32_16x16x32_bf16 v[132:135], v[244:247], v[124:127], v[132:135]
    s_nop 6
    buffer_store_dword v128, v11, s[44:47], s58 offen offset:0 sc1
    buffer_store_dword v132, v11, s[44:47], s58 offen offset:64 sc1
L_hdb:
    s_sleep 4
    s_memrealtime s[62:63]
    s_waitcnt lgkmcnt(0)
    s_sub_u32 s62, s62, s90
    s_cmp_lt_u32 s62, 640
    s_cbranch_scc1 L_hdb
    s_waitcnt vmcnt(0)
    s_barrier
    s_mov_b32 s40, s16
    s_mov_b32 s41, s17
    s_mov_b32 s42, 1605632
    s_mov_b32 s43, 0x20000
    s_add_u32 s44, s24, 12746752
    s_addc_u32 s45, s25, 0
    s_mov_b32 s46, 1605632
    s_mov_b32 s47, 0x20000
    s_mul_i32 s56, s26, 7168
    s_add_u32 s55, s48, 0
    s_cmp_lt_u32 s55, 56
    s_cselect_b32 s42, s42, 0
    s_mul_i32 s55, s55, 28672
    s_add_u32 s55, s55, s56
    s_add_u32 m0, s56, 0
    s_add_u32 s53, s55, 0
    buffer_load_dwordx4 v2, s[40:43], s53 offen lds
    s_add_u32 m0, s56, 1024
    s_add_u32 s53, s55, 1024
    buffer_load_dwordx4 v2, s[40:43], s53 offen lds
    s_add_u32 m0, s56, 2048
    s_add_u32 s53, s55, 2048
    buffer_load_dwordx4 v2, s[40:43], s53 offen lds
    s_add_u32 m0, s56, 3072
    s_add_u32 s53, s55, 3072
    buffer_load_dwordx4 v2, s[40:43], s53 offen lds
    s_add_u32 m0, s56, 4096
    s_add_u32 s53, s55, 4096
    buffer_load_dwordx4 v2, s[40:43], s53 offen lds
    s_add_u32 m0, s56, 5120
    s_add_u32 s53, s55, 5120
    buffer_load_dwordx4 v2, s[40:43], s53 offen lds
    s_add_u32 m0, s56, 6144
    s_add_u32 s53, s55, 6144
    buffer_load_dwordx4 v2, s[40:43], s53 offen lds
    s_add_u32 s55, s48, 32
    s_cmp_lt_u32 s55, 56
    s_cselect_b32 s42, s42, 0
    s_mul_i32 s55, s55, 28672
    s_add_u32 s55, s55, s56
    s_add_u32 m0, s56, 28672
    s_add_u32 s53, s55, 0
    buffer_load_dwordx4 v2, s[40:43], s53 offen lds
    s_add_u32 m0, s56, 29696
    s_add_u32 s53, s55, 1024
    buffer_load_dwordx4 v2, s[40:43], s53 offen lds
    s_add_u32 m0, s56, 30720
    s_add_u32 s53, s55, 2048
    buffer_load_dwordx4 v2, s[40:43], s53 offen lds
    s_add_u32 m0, s56, 31744
    s_add_u32 s53, s55, 3072
    buffer_load_dwordx4 v2, s[40:43], s53 offen lds
    s_add_u32 m0, s56, 32768
    s_add_u32 s53, s55, 4096
    buffer_load_dwordx4 v2, s[40:43], s53 offen lds
    s_add_u32 m0, s56, 33792
    s_add_u32 s53, s55, 5120
    buffer_load_dwordx4 v2, s[40:43], s53 offen lds
    s_add_u32 m0, s56, 34816
    s_add_u32 s53, s55, 6144
    buffer_load_dwordx4 v2, s[40:43], s53 offen lds
    v_mov_b32 v16, 0
    v_mov_b32 v17, 0
    v_mov_b32 v18, 0
    v_mov_b32 v19, 0
    s_mul_i32 s53, s59, 1024
    s_add_u32 s53, s53, 5734400
    s_mov_b32 s55, 1
L_pfx2:
    buffer_store_dwordx4 v[16:19], v2, s[28:31], s53 offen offset:0 sc1
    s_add_u32 s53, s53, 1024
    s_sub_u32 s55, s55, 1
    s_cmp_lg_u32 s55, 0
    s_cbranch_scc1 L_pfx2
    v_lshrrev_b32 v10, 2, v3
    v_lshl_add_u32 v10, v4, 2, v10
    v_mul_u32_u24 v10, 896, v10
    v_and_b32 v11, 3, v3
    v_lshl_add_u32 v10, v11, 5, v10
    v_lshl_add_u32 v10, v1, 3, v10
    s_lshl_b32 s57, s26, 10
    s_waitcnt vmcnt(1)
    s_barrier
    s_add_u32 s55, s48, 0
    s_cmp_lt_u32 s55, 56
    s_cselect_b32 s46, s46, 0
    s_lshl_b32 s55, s55, 12
    s_add_u32 s55, s55, s57
    ds_read_b64_tr_b16 v[16:17], v10 offset:0
    ds_read_b64_tr_b16 v[18:19], v10 offset:14336
    ds_read_b64_tr_b16 v[20:21], v10 offset:128
    ds_read_b64_tr_b16 v[22:23], v10 offset:14464
    ds_read_b64_tr_b16 v[24:25], v10 offset:256
    ds_read_b64_tr_b16 v[26:27], v10 offset:14592
    ds_read_b64_tr_b16 v[28:29], v10 offset:384
    ds_read_b64_tr_b16 v[30:31], v10 offset:14720
    ds_read_b64_tr_b16 v[32:33], v10 offset:512
    ds_read_b64_tr_b16 v[34:35], v10 offset:14848
    ds_read_b64_tr_b16 v[36:37], v10 offset:640
    ds_read_b64_tr_b16 v[38:39], v10 offset:14976
    ds_read_b64_tr_b16 v[40:41], v10 offset:768
    ds_read_b64_tr_b16 v[42:43], v10 offset:15104
    s_add_u32 s53, s55, 0
    s_waitcnt lgkmcnt(12)
    buffer_store_dwordx4 v[16:19], v2, s[44:47], s53 offen sc1
    s_add_u32 s53, s55, 229376
    s_waitcnt lgkmcnt(10)
    buffer_store_dwordx4 v[20:23], v2, s[44:47], s53 offen sc1
    s_add_u32 s53, s55, 458752
    s_waitcnt lgkmcnt(8)
    buffer_store_dwordx4 v[24:27], v2, s[44:47], s53 offen sc1
    s_add_u32 s53, s55, 688128
    s_waitcnt lgkmcnt(6)
    buffer_store_dwordx4 v[28:31], v2, s[44:47], s53 offen sc1
    s_add_u32 s53, s55, 917504
    s_waitcnt lgkmcnt(4)
    buffer_store_dwordx4 v[32:35], v2, s[44:47], s53 offen sc1
    s_add_u32 s53, s55, 1146880
    s_waitcnt lgkmcnt(2)
    buffer_store_dwordx4 v[36:39], v2, s[44:47], s53 offen sc1
    s_add_u32 s53, s55, 1376256
    s_waitcnt lgkmcnt(0)
    buffer_store_dwordx4 v[40:43], v2, s[44:47], s53 offen sc1
    s_add_u32 s55, s48, 32
    s_cmp_lt_u32 s55, 56
    s_cselect_b32 s46, s46, 0
    s_lshl_b32 s55, s55, 12
    s_add_u32 s55, s55, s57
    ds_read_b64_tr_b16 v[44:45], v10 offset:28672
    ds_read_b64_tr_b16 v[46:47], v10 offset:43008
    ds_read_b64_tr_b16 v[48:49], v10 offset:28800
    ds_read_b64_tr_b16 v[50:51], v10 offset:43136
    ds_read_b64_tr_b16 v[52:53], v10 offset:28928
    ds_read_b64_tr_b16 v[54:55], v10 offset:43264
    ds_read_b64_tr_b16 v[56:57], v10 offset:29056
    ds_read_b64_tr_b16 v[58:59], v10 offset:43392
    ds_read_b64_tr_b16 v[60:61], v10 offset:29184
    ds_read_b64_tr_b16 v[62:63], v10 offset:43520
    ds_read_b64_tr_b16 v[64:65], v10 offset:29312
    ds_read_b64_tr_b16 v[66:67], v10 offset:43648
    ds_read_b64_tr_b16 v[68:69], v10 offset:29440
    ds_read_b64_tr_b16 v[70:71], v10 offset:43776
    s_add_u32 s53, s55, 0
    s_waitcnt lgkmcnt(12)
    buffer_store_dwordx4 v[44:47], v2, s[44:47], s53 offen sc1
    s_add_u32 s53, s55, 229376
    s_waitcnt lgkmcnt(10)
    buffer_store_dwordx4 v[48:51], v2, s[44:47], s53 offen sc1
    s_add_u32 s53, s55, 458752
    s_waitcnt lgkmcnt(8)
    buffer_store_dwordx4 v[52:55], v2, s[44:47], s53 offen sc1
    s_add_u32 s53, s55, 688128
    s_waitcnt lgkmcnt(6)
    buffer_store_dwordx4 v[56:59], v2, s[44:47], s53 offen sc1
    s_add_u32 s53, s55, 917504
    s_waitcnt lgkmcnt(4)
    buffer_store_dwordx4 v[60:63], v2, s[44:47], s53 offen sc1
    s_add_u32 s53, s55, 1146880
    s_waitcnt lgkmcnt(2)
    buffer_store_dwordx4 v[64:67], v2, s[44:47], s53 offen sc1
    s_add_u32 s53, s55, 1376256
    s_waitcnt lgkmcnt(0)
    buffer_store_dwordx4 v[68:71], v2, s[44:47], s53 offen sc1
    s_waitcnt vmcnt(0)
    s_barrier
    s_add_u32 s53, s96, 0
    s_cmp_lg_u32 s26, 0
    s_cbranch_scc1 L_hfa
    v_mov_b32 v14, s12
    v_mov_b32 v15, s13
    s_mov_b64 exec, 1
    buffer_store_dwordx2 v[14:15], off, s[28:31], s53 sc1
    s_mov_b64 exec, -1
L_hfa:
    s_lshl_b32 s48, s50, 2
    s_add_u32 s48, s48, s51
    s_sub_u32 s48, s48, 28
    s_lshl_b32 s59, s48, 2
    s_add_u32 s59, s59, s26
    s_mul_i32 s53, s59, 28672
    s_add_u32 s53, s53, 5865472
    s_mov_b32 s55, 7
L_pfr:
    buffer_store_dwordx4 v[168:171], v2, s[28:31], s53 offen offset:0 sc1
    buffer_store_dwordx4 v[168:171], v2, s[28:31], s53 offen offset:1024 sc1
    buffer_store_dwordx4 v[168:171], v2, s[28:31], s53 offen offset:2048 sc1
    buffer_store_dwordx4 v[168:171], v2, s[28:31], s53 offen offset:3072 sc1
    s_add_u32 s53, s53, 4096
    s_sub_u32 s55, s55, 1
    s_cmp_lg_u32 s55, 0
    s_cbranch_scc1 L_pfr
    v_lshrrev_b32 v16, 2, v3
    v_and_b32 v28, 3, v3
    v_lshl_add_u32 v16, v16, 4, v28
    v_lshl_add_u32 v16, v1, 6, v16
    v_cvt_f32_u32 v16, v16
    v_and_b32 v24, 1, v3
    v_lshlrev_b32 v26, 4, v24
    s_brev_b32 s53, 1
    v_lshrrev_b32 v26, v26, s53
    v_lshlrev_b32 v24, 15, v24
    v_or_b32 v24, 1027751234, v24
    v_and_b32 v25, 2, v3
    v_lshlrev_b32 v25, 3, v25
    v_lshrrev_b32 v25, v25, s53
    v_xor_b32 v25, v25, v24
    v_cmp_eq_u32 s[58:59], 0, v4
    v_cvt_f32_u32 v28, v4
    v_add_f32 v28, v28, v28
    v_add_f32 v29, 1.0, v28
    v_add_f32 v30, 0x41000000, v28
    v_add_f32 v31, 0x41000000, v29
    s_mov_b32 s56, 0x3b124925
    s_mov_b32 s57, 0x3d88d677
    v_add_f32 v17, 0x40800000, v16
    v_add_f32 v18, 0x41000000, v16
    v_add_f32 v19, 0x41400000, v16
    v_mul_f32 v20, 0x3c924925, v16
    v_mul_f32 v21, 0x3c924925, v17
    v_mul_f32 v22, 0x3c924925, v18
    v_mul_f32 v23, 0x3c924925, v19
    v_cos_f32 v20, v20
    v_cos_f32 v21, v21
    v_cos_f32 v22, v22
    v_cos_f32 v23, v23
    v_add_f32 v20, v20, v20
    v_add_f32 v21, v21, v21
    v_add_f32 v22, v22, v22
    v_add_f32 v23, v23, v23
    v_mul_f32 v32, v16, v28
    v_mul_f32 v34, v16, v29
    v_mul_f32 v36, v17, v28
    v_mul_f32 v38, v17, v29
    v_mul_f32 v40, v18, v28
    v_mul_f32 v42, v18, v29
    v_mul_f32 v44, v19, v28
    v_mul_f32 v46, v19, v29
    v_mul_f32 v32, s56, v32
    v_mul_f32 v34, s56, v34
    v_mul_f32 v36, s56, v36
    v_mul_f32 v38, s56, v38
    v_mul_f32 v40, s56, v40
    v_mul_f32 v42, s56, v42
    v_mul_f32 v44, s56, v44
    v_mul_f32 v46, s56, v46
    v_add_f32 v33, 0x3e800000, v32
    v_add_f32 v35, 0x3e800000, v34
    v_add_f32 v37, 0x3e800000, v36
    v_add_f32 v39, 0x3e800000, v38
    v_add_f32 v41, 0x3e800000, v40
    v_add_f32 v43, 0x3e800000, v42
    v_add_f32 v45, 0x3e800000, v44
    v_add_f32 v47, 0x3e800000, v46
    v_cos_f32 v32, v32
    v_cos_f32 v33, v33
    v_cos_f32 v34, v34
    v_cos_f32 v35, v35
    v_cos_f32 v36, v36
    v_cos_f32 v37, v37
    v_cos_f32 v38, v38
    v_cos_f32 v39, v39
    v_cos_f32 v40, v40
    v_cos_f32 v41, v41
    v_cos_f32 v42, v42
    v_cos_f32 v43, v43
    v_cos_f32 v44, v44
    v_cos_f32 v45, v45
    v_cos_f32 v46, v46
    v_cos_f32 v47, v47
    v_mul_f32 v32, s57, v32
    v_mul_f32 v33, s57, v33
    v_mul_f32 v34, s57, v34
    v_mul_f32 v35, s57, v35
    v_mul_f32 v36, s57, v36
    v_mul_f32 v37, s57, v37
    v_mul_f32 v38, s57, v38
    v_mul_f32 v39, s57, v39
    v_mul_f32 v40, s57, v40
    v_mul_f32 v41, s57, v41
    v_mul_f32 v42, s57, v42
    v_mul_f32 v43, s57, v43
    v_mul_f32 v44, s57, v44
    v_mul_f32 v45, s57, v45
    v_mul_f32 v46, s57, v46
    v_mul_f32 v47, s57, v47
    v_mul_f32 v48, v16, v30
    v_mul_f32 v50, v16, v31
    v_mul_f32 v52, v17, v30
    v_mul_f32 v54, v17, v31
    v_mul_f32 v56, v18, v30
    v_mul_f32 v58, v18, v31
    v_mul_f32 v60, v19, v30
    v_mul_f32 v62, v19, v31
    v_mul_f32 v48, s56, v48
    v_mul_f32 v50, s56, v50
    v_mul_f32 v52, s56, v52
    v_mul_f32 v54, s56, v54
    v_mul_f32 v56, s56, v56
    v_mul_f32 v58, s56, v58
    v_mul_f32 v60, s56, v60
    v_mul_f32 v62, s56, v62
    v_add_f32 v49, 0x3e800000, v48
    v_add_f32 v51, 0x3e800000, v50
    v_add_f32 v53, 0x3e800000, v52
    v_add_f32 v55, 0x3e800000, v54
    v_add_f32 v57, 0x3e800000, v56
    v_add_f32 v59, 0x3e800000, v58
    v_add_f32 v61, 0x3e800000, v60
    v_add_f32 v63, 0x3e800000, v62
    v_cos_f32 v48, v48
    v_cos_f32 v49, v49
    v_cos_f32 v50, v50
    v_cos_f32 v51, v51
    v_cos_f32 v52, v52
    v_cos_f32 v53, v53
    v_cos_f32 v54, v54
    v_cos_f32 v55, v55
    v_cos_f32 v56, v56
    v_cos_f32 v57, v57
    v_cos_f32 v58, v58
    v_cos_f32 v59, v59
    v_cos_f32 v60, v60
    v_cos_f32 v61, v61
    v_cos_f32 v62, v62
    v_cos_f32 v63, v63
    v_mul_f32 v48, s57, v48
    v_mul_f32 v49, s57, v49
    v_mul_f32 v50, s57, v50
    v_mul_f32 v51, s57, v51
    v_mul_f32 v52, s57, v52
    v_mul_f32 v53, s57, v53
    v_mul_f32 v54, s57, v54
    v_mul_f32 v55, s57, v55
    v_mul_f32 v56, s57, v56
    v_mul_f32 v57, s57, v57
    v_mul_f32 v58, s57, v58
    v_mul_f32 v59, s57, v59
    v_mul_f32 v60, s57, v60
    v_mul_f32 v61, s57, v61
    v_mul_f32 v62, s57, v62
    v_mul_f32 v63, s57, v63
    v_cvt_pk_bf16_f32 v80, v32, v33
    v_cvt_pk_bf16_f32 v82, v34, v35
    v_cvt_pk_bf16_f32 v84, v36, v37
    v_cvt_pk_bf16_f32 v86, v38, v39
    v_cvt_pk_bf16_f32 v88, v40, v41
    v_cvt_pk_bf16_f32 v90, v42, v43
    v_cvt_pk_bf16_f32 v92, v44, v45
    v_cvt_pk_bf16_f32 v94, v46, v47
    v_xor_b32 v81, v26, v80
    v_xor_b32 v83, v26, v82
    v_xor_b32 v85, v26, v84
    v_xor_b32 v87, v26, v86
    v_xor_b32 v89, v26, v88
    v_xor_b32 v91, v26, v90
    v_xor_b32 v93, v26, v92
    v_xor_b32 v95, v26, v94
    v_cndmask_b32 v80, v80, v24, s[58:59]
    v_cndmask_b32 v81, v81, v25, s[58:59]
    v_cndmask_b32 v84, v84, v24, s[58:59]
    v_cndmask_b32 v85, v85, v25, s[58:59]
    v_cndmask_b32 v88, v88, v24, s[58:59]
    v_cndmask_b32 v89, v89, v25, s[58:59]
    v_cndmask_b32 v92, v92, v24, s[58:59]
    v_cndmask_b32 v93, v93, v25, s[58:59]
    v_accvgpr_write_b32 a0, v80
    v_accvgpr_write_b32 a1, v81
    v_accvgpr_write_b32 a16, v82
    v_accvgpr_write_b32 a17, v83
    v_accvgpr_write_b32 a4, v84
    v_accvgpr_write_b32 a5, v85
    v_accvgpr_write_b32 a20, v86
    v_accvgpr_write_b32 a21, v87
    v_accvgpr_write_b32 a8, v88
    v_accvgpr_write_b32 a9, v89
    v_accvgpr_write_b32 a24, v90
    v_accvgpr_write_b32 a25, v91
    v_accvgpr_write_b32 a12, v92
    v_accvgpr_write_b32 a13, v93
    v_accvgpr_write_b32 a28, v94
    v_accvgpr_write_b32 a29, v95
    v_cvt_pk_bf16_f32 v80, v48, v49
    v_cvt_pk_bf16_f32 v82, v50, v51
    v_cvt_pk_bf16_f32 v84, v52, v53
    v_cvt_pk_bf16_f32 v86, v54, v55
    v_cvt_pk_bf16_f32 v88, v56, v57
    v_cvt_pk_bf16_f32 v90, v58, v59
    v_cvt_pk_bf16_f32 v92, v60, v61
    v_cvt_pk_bf16_f32 v94, v62, v63
    v_xor_b32 v81, v26, v80
    v_xor_b32 v83, v26, v82
    v_xor_b32 v85, v26, v84
    v_xor_b32 v87, v26, v86
    v_xor_b32 v89, v26, v88
    v_xor_b32 v91, v26, v90
    v_xor_b32 v93, v26, v92
    v_xor_b32 v95, v26, v94
    v_accvgpr_write_b32 a2, v80
    v_accvgpr_write_b32 a3, v81
    v_accvgpr_write_b32 a18, v82
    v_accvgpr_write_b32 a19, v83
    v_accvgpr_write_b32 a6, v84
    v_accvgpr_write_b32 a7, v85
    v_accvgpr_write_b32 a22, v86
    v_accvgpr_write_b32 a23, v87
    v_accvgpr_write_b32 a10, v88
    v_accvgpr_write_b32 a11, v89
    v_accvgpr_write_b32 a26, v90
    v_accvgpr_write_b32 a27, v91
    v_accvgpr_write_b32 a14, v92
    v_accvgpr_write_b32 a15, v93
    v_accvgpr_write_b32 a30, v94
    v_accvgpr_write_b32 a31, v95
    v_pk_fma_f32 v[64:65], v[20:21], v[48:49], v[32:33] op_sel:[0,0,0] op_sel_hi:[0,1,1] neg_lo:[0,0,1] neg_hi:[0,0,1]
    v_pk_fma_f32 v[66:67], v[20:21], v[50:51], v[34:35] op_sel:[0,0,0] op_sel_hi:[0,1,1] neg_lo:[0,0,1] neg_hi:[0,0,1]
    v_pk_fma_f32 v[68:69], v[20:21], v[52:53], v[36:37] op_sel:[1,0,0] op_sel_hi:[1,1,1] neg_lo:[0,0,1] neg_hi:[0,0,1]
    v_pk_fma_f32 v[70:71], v[20:21], v[54:55], v[38:39] op_sel:[1,0,0] op_sel_hi:[1,1,1] neg_lo:[0,0,1] neg_hi:[0,0,1]
    v_pk_fma_f32 v[72:73], v[22:23], v[56:57], v[40:41] op_sel:[0,0,0] op_sel_hi:[0,1,1] neg_lo:[0,0,1] neg_hi:[0,0,1]
    v_pk_fma_f32 v[74:75], v[22:23], v[58:59], v[42:43] op_sel:[0,0,0] op_sel_hi:[0,1,1] neg_lo:[0,0,1] neg_hi:[0,0,1]
    v_pk_fma_f32 v[76:77], v[22:23], v[60:61], v[44:45] op_sel:[1,0,0] op_sel_hi:[1,1,1] neg_lo:[0,0,1] neg_hi:[0,0,1]
    v_pk_fma_f32 v[78:79], v[22:23], v[62:63], v[46:47] op_sel:[1,0,0] op_sel_hi:[1,1,1] neg_lo:[0,0,1] neg_hi:[0,0,1]
    v_cvt_pk_bf16_f32 v80, v64, v65
    v_cvt_pk_bf16_f32 v82, v66, v67
    v_cvt_pk_bf16_f32 v84, v68, v69
    v_cvt_pk_bf16_f32 v86, v70, v71
    v_cvt_pk_bf16_f32 v88, v72, v73
    v_cvt_pk_bf16_f32 v90, v74, v75
    v_cvt_pk_bf16_f32 v92, v76, v77
    v_cvt_pk_bf16_f32 v94, v78, v79
    v_xor_b32 v81, v26, v80
    v_xor_b32 v83, v26, v82
    v_xor_b32 v85, v26, v84
    v_xor_b32 v87, v26, v86
    v_xor_b32 v89, v26, v88
    v_xor_b32 v91, v26, v90
    v_xor_b32 v93, v26, v92
    v_xor_b32 v95, v26, v94
    v_accvgpr_write_b32 a32, v80
    v_accvgpr_write_b32 a33, v81
    v_accvgpr_write_b32 a48, v82
    v_accvgpr_write_b32 a49, v83
    v_accvgpr_write_b32 a36, v84
    v_accvgpr_write_b32 a37, v85
    v_accvgpr_write_b32 a52, v86
    v_accvgpr_write_b32 a53, v87
    v_accvgpr_write_b32 a40, v88
    v_accvgpr_write_b32 a41, v89
    v_accvgpr_write_b32 a56, v90
    v_accvgpr_write_b32 a57, v91
    v_accvgpr_write_b32 a44, v92
    v_accvgpr_write_b32 a45, v93
    v_accvgpr_write_b32 a60, v94
    v_accvgpr_write_b32 a61, v95
    v_pk_fma_f32 v[32:33], v[20:21], v[64:65], v[48:49] op_sel:[0,0,0] op_sel_hi:[0,1,1] neg_lo:[0,0,1] neg_hi:[0,0,1]
    v_pk_fma_f32 v[34:35], v[20:21], v[66:67], v[50:51] op_sel:[0,0,0] op_sel_hi:[0,1,1] neg_lo:[0,0,1] neg_hi:[0,0,1]
    v_pk_fma_f32 v[36:37], v[20:21], v[68:69], v[52:53] op_sel:[1,0,0] op_sel_hi:[1,1,1] neg_lo:[0,0,1] neg_hi:[0,0,1]
    v_pk_fma_f32 v[38:39], v[20:21], v[70:71], v[54:55] op_sel:[1,0,0] op_sel_hi:[1,1,1] neg_lo:[0,0,1] neg_hi:[0,0,1]
    v_pk_fma_f32 v[40:41], v[22:23], v[72:73], v[56:57] op_sel:[0,0,0] op_sel_hi:[0,1,1] neg_lo:[0,0,1] neg_hi:[0,0,1]
    v_pk_fma_f32 v[42:43], v[22:23], v[74:75], v[58:59] op_sel:[0,0,0] op_sel_hi:[0,1,1] neg_lo:[0,0,1] neg_hi:[0,0,1]
    v_pk_fma_f32 v[44:45], v[22:23], v[76:77], v[60:61] op_sel:[1,0,0] op_sel_hi:[1,1,1] neg_lo:[0,0,1] neg_hi:[0,0,1]
    v_pk_fma_f32 v[46:47], v[22:23], v[78:79], v[62:63] op_sel:[1,0,0] op_sel_hi:[1,1,1] neg_lo:[0,0,1] neg_hi:[0,0,1]
    v_cvt_pk_bf16_f32 v80, v32, v33
    v_cvt_pk_bf16_f32 v82, v34, v35
    v_cvt_pk_bf16_f32 v84, v36, v37
    v_cvt_pk_bf16_f32 v86, v38, v39
    v_cvt_pk_bf16_f32 v88, v40, v41
    v_cvt_pk_bf16_f32 v90, v42, v43
    v_cvt_pk_bf16_f32 v92, v44, v45
    v_cvt_pk_bf16_f32 v94, v46, v47
    v_xor_b32 v81, v26, v80
    v_xor_b32 v83, v26, v82
    v_xor_b32 v85, v26, v84
    v_xor_b32 v87, v26, v86
    v_xor_b32 v89, v26, v88
    v_xor_b32 v91, v26, v90
    v_xor_b32 v93, v26, v92
    v_xor_b32 v95, v26, v94
    v_accvgpr_write_b32 a34, v80
    v_accvgpr_write_b32 a35, v81
    v_accvgpr_write_b32 a50, v82
    v_accvgpr_write_b32 a51, v83
    v_accvgpr_write_b32 a38, v84
    v_accvgpr_write_b32 a39, v85
    v_accvgpr_write_b32 a54, v86
    v_accvgpr_write_b32 a55, v87
    v_accvgpr_write_b32 a42, v88
    v_accvgpr_write_b32 a43, v89
    v_accvgpr_write_b32 a58, v90
    v_accvgpr_write_b32 a59, v91
    v_accvgpr_write_b32 a46, v92
    v_accvgpr_write_b32 a47, v93
    v_accvgpr_write_b32 a62, v94
    v_accvgpr_write_b32 a63, v95
    v_pk_fma_f32 v[48:49], v[20:21], v[32:33], v[64:65] op_sel:[0,0,0] op_sel_hi:[0,1,1] neg_lo:[0,0,1] neg_hi:[0,0,1]
    v_pk_fma_f32 v[50:51], v[20:21], v[34:35], v[66:67] op_sel:[0,0,0] op_sel_hi:[0,1,1] neg_lo:[0,0,1] neg_hi:[0,0,1]
    v_pk_fma_f32 v[52:53], v[20:21], v[36:37], v[68:69] op_sel:[1,0,0] op_sel_hi:[1,1,1] neg_lo:[0,0,1] neg_hi:[0,0,1]
    v_pk_fma_f32 v[54:55], v[20:21], v[38:39], v[70:71] op_sel:[1,0,0] op_sel_hi:[1,1,1] neg_lo:[0,0,1] neg_hi:[0,0,1]
    v_pk_fma_f32 v[56:57], v[22:23], v[40:41], v[72:73] op_sel:[0,0,0] op_sel_hi:[0,1,1] neg_lo:[0,0,1] neg_hi:[0,0,1]
    v_pk_fma_f32 v[58:59], v[22:23], v[42:43], v[74:75] op_sel:[0,0,0] op_sel_hi:[0,1,1] neg_lo:[0,0,1] neg_hi:[0,0,1]
    v_pk_fma_f32 v[60:61], v[22:23], v[44:45], v[76:77] op_sel:[1,0,0] op_sel_hi:[1,1,1] neg_lo:[0,0,1] neg_hi:[0,0,1]
    v_pk_fma_f32 v[62:63], v[22:23], v[46:47], v[78:79] op_sel:[1,0,0] op_sel_hi:[1,1,1] neg_lo:[0,0,1] neg_hi:[0,0,1]
    v_cvt_pk_bf16_f32 v80, v48, v49
    v_cvt_pk_bf16_f32 v82, v50, v51
    v_cvt_pk_bf16_f32 v84, v52, v53
    v_cvt_pk_bf16_f32 v86, v54, v55
    v_cvt_pk_bf16_f32 v88, v56, v57
    v_cvt_pk_bf16_f32 v90, v58, v59
    v_cvt_pk_bf16_f32 v92, v60, v61
    v_cvt_pk_bf16_f32 v94, v62, v63
    v_xor_b32 v81, v26, v80
    v_xor_b32 v83, v26, v82
    v_xor_b32 v85, v26, v84
    v_xor_b32 v87, v26, v86
    v_xor_b32 v89, v26, v88
    v_xor_b32 v91, v26, v90
    v_xor_b32 v93, v26, v92
    v_xor_b32 v95, v26, v94
    v_accvgpr_write_b32 a64, v80
    v_accvgpr_write_b32 a65, v81
    v_accvgpr_write_b32 a80, v82
    v_accvgpr_write_b32 a81, v83
    v_accvgpr_write_b32 a68, v84
    v_accvgpr_write_b32 a69, v85
    v_accvgpr_write_b32 a84, v86
    v_accvgpr_write_b32 a85, v87
    v_accvgpr_write_b32 a72, v88
    v_accvgpr_write_b32 a73, v89
    v_accvgpr_write_b32 a88, v90
    v_accvgpr_write_b32 a89, v91
    v_accvgpr_write_b32 a76, v92
    v_accvgpr_write_b32 a77, v93
    v_accvgpr_write_b32 a92, v94
    v_accvgpr_write_b32 a93, v95
    v_pk_fma_f32 v[64:65], v[20:21], v[48:49], v[32:33] op_sel:[0,0,0] op_sel_hi:[0,1,1] neg_lo:[0,0,1] neg_hi:[0,0,1]
    v_pk_fma_f32 v[66:67], v[20:21], v[50:51], v[34:35] op_sel:[0,0,0] op_sel_hi:[0,1,1] neg_lo:[0,0,1] neg_hi:[0,0,1]
    v_pk_fma_f32 v[68:69], v[20:21], v[52:53], v[36:37] op_sel:[1,0,0] op_sel_hi:[1,1,1] neg_lo:[0,0,1] neg_hi:[0,0,1]
    v_pk_fma_f32 v[70:71], v[20:21], v[54:55], v[38:39] op_sel:[1,0,0] op_sel_hi:[1,1,1] neg_lo:[0,0,1] neg_hi:[0,0,1]
    v_pk_fma_f32 v[72:73], v[22:23], v[56:57], v[40:41] op_sel:[0,0,0] op_sel_hi:[0,1,1] neg_lo:[0,0,1] neg_hi:[0,0,1]
    v_pk_fma_f32 v[74:75], v[22:23], v[58:59], v[42:43] op_sel:[0,0,0] op_sel_hi:[0,1,1] neg_lo:[0,0,1] neg_hi:[0,0,1]
    v_pk_fma_f32 v[76:77], v[22:23], v[60:61], v[44:45] op_sel:[1,0,0] op_sel_hi:[1,1,1] neg_lo:[0,0,1] neg_hi:[0,0,1]
    v_pk_fma_f32 v[78:79], v[22:23], v[62:63], v[46:47] op_sel:[1,0,0] op_sel_hi:[1,1,1] neg_lo:[0,0,1] neg_hi:[0,0,1]
    v_cvt_pk_bf16_f32 v80, v64, v65
    v_cvt_pk_bf16_f32 v82, v66, v67
    v_cvt_pk_bf16_f32 v84, v68, v69
    v_cvt_pk_bf16_f32 v86, v70, v71
    v_cvt_pk_bf16_f32 v88, v72, v73
    v_cvt_pk_bf16_f32 v90, v74, v75
    v_cvt_pk_bf16_f32 v92, v76, v77
    v_cvt_pk_bf16_f32 v94, v78, v79
    v_xor_b32 v81, v26, v80
    v_xor_b32 v83, v26, v82
    v_xor_b32 v85, v26, v84
    v_xor_b32 v87, v26, v86
    v_xor_b32 v89, v26, v88
    v_xor_b32 v91, v26, v90
    v_xor_b32 v93, v26, v92
    v_xor_b32 v95, v26, v94
    v_accvgpr_write_b32 a66, v80
    v_accvgpr_write_b32 a67, v81
    v_accvgpr_write_b32 a82, v82
    v_accvgpr_write_b32 a83, v83
    v_accvgpr_write_b32 a70, v84
    v_accvgpr_write_b32 a71, v85
    v_accvgpr_write_b32 a86, v86
    v_accvgpr_write_b32 a87, v87
    v_accvgpr_write_b32 a74, v88
    v_accvgpr_write_b32 a75, v89
    v_accvgpr_write_b32 a90, v90
    v_accvgpr_write_b32 a91, v91
    v_accvgpr_write_b32 a78, v92
    v_accvgpr_write_b32 a79, v93
    v_accvgpr_write_b32 a94, v94
    v_accvgpr_write_b32 a95, v95
    v_pk_fma_f32 v[32:33], v[20:21], v[64:65], v[48:49] op_sel:[0,0,0] op_sel_hi:[0,1,1] neg_lo:[0,0,1] neg_hi:[0,0,1]
    v_pk_fma_f32 v[34:35], v[20:21], v[66:67], v[50:51] op_sel:[0,0,0] op_sel_hi:[0,1,1] neg_lo:[0,0,1] neg_hi:[0,0,1]
    v_pk_fma_f32 v[36:37], v[20:21], v[68:69], v[52:53] op_sel:[1,0,0] op_sel_hi:[1,1,1] neg_lo:[0,0,1] neg_hi:[0,0,1]
    v_pk_fma_f32 v[38:39], v[20:21], v[70:71], v[54:55] op_sel:[1,0,0] op_sel_hi:[1,1,1] neg_lo:[0,0,1] neg_hi:[0,0,1]
    v_pk_fma_f32 v[40:41], v[22:23], v[72:73], v[56:57] op_sel:[0,0,0] op_sel_hi:[0,1,1] neg_lo:[0,0,1] neg_hi:[0,0,1]
    v_pk_fma_f32 v[42:43], v[22:23], v[74:75], v[58:59] op_sel:[0,0,0] op_sel_hi:[0,1,1] neg_lo:[0,0,1] neg_hi:[0,0,1]
    v_pk_fma_f32 v[44:45], v[22:23], v[76:77], v[60:61] op_sel:[1,0,0] op_sel_hi:[1,1,1] neg_lo:[0,0,1] neg_hi:[0,0,1]
    v_pk_fma_f32 v[46:47], v[22:23], v[78:79], v[62:63] op_sel:[1,0,0] op_sel_hi:[1,1,1] neg_lo:[0,0,1] neg_hi:[0,0,1]
    v_cvt_pk_bf16_f32 v80, v32, v33
    v_cvt_pk_bf16_f32 v82, v34, v35
    v_cvt_pk_bf16_f32 v84, v36, v37
    v_cvt_pk_bf16_f32 v86, v38, v39
    v_cvt_pk_bf16_f32 v88, v40, v41
    v_cvt_pk_bf16_f32 v90, v42, v43
    v_cvt_pk_bf16_f32 v92, v44, v45
    v_cvt_pk_bf16_f32 v94, v46, v47
    v_xor_b32 v81, v26, v80
    v_xor_b32 v83, v26, v82
    v_xor_b32 v85, v26, v84
    v_xor_b32 v87, v26, v86
    v_xor_b32 v89, v26, v88
    v_xor_b32 v91, v26, v90
    v_xor_b32 v93, v26, v92
    v_xor_b32 v95, v26, v94
    v_accvgpr_write_b32 a96, v80
    v_accvgpr_write_b32 a97, v81
    v_accvgpr_write_b32 a112, v82
    v_accvgpr_write_b32 a113, v83
    v_accvgpr_write_b32 a100, v84
    v_accvgpr_write_b32 a101, v85
    v_accvgpr_write_b32 a116, v86
    v_accvgpr_write_b32 a117, v87
    v_accvgpr_write_b32 a104, v88
    v_accvgpr_write_b32 a105, v89
    v_accvgpr_write_b32 a120, v90
    v_accvgpr_write_b32 a121, v91
    v_accvgpr_write_b32 a108, v92
    v_accvgpr_write_b32 a109, v93
    v_accvgpr_write_b32 a124, v94
    v_accvgpr_write_b32 a125, v95
    v_pk_fma_f32 v[48:49], v[20:21], v[32:33], v[64:65] op_sel:[0,0,0] op_sel_hi:[0,1,1] neg_lo:[0,0,1] neg_hi:[0,0,1]
    v_pk_fma_f32 v[50:51], v[20:21], v[34:35], v[66:67] op_sel:[0,0,0] op_sel_hi:[0,1,1] neg_lo:[0,0,1] neg_hi:[0,0,1]
    v_pk_fma_f32 v[52:53], v[20:21], v[36:37], v[68:69] op_sel:[1,0,0] op_sel_hi:[1,1,1] neg_lo:[0,0,1] neg_hi:[0,0,1]
    v_pk_fma_f32 v[54:55], v[20:21], v[38:39], v[70:71] op_sel:[1,0,0] op_sel_hi:[1,1,1] neg_lo:[0,0,1] neg_hi:[0,0,1]
    v_pk_fma_f32 v[56:57], v[22:23], v[40:41], v[72:73] op_sel:[0,0,0] op_sel_hi:[0,1,1] neg_lo:[0,0,1] neg_hi:[0,0,1]
    v_pk_fma_f32 v[58:59], v[22:23], v[42:43], v[74:75] op_sel:[0,0,0] op_sel_hi:[0,1,1] neg_lo:[0,0,1] neg_hi:[0,0,1]
    v_pk_fma_f32 v[60:61], v[22:23], v[44:45], v[76:77] op_sel:[1,0,0] op_sel_hi:[1,1,1] neg_lo:[0,0,1] neg_hi:[0,0,1]
    v_pk_fma_f32 v[62:63], v[22:23], v[46:47], v[78:79] op_sel:[1,0,0] op_sel_hi:[1,1,1] neg_lo:[0,0,1] neg_hi:[0,0,1]
    v_cvt_pk_bf16_f32 v80, v48, v49
    v_cvt_pk_bf16_f32 v82, v50, v51
    v_cvt_pk_bf16_f32 v84, v52, v53
    v_cvt_pk_bf16_f32 v86, v54, v55
    v_cvt_pk_bf16_f32 v88, v56, v57
    v_cvt_pk_bf16_f32 v90, v58, v59
    v_cvt_pk_bf16_f32 v92, v60, v61
    v_cvt_pk_bf16_f32 v94, v62, v63
    v_xor_b32 v81, v26, v80
    v_xor_b32 v83, v26, v82
    v_xor_b32 v85, v26, v84
    v_xor_b32 v87, v26, v86
    v_xor_b32 v89, v26, v88
    v_xor_b32 v91, v26, v90
    v_xor_b32 v93, v26, v92
    v_xor_b32 v95, v26, v94
    v_accvgpr_write_b32 a98, v80
    v_accvgpr_write_b32 a99, v81
    v_accvgpr_write_b32 a114, v82
    v_accvgpr_write_b32 a115, v83
    v_accvgpr_write_b32 a102, v84
    v_accvgpr_write_b32 a103, v85
    v_accvgpr_write_b32 a118, v86
    v_accvgpr_write_b32 a119, v87
    v_accvgpr_write_b32 a106, v88
    v_accvgpr_write_b32 a107, v89
    v_accvgpr_write_b32 a122, v90
    v_accvgpr_write_b32 a123, v91
    v_accvgpr_write_b32 a110, v92
    v_accvgpr_write_b32 a111, v93
    v_accvgpr_write_b32 a126, v94
    v_accvgpr_write_b32 a127, v95
    v_pk_fma_f32 v[64:65], v[20:21], v[48:49], v[32:33] op_sel:[0,0,0] op_sel_hi:[0,1,1] neg_lo:[0,0,1] neg_hi:[0,0,1]
    v_pk_fma_f32 v[66:67], v[20:21], v[50:51], v[34:35] op_sel:[0,0,0] op_sel_hi:[0,1,1] neg_lo:[0,0,1] neg_hi:[0,0,1]
    v_pk_fma_f32 v[68:69], v[20:21], v[52:53], v[36:37] op_sel:[1,0,0] op_sel_hi:[1,1,1] neg_lo:[0,0,1] neg_hi:[0,0,1]
    v_pk_fma_f32 v[70:71], v[20:21], v[54:55], v[38:39] op_sel:[1,0,0] op_sel_hi:[1,1,1] neg_lo:[0,0,1] neg_hi:[0,0,1]
    v_pk_fma_f32 v[72:73], v[22:23], v[56:57], v[40:41] op_sel:[0,0,0] op_sel_hi:[0,1,1] neg_lo:[0,0,1] neg_hi:[0,0,1]
    v_pk_fma_f32 v[74:75], v[22:23], v[58:59], v[42:43] op_sel:[0,0,0] op_sel_hi:[0,1,1] neg_lo:[0,0,1] neg_hi:[0,0,1]
    v_pk_fma_f32 v[76:77], v[22:23], v[60:61], v[44:45] op_sel:[1,0,0] op_sel_hi:[1,1,1] neg_lo:[0,0,1] neg_hi:[0,0,1]
    v_pk_fma_f32 v[78:79], v[22:23], v[62:63], v[46:47] op_sel:[1,0,0] op_sel_hi:[1,1,1] neg_lo:[0,0,1] neg_hi:[0,0,1]
    v_cvt_pk_bf16_f32 v80, v64, v65
    v_cvt_pk_bf16_f32 v82, v66, v67
    v_cvt_pk_bf16_f32 v84, v68, v69
    v_cvt_pk_bf16_f32 v86, v70, v71
    v_cvt_pk_bf16_f32 v88, v72, v73
    v_cvt_pk_bf16_f32 v90, v74, v75
    v_cvt_pk_bf16_f32 v92, v76, v77
    v_cvt_pk_bf16_f32 v94, v78, v79
    v_xor_b32 v81, v26, v80
    v_xor_b32 v83, v26, v82
    v_xor_b32 v85, v26, v84
    v_xor_b32 v87, v26, v86
    v_xor_b32 v89, v26, v88
    v_xor_b32 v91, v26, v90
    v_xor_b32 v93, v26, v92
    v_xor_b32 v95, v26, v94
    v_accvgpr_write_b32 a128, v80
    v_accvgpr_write_b32 a129, v81
    v_accvgpr_write_b32 a144, v82
    v_accvgpr_write_b32 a145, v83
    v_accvgpr_write_b32 a132, v84
    v_accvgpr_write_b32 a133, v85
    v_accvgpr_write_b32 a148, v86
    v_accvgpr_write_b32 a149, v87
    v_accvgpr_write_b32 a136, v88
    v_accvgpr_write_b32 a137, v89
    v_accvgpr_write_b32 a152, v90
    v_accvgpr_write_b32 a153, v91
    v_accvgpr_write_b32 a140, v92
    v_accvgpr_write_b32 a141, v93
    v_accvgpr_write_b32 a156, v94
    v_accvgpr_write_b32 a157, v95
    v_pk_fma_f32 v[32:33], v[20:21], v[64:65], v[48:49] op_sel:[0,0,0] op_sel_hi:[0,1,1] neg_lo:[0,0,1] neg_hi:[0,0,1]
    v_pk_fma_f32 v[34:35], v[20:21], v[66:67], v[50:51] op_sel:[0,0,0] op_sel_hi:[0,1,1] neg_lo:[0,0,1] neg_hi:[0,0,1]
    v_pk_fma_f32 v[36:37], v[20:21], v[68:69], v[52:53] op_sel:[1,0,0] op_sel_hi:[1,1,1] neg_lo:[0,0,1] neg_hi:[0,0,1]
    v_pk_fma_f32 v[38:39], v[20:21], v[70:71], v[54:55] op_sel:[1,0,0] op_sel_hi:[1,1,1] neg_lo:[0,0,1] neg_hi:[0,0,1]
    v_pk_fma_f32 v[40:41], v[22:23], v[72:73], v[56:57] op_sel:[0,0,0] op_sel_hi:[0,1,1] neg_lo:[0,0,1] neg_hi:[0,0,1]
    v_pk_fma_f32 v[42:43], v[22:23], v[74:75], v[58:59] op_sel:[0,0,0] op_sel_hi:[0,1,1] neg_lo:[0,0,1] neg_hi:[0,0,1]
    v_pk_fma_f32 v[44:45], v[22:23], v[76:77], v[60:61] op_sel:[1,0,0] op_sel_hi:[1,1,1] neg_lo:[0,0,1] neg_hi:[0,0,1]
    v_pk_fma_f32 v[46:47], v[22:23], v[78:79], v[62:63] op_sel:[1,0,0] op_sel_hi:[1,1,1] neg_lo:[0,0,1] neg_hi:[0,0,1]
    v_cvt_pk_bf16_f32 v80, v32, v33
    v_cvt_pk_bf16_f32 v82, v34, v35
    v_cvt_pk_bf16_f32 v84, v36, v37
    v_cvt_pk_bf16_f32 v86, v38, v39
    v_cvt_pk_bf16_f32 v88, v40, v41
    v_cvt_pk_bf16_f32 v90, v42, v43
    v_cvt_pk_bf16_f32 v92, v44, v45
    v_cvt_pk_bf16_f32 v94, v46, v47
    v_xor_b32 v81, v26, v80
    v_xor_b32 v83, v26, v82
    v_xor_b32 v85, v26, v84
    v_xor_b32 v87, v26, v86
    v_xor_b32 v89, v26, v88
    v_xor_b32 v91, v26, v90
    v_xor_b32 v93, v26, v92
    v_xor_b32 v95, v26, v94
    v_accvgpr_write_b32 a130, v80
    v_accvgpr_write_b32 a131, v81
    v_accvgpr_write_b32 a146, v82
    v_accvgpr_write_b32 a147, v83
    v_accvgpr_write_b32 a134, v84
    v_accvgpr_write_b32 a135, v85
    v_accvgpr_write_b32 a150, v86
    v_accvgpr_write_b32 a151, v87
    v_accvgpr_write_b32 a138, v88
    v_accvgpr_write_b32 a139, v89
    v_accvgpr_write_b32 a154, v90
    v_accvgpr_write_b32 a155, v91
    v_accvgpr_write_b32 a142, v92
    v_accvgpr_write_b32 a143, v93
    v_accvgpr_write_b32 a158, v94
    v_accvgpr_write_b32 a159, v95
    v_pk_fma_f32 v[48:49], v[20:21], v[32:33], v[64:65] op_sel:[0,0,0] op_sel_hi:[0,1,1] neg_lo:[0,0,1] neg_hi:[0,0,1]
    v_pk_fma_f32 v[50:51], v[20:21], v[34:35], v[66:67] op_sel:[0,0,0] op_sel_hi:[0,1,1] neg_lo:[0,0,1] neg_hi:[0,0,1]
    v_pk_fma_f32 v[52:53], v[20:21], v[36:37], v[68:69] op_sel:[1,0,0] op_sel_hi:[1,1,1] neg_lo:[0,0,1] neg_hi:[0,0,1]
    v_pk_fma_f32 v[54:55], v[20:21], v[38:39], v[70:71] op_sel:[1,0,0] op_sel_hi:[1,1,1] neg_lo:[0,0,1] neg_hi:[0,0,1]
    v_pk_fma_f32 v[56:57], v[22:23], v[40:41], v[72:73] op_sel:[0,0,0] op_sel_hi:[0,1,1] neg_lo:[0,0,1] neg_hi:[0,0,1]
    v_pk_fma_f32 v[58:59], v[22:23], v[42:43], v[74:75] op_sel:[0,0,0] op_sel_hi:[0,1,1] neg_lo:[0,0,1] neg_hi:[0,0,1]
    v_pk_fma_f32 v[60:61], v[22:23], v[44:45], v[76:77] op_sel:[1,0,0] op_sel_hi:[1,1,1] neg_lo:[0,0,1] neg_hi:[0,0,1]
    v_pk_fma_f32 v[62:63], v[22:23], v[46:47], v[78:79] op_sel:[1,0,0] op_sel_hi:[1,1,1] neg_lo:[0,0,1] neg_hi:[0,0,1]
    v_cvt_pk_bf16_f32 v80, v48, v49
    v_cvt_pk_bf16_f32 v82, v50, v51
    v_cvt_pk_bf16_f32 v84, v52, v53
    v_cvt_pk_bf16_f32 v86, v54, v55
    v_cvt_pk_bf16_f32 v88, v56, v57
    v_cvt_pk_bf16_f32 v90, v58, v59
    v_cvt_pk_bf16_f32 v92, v60, v61
    v_cvt_pk_bf16_f32 v94, v62, v63
    v_xor_b32 v81, v26, v80
    v_xor_b32 v83, v26, v82
    v_xor_b32 v85, v26, v84
    v_xor_b32 v87, v26, v86
    v_xor_b32 v89, v26, v88
    v_xor_b32 v91, v26, v90
    v_xor_b32 v93, v26, v92
    v_xor_b32 v95, v26, v94
    v_accvgpr_write_b32 a160, v80
    v_accvgpr_write_b32 a161, v81
    v_accvgpr_write_b32 a176, v82
    v_accvgpr_write_b32 a177, v83
    v_accvgpr_write_b32 a164, v84
    v_accvgpr_write_b32 a165, v85
    v_accvgpr_write_b32 a180, v86
    v_accvgpr_write_b32 a181, v87
    v_accvgpr_write_b32 a168, v88
    v_accvgpr_write_b32 a169, v89
    v_accvgpr_write_b32 a184, v90
    v_accvgpr_write_b32 a185, v91
    v_accvgpr_write_b32 a172, v92
    v_accvgpr_write_b32 a173, v93
    v_accvgpr_write_b32 a188, v94
    v_accvgpr_write_b32 a189, v95
    v_pk_fma_f32 v[64:65], v[20:21], v[48:49], v[32:33] op_sel:[0,0,0] op_sel_hi:[0,1,1] neg_lo:[0,0,1] neg_hi:[0,0,1]
    v_pk_fma_f32 v[66:67], v[20:21], v[50:51], v[34:35] op_sel:[0,0,0] op_sel_hi:[0,1,1] neg_lo:[0,0,1] neg_hi:[0,0,1]
    v_pk_fma_f32 v[68:69], v[20:21], v[52:53], v[36:37] op_sel:[1,0,0] op_sel_hi:[1,1,1] neg_lo:[0,0,1] neg_hi:[0,0,1]
    v_pk_fma_f32 v[70:71], v[20:21], v[54:55], v[38:39] op_sel:[1,0,0] op_sel_hi:[1,1,1] neg_lo:[0,0,1] neg_hi:[0,0,1]
    v_pk_fma_f32 v[72:73], v[22:23], v[56:57], v[40:41] op_sel:[0,0,0] op_sel_hi:[0,1,1] neg_lo:[0,0,1] neg_hi:[0,0,1]
    v_pk_fma_f32 v[74:75], v[22:23], v[58:59], v[42:43] op_sel:[0,0,0] op_sel_hi:[0,1,1] neg_lo:[0,0,1] neg_hi:[0,0,1]
    v_pk_fma_f32 v[76:77], v[22:23], v[60:61], v[44:45] op_sel:[1,0,0] op_sel_hi:[1,1,1] neg_lo:[0,0,1] neg_hi:[0,0,1]
    v_pk_fma_f32 v[78:79], v[22:23], v[62:63], v[46:47] op_sel:[1,0,0] op_sel_hi:[1,1,1] neg_lo:[0,0,1] neg_hi:[0,0,1]
    v_cvt_pk_bf16_f32 v80, v64, v65
    v_cvt_pk_bf16_f32 v82, v66, v67
    v_cvt_pk_bf16_f32 v84, v68, v69
    v_cvt_pk_bf16_f32 v86, v70, v71
    v_cvt_pk_bf16_f32 v88, v72, v73
    v_cvt_pk_bf16_f32 v90, v74, v75
    v_cvt_pk_bf16_f32 v92, v76, v77
    v_cvt_pk_bf16_f32 v94, v78, v79
    v_xor_b32 v81, v26, v80
    v_xor_b32 v83, v26, v82
    v_xor_b32 v85, v26, v84
    v_xor_b32 v87, v26, v86
    v_xor_b32 v89, v26, v88
    v_xor_b32 v91, v26, v90
    v_xor_b32 v93, v26, v92
    v_xor_b32 v95, v26, v94
    v_accvgpr_write_b32 a162, v80
    v_accvgpr_write_b32 a163, v81
    v_accvgpr_write_b32 a178, v82
    v_accvgpr_write_b32 a179, v83
    v_accvgpr_write_b32 a166, v84
    v_accvgpr_write_b32 a167, v85
    v_accvgpr_write_b32 a182, v86
    v_accvgpr_write_b32 a183, v87
    v_accvgpr_write_b32 a170, v88
    v_accvgpr_write_b32 a171, v89
    v_accvgpr_write_b32 a186, v90
    v_accvgpr_write_b32 a187, v91
    v_accvgpr_write_b32 a174, v92
    v_accvgpr_write_b32 a175, v93
    v_accvgpr_write_b32 a190, v94
    v_accvgpr_write_b32 a191, v95
    v_pk_fma_f32 v[32:33], v[20:21], v[64:65], v[48:49] op_sel:[0,0,0] op_sel_hi:[0,1,1] neg_lo:[0,0,1] neg_hi:[0,0,1]
    v_pk_fma_f32 v[34:35], v[20:21], v[66:67], v[50:51] op_sel:[0,0,0] op_sel_hi:[0,1,1] neg_lo:[0,0,1] neg_hi:[0,0,1]
    v_pk_fma_f32 v[36:37], v[20:21], v[68:69], v[52:53] op_sel:[1,0,0] op_sel_hi:[1,1,1] neg_lo:[0,0,1] neg_hi:[0,0,1]
    v_pk_fma_f32 v[38:39], v[20:21], v[70:71], v[54:55] op_sel:[1,0,0] op_sel_hi:[1,1,1] neg_lo:[0,0,1] neg_hi:[0,0,1]
    v_pk_fma_f32 v[40:41], v[22:23], v[72:73], v[56:57] op_sel:[0,0,0] op_sel_hi:[0,1,1] neg_lo:[0,0,1] neg_hi:[0,0,1]
    v_pk_fma_f32 v[42:43], v[22:23], v[74:75], v[58:59] op_sel:[0,0,0] op_sel_hi:[0,1,1] neg_lo:[0,0,1] neg_hi:[0,0,1]
    v_pk_fma_f32 v[44:45], v[22:23], v[76:77], v[60:61] op_sel:[1,0,0] op_sel_hi:[1,1,1] neg_lo:[0,0,1] neg_hi:[0,0,1]
    v_pk_fma_f32 v[46:47], v[22:23], v[78:79], v[62:63] op_sel:[1,0,0] op_sel_hi:[1,1,1] neg_lo:[0,0,1] neg_hi:[0,0,1]
    v_cvt_pk_bf16_f32 v80, v32, v33
    v_cvt_pk_bf16_f32 v82, v34, v35
    v_cvt_pk_bf16_f32 v84, v36, v37
    v_cvt_pk_bf16_f32 v86, v38, v39
    v_cvt_pk_bf16_f32 v88, v40, v41
    v_cvt_pk_bf16_f32 v90, v42, v43
    v_cvt_pk_bf16_f32 v92, v44, v45
    v_cvt_pk_bf16_f32 v94, v46, v47
    v_xor_b32 v81, v26, v80
    v_xor_b32 v83, v26, v82
    v_xor_b32 v85, v26, v84
    v_xor_b32 v87, v26, v86
    v_xor_b32 v89, v26, v88
    v_xor_b32 v91, v26, v90
    v_xor_b32 v93, v26, v92
    v_xor_b32 v95, v26, v94
    v_accvgpr_write_b32 a192, v80
    v_accvgpr_write_b32 a193, v81
    v_accvgpr_write_b32 a208, v82
    v_accvgpr_write_b32 a209, v83
    v_accvgpr_write_b32 a196, v84
    v_accvgpr_write_b32 a197, v85
    v_accvgpr_write_b32 a212, v86
    v_accvgpr_write_b32 a213, v87
    v_accvgpr_write_b32 a200, v88
    v_accvgpr_write_b32 a201, v89
    v_accvgpr_write_b32 a216, v90
    v_accvgpr_write_b32 a217, v91
    v_accvgpr_write_b32 a204, v92
    v_accvgpr_write_b32 a205, v93
    v_accvgpr_write_b32 a220, v94
    v_accvgpr_write_b32 a221, v95
    v_pk_fma_f32 v[48:49], v[20:21], v[32:33], v[64:65] op_sel:[0,0,0] op_sel_hi:[0,1,1] neg_lo:[0,0,1] neg_hi:[0,0,1]
    v_pk_fma_f32 v[50:51], v[20:21], v[34:35], v[66:67] op_sel:[0,0,0] op_sel_hi:[0,1,1] neg_lo:[0,0,1] neg_hi:[0,0,1]
    v_pk_fma_f32 v[52:53], v[20:21], v[36:37], v[68:69] op_sel:[1,0,0] op_sel_hi:[1,1,1] neg_lo:[0,0,1] neg_hi:[0,0,1]
    v_pk_fma_f32 v[54:55], v[20:21], v[38:39], v[70:71] op_sel:[1,0,0] op_sel_hi:[1,1,1] neg_lo:[0,0,1] neg_hi:[0,0,1]
    v_pk_fma_f32 v[56:57], v[22:23], v[40:41], v[72:73] op_sel:[0,0,0] op_sel_hi:[0,1,1] neg_lo:[0,0,1] neg_hi:[0,0,1]
    v_pk_fma_f32 v[58:59], v[22:23], v[42:43], v[74:75] op_sel:[0,0,0] op_sel_hi:[0,1,1] neg_lo:[0,0,1] neg_hi:[0,0,1]
    v_pk_fma_f32 v[60:61], v[22:23], v[44:45], v[76:77] op_sel:[1,0,0] op_sel_hi:[1,1,1] neg_lo:[0,0,1] neg_hi:[0,0,1]
    v_pk_fma_f32 v[62:63], v[22:23], v[46:47], v[78:79] op_sel:[1,0,0] op_sel_hi:[1,1,1] neg_lo:[0,0,1] neg_hi:[0,0,1]
    v_cvt_pk_bf16_f32 v80, v48, v49
    v_cvt_pk_bf16_f32 v82, v50, v51
    v_cvt_pk_bf16_f32 v84, v52, v53
    v_cvt_pk_bf16_f32 v86, v54, v55
    v_cvt_pk_bf16_f32 v88, v56, v57
    v_cvt_pk_bf16_f32 v90, v58, v59
    v_cvt_pk_bf16_f32 v92, v60, v61
    v_cvt_pk_bf16_f32 v94, v62, v63
    v_xor_b32 v81, v26, v80
    v_xor_b32 v83, v26, v82
    v_xor_b32 v85, v26, v84
    v_xor_b32 v87, v26, v86
    v_xor_b32 v89, v26, v88
    v_xor_b32 v91, v26, v90
    v_xor_b32 v93, v26, v92
    v_xor_b32 v95, v26, v94
    v_accvgpr_write_b32 a194, v80
    v_accvgpr_write_b32 a195, v81
    v_accvgpr_write_b32 a210, v82
    v_accvgpr_write_b32 a211, v83
    v_accvgpr_write_b32 a198, v84
    v_accvgpr_write_b32 a199, v85
    v_accvgpr_write_b32 a214, v86
    v_accvgpr_write_b32 a215, v87
    v_accvgpr_write_b32 a202, v88
    v_accvgpr_write_b32 a203, v89
    v_accvgpr_write_b32 a218, v90
    v_accvgpr_write_b32 a219, v91
    v_accvgpr_write_b32 a206, v92
    v_accvgpr_write_b32 a207, v93
    v_accvgpr_write_b32 a222, v94
    v_accvgpr_write_b32 a223, v95
    s_waitcnt vmcnt(0)
    s_barrier
    s_add_u32 s53, s96, 1024
    s_cmp_lg_u32 s26, 0
    s_cbranch_scc1 L_hfb
    v_mov_b32 v14, s12
    v_mov_b32 v15, s13
    s_mov_b64 exec, 1
    buffer_store_dwordx2 v[14:15], off, s[28:31], s53 sc1
    s_mov_b64 exec, -1
L_hfb:
    v_lshlrev_b32 v10, 7, v1
    v_lshl_add_u32 v10, v4, 5, v10
    buffer_load_dwordx4 v[144:147], v10, s[36:39], 0 offen offset:0
    buffer_load_dwordx4 v[148:151], v10, s[36:39], 0 offen offset:16
    buffer_load_dwordx4 v[152:155], v10, s[36:39], 0 offen offset:448
    buffer_load_dwordx4 v[156:159], v10, s[36:39], 0 offen offset:464
    s_lshr_b32 s4, s48, 2
    s_lshl_b32 s4, s4, 4
    s_and_b32 s5, s48, 3
    s_add_u32 s4, s4, s5
    s_lshl_b32 s4, s4, 8
    s_add_u32 s4, s4, 14389248
    v_and_b32 v11, 12, v3
    v_lshlrev_b32 v11, 8, v11
    v_and_b32 v9, 3, v3
    v_lshl_add_u32 v11, v9, 5, v11
    buffer_load_dwordx2 v[252:253], v11, s[28:31], s4 offen sc1
    s_waitcnt vmcnt(4)
    v_lshlrev_b32 v160, 16, v144
    v_and_b32 v161, 0xffff0000, v144
    v_lshlrev_b32 v162, 16, v145
    v_and_b32 v163, 0xffff0000, v145
    v_lshlrev_b32 v164, 16, v146
    v_and_b32 v165, 0xffff0000, v146
    v_lshlrev_b32 v166, 16, v147
    v_and_b32 v167, 0xffff0000, v147
    s_waitcnt vmcnt(3)
    v_lshlrev_b32 v168, 16, v148
    v_and_b32 v169, 0xffff0000, v148
    v_lshlrev_b32 v170, 16, v149
    v_and_b32 v171, 0xffff0000, v149
    v_lshlrev_b32 v172, 16, v150
    v_and_b32 v173, 0xffff0000, v150
    v_lshlrev_b32 v174, 16, v151
    v_and_b32 v175, 0xffff0000, v151
    s_waitcnt vmcnt(2)
    v_lshlrev_b32 v176, 16, v152
    v_and_b32 v177, 0xffff0000, v152
    v_lshlrev_b32 v178, 16, v153
    v_and_b32 v179, 0xffff0000, v153
    v_lshlrev_b32 v180, 16, v154
    v_and_b32 v181, 0xffff0000, v154
    v_lshlrev_b32 v182, 16, v155
    v_and_b32 v183, 0xffff0000, v155
    s_waitcnt vmcnt(1)
    v_lshlrev_b32 v184, 16, v156
    v_and_b32 v185, 0xffff0000, v156
    v_lshlrev_b32 v186, 16, v157
    v_and_b32 v187, 0xffff0000, v157
    v_lshlrev_b32 v188, 16, v158
    v_and_b32 v189, 0xffff0000, v158
    v_lshlrev_b32 v190, 16, v159
    v_and_b32 v191, 0xffff0000, v159
    v_mul_f32 v160, 0.5, v160
    v_mul_f32 v161, 0.5, v161
    v_mul_f32 v162, 0.5, v162
    v_mul_f32 v163, 0.5, v163
    v_mul_f32 v164, 0.5, v164
    v_mul_f32 v165, 0.5, v165
    v_mul_f32 v166, 0.5, v166
    v_mul_f32 v167, 0.5, v167
    v_mul_f32 v168, 0.5, v168
    v_mul_f32 v169, 0.5, v169
    v_mul_f32 v170, 0.5, v170
    v_mul_f32 v171, 0.5, v171
    v_mul_f32 v172, 0.5, v172
    v_mul_f32 v173, 0.5, v173
    v_mul_f32 v174, 0.5, v174
    v_mul_f32 v175, 0.5, v175
    v_mul_f32 v176, 0.5, v176
    v_mul_f32 v177, 0.5, v177
    v_mul_f32 v178, 0.5, v178
    v_mul_f32 v179, 0.5, v179
    v_mul_f32 v180, 0.5, v180
    v_mul_f32 v181, 0.5, v181
    v_mul_f32 v182, 0.5, v182
    v_mul_f32 v183, 0.5, v183
    v_mul_f32 v184, 0.5, v184
    v_mul_f32 v185, 0.5, v185
    v_mul_f32 v186, 0.5, v186
    v_mul_f32 v187, 0.5, v187
    v_mul_f32 v188, 0.5, v188
    v_mul_f32 v189, 0.5, v189
    v_mul_f32 v190, 0.5, v190
    v_mul_f32 v191, 0.5, v191
    v_pk_add_f32 v[16:17], v[160:161], v[176:177]
    v_pk_add_f32 v[18:19], v[162:163], v[178:179]
    v_pk_add_f32 v[20:21], v[160:161], v[176:177]
    v_pk_add_f32 v[22:23], v[162:163], v[178:179]
    v_pk_add_f32 v[24:25], v[160:161], v[176:177]
    v_pk_add_f32 v[26:27], v[162:163], v[178:179]
    v_pk_add_f32 v[28:29], v[160:161], v[176:177]
    v_pk_add_f32 v[30:31], v[162:163], v[178:179]
    v_pk_add_f32 v[32:33], v[164:165], v[180:181]
    v_pk_add_f32 v[34:35], v[166:167], v[182:183]
    v_pk_add_f32 v[36:37], v[164:165], v[180:181]
    v_pk_add_f32 v[38:39], v[166:167], v[182:183]
    v_pk_add_f32 v[40:41], v[164:165], v[180:181]
    v_pk_add_f32 v[42:43], v[166:167], v[182:183]
    v_pk_add_f32 v[44:45], v[164:165], v[180:181]
    v_pk_add_f32 v[46:47], v[166:167], v[182:183]
    v_pk_add_f32 v[48:49], v[168:169], v[184:185]
    v_pk_add_f32 v[50:51], v[170:171], v[186:187]
    v_pk_add_f32 v[52:53], v[168:169], v[184:185]
    v_pk_add_f32 v[54:55], v[170:171], v[186:187]
    v_pk_add_f32 v[56:57], v[168:169], v[184:185]
    v_pk_add_f32 v[58:59], v[170:171], v[186:187]
    v_pk_add_f32 v[60:61], v[168:169], v[184:185]
    v_pk_add_f32 v[62:63], v[170:171], v[186:187]
    v_pk_add_f32 v[64:65], v[172:173], v[188:189]
    v_pk_add_f32 v[66:67], v[174:175], v[190:191]
    v_pk_add_f32 v[68:69], v[172:173], v[188:189]
    v_pk_add_f32 v[70:71], v[174:175], v[190:191]
    v_pk_add_f32 v[72:73], v[172:173], v[188:189]
    v_pk_add_f32 v[74:75], v[174:175], v[190:191]
    v_pk_add_f32 v[76:77], v[172:173], v[188:189]
    v_pk_add_f32 v[78:79], v[174:175], v[190:191]
    v_pk_add_f32 v[80:81], v[160:161], v[176:177] neg_lo:[0,1] neg_hi:[0,1]
    v_pk_add_f32 v[82:83], v[162:163], v[178:179] neg_lo:[0,1] neg_hi:[0,1]
    v_pk_add_f32 v[84:85], v[160:161], v[176:177] neg_lo:[0,1] neg_hi:[0,1]
    v_pk_add_f32 v[86:87], v[162:163], v[178:179] neg_lo:[0,1] neg_hi:[0,1]
    v_pk_add_f32 v[88:89], v[160:161], v[176:177] neg_lo:[0,1] neg_hi:[0,1]
    v_pk_add_f32 v[90:91], v[162:163], v[178:179] neg_lo:[0,1] neg_hi:[0,1]
    v_pk_add_f32 v[92:93], v[160:161], v[176:177] neg_lo:[0,1] neg_hi:[0,1]
    v_pk_add_f32 v[94:95], v[162:163], v[178:179] neg_lo:[0,1] neg_hi:[0,1]
    v_pk_add_f32 v[96:97], v[164:165], v[180:181] neg_lo:[0,1] neg_hi:[0,1]
    v_pk_add_f32 v[98:99], v[166:167], v[182:183] neg_lo:[0,1] neg_hi:[0,1]
    v_pk_add_f32 v[100:101], v[164:165], v[180:181] neg_lo:[0,1] neg_hi:[0,1]
    v_pk_add_f32 v[102:103], v[166:167], v[182:183] neg_lo:[0,1] neg_hi:[0,1]
    v_pk_add_f32 v[104:105], v[164:165], v[180:181] neg_lo:[0,1] neg_hi:[0,1]
    v_pk_add_f32 v[106:107], v[166:167], v[182:183] neg_lo:[0,1] neg_hi:[0,1]
    v_pk_add_f32 v[108:109], v[164:165], v[180:181] neg_lo:[0,1] neg_hi:[0,1]
    v_pk_add_f32 v[110:111], v[166:167], v[182:183] neg_lo:[0,1] neg_hi:[0,1]
    v_pk_add_f32 v[112:113], v[168:169], v[184:185] neg_lo:[0,1] neg_hi:[0,1]
    v_pk_add_f32 v[114:115], v[170:171], v[186:187] neg_lo:[0,1] neg_hi:[0,1]
    v_pk_add_f32 v[116:117], v[168:169], v[184:185] neg_lo:[0,1] neg_hi:[0,1]
    v_pk_add_f32 v[118:119], v[170:171], v[186:187] neg_lo:[0,1] neg_hi:[0,1]
    v_pk_add_f32 v[120:121], v[168:169], v[184:185] neg_lo:[0,1] neg_hi:[0,1]
    v_pk_add_f32 v[122:123], v[170:171], v[186:187] neg_lo:[0,1] neg_hi:[0,1]
    v_pk_add_f32 v[124:125], v[168:169], v[184:185] neg_lo:[0,1] neg_hi:[0,1]
    v_pk_add_f32 v[126:127], v[170:171], v[186:187] neg_lo:[0,1] neg_hi:[0,1]
    v_pk_add_f32 v[128:129], v[172:173], v[188:189] neg_lo:[0,1] neg_hi:[0,1]
    v_pk_add_f32 v[130:131], v[174:175], v[190:191] neg_lo:[0,1] neg_hi:[0,1]
    v_pk_add_f32 v[132:133], v[172:173], v[188:189] neg_lo:[0,1] neg_hi:[0,1]
    v_pk_add_f32 v[134:135], v[174:175], v[190:191] neg_lo:[0,1] neg_hi:[0,1]
    v_pk_add_f32 v[136:137], v[172:173], v[188:189] neg_lo:[0,1] neg_hi:[0,1]
    v_pk_add_f32 v[138:139], v[174:175], v[190:191] neg_lo:[0,1] neg_hi:[0,1]
    v_pk_add_f32 v[140:141], v[172:173], v[188:189] neg_lo:[0,1] neg_hi:[0,1]
    v_pk_add_f32 v[142:143], v[174:175], v[190:191] neg_lo:[0,1] neg_hi:[0,1]
    s_waitcnt vmcnt(0)
    v_cmp_ne_u64 vcc, s[12:13], v[252:253]
    s_cbranch_vccnz L_slow_hf1
L_back_hf1:
    s_mov_b32 s32, s24
    s_mov_b32 s33, s25
    s_mov_b32 s34, 3670016
    s_mov_b32 s35, 0x20000
    s_mul_i32 s64, s48, 114688
    s_add_u32 s65, s64, 8192
    s_add_u32 s66, s65, 8192
    s_add_u32 s67, s66, 8192
    s_add_u32 s68, s67, 8192
    s_add_u32 s69, s68, 8192
    s_add_u32 s70, s69, 8192
    v_add_u32 v12, 4096, v251
    s_mul_i32 s72, s48, 7
    s_add_u32 s72, s72, s26
    s_lshl_b32 s72, s72, 14
    s_add_u32 s72, s72, 5865472
    s_add_u32 s73, s72, 4096
    s_add_u32 s74, s73, 4096
    s_add_u32 s75, s74, 4096
    v_lshrrev_b32 v13, 1, v4
    v_add_u32 v13, 3, v13
    v_xor_b32 v14, 512, v2
    v_lshl_add_u32 v13, v13, 14, v14
    buffer_load_dword v10, off, s[32:35], s64 offset:12 sc1
    s_waitcnt vmcnt(0)
    v_and_b32 v10, 1, v10
    v_cmp_eq_u32 vcc, 0, v10
    s_cbranch_vccnz L_slow_hpl
L_back_hpl:
    buffer_load_dwordx4 v[144:147], v251, s[32:35], s64 offen offset:0 sc1
    buffer_load_dwordx4 v[148:151], v251, s[32:35], s64 offen offset:2048 sc1
    buffer_load_dwordx4 v[152:155], v12, s[32:35], s64 offen offset:0 sc1
    buffer_load_dwordx4 v[156:159], v12, s[32:35], s64 offen offset:2048 sc1
    buffer_load_dwordx4 v[160:163], v251, s[32:35], s64 offen offset:256 sc1
    buffer_load_dwordx4 v[164:167], v251, s[32:35], s64 offen offset:2304 sc1
    buffer_load_dwordx4 v[168:171], v12, s[32:35], s64 offen offset:256 sc1
    buffer_load_dwordx4 v[172:175], v12, s[32:35], s64 offen offset:2304 sc1
    buffer_load_dwordx4 v[176:179], v251, s[32:35], s65 offen offset:0 sc1
    buffer_load_dwordx4 v[180:183], v251, s[32:35], s65 offen offset:2048 sc1
    buffer_load_dwordx4 v[184:187], v12, s[32:35], s65 offen offset:0 sc1
    buffer_load_dwordx4 v[188:191], v12, s[32:35], s65 offen offset:2048 sc1
    buffer_load_dwordx4 v[192:195], v251, s[32:35], s65 offen offset:256 sc1
    buffer_load_dwordx4 v[196:199], v251, s[32:35], s65 offen offset:2304 sc1
    buffer_load_dwordx4 v[200:203], v12, s[32:35], s65 offen offset:256 sc1
    buffer_load_dwordx4 v[204:207], v12, s[32:35], s65 offen offset:2304 sc1
    buffer_load_dwordx4 v[208:211], v251, s[32:35], s66 offen offset:0 sc1
    buffer_load_dwordx4 v[212:215], v251, s[32:35], s66 offen offset:2048 sc1
    buffer_load_dwordx4 v[216:219], v12, s[32:35], s66 offen offset:0 sc1
    buffer_load_dwordx4 v[220:223], v12, s[32:35], s66 offen offset:2048 sc1
    s_waitcnt vmcnt(17)
    v_bitop3_b32 v9, v147, v151, v155 bitop3:0x80
    s_waitcnt vmcnt(16)
    v_bitop3_b32 v9, v9, v159, 1 bitop3:0x80
    v_cmp_eq_u32 vcc, 0, v9
    s_cbranch_vccnz L_slow_hr_0
L_back_hr_0:
    v_swap_b32 v148, v145
    v_swap_b32 v152, v146
    v_swap_b32 v153, v150
    v_swap_b32 v156, v147
    v_swap_b32 v157, v151
    v_swap_b32 v158, v155
    v_mfma_f32_16x16x32_bf16 v[16:19], a[0:3], v[144:147], v[16:19]
    buffer_load_dwordx4 v[224:227], v251, s[32:35], s66 offen offset:256 sc1
    v_mfma_f32_16x16x32_bf16 v[20:23], a[0:3], v[148:151], v[20:23]
    buffer_load_dwordx4 v[228:231], v251, s[32:35], s66 offen offset:2304 sc1
    v_mfma_f32_16x16x32_bf16 v[24:27], a[0:3], v[152:155], v[24:27]
    buffer_load_dwordx4 v[232:235], v12, s[32:35], s66 offen offset:256 sc1
    v_mfma_f32_16x16x32_bf16 v[28:31], a[0:3], v[156:159], v[28:31]
    buffer_load_dwordx4 v[236:239], v12, s[32:35], s66 offen offset:2304 sc1
    v_mfma_f32_16x16x32_bf16 v[32:35], a[4:7], v[144:147], v[32:35]
    v_mfma_f32_16x16x32_bf16 v[36:39], a[4:7], v[148:151], v[36:39]
    s_waitcnt vmcnt(17)
    v_bitop3_b32 v9, v163, v167, v171 bitop3:0x80
    v_mfma_f32_16x16x32_bf16 v[40:43], a[4:7], v[152:155], v[40:43]
    s_waitcnt vmcnt(16)
    v_bitop3_b32 v9, v9, v175, 1 bitop3:0x80
    v_mfma_f32_16x16x32_bf16 v[44:47], a[4:7], v[156:159], v[44:47]
    v_cmp_eq_u32 vcc, 0, v9
    s_cbranch_vccnz L_slow_hr_1
L_back_hr_1:
    v_mfma_f32_16x16x32_bf16 v[48:51], a[8:11], v[144:147], v[48:51]
    v_swap_b32 v164, v161
    v_mfma_f32_16x16x32_bf16 v[52:55], a[8:11], v[148:151], v[52:55]
    v_swap_b32 v168, v162
    v_mfma_f32_16x16x32_bf16 v[56:59], a[8:11], v[152:155], v[56:59]
    v_swap_b32 v169, v166
    v_mfma_f32_16x16x32_bf16 v[60:63], a[8:11], v[156:159], v[60:63]
    v_swap_b32 v172, v163
    v_mfma_f32_16x16x32_bf16 v[64:67], a[12:15], v[144:147], v[64:67]
    v_swap_b32 v173, v167
    v_mfma_f32_16x16x32_bf16 v[68:71], a[12:15], v[148:151], v[68:71]
    v_swap_b32 v174, v171
    v_mfma_f32_16x16x32_bf16 v[72:75], a[12:15], v[152:155], v[72:75]
    v_mfma_f32_16x16x32_bf16 v[76:79], a[12:15], v[156:159], v[76:79]
    v_mfma_f32_16x16x32_bf16 v[80:83], a[16:19], v[160:163], v[80:83]
    buffer_load_dwordx4 v[144:147], v251, s[32:35], s67 offen offset:0 sc1
    v_mfma_f32_16x16x32_bf16 v[84:87], a[16:19], v[164:167], v[84:87]
    buffer_load_dwordx4 v[148:151], v251, s[32:35], s67 offen offset:2048 sc1
    v_mfma_f32_16x16x32_bf16 v[88:91], a[16:19], v[168:171], v[88:91]
    buffer_load_dwordx4 v[152:155], v12, s[32:35], s67 offen offset:0 sc1
    v_mfma_f32_16x16x32_bf16 v[92:95], a[16:19], v[172:175], v[92:95]
    buffer_load_dwordx4 v[156:159], v12, s[32:35], s67 offen offset:2048 sc1
    v_mfma_f32_16x16x32_bf16 v[96:99], a[20:23], v[160:163], v[96:99]
    v_mfma_f32_16x16x32_bf16 v[100:103], a[20:23], v[164:167], v[100:103]
    s_waitcnt vmcnt(17)
    v_bitop3_b32 v9, v179, v183, v187 bitop3:0x80
    v_mfma_f32_16x16x32_bf16 v[104:107], a[20:23], v[168:171], v[104:107]
    s_waitcnt vmcnt(16)
    v_bitop3_b32 v9, v9, v191, 1 bitop3:0x80
    v_mfma_f32_16x16x32_bf16 v[108:111], a[20:23], v[172:175], v[108:111]
    v_cmp_eq_u32 vcc, 0, v9
    s_cbranch_vccnz L_slow_hr_2
L_back_hr_2:
    v_mfma_f32_16x16x32_bf16 v[112:115], a[24:27], v[160:163], v[112:115]
    v_swap_b32 v180, v177
    v_mfma_f32_16x16x32_bf16 v[116:119], a[24:27], v[164:167], v[116:119]
    v_swap_b32 v184, v178
    v_mfma_f32_16x16x32_bf16 v[120:123], a[24:27], v[168:171], v[120:123]
    v_swap_b32 v185, v182
    v_mfma_f32_16x16x32_bf16 v[124:127], a[24:27], v[172:175], v[124:127]
    v_swap_b32 v188, v179
    v_mfma_f32_16x16x32_bf16 v[128:131], a[28:31], v[160:163], v[128:131]
    v_swap_b32 v189, v183
    v_mfma_f32_16x16x32_bf16 v[132:135], a[28:31], v[164:167], v[132:135]
    v_swap_b32 v190, v187
    v_mfma_f32_16x16x32_bf16 v[136:139], a[28:31], v[168:171], v[136:139]
    v_mfma_f32_16x16x32_bf16 v[140:143], a[28:31], v[172:175], v[140:143]
    v_mfma_f32_16x16x32_bf16 v[16:19], a[32:35], v[176:179], v[16:19]
    buffer_load_dwordx4 v[160:163], v251, s[32:35], s67 offen offset:256 sc1
    v_mfma_f32_16x16x32_bf16 v[20:23], a[32:35], v[180:183], v[20:23]
    buffer_load_dwordx4 v[164:167], v251, s[32:35], s67 offen offset:2304 sc1
    v_mfma_f32_16x16x32_bf16 v[24:27], a[32:35], v[184:187], v[24:27]
    buffer_load_dwordx4 v[168:171], v12, s[32:35], s67 offen offset:256 sc1
    v_mfma_f32_16x16x32_bf16 v[28:31], a[32:35], v[188:191], v[28:31]
    buffer_load_dwordx4 v[172:175], v12, s[32:35], s67 offen offset:2304 sc1
    v_mfma_f32_16x16x32_bf16 v[32:35], a[36:39], v[176:179], v[32:35]
    v_mfma_f32_16x16x32_bf16 v[36:39], a[36:39], v[180:183], v[36:39]
    s_waitcnt vmcnt(17)
    v_bitop3_b32 v9, v195, v199, v203 bitop3:0x80
    v_mfma_f32_16x16x32_bf16 v[40:43], a[36:39], v[184:187], v[40:43]
    s_waitcnt vmcnt(16)
    v_bitop3_b32 v9, v9, v207, 1 bitop3:0x80
    v_mfma_f32_16x16x32_bf16 v[44:47], a[36:39], v[188:191], v[44:47]
    v_cmp_eq_u32 vcc, 0, v9
    s_cbranch_vccnz L_slow_hr_3
L_back_hr_3:
    v_mfma_f32_16x16x32_bf16 v[48:51], a[40:43], v[176:179], v[48:51]
    v_swap_b32 v196, v193
    v_mfma_f32_16x16x32_bf16 v[52:55], a[40:43], v[180:183], v[52:55]
    v_swap_b32 v200, v194
    v_mfma_f32_16x16x32_bf16 v[56:59], a[40:43], v[184:187], v[56:59]
    v_swap_b32 v201, v198
    v_mfma_f32_16x16x32_bf16 v[60:63], a[40:43], v[188:191], v[60:63]
    v_swap_b32 v204, v195
    v_mfma_f32_16x16x32_bf16 v[64:67], a[44:47], v[176:179], v[64:67]
    v_swap_b32 v205, v199
    v_mfma_f32_16x16x32_bf16 v[68:71], a[44:47], v[180:183], v[68:71]
    v_swap_b32 v206, v203
    v_mfma_f32_16x16x32_bf16 v[72:75], a[44:47], v[184:187], v[72:75]
    v_mfma_f32_16x16x32_bf16 v[76:79], a[44:47], v[188:191], v[76:79]
    v_mfma_f32_16x16x32_bf16 v[80:83], a[48:51], v[192:195], v[80:83]
    buffer_load_dwordx4 v[176:179], v251, s[32:35], s68 offen offset:0 sc1
    v_mfma_f32_16x16x32_bf16 v[84:87], a[48:51], v[196:199], v[84:87]
    buffer_load_dwordx4 v[180:183], v251, s[32:35], s68 offen offset:2048 sc1
    v_mfma_f32_16x16x32_bf16 v[88:91], a[48:51], v[200:203], v[88:91]
    buffer_load_dwordx4 v[184:187], v12, s[32:35], s68 offen offset:0 sc1
    v_mfma_f32_16x16x32_bf16 v[92:95], a[48:51], v[204:207], v[92:95]
    buffer_load_dwordx4 v[188:191], v12, s[32:35], s68 offen offset:2048 sc1
    v_mfma_f32_16x16x32_bf16 v[96:99], a[52:55], v[192:195], v[96:99]
    v_mfma_f32_16x16x32_bf16 v[100:103], a[52:55], v[196:199], v[100:103]
    s_waitcnt vmcnt(17)
    v_bitop3_b32 v9, v211, v215, v219 bitop3:0x80
    v_mfma_f32_16x16x32_bf16 v[104:107], a[52:55], v[200:203], v[104:107]
    s_waitcnt vmcnt(16)
    v_bitop3_b32 v9, v9, v223, 1 bitop3:0x80
    v_mfma_f32_16x16x32_bf16 v[108:111], a[52:55], v[204:207], v[108:111]
    v_cmp_eq_u32 vcc, 0, v9
    s_cbranch_vccnz L_slow_hr_4
L_back_hr_4:
    v_mfma_f32_16x16x32_bf16 v[112:115], a[56:59], v[192:195], v[112:115]
    v_swap_b32 v212, v209
    v_mfma_f32_16x16x32_bf16 v[116:119], a[56:59], v[196:199], v[116:119]
    v_swap_b32 v216, v210
    v_mfma_f32_16x16x32_bf16 v[120:123], a[56:59], v[200:203], v[120:123]
    v_swap_b32 v217, v214
    v_mfma_f32_16x16x32_bf16 v[124:127], a[56:59], v[204:207], v[124:127]
    v_swap_b32 v220, v211
    v_mfma_f32_16x16x32_bf16 v[128:131], a[60:63], v[192:195], v[128:131]
    v_swap_b32 v221, v215
    v_mfma_f32_16x16x32_bf16 v[132:135], a[60:63], v[196:199], v[132:135]
    v_swap_b32 v222, v219
    v_mfma_f32_16x16x32_bf16 v[136:139], a[60:63], v[200:203], v[136:139]
    v_mfma_f32_16x16x32_bf16 v[140:143], a[60:63], v[204:207], v[140:143]
    v_mfma_f32_16x16x32_bf16 v[16:19], a[64:67], v[208:211], v[16:19]
    buffer_load_dwordx4 v[192:195], v251, s[32:35], s68 offen offset:256 sc1
    v_mfma_f32_16x16x32_bf16 v[20:23], a[64:67], v[212:215], v[20:23]
    buffer_load_dwordx4 v[196:199], v251, s[32:35], s68 offen offset:2304 sc1
    v_mfma_f32_16x16x32_bf16 v[24:27], a[64:67], v[216:219], v[24:27]
    buffer_load_dwordx4 v[200:203], v12, s[32:35], s68 offen offset:256 sc1
    v_mfma_f32_16x16x32_bf16 v[28:31], a[64:67], v[220:223], v[28:31]
    buffer_load_dwordx4 v[204:207], v12, s[32:35], s68 offen offset:2304 sc1
    v_mfma_f32_16x16x32_bf16 v[32:35], a[68:71], v[208:211], v[32:35]
    v_mfma_f32_16x16x32_bf16 v[36:39], a[68:71], v[212:215], v[36:39]
    s_waitcnt vmcnt(17)
    v_bitop3_b32 v9, v227, v231, v235 bitop3:0x80
    v_mfma_f32_16x16x32_bf16 v[40:43], a[68:71], v[216:219], v[40:43]
    s_waitcnt vmcnt(16)
    v_bitop3_b32 v9, v9, v239, 1 bitop3:0x80
    v_mfma_f32_16x16x32_bf16 v[44:47], a[68:71], v[220:223], v[44:47]
    v_cmp_eq_u32 vcc, 0, v9
    s_cbranch_vccnz L_slow_hr_5
L_back_hr_5:
    v_mfma_f32_16x16x32_bf16 v[48:51], a[72:75], v[208:211], v[48:51]
    v_swap_b32 v228, v225
    v_mfma_f32_16x16x32_bf16 v[52:55], a[72:75], v[212:215], v[52:55]
    v_swap_b32 v232, v226
    v_mfma_f32_16x16x32_bf16 v[56:59], a[72:75], v[216:219], v[56:59]
    v_swap_b32 v233, v230
    v_mfma_f32_16x16x32_bf16 v[60:63], a[72:75], v[220:223], v[60:63]
    v_swap_b32 v236, v227
    v_mfma_f32_16x16x32_bf16 v[64:67], a[76:79], v[208:211], v[64:67]
    v_swap_b32 v237, v231
    v_mfma_f32_16x16x32_bf16 v[68:71], a[76:79], v[212:215], v[68:71]
    v_swap_b32 v238, v235
    v_mfma_f32_16x16x32_bf16 v[72:75], a[76:79], v[216:219], v[72:75]
    v_mfma_f32_16x16x32_bf16 v[76:79], a[76:79], v[220:223], v[76:79]
    v_mfma_f32_16x16x32_bf16 v[80:83], a[80:83], v[224:227], v[80:83]
    buffer_load_dwordx4 v[208:211], v251, s[32:35], s69 offen offset:0 sc1
    v_mfma_f32_16x16x32_bf16 v[84:87], a[80:83], v[228:231], v[84:87]
    buffer_load_dwordx4 v[212:215], v251, s[32:35], s69 offen offset:2048 sc1
    v_mfma_f32_16x16x32_bf16 v[88:91], a[80:83], v[232:235], v[88:91]
    buffer_load_dwordx4 v[216:219], v12, s[32:35], s69 offen offset:0 sc1
    v_mfma_f32_16x16x32_bf16 v[92:95], a[80:83], v[236:239], v[92:95]
    buffer_load_dwordx4 v[220:223], v12, s[32:35], s69 offen offset:2048 sc1
    v_mfma_f32_16x16x32_bf16 v[96:99], a[84:87], v[224:227], v[96:99]
    v_mfma_f32_16x16x32_bf16 v[100:103], a[84:87], v[228:231], v[100:103]
    s_waitcnt vmcnt(17)
    v_bitop3_b32 v9, v147, v151, v155 bitop3:0x80
    v_mfma_f32_16x16x32_bf16 v[104:107], a[84:87], v[232:235], v[104:107]
    s_waitcnt vmcnt(16)
    v_bitop3_b32 v9, v9, v159, 1 bitop3:0x80
    v_mfma_f32_16x16x32_bf16 v[108:111], a[84:87], v[236:239], v[108:111]
    v_cmp_eq_u32 vcc, 0, v9
    s_cbranch_vccnz L_slow_hr_6
L_back_hr_6:
    v_mfma_f32_16x16x32_bf16 v[112:115], a[88:91], v[224:227], v[112:115]
    v_swap_b32 v148, v145
    v_mfma_f32_16x16x32_bf16 v[116:119], a[88:91], v[228:231], v[116:119]
    v_swap_b32 v152, v146
    v_mfma_f32_16x16x32_bf16 v[120:123], a[88:91], v[232:235], v[120:123]
    v_swap_b32 v153, v150
    v_mfma_f32_16x16x32_bf16 v[124:127], a[88:91], v[236:239], v[124:127]
    v_swap_b32 v156, v147
    v_mfma_f32_16x16x32_bf16 v[128:131], a[92:95], v[224:227], v[128:131]
    v_swap_b32 v157, v151
    v_mfma_f32_16x16x32_bf16 v[132:135], a[92:95], v[228:231], v[132:135]
    v_swap_b32 v158, v155
    v_mfma_f32_16x16x32_bf16 v[136:139], a[92:95], v[232:235], v[136:139]
    v_mfma_f32_16x16x32_bf16 v[140:143], a[92:95], v[236:239], v[140:143]
    v_mfma_f32_16x16x32_bf16 v[16:19], a[96:99], v[144:147], v[16:19]
    buffer_load_dwordx4 v[224:227], v251, s[32:35], s69 offen offset:256 sc1
    v_mfma_f32_16x16x32_bf16 v[20:23], a[96:99], v[148:151], v[20:23]
    buffer_load_dwordx4 v[228:231], v251, s[32:35], s69 offen offset:2304 sc1
    v_mfma_f32_16x16x32_bf16 v[24:27], a[96:99], v[152:155], v[24:27]
    buffer_load_dwordx4 v[232:235], v12, s[32:35], s69 offen offset:256 sc1
    v_mfma_f32_16x16x32_bf16 v[28:31], a[96:99], v[156:159], v[28:31]
    buffer_load_dwordx4 v[236:239], v12, s[32:35], s69 offen offset:2304 sc1
    v_mfma_f32_16x16x32_bf16 v[32:35], a[100:103], v[144:147], v[32:35]
    v_mfma_f32_16x16x32_bf16 v[36:39], a[100:103], v[148:151], v[36:39]
    s_waitcnt vmcnt(17)
    v_bitop3_b32 v9, v163, v167, v171 bitop3:0x80
    v_mfma_f32_16x16x32_bf16 v[40:43], a[100:103], v[152:155], v[40:43]
    s_waitcnt vmcnt(16)
    v_bitop3_b32 v9, v9, v175, 1 bitop3:0x80
    v_mfma_f32_16x16x32_bf16 v[44:47], a[100:103], v[156:159], v[44:47]
    v_cmp_eq_u32 vcc, 0, v9
    s_cbranch_vccnz L_slow_hr_7
L_back_hr_7:
    v_mfma_f32_16x16x32_bf16 v[48:51], a[104:107], v[144:147], v[48:51]
    v_swap_b32 v164, v161
    v_mfma_f32_16x16x32_bf16 v[52:55], a[104:107], v[148:151], v[52:55]
    v_swap_b32 v168, v162
    v_mfma_f32_16x16x32_bf16 v[56:59], a[104:107], v[152:155], v[56:59]
    v_swap_b32 v169, v166
    v_mfma_f32_16x16x32_bf16 v[60:63], a[104:107], v[156:159], v[60:63]
    v_swap_b32 v172, v163
    v_mfma_f32_16x16x32_bf16 v[64:67], a[108:111], v[144:147], v[64:67]
    v_swap_b32 v173, v167
    v_mfma_f32_16x16x32_bf16 v[68:71], a[108:111], v[148:151], v[68:71]
    v_swap_b32 v174, v171
    v_mfma_f32_16x16x32_bf16 v[72:75], a[108:111], v[152:155], v[72:75]
    v_mfma_f32_16x16x32_bf16 v[76:79], a[108:111], v[156:159], v[76:79]
    v_mfma_f32_16x16x32_bf16 v[80:83], a[112:115], v[160:163], v[80:83]
    buffer_load_dwordx4 v[144:147], v251, s[32:35], s70 offen offset:0 sc1
    v_mfma_f32_16x16x32_bf16 v[84:87], a[112:115], v[164:167], v[84:87]
    buffer_load_dwordx4 v[148:151], v251, s[32:35], s70 offen offset:2048 sc1
    v_mfma_f32_16x16x32_bf16 v[88:91], a[112:115], v[168:171], v[88:91]
    buffer_load_dwordx4 v[152:155], v12, s[32:35], s70 offen offset:0 sc1
    v_mfma_f32_16x16x32_bf16 v[92:95], a[112:115], v[172:175], v[92:95]
    buffer_load_dwordx4 v[156:159], v12, s[32:35], s70 offen offset:2048 sc1
    v_mfma_f32_16x16x32_bf16 v[96:99], a[116:119], v[160:163], v[96:99]
    v_mfma_f32_16x16x32_bf16 v[100:103], a[116:119], v[164:167], v[100:103]
    s_waitcnt vmcnt(17)
    v_bitop3_b32 v9, v179, v183, v187 bitop3:0x80
    v_mfma_f32_16x16x32_bf16 v[104:107], a[116:119], v[168:171], v[104:107]
    s_waitcnt vmcnt(16)
    v_bitop3_b32 v9, v9, v191, 1 bitop3:0x80
    v_mfma_f32_16x16x32_bf16 v[108:111], a[116:119], v[172:175], v[108:111]
    v_cmp_eq_u32 vcc, 0, v9
    s_cbranch_vccnz L_slow_hr_8
L_back_hr_8:
    v_mfma_f32_16x16x32_bf16 v[112:115], a[120:123], v[160:163], v[112:115]
    v_swap_b32 v180, v177
    v_mfma_f32_16x16x32_bf16 v[116:119], a[120:123], v[164:167], v[116:119]
    v_swap_b32 v184, v178
    v_mfma_f32_16x16x32_bf16 v[120:123], a[120:123], v[168:171], v[120:123]
    v_swap_b32 v185, v182
    v_mfma_f32_16x16x32_bf16 v[124:127], a[120:123], v[172:175], v[124:127]
    v_swap_b32 v188, v179
    v_mfma_f32_16x16x32_bf16 v[128:131], a[124:127], v[160:163], v[128:131]
    v_swap_b32 v189, v183
    v_mfma_f32_16x16x32_bf16 v[132:135], a[124:127], v[164:167], v[132:135]
    v_swap_b32 v190, v187
    v_mfma_f32_16x16x32_bf16 v[136:139], a[124:127], v[168:171], v[136:139]
    v_mfma_f32_16x16x32_bf16 v[140:143], a[124:127], v[172:175], v[140:143]
    v_mfma_f32_16x16x32_bf16 v[16:19], a[128:131], v[176:179], v[16:19]
    buffer_load_dwordx4 v[160:163], v251, s[32:35], s70 offen offset:256 sc1
    v_mfma_f32_16x16x32_bf16 v[20:23], a[128:131], v[180:183], v[20:23]
    buffer_load_dwordx4 v[164:167], v251, s[32:35], s70 offen offset:2304 sc1
    v_mfma_f32_16x16x32_bf16 v[24:27], a[128:131], v[184:187], v[24:27]
    buffer_load_dwordx4 v[168:171], v12, s[32:35], s70 offen offset:256 sc1
    v_mfma_f32_16x16x32_bf16 v[28:31], a[128:131], v[188:191], v[28:31]
    buffer_load_dwordx4 v[172:175], v12, s[32:35], s70 offen offset:2304 sc1
    v_mfma_f32_16x16x32_bf16 v[32:35], a[132:135], v[176:179], v[32:35]
    v_mfma_f32_16x16x32_bf16 v[36:39], a[132:135], v[180:183], v[36:39]
    s_waitcnt vmcnt(17)
    v_bitop3_b32 v9, v195, v199, v203 bitop3:0x80
    v_mfma_f32_16x16x32_bf16 v[40:43], a[132:135], v[184:187], v[40:43]
    s_waitcnt vmcnt(16)
    v_bitop3_b32 v9, v9, v207, 1 bitop3:0x80
    v_mfma_f32_16x16x32_bf16 v[44:47], a[132:135], v[188:191], v[44:47]
    v_cmp_eq_u32 vcc, 0, v9
    s_cbranch_vccnz L_slow_hr_9
L_back_hr_9:
    v_mfma_f32_16x16x32_bf16 v[48:51], a[136:139], v[176:179], v[48:51]
    v_swap_b32 v196, v193
    v_mfma_f32_16x16x32_bf16 v[52:55], a[136:139], v[180:183], v[52:55]
    v_swap_b32 v200, v194
    v_mfma_f32_16x16x32_bf16 v[56:59], a[136:139], v[184:187], v[56:59]
    v_swap_b32 v201, v198
    v_mfma_f32_16x16x32_bf16 v[60:63], a[136:139], v[188:191], v[60:63]
    v_swap_b32 v204, v195
    v_mfma_f32_16x16x32_bf16 v[64:67], a[140:143], v[176:179], v[64:67]
    v_swap_b32 v205, v199
    v_mfma_f32_16x16x32_bf16 v[68:71], a[140:143], v[180:183], v[68:71]
    v_swap_b32 v206, v203
    v_mfma_f32_16x16x32_bf16 v[72:75], a[140:143], v[184:187], v[72:75]
    v_mfma_f32_16x16x32_bf16 v[76:79], a[140:143], v[188:191], v[76:79]
    v_mfma_f32_16x16x32_bf16 v[80:83], a[144:147], v[192:195], v[80:83]
    v_mfma_f32_16x16x32_bf16 v[84:87], a[144:147], v[196:199], v[84:87]
    v_mfma_f32_16x16x32_bf16 v[88:91], a[144:147], v[200:203], v[88:91]
    v_mfma_f32_16x16x32_bf16 v[92:95], a[144:147], v[204:207], v[92:95]
    v_mfma_f32_16x16x32_bf16 v[96:99], a[148:151], v[192:195], v[96:99]
    v_mfma_f32_16x16x32_bf16 v[100:103], a[148:151], v[196:199], v[100:103]
    s_waitcnt vmcnt(13)
    v_bitop3_b32 v9, v211, v215, v219 bitop3:0x80
    v_mfma_f32_16x16x32_bf16 v[104:107], a[148:151], v[200:203], v[104:107]
    s_waitcnt vmcnt(12)
    v_bitop3_b32 v9, v9, v223, 1 bitop3:0x80
    v_mfma_f32_16x16x32_bf16 v[108:111], a[148:151], v[204:207], v[108:111]
    v_cmp_eq_u32 vcc, 0, v9
    s_cbranch_vccnz L_slow_hr_10
L_back_hr_10:
    v_mfma_f32_16x16x32_bf16 v[112:115], a[152:155], v[192:195], v[112:115]
    v_swap_b32 v212, v209
    v_mfma_f32_16x16x32_bf16 v[116:119], a[152:155], v[196:199], v[116:119]
    v_swap_b32 v216, v210
    v_mfma_f32_16x16x32_bf16 v[120:123], a[152:155], v[200:203], v[120:123]
    v_swap_b32 v217, v214
    v_mfma_f32_16x16x32_bf16 v[124:127], a[152:155], v[204:207], v[124:127]
    v_swap_b32 v220, v211
    v_mfma_f32_16x16x32_bf16 v[128:131], a[156:159], v[192:195], v[128:131]
    v_swap_b32 v221, v215
    v_mfma_f32_16x16x32_bf16 v[132:135], a[156:159], v[196:199], v[132:135]
    v_swap_b32 v222, v219
    v_mfma_f32_16x16x32_bf16 v[136:139], a[156:159], v[200:203], v[136:139]
    v_mfma_f32_16x16x32_bf16 v[140:143], a[156:159], v[204:207], v[140:143]
    v_mfma_f32_16x16x32_bf16 v[16:19], a[160:163], v[208:211], v[16:19]
    v_mfma_f32_16x16x32_bf16 v[20:23], a[160:163], v[212:215], v[20:23]
    v_mfma_f32_16x16x32_bf16 v[24:27], a[160:163], v[216:219], v[24:27]
    v_mfma_f32_16x16x32_bf16 v[28:31], a[160:163], v[220:223], v[28:31]
    v_mfma_f32_16x16x32_bf16 v[32:35], a[164:167], v[208:211], v[32:35]
    v_mfma_f32_16x16x32_bf16 v[36:39], a[164:167], v[212:215], v[36:39]
    s_waitcnt vmcnt(9)
    v_bitop3_b32 v9, v227, v231, v235 bitop3:0x80
    v_mfma_f32_16x16x32_bf16 v[40:43], a[164:167], v[216:219], v[40:43]
    s_waitcnt vmcnt(8)
    v_bitop3_b32 v9, v9, v239, 1 bitop3:0x80
    v_mfma_f32_16x16x32_bf16 v[44:47], a[164:167], v[220:223], v[44:47]
    v_cmp_eq_u32 vcc, 0, v9
    s_cbranch_vccnz L_slow_hr_11
L_back_hr_11:
    v_mfma_f32_16x16x32_bf16 v[48:51], a[168:171], v[208:211], v[48:51]
    v_swap_b32 v228, v225
    v_mfma_f32_16x16x32_bf16 v[52:55], a[168:171], v[212:215], v[52:55]
    v_swap_b32 v232, v226
    v_mfma_f32_16x16x32_bf16 v[56:59], a[168:171], v[216:219], v[56:59]
    v_swap_b32 v233, v230
    v_mfma_f32_16x16x32_bf16 v[60:63], a[168:171], v[220:223], v[60:63]
    v_swap_b32 v236, v227
    v_mfma_f32_16x16x32_bf16 v[64:67], a[172:175], v[208:211], v[64:67]
    v_swap_b32 v237, v231
    v_mfma_f32_16x16x32_bf16 v[68:71], a[172:175], v[212:215], v[68:71]
    v_swap_b32 v238, v235
    v_mfma_f32_16x16x32_bf16 v[72:75], a[172:175], v[216:219], v[72:75]
    v_mfma_f32_16x16x32_bf16 v[76:79], a[172:175], v[220:223], v[76:79]
    v_mfma_f32_16x16x32_bf16 v[80:83], a[176:179], v[224:227], v[80:83]
    v_mfma_f32_16x16x32_bf16 v[84:87], a[176:179], v[228:231], v[84:87]
    v_mfma_f32_16x16x32_bf16 v[88:91], a[176:179], v[232:235], v[88:91]
    v_mfma_f32_16x16x32_bf16 v[92:95], a[176:179], v[236:239], v[92:95]
    v_mfma_f32_16x16x32_bf16 v[96:99], a[180:183], v[224:227], v[96:99]
    v_mfma_f32_16x16x32_bf16 v[100:103], a[180:183], v[228:231], v[100:103]
    s_waitcnt vmcnt(5)
    v_bitop3_b32 v9, v147, v151, v155 bitop3:0x80
    v_mfma_f32_16x16x32_bf16 v[104:107], a[180:183], v[232:235], v[104:107]
    s_waitcnt vmcnt(4)
    v_bitop3_b32 v9, v9, v159, 1 bitop3:0x80
    v_mfma_f32_16x16x32_bf16 v[108:111], a[180:183], v[236:239], v[108:111]
    v_cmp_eq_u32 vcc, 0, v9
    s_cbranch_vccnz L_slow_hr_12
L_back_hr_12:
    v_mfma_f32_16x16x32_bf16 v[112:115], a[184:187], v[224:227], v[112:115]
    v_swap_b32 v148, v145
    v_mfma_f32_16x16x32_bf16 v[116:119], a[184:187], v[228:231], v[116:119]
    v_swap_b32 v152, v146
    v_mfma_f32_16x16x32_bf16 v[120:123], a[184:187], v[232:235], v[120:123]
    v_swap_b32 v153, v150
    v_mfma_f32_16x16x32_bf16 v[124:127], a[184:187], v[236:239], v[124:127]
    v_swap_b32 v156, v147
    v_mfma_f32_16x16x32_bf16 v[128:131], a[188:191], v[224:227], v[128:131]
    v_swap_b32 v157, v151
    v_mfma_f32_16x16x32_bf16 v[132:135], a[188:191], v[228:231], v[132:135]
    v_swap_b32 v158, v155
    v_mfma_f32_16x16x32_bf16 v[136:139], a[188:191], v[232:235], v[136:139]
    v_mfma_f32_16x16x32_bf16 v[140:143], a[188:191], v[236:239], v[140:143]
    v_mfma_f32_16x16x32_bf16 v[16:19], a[192:195], v[144:147], v[16:19]
    v_mfma_f32_16x16x32_bf16 v[20:23], a[192:195], v[148:151], v[20:23]
    v_mfma_f32_16x16x32_bf16 v[24:27], a[192:195], v[152:155], v[24:27]
    v_mfma_f32_16x16x32_bf16 v[28:31], a[192:195], v[156:159], v[28:31]
    v_mfma_f32_16x16x32_bf16 v[32:35], a[196:199], v[144:147], v[32:35]
    v_mfma_f32_16x16x32_bf16 v[36:39], a[196:199], v[148:151], v[36:39]
    s_waitcnt vmcnt(1)
    v_bitop3_b32 v9, v163, v167, v171 bitop3:0x80
    v_mfma_f32_16x16x32_bf16 v[40:43], a[196:199], v[152:155], v[40:43]
    s_waitcnt vmcnt(0)
    v_bitop3_b32 v9, v9, v175, 1 bitop3:0x80
    v_mfma_f32_16x16x32_bf16 v[44:47], a[196:199], v[156:159], v[44:47]
    v_cmp_eq_u32 vcc, 0, v9
    s_cbranch_vccnz L_slow_hr_13
L_back_hr_13:
    v_mfma_f32_16x16x32_bf16 v[48:51], a[200:203], v[144:147], v[48:51]
    v_swap_b32 v164, v161
    v_mfma_f32_16x16x32_bf16 v[52:55], a[200:203], v[148:151], v[52:55]
    v_swap_b32 v168, v162
    v_mfma_f32_16x16x32_bf16 v[56:59], a[200:203], v[152:155], v[56:59]
    v_swap_b32 v169, v166
    v_mfma_f32_16x16x32_bf16 v[60:63], a[200:203], v[156:159], v[60:63]
    v_swap_b32 v172, v163
    v_mfma_f32_16x16x32_bf16 v[64:67], a[204:207], v[144:147], v[64:67]
    v_swap_b32 v173, v167
    v_mfma_f32_16x16x32_bf16 v[68:71], a[204:207], v[148:151], v[68:71]
    v_swap_b32 v174, v171
    v_mfma_f32_16x16x32_bf16 v[72:75], a[204:207], v[152:155], v[72:75]
    v_mfma_f32_16x16x32_bf16 v[76:79], a[204:207], v[156:159], v[76:79]
    v_mfma_f32_16x16x32_bf16 v[80:83], a[208:211], v[160:163], v[80:83]
    v_mfma_f32_16x16x32_bf16 v[84:87], a[208:211], v[164:167], v[84:87]
    v_mfma_f32_16x16x32_bf16 v[88:91], a[208:211], v[168:171], v[88:91]
    v_mfma_f32_16x16x32_bf16 v[92:95], a[208:211], v[172:175], v[92:95]
    v_mfma_f32_16x16x32_bf16 v[96:99], a[212:215], v[160:163], v[96:99]
    v_mfma_f32_16x16x32_bf16 v[100:103], a[212:215], v[164:167], v[100:103]
    v_mfma_f32_16x16x32_bf16 v[104:107], a[212:215], v[168:171], v[104:107]
    v_mfma_f32_16x16x32_bf16 v[108:111], a[212:215], v[172:175], v[108:111]
    v_mfma_f32_16x16x32_bf16 v[112:115], a[216:219], v[160:163], v[112:115]
    v_mfma_f32_16x16x32_bf16 v[116:119], a[216:219], v[164:167], v[116:119]
    v_mfma_f32_16x16x32_bf16 v[120:123], a[216:219], v[168:171], v[120:123]
    v_mfma_f32_16x16x32_bf16 v[124:127], a[216:219], v[172:175], v[124:127]
    v_mfma_f32_16x16x32_bf16 v[128:131], a[220:223], v[160:163], v[128:131]
    v_mfma_f32_16x16x32_bf16 v[132:135], a[220:223], v[164:167], v[132:135]
    v_mfma_f32_16x16x32_bf16 v[136:139], a[220:223], v[168:171], v[136:139]
    v_mfma_f32_16x16x32_bf16 v[140:143], a[220:223], v[172:175], v[140:143]
    s_cmp_eq_u32 s26, 3
    s_cselect_b32 exec_hi, 0, -1
    v_pk_add_f32 v[144:145], v[16:17], v[80:81]
    v_pk_add_f32 v[146:147], v[18:19], v[82:83]
    v_pk_add_f32 v[16:17], v[16:17], v[80:81] neg_lo:[0,1] neg_hi:[0,1]
    v_pk_add_f32 v[18:19], v[18:19], v[82:83] neg_lo:[0,1] neg_hi:[0,1]
    buffer_store_dwordx4 v[144:147], v2, s[28:31], s72 offen offset:0 sc1
    buffer_store_dwordx4 v[16:19], v13, s[28:31], s72 offen offset:0 sc1
    v_pk_add_f32 v[148:149], v[20:21], v[84:85]
    v_pk_add_f32 v[150:151], v[22:23], v[86:87]
    v_pk_add_f32 v[20:21], v[20:21], v[84:85] neg_lo:[0,1] neg_hi:[0,1]
    v_pk_add_f32 v[22:23], v[22:23], v[86:87] neg_lo:[0,1] neg_hi:[0,1]
    buffer_store_dwordx4 v[148:151], v2, s[28:31], s73 offen offset:0 sc1
    buffer_store_dwordx4 v[20:23], v13, s[28:31], s73 offen offset:0 sc1
    v_pk_add_f32 v[152:153], v[24:25], v[88:89]
    v_pk_add_f32 v[154:155], v[26:27], v[90:91]
    v_pk_add_f32 v[24:25], v[24:25], v[88:89] neg_lo:[0,1] neg_hi:[0,1]
    v_pk_add_f32 v[26:27], v[26:27], v[90:91] neg_lo:[0,1] neg_hi:[0,1]
    buffer_store_dwordx4 v[152:155], v2, s[28:31], s74 offen offset:0 sc1
    buffer_store_dwordx4 v[24:27], v13, s[28:31], s74 offen offset:0 sc1
    v_pk_add_f32 v[156:157], v[28:29], v[92:93]
    v_pk_add_f32 v[158:159], v[30:31], v[94:95]
    v_pk_add_f32 v[28:29], v[28:29], v[92:93] neg_lo:[0,1] neg_hi:[0,1]
    v_pk_add_f32 v[30:31], v[30:31], v[94:95] neg_lo:[0,1] neg_hi:[0,1]
    buffer_store_dwordx4 v[156:159], v2, s[28:31], s75 offen offset:0 sc1
    buffer_store_dwordx4 v[28:31], v13, s[28:31], s75 offen offset:0 sc1
    v_pk_add_f32 v[160:161], v[32:33], v[96:97]
    v_pk_add_f32 v[162:163], v[34:35], v[98:99]
    v_pk_add_f32 v[32:33], v[32:33], v[96:97] neg_lo:[0,1] neg_hi:[0,1]
    v_pk_add_f32 v[34:35], v[34:35], v[98:99] neg_lo:[0,1] neg_hi:[0,1]
    buffer_store_dwordx4 v[160:163], v2, s[28:31], s72 offen offset:1024 sc1
    buffer_store_dwordx4 v[32:35], v13, s[28:31], s72 offen offset:1024 sc1
    v_pk_add_f32 v[164:165], v[36:37], v[100:101]
    v_pk_add_f32 v[166:167], v[38:39], v[102:103]
    v_pk_add_f32 v[36:37], v[36:37], v[100:101] neg_lo:[0,1] neg_hi:[0,1]
    v_pk_add_f32 v[38:39], v[38:39], v[102:103] neg_lo:[0,1] neg_hi:[0,1]
    buffer_store_dwordx4 v[164:167], v2, s[28:31], s73 offen offset:1024 sc1
    buffer_store_dwordx4 v[36:39], v13, s[28:31], s73 offen offset:1024 sc1
    v_pk_add_f32 v[168:169], v[40:41], v[104:105]
    v_pk_add_f32 v[170:171], v[42:43], v[106:107]
    v_pk_add_f32 v[40:41], v[40:41], v[104:105] neg_lo:[0,1] neg_hi:[0,1]
    v_pk_add_f32 v[42:43], v[42:43], v[106:107] neg_lo:[0,1] neg_hi:[0,1]
    buffer_store_dwordx4 v[168:171], v2, s[28:31], s74 offen offset:1024 sc1
    buffer_store_dwordx4 v[40:43], v13, s[28:31], s74 offen offset:1024 sc1
    v_pk_add_f32 v[172:173], v[44:45], v[108:109]
    v_pk_add_f32 v[174:175], v[46:47], v[110:111]
    v_pk_add_f32 v[44:45], v[44:45], v[108:109] neg_lo:[0,1] neg_hi:[0,1]
    v_pk_add_f32 v[46:47], v[46:47], v[110:111] neg_lo:[0,1] neg_hi:[0,1]
    buffer_store_dwordx4 v[172:175], v2, s[28:31], s75 offen offset:1024 sc1
    buffer_store_dwordx4 v[44:47], v13, s[28:31], s75 offen offset:1024 sc1
    v_pk_add_f32 v[176:177], v[48:49], v[112:113]
    v_pk_add_f32 v[178:179], v[50:51], v[114:115]
    v_pk_add_f32 v[48:49], v[48:49], v[112:113] neg_lo:[0,1] neg_hi:[0,1]
    v_pk_add_f32 v[50:51], v[50:51], v[114:115] neg_lo:[0,1] neg_hi:[0,1]
    buffer_store_dwordx4 v[176:179], v2, s[28:31], s72 offen offset:2048 sc1
    buffer_store_dwordx4 v[48:51], v13, s[28:31], s72 offen offset:2048 sc1
    v_pk_add_f32 v[180:181], v[52:53], v[116:117]
    v_pk_add_f32 v[182:183], v[54:55], v[118:119]
    v_pk_add_f32 v[52:53], v[52:53], v[116:117] neg_lo:[0,1] neg_hi:[0,1]
    v_pk_add_f32 v[54:55], v[54:55], v[118:119] neg_lo:[0,1] neg_hi:[0,1]
    buffer_store_dwordx4 v[180:183], v2, s[28:31], s73 offen offset:2048 sc1
    buffer_store_dwordx4 v[52:55], v13, s[28:31], s73 offen offset:2048 sc1
    v_pk_add_f32 v[184:185], v[56:57], v[120:121]
    v_pk_add_f32 v[186:187], v[58:59], v[122:123]
    v_pk_add_f32 v[56:57], v[56:57], v[120:121] neg_lo:[0,1] neg_hi:[0,1]
    v_pk_add_f32 v[58:59], v[58:59], v[122:123] neg_lo:[0,1] neg_hi:[0,1]
    buffer_store_dwordx4 v[184:187], v2, s[28:31], s74 offen offset:2048 sc1
    buffer_store_dwordx4 v[56:59], v13, s[28:31], s74 offen offset:2048 sc1
    v_pk_add_f32 v[188:189], v[60:61], v[124:125]
    v_pk_add_f32 v[190:191], v[62:63], v[126:127]
    v_pk_add_f32 v[60:61], v[60:61], v[124:125] neg_lo:[0,1] neg_hi:[0,1]
    v_pk_add_f32 v[62:63], v[62:63], v[126:127] neg_lo:[0,1] neg_hi:[0,1]
    buffer_store_dwordx4 v[188:191], v2, s[28:31], s75 offen offset:2048 sc1
    buffer_store_dwordx4 v[60:63], v13, s[28:31], s75 offen offset:2048 sc1
    v_pk_add_f32 v[192:193], v[64:65], v[128:129]
    v_pk_add_f32 v[194:195], v[66:67], v[130:131]
    v_pk_add_f32 v[64:65], v[64:65], v[128:129] neg_lo:[0,1] neg_hi:[0,1]
    v_pk_add_f32 v[66:67], v[66:67], v[130:131] neg_lo:[0,1] neg_hi:[0,1]
    buffer_store_dwordx4 v[192:195], v2, s[28:31], s72 offen offset:3072 sc1
    buffer_store_dwordx4 v[64:67], v13, s[28:31], s72 offen offset:3072 sc1
    v_pk_add_f32 v[196:197], v[68:69], v[132:133]
    v_pk_add_f32 v[198:199], v[70:71], v[134:135]
    v_pk_add_f32 v[68:69], v[68:69], v[132:133] neg_lo:[0,1] neg_hi:[0,1]
    v_pk_add_f32 v[70:71], v[70:71], v[134:135] neg_lo:[0,1] neg_hi:[0,1]
    buffer_store_dwordx4 v[196:199], v2, s[28:31], s73 offen offset:3072 sc1
    buffer_store_dwordx4 v[68:71], v13, s[28:31], s73 offen offset:3072 sc1
    v_pk_add_f32 v[200:201], v[72:73], v[136:137]
    v_pk_add_f32 v[202:203], v[74:75], v[138:139]
    v_pk_add_f32 v[72:73], v[72:73], v[136:137] neg_lo:[0,1] neg_hi:[0,1]
    v_pk_add_f32 v[74:75], v[74:75], v[138:139] neg_lo:[0,1] neg_hi:[0,1]
    buffer_store_dwordx4 v[200:203], v2, s[28:31], s74 offen offset:3072 sc1
    buffer_store_dwordx4 v[72:75], v13, s[28:31], s74 offen offset:3072 sc1
    v_pk_add_f32 v[204:205], v[76:77], v[140:141]
    v_pk_add_f32 v[206:207], v[78:79], v[142:143]
    v_pk_add_f32 v[76:77], v[76:77], v[140:141] neg_lo:[0,1] neg_hi:[0,1]
    v_pk_add_f32 v[78:79], v[78:79], v[142:143] neg_lo:[0,1] neg_hi:[0,1]
    buffer_store_dwordx4 v[204:207], v2, s[28:31], s75 offen offset:3072 sc1
    buffer_store_dwordx4 v[76:79], v13, s[28:31], s75 offen offset:3072 sc1
L_end:
    s_endpgm
L_slow_tgw:
    s_sub_u32 s27, s27, 1
    s_cbranch_scc1 L_give_tgw
    s_sleep 1
    s_sleep 2
    buffer_load_dwordx2 v[12:13], off, s[32:35], 0 sc1
    s_waitcnt vmcnt(0)
    v_cmp_eq_u32 vcc, 0, v12
    s_cbranch_vccnz L_slow_tgw
    s_branch L_back_tgw
L_give_tgw:
    s_mov_b32 s27, 0
    s_waitcnt vmcnt(0)
    s_branch L_back_tgw
L_slow_c1x:
    s_sub_u32 s27, s27, 1
    s_cbranch_scc1 L_give_c1x
    s_sleep 1
    buffer_load_dwordx4 v[176:179], v248, s[28:31], s54 offen sc1
    buffer_load_dwordx4 v[180:183], v248, s[28:31], s89 offen sc1
    buffer_load_dwordx4 v[184:187], v249, s[28:31], s54 offen sc1
    buffer_load_dwordx4 v[188:191], v249, s[28:31], s89 offen sc1
    s_waitcnt vmcnt(3)
    v_cmp_ne_u32 vcc, s12, v179
    v_lshlrev_b32 v24, 16, v178
    v_and_b32 v25, 0xffff0000, v178
    v_lshlrev_b32 v72, 16, v176
    v_lshlrev_b32 v73, 16, v177
    v_and_b32 v88, s57, v176
    v_and_b32 v89, s57, v177
    s_waitcnt vmcnt(2)
    v_cmp_ne_u32 s[98:99], s12, v183
    v_lshlrev_b32 v26, 16, v182
    v_and_b32 v27, 0xffff0000, v182
    v_lshlrev_b32 v74, 16, v180
    v_lshlrev_b32 v75, 16, v181
    v_and_b32 v90, s57, v180
    v_and_b32 v91, s57, v181
    s_or_b64 vcc, vcc, s[98:99]
    s_waitcnt vmcnt(1)
    v_cmp_ne_u32 s[98:99], s12, v187
    v_lshlrev_b32 v28, 16, v186
    v_and_b32 v29, 0xffff0000, v186
    v_lshlrev_b32 v76, 16, v184
    v_lshlrev_b32 v77, 16, v185
    v_and_b32 v92, s57, v184
    v_and_b32 v93, s57, v185
    s_or_b64 vcc, vcc, s[98:99]
    s_waitcnt vmcnt(0)
    v_cmp_ne_u32 s[98:99], s12, v191
    v_lshlrev_b32 v30, 16, v190
    v_and_b32 v31, 0xffff0000, v190
    s_or_b64 vcc, vcc, s[98:99]
    s_cbranch_scc1 L_slow_c1x
    s_branch L_back_c1x
L_give_c1x:
    s_mov_b32 s27, 0
    s_waitcnt vmcnt(0)
    s_branch L_back_c1x
L_slow_arr:
    s_sub_u32 s27, s27, 1
    s_cbranch_scc1 L_give_arr
    s_sleep 1
    s_sleep 2
    buffer_load_dwordx2 v[252:253], v254, s[28:31], s78 offen sc1
    s_waitcnt vmcnt(0)
    v_cmp_ne_u64 vcc, s[12:13], v[252:253]
    s_cbranch_vccnz L_slow_arr
    s_branch L_back_arr
L_give_arr:
    s_mov_b32 s27, 0
    s_waitcnt vmcnt(0)
    s_branch L_back_arr
L_slow_f1:
    s_sub_u32 s27, s27, 1
    s_cbranch_scc1 L_give_f1
    s_sleep 1
    s_sleep 2
    buffer_load_dwordx2 v[252:253], v175, s[28:31], 0 offen sc1
    s_waitcnt vmcnt(0)
    v_cmp_ne_u64 vcc, s[12:13], v[252:253]
    s_cbranch_vccnz L_slow_f1
    s_branch L_back_f1
L_give_f1:
    s_mov_b32 s27, 0
    s_waitcnt vmcnt(0)
    s_branch L_back_f1
L_slow_g1a_0:
    s_sub_u32 s27, s27, 1
    s_cbranch_scc1 L_give_g1a_0
    s_sleep 1
    buffer_load_dwordx4 v[80:83], v251, s[32:35], s64 offen offset:0 sc1
    buffer_load_dwordx4 v[84:87], v251, s[32:35], s64 offen offset:256 sc1
    buffer_load_dwordx4 v[88:91], v251, s[32:35], s64 offen offset:2048 sc1
    buffer_load_dwordx4 v[92:95], v251, s[32:35], s64 offen offset:2304 sc1
    buffer_load_dwordx4 v[96:99], v251, s[32:35], s65 offen offset:0 sc1
    buffer_load_dwordx4 v[100:103], v251, s[32:35], s65 offen offset:256 sc1
    buffer_load_dwordx4 v[104:107], v251, s[32:35], s65 offen offset:2048 sc1
    buffer_load_dwordx4 v[108:111], v251, s[32:35], s65 offen offset:2304 sc1
    buffer_load_dwordx4 v[112:115], v251, s[32:35], s66 offen offset:0 sc1
    buffer_load_dwordx4 v[116:119], v251, s[32:35], s66 offen offset:256 sc1
    buffer_load_dwordx4 v[120:123], v251, s[32:35], s66 offen offset:2048 sc1
    buffer_load_dwordx4 v[124:127], v251, s[32:35], s66 offen offset:2304 sc1
    s_waitcnt vmcnt(8)
    v_max3_u32 v9, v95, v87, v91
    v_max_u32 v9, v9, v83
    v_cmp_le_u32 vcc, 0xff800000, v9
    s_cbranch_vccnz L_slow_g1a_0
    s_waitcnt vmcnt(0)
    s_branch L_back_g1a_0
L_give_g1a_0:
    s_mov_b32 s27, 0
    s_waitcnt vmcnt(0)
    s_branch L_back_g1a_0
L_slow_g1a_1:
    s_sub_u32 s27, s27, 1
    s_cbranch_scc1 L_give_g1a_1
    s_sleep 1
    buffer_load_dwordx4 v[96:99], v251, s[32:35], s65 offen offset:0 sc1
    buffer_load_dwordx4 v[100:103], v251, s[32:35], s65 offen offset:256 sc1
    buffer_load_dwordx4 v[104:107], v251, s[32:35], s65 offen offset:2048 sc1
    buffer_load_dwordx4 v[108:111], v251, s[32:35], s65 offen offset:2304 sc1
    buffer_load_dwordx4 v[112:115], v251, s[32:35], s66 offen offset:0 sc1
    buffer_load_dwordx4 v[116:119], v251, s[32:35], s66 offen offset:256 sc1
    buffer_load_dwordx4 v[120:123], v251, s[32:35], s66 offen offset:2048 sc1
    buffer_load_dwordx4 v[124:127], v251, s[32:35], s66 offen offset:2304 sc1
    buffer_load_dwordx4 v[128:131], v251, s[32:35], s67 offen offset:0 sc1
    buffer_load_dwordx4 v[132:135], v251, s[32:35], s67 offen offset:256 sc1
    buffer_load_dwordx4 v[136:139], v251, s[32:35], s67 offen offset:2048 sc1
    buffer_load_dwordx4 v[140:143], v251, s[32:35], s67 offen offset:2304 sc1
    buffer_load_dwordx4 v[144:147], v251, s[32:35], s68 offen offset:0 sc1
    buffer_load_dwordx4 v[148:151], v251, s[32:35], s68 offen offset:256 sc1
    buffer_load_dwordx4 v[152:155], v251, s[32:35], s68 offen offset:2048 sc1
    buffer_load_dwordx4 v[156:159], v251, s[32:35], s68 offen offset:2304 sc1
    buffer_load_dwordx4 v[160:163], v251, s[32:35], s69 offen offset:0 sc1
    buffer_load_dwordx4 v[164:167], v251, s[32:35], s69 offen offset:256 sc1
    buffer_load_dwordx4 v[168:171], v251, s[32:35], s69 offen offset:2048 sc1
    buffer_load_dwordx4 v[172:175], v251, s[32:35], s69 offen offset:2304 sc1
    buffer_load_dwordx4 v[176:179], v251, s[32:35], s70 offen offset:0 sc1
    buffer_load_dwordx4 v[180:183], v251, s[32:35], s70 offen offset:256 sc1
    buffer_load_dwordx4 v[184:187], v251, s[32:35], s70 offen offset:2048 sc1
    buffer_load_dwordx4 v[188:191], v251, s[32:35], s70 offen offset:2304 sc1
    buffer_load_dwordx4 v[192:195], v251, s[32:35], s71 offen offset:0 sc1
    buffer_load_dwordx4 v[196:199], v251, s[32:35], s71 offen offset:256 sc1
    buffer_load_dwordx4 v[200:203], v251, s[32:35], s71 offen offset:2048 sc1
    buffer_load_dwordx4 v[204:207], v251, s[32:35], s71 offen offset:2304 sc1
    s_waitcnt vmcnt(24)
    v_max3_u32 v9, v111, v103, v107
    v_max_u32 v9, v9, v99
    v_cmp_le_u32 vcc, 0xff800000, v9
    s_cbranch_vccnz L_slow_g1a_1
    s_waitcnt vmcnt(16)
    s_branch L_back_g1a_1
L_give_g1a_1:
    s_mov_b32 s27, 0
    s_waitcnt vmcnt(0)
    s_branch L_back_g1a_1
L_slow_g1a_2:
    s_sub_u32 s27, s27, 1
    s_cbranch_scc1 L_give_g1a_2
    s_sleep 1
    buffer_load_dwordx4 v[112:115], v251, s[32:35], s66 offen offset:0 sc1
    buffer_load_dwordx4 v[116:119], v251, s[32:35], s66 offen offset:256 sc1
    buffer_load_dwordx4 v[120:123], v251, s[32:35], s66 offen offset:2048 sc1
    buffer_load_dwordx4 v[124:127], v251, s[32:35], s66 offen offset:2304 sc1
    buffer_load_dwordx4 v[128:131], v251, s[32:35], s67 offen offset:0 sc1
    buffer_load_dwordx4 v[132:135], v251, s[32:35], s67 offen offset:256 sc1
    buffer_load_dwordx4 v[136:139], v251, s[32:35], s67 offen offset:2048 sc1
    buffer_load_dwordx4 v[140:143], v251, s[32:35], s67 offen offset:2304 sc1
    buffer_load_dwordx4 v[144:147], v251, s[32:35], s68 offen offset:0 sc1
    buffer_load_dwordx4 v[148:151], v251, s[32:35], s68 offen offset:256 sc1
    buffer_load_dwordx4 v[152:155], v251, s[32:35], s68 offen offset:2048 sc1
    buffer_load_dwordx4 v[156:159], v251, s[32:35], s68 offen offset:2304 sc1
    buffer_load_dwordx4 v[160:163], v251, s[32:35], s69 offen offset:0 sc1
    buffer_load_dwordx4 v[164:167], v251, s[32:35], s69 offen offset:256 sc1
    buffer_load_dwordx4 v[168:171], v251, s[32:35], s69 offen offset:2048 sc1
    buffer_load_dwordx4 v[172:175], v251, s[32:35], s69 offen offset:2304 sc1
    buffer_load_dwordx4 v[176:179], v251, s[32:35], s70 offen offset:0 sc1
    buffer_load_dwordx4 v[180:183], v251, s[32:35], s70 offen offset:256 sc1
    buffer_load_dwordx4 v[184:187], v251, s[32:35], s70 offen offset:2048 sc1
    buffer_load_dwordx4 v[188:191], v251, s[32:35], s70 offen offset:2304 sc1
    buffer_load_dwordx4 v[192:195], v251, s[32:35], s71 offen offset:0 sc1
    buffer_load_dwordx4 v[196:199], v251, s[32:35], s71 offen offset:256 sc1
    buffer_load_dwordx4 v[200:203], v251, s[32:35], s71 offen offset:2048 sc1
    buffer_load_dwordx4 v[204:207], v251, s[32:35], s71 offen offset:2304 sc1
    buffer_load_dwordx4 v[80:83], v251, s[32:35], s72 offen offset:0 sc1
    buffer_load_dwordx4 v[84:87], v251, s[32:35], s72 offen offset:256 sc1
    buffer_load_dwordx4 v[88:91], v251, s[32:35], s72 offen offset:2048 sc1
    buffer_load_dwordx4 v[92:95], v251, s[32:35], s72 offen offset:2304 sc1
    s_waitcnt vmcnt(24)
    v_max3_u32 v9, v127, v119, v123
    v_max_u32 v9, v9, v115
    v_cmp_le_u32 vcc, 0xff800000, v9
    s_cbranch_vccnz L_slow_g1a_2
    s_waitcnt vmcnt(12)
    s_branch L_back_g1a_2
L_give_g1a_2:
    s_mov_b32 s27, 0
    s_waitcnt vmcnt(0)
    s_branch L_back_g1a_2
L_slow_g1a_3:
    s_sub_u32 s27, s27, 1
    s_cbranch_scc1 L_give_g1a_3
    s_sleep 1
    buffer_load_dwordx4 v[128:131], v251, s[32:35], s67 offen offset:0 sc1
    buffer_load_dwordx4 v[132:135], v251, s[32:35], s67 offen offset:256 sc1
    buffer_load_dwordx4 v[136:139], v251, s[32:35], s67 offen offset:2048 sc1
    buffer_load_dwordx4 v[140:143], v251, s[32:35], s67 offen offset:2304 sc1
    buffer_load_dwordx4 v[144:147], v251, s[32:35], s68 offen offset:0 sc1
    buffer_load_dwordx4 v[148:151], v251, s[32:35], s68 offen offset:256 sc1
    buffer_load_dwordx4 v[152:155], v251, s[32:35], s68 offen offset:2048 sc1
    buffer_load_dwordx4 v[156:159], v251, s[32:35], s68 offen offset:2304 sc1
    buffer_load_dwordx4 v[160:163], v251, s[32:35], s69 offen offset:0 sc1
    buffer_load_dwordx4 v[164:167], v251, s[32:35], s69 offen offset:256 sc1
    buffer_load_dwordx4 v[168:171], v251, s[32:35], s69 offen offset:2048 sc1
    buffer_load_dwordx4 v[172:175], v251, s[32:35], s69 offen offset:2304 sc1
    buffer_load_dwordx4 v[176:179], v251, s[32:35], s70 offen offset:0 sc1
    buffer_load_dwordx4 v[180:183], v251, s[32:35], s70 offen offset:256 sc1
    buffer_load_dwordx4 v[184:187], v251, s[32:35], s70 offen offset:2048 sc1
    buffer_load_dwordx4 v[188:191], v251, s[32:35], s70 offen offset:2304 sc1
    buffer_load_dwordx4 v[192:195], v251, s[32:35], s71 offen offset:0 sc1
    buffer_load_dwordx4 v[196:199], v251, s[32:35], s71 offen offset:256 sc1
    buffer_load_dwordx4 v[200:203], v251, s[32:35], s71 offen offset:2048 sc1
    buffer_load_dwordx4 v[204:207], v251, s[32:35], s71 offen offset:2304 sc1
    buffer_load_dwordx4 v[80:83], v251, s[32:35], s72 offen offset:0 sc1
    buffer_load_dwordx4 v[84:87], v251, s[32:35], s72 offen offset:256 sc1
    buffer_load_dwordx4 v[88:91], v251, s[32:35], s72 offen offset:2048 sc1
    buffer_load_dwordx4 v[92:95], v251, s[32:35], s72 offen offset:2304 sc1
    buffer_load_dwordx4 v[96:99], v251, s[32:35], s73 offen offset:0 sc1
    buffer_load_dwordx4 v[100:103], v251, s[32:35], s73 offen offset:256 sc1
    buffer_load_dwordx4 v[104:107], v251, s[32:35], s73 offen offset:2048 sc1
    buffer_load_dwordx4 v[108:111], v251, s[32:35], s73 offen offset:2304 sc1
    s_waitcnt vmcnt(24)
    v_max3_u32 v9, v143, v135, v139
    v_max_u32 v9, v9, v131
    v_cmp_le_u32 vcc, 0xff800000, v9
    s_cbranch_vccnz L_slow_g1a_3
    s_waitcnt vmcnt(8)
    s_branch L_back_g1a_3
L_give_g1a_3:
    s_mov_b32 s27, 0
    s_waitcnt vmcnt(0)
    s_branch L_back_g1a_3
L_slow_g1a_4:
    s_sub_u32 s27, s27, 1
    s_cbranch_scc1 L_give_g1a_4
    s_sleep 1
    buffer_load_dwordx4 v[144:147], v251, s[32:35], s68 offen offset:0 sc1
    buffer_load_dwordx4 v[148:151], v251, s[32:35], s68 offen offset:256 sc1
    buffer_load_dwordx4 v[152:155], v251, s[32:35], s68 offen offset:2048 sc1
    buffer_load_dwordx4 v[156:159], v251, s[32:35], s68 offen offset:2304 sc1
    buffer_load_dwordx4 v[160:163], v251, s[32:35], s69 offen offset:0 sc1
    buffer_load_dwordx4 v[164:167], v251, s[32:35], s69 offen offset:256 sc1
    buffer_load_dwordx4 v[168:171], v251, s[32:35], s69 offen offset:2048 sc1
    buffer_load_dwordx4 v[172:175], v251, s[32:35], s69 offen offset:2304 sc1
    buffer_load_dwordx4 v[176:179], v251, s[32:35], s70 offen offset:0 sc1
    buffer_load_dwordx4 v[180:183], v251, s[32:35], s70 offen offset:256 sc1
    buffer_load_dwordx4 v[184:187], v251, s[32:35], s70 offen offset:2048 sc1
    buffer_load_dwordx4 v[188:191], v251, s[32:35], s70 offen offset:2304 sc1
    buffer_load_dwordx4 v[192:195], v251, s[32:35], s71 offen offset:0 sc1
    buffer_load_dwordx4 v[196:199], v251, s[32:35], s71 offen offset:256 sc1
    buffer_load_dwordx4 v[200:203], v251, s[32:35], s71 offen offset:2048 sc1
    buffer_load_dwordx4 v[204:207], v251, s[32:35], s71 offen offset:2304 sc1
    buffer_load_dwordx4 v[80:83], v251, s[32:35], s72 offen offset:0 sc1
    buffer_load_dwordx4 v[84:87], v251, s[32:35], s72 offen offset:256 sc1
    buffer_load_dwordx4 v[88:91], v251, s[32:35], s72 offen offset:2048 sc1
    buffer_load_dwordx4 v[92:95], v251, s[32:35], s72 offen offset:2304 sc1
    buffer_load_dwordx4 v[96:99], v251, s[32:35], s73 offen offset:0 sc1
    buffer_load_dwordx4 v[100:103], v251, s[32:35], s73 offen offset:256 sc1
    buffer_load_dwordx4 v[104:107], v251, s[32:35], s73 offen offset:2048 sc1
    buffer_load_dwordx4 v[108:111], v251, s[32:35], s73 offen offset:2304 sc1
    buffer_load_dwordx4 v[112:115], v251, s[32:35], s74 offen offset:0 sc1
    buffer_load_dwordx4 v[116:119], v251, s[32:35], s74 offen offset:256 sc1
    buffer_load_dwordx4 v[120:123], v251, s[32:35], s74 offen offset:2048 sc1
    buffer_load_dwordx4 v[124:127], v251, s[32:35], s74 offen offset:2304 sc1
    s_waitcnt vmcnt(24)
    v_max3_u32 v9, v159, v151, v155
    v_max_u32 v9, v9, v147
    v_cmp_le_u32 vcc, 0xff800000, v9
    s_cbranch_vccnz L_slow_g1a_4
    s_waitcnt vmcnt(4)
    s_branch L_back_g1a_4
L_give_g1a_4:
    s_mov_b32 s27, 0
    s_waitcnt vmcnt(0)
    s_branch L_back_g1a_4
L_slow_g1a_5:
    s_sub_u32 s27, s27, 1
    s_cbranch_scc1 L_give_g1a_5
    s_sleep 1
    buffer_load_dwordx4 v[160:163], v251, s[32:35], s69 offen offset:0 sc1
    buffer_load_dwordx4 v[164:167], v251, s[32:35], s69 offen offset:256 sc1
    buffer_load_dwordx4 v[168:171], v251, s[32:35], s69 offen offset:2048 sc1
    buffer_load_dwordx4 v[172:175], v251, s[32:35], s69 offen offset:2304 sc1
    buffer_load_dwordx4 v[176:179], v251, s[32:35], s70 offen offset:0 sc1
    buffer_load_dwordx4 v[180:183], v251, s[32:35], s70 offen offset:256 sc1
    buffer_load_dwordx4 v[184:187], v251, s[32:35], s70 offen offset:2048 sc1
    buffer_load_dwordx4 v[188:191], v251, s[32:35], s70 offen offset:2304 sc1
    buffer_load_dwordx4 v[192:195], v251, s[32:35], s71 offen offset:0 sc1
    buffer_load_dwordx4 v[196:199], v251, s[32:35], s71 offen offset:256 sc1
    buffer_load_dwordx4 v[200:203], v251, s[32:35], s71 offen offset:2048 sc1
    buffer_load_dwordx4 v[204:207], v251, s[32:35], s71 offen offset:2304 sc1
    buffer_load_dwordx4 v[80:83], v251, s[32:35], s72 offen offset:0 sc1
    buffer_load_dwordx4 v[84:87], v251, s[32:35], s72 offen offset:256 sc1
    buffer_load_dwordx4 v[88:91], v251, s[32:35], s72 offen offset:2048 sc1
    buffer_load_dwordx4 v[92:95], v251, s[32:35], s72 offen offset:2304 sc1
    buffer_load_dwordx4 v[96:99], v251, s[32:35], s73 offen offset:0 sc1
    buffer_load_dwordx4 v[100:103], v251, s[32:35], s73 offen offset:256 sc1
    buffer_load_dwordx4 v[104:107], v251, s[32:35], s73 offen offset:2048 sc1
    buffer_load_dwordx4 v[108:111], v251, s[32:35], s73 offen offset:2304 sc1
    buffer_load_dwordx4 v[112:115], v251, s[32:35], s74 offen offset:0 sc1
    buffer_load_dwordx4 v[116:119], v251, s[32:35], s74 offen offset:256 sc1
    buffer_load_dwordx4 v[120:123], v251, s[32:35], s74 offen offset:2048 sc1
    buffer_load_dwordx4 v[124:127], v251, s[32:35], s74 offen offset:2304 sc1
    buffer_load_dwordx4 v[128:131], v251, s[32:35], s75 offen offset:0 sc1
    buffer_load_dwordx4 v[132:135], v251, s[32:35], s75 offen offset:256 sc1
    buffer_load_dwordx4 v[136:139], v251, s[32:35], s75 offen offset:2048 sc1
    buffer_load_dwordx4 v[140:143], v251, s[32:35], s75 offen offset:2304 sc1
    s_waitcnt vmcnt(24)
    v_max3_u32 v9, v175, v167, v171
    v_max_u32 v9, v9, v163
    v_cmp_le_u32 vcc, 0xff800000, v9
    s_cbranch_vccnz L_slow_g1a_5
    s_waitcnt vmcnt(8)
    s_branch L_back_g1a_5
L_give_g1a_5:
    s_mov_b32 s27, 0
    s_waitcnt vmcnt(0)
    s_branch L_back_g1a_5
L_slow_g1a_6:
    s_sub_u32 s27, s27, 1
    s_cbranch_scc1 L_give_g1a_6
    s_sleep 1
    buffer_load_dwordx4 v[176:179], v251, s[32:35], s70 offen offset:0 sc1
    buffer_load_dwordx4 v[180:183], v251, s[32:35], s70 offen offset:256 sc1
    buffer_load_dwordx4 v[184:187], v251, s[32:35], s70 offen offset:2048 sc1
    buffer_load_dwordx4 v[188:191], v251, s[32:35], s70 offen offset:2304 sc1
    buffer_load_dwordx4 v[192:195], v251, s[32:35], s71 offen offset:0 sc1
    buffer_load_dwordx4 v[196:199], v251, s[32:35], s71 offen offset:256 sc1
    buffer_load_dwordx4 v[200:203], v251, s[32:35], s71 offen offset:2048 sc1
    buffer_load_dwordx4 v[204:207], v251, s[32:35], s71 offen offset:2304 sc1
    buffer_load_dwordx4 v[80:83], v251, s[32:35], s72 offen offset:0 sc1
    buffer_load_dwordx4 v[84:87], v251, s[32:35], s72 offen offset:256 sc1
    buffer_load_dwordx4 v[88:91], v251, s[32:35], s72 offen offset:2048 sc1
    buffer_load_dwordx4 v[92:95], v251, s[32:35], s72 offen offset:2304 sc1
    buffer_load_dwordx4 v[96:99], v251, s[32:35], s73 offen offset:0 sc1
    buffer_load_dwordx4 v[100:103], v251, s[32:35], s73 offen offset:256 sc1
    buffer_load_dwordx4 v[104:107], v251, s[32:35], s73 offen offset:2048 sc1
    buffer_load_dwordx4 v[108:111], v251, s[32:35], s73 offen offset:2304 sc1
    buffer_load_dwordx4 v[112:115], v251, s[32:35], s74 offen offset:0 sc1
    buffer_load_dwordx4 v[116:119], v251, s[32:35], s74 offen offset:256 sc1
    buffer_load_dwordx4 v[120:123], v251, s[32:35], s74 offen offset:2048 sc1
    buffer_load_dwordx4 v[124:127], v251, s[32:35], s74 offen offset:2304 sc1
    buffer_load_dwordx4 v[128:131], v251, s[32:35], s75 offen offset:0 sc1
    buffer_load_dwordx4 v[132:135], v251, s[32:35], s75 offen offset:256 sc1
    buffer_load_dwordx4 v[136:139], v251, s[32:35], s75 offen offset:2048 sc1
    buffer_load_dwordx4 v[140:143], v251, s[32:35], s75 offen offset:2304 sc1
    buffer_load_dwordx4 v[144:147], v251, s[32:35], s76 offen offset:0 sc1
    buffer_load_dwordx4 v[148:151], v251, s[32:35], s76 offen offset:256 sc1
    buffer_load_dwordx4 v[152:155], v251, s[32:35], s76 offen offset:2048 sc1
    buffer_load_dwordx4 v[156:159], v251, s[32:35], s76 offen offset:2304 sc1
    s_waitcnt vmcnt(24)
    v_max3_u32 v9, v191, v183, v187
    v_max_u32 v9, v9, v179
    v_cmp_le_u32 vcc, 0xff800000, v9
    s_cbranch_vccnz L_slow_g1a_6
    s_waitcnt vmcnt(12)
    s_branch L_back_g1a_6
L_give_g1a_6:
    s_mov_b32 s27, 0
    s_waitcnt vmcnt(0)
    s_branch L_back_g1a_6
L_slow_f2:
    s_sub_u32 s27, s27, 1
    s_cbranch_scc1 L_give_f2
    s_sleep 1
    s_sleep 2
    buffer_load_dwordx2 v[252:253], v0, s[28:31], s58 offen sc1
    s_waitcnt vmcnt(0)
    v_cmp_ne_u64 s[98:99], s[12:13], v[252:253]
    s_nop 0
    s_cmp_lg_u64 s[98:99], 0
    s_cbranch_scc1 L_slow_f2
    s_branch L_back_f2
L_give_f2:
    s_mov_b32 s27, 0
    s_waitcnt vmcnt(0)
    s_branch L_back_f2
L_slow_g1a_7:
    s_sub_u32 s27, s27, 1
    s_cbranch_scc1 L_give_g1a_7
    s_sleep 1
    buffer_load_dwordx4 v[192:195], v251, s[32:35], s71 offen offset:0 sc1
    buffer_load_dwordx4 v[196:199], v251, s[32:35], s71 offen offset:256 sc1
    buffer_load_dwordx4 v[200:203], v251, s[32:35], s71 offen offset:2048 sc1
    buffer_load_dwordx4 v[204:207], v251, s[32:35], s71 offen offset:2304 sc1
    buffer_load_dwordx4 v[80:83], v251, s[32:35], s72 offen offset:0 sc1
    buffer_load_dwordx4 v[84:87], v251, s[32:35], s72 offen offset:256 sc1
    buffer_load_dwordx4 v[88:91], v251, s[32:35], s72 offen offset:2048 sc1
    buffer_load_dwordx4 v[92:95], v251, s[32:35], s72 offen offset:2304 sc1
    buffer_load_dwordx4 v[96:99], v251, s[32:35], s73 offen offset:0 sc1
    buffer_load_dwordx4 v[100:103], v251, s[32:35], s73 offen offset:256 sc1
    buffer_load_dwordx4 v[104:107], v251, s[32:35], s73 offen offset:2048 sc1
    buffer_load_dwordx4 v[108:111], v251, s[32:35], s73 offen offset:2304 sc1
    buffer_load_dwordx4 v[112:115], v251, s[32:35], s74 offen offset:0 sc1
    buffer_load_dwordx4 v[116:119], v251, s[32:35], s74 offen offset:256 sc1
    buffer_load_dwordx4 v[120:123], v251, s[32:35], s74 offen offset:2048 sc1
    buffer_load_dwordx4 v[124:127], v251, s[32:35], s74 offen offset:2304 sc1
    buffer_load_dwordx4 v[128:131], v251, s[32:35], s75 offen offset:0 sc1
    buffer_load_dwordx4 v[132:135], v251, s[32:35], s75 offen offset:256 sc1
    buffer_load_dwordx4 v[136:139], v251, s[32:35], s75 offen offset:2048 sc1
    buffer_load_dwordx4 v[140:143], v251, s[32:35], s75 offen offset:2304 sc1
    buffer_load_dwordx4 v[144:147], v251, s[32:35], s76 offen offset:0 sc1
    buffer_load_dwordx4 v[148:151], v251, s[32:35], s76 offen offset:256 sc1
    buffer_load_dwordx4 v[152:155], v251, s[32:35], s76 offen offset:2048 sc1
    buffer_load_dwordx4 v[156:159], v251, s[32:35], s76 offen offset:2304 sc1
    buffer_load_dwordx4 v[160:163], v251, s[32:35], s77 offen offset:0 sc1
    buffer_load_dwordx4 v[164:167], v251, s[32:35], s77 offen offset:256 sc1
    buffer_load_dwordx4 v[168:171], v251, s[32:35], s77 offen offset:2048 sc1
    buffer_load_dwordx4 v[172:175], v251, s[32:35], s77 offen offset:2304 sc1
    s_waitcnt vmcnt(24)
    v_max3_u32 v9, v207, v199, v203
    v_max_u32 v9, v9, v195
    v_cmp_le_u32 vcc, 0xff800000, v9
    s_cbranch_vccnz L_slow_g1a_7
    s_waitcnt vmcnt(0)
    s_branch L_back_g1a_7
L_give_g1a_7:
    s_mov_b32 s27, 0
    s_waitcnt vmcnt(0)
    s_branch L_back_g1a_7
L_slow_g1a_8:
    s_sub_u32 s27, s27, 1
    s_cbranch_scc1 L_give_g1a_8
    s_sleep 1
    buffer_load_dwordx4 v[80:83], v251, s[32:35], s72 offen offset:0 sc1
    buffer_load_dwordx4 v[84:87], v251, s[32:35], s72 offen offset:256 sc1
    buffer_load_dwordx4 v[88:91], v251, s[32:35], s72 offen offset:2048 sc1
    buffer_load_dwordx4 v[92:95], v251, s[32:35], s72 offen offset:2304 sc1
    buffer_load_dwordx4 v[96:99], v251, s[32:35], s73 offen offset:0 sc1
    buffer_load_dwordx4 v[100:103], v251, s[32:35], s73 offen offset:256 sc1
    buffer_load_dwordx4 v[104:107], v251, s[32:35], s73 offen offset:2048 sc1
    buffer_load_dwordx4 v[108:111], v251, s[32:35], s73 offen offset:2304 sc1
    buffer_load_dwordx4 v[112:115], v251, s[32:35], s74 offen offset:0 sc1
    buffer_load_dwordx4 v[116:119], v251, s[32:35], s74 offen offset:256 sc1
    buffer_load_dwordx4 v[120:123], v251, s[32:35], s74 offen offset:2048 sc1
    buffer_load_dwordx4 v[124:127], v251, s[32:35], s74 offen offset:2304 sc1
    buffer_load_dwordx4 v[128:131], v251, s[32:35], s75 offen offset:0 sc1
    buffer_load_dwordx4 v[132:135], v251, s[32:35], s75 offen offset:256 sc1
    buffer_load_dwordx4 v[136:139], v251, s[32:35], s75 offen offset:2048 sc1
    buffer_load_dwordx4 v[140:143], v251, s[32:35], s75 offen offset:2304 sc1
    buffer_load_dwordx4 v[144:147], v251, s[32:35], s76 offen offset:0 sc1
    buffer_load_dwordx4 v[148:151], v251, s[32:35], s76 offen offset:256 sc1
    buffer_load_dwordx4 v[152:155], v251, s[32:35], s76 offen offset:2048 sc1
    buffer_load_dwordx4 v[156:159], v251, s[32:35], s76 offen offset:2304 sc1
    buffer_load_dwordx4 v[160:163], v251, s[32:35], s77 offen offset:0 sc1
    buffer_load_dwordx4 v[164:167], v251, s[32:35], s77 offen offset:256 sc1
    buffer_load_dwordx4 v[168:171], v251, s[32:35], s77 offen offset:2048 sc1
    buffer_load_dwordx4 v[172:175], v251, s[32:35], s77 offen offset:2304 sc1
    s_waitcnt vmcnt(20)
    v_max3_u32 v9, v95, v87, v91
    v_max_u32 v9, v9, v83
    v_cmp_le_u32 vcc, 0xff800000, v9
    s_cbranch_vccnz L_slow_g1a_8
    s_waitcnt vmcnt(0)
    s_branch L_back_g1a_8
L_give_g1a_8:
    s_mov_b32 s27, 0
    s_waitcnt vmcnt(0)
    s_branch L_back_g1a_8
L_slow_g1a_9:
    s_sub_u32 s27, s27, 1
    s_cbranch_scc1 L_give_g1a_9
    s_sleep 1
    buffer_load_dwordx4 v[96:99], v251, s[32:35], s73 offen offset:0 sc1
    buffer_load_dwordx4 v[100:103], v251, s[32:35], s73 offen offset:256 sc1
    buffer_load_dwordx4 v[104:107], v251, s[32:35], s73 offen offset:2048 sc1
    buffer_load_dwordx4 v[108:111], v251, s[32:35], s73 offen offset:2304 sc1
    buffer_load_dwordx4 v[112:115], v251, s[32:35], s74 offen offset:0 sc1
    buffer_load_dwordx4 v[116:119], v251, s[32:35], s74 offen offset:256 sc1
    buffer_load_dwordx4 v[120:123], v251, s[32:35], s74 offen offset:2048 sc1
    buffer_load_dwordx4 v[124:127], v251, s[32:35], s74 offen offset:2304 sc1
    buffer_load_dwordx4 v[128:131], v251, s[32:35], s75 offen offset:0 sc1
    buffer_load_dwordx4 v[132:135], v251, s[32:35], s75 offen offset:256 sc1
    buffer_load_dwordx4 v[136:139], v251, s[32:35], s75 offen offset:2048 sc1
    buffer_load_dwordx4 v[140:143], v251, s[32:35], s75 offen offset:2304 sc1
    buffer_load_dwordx4 v[144:147], v251, s[32:35], s76 offen offset:0 sc1
    buffer_load_dwordx4 v[148:151], v251, s[32:35], s76 offen offset:256 sc1
    buffer_load_dwordx4 v[152:155], v251, s[32:35], s76 offen offset:2048 sc1
    buffer_load_dwordx4 v[156:159], v251, s[32:35], s76 offen offset:2304 sc1
    buffer_load_dwordx4 v[160:163], v251, s[32:35], s77 offen offset:0 sc1
    buffer_load_dwordx4 v[164:167], v251, s[32:35], s77 offen offset:256 sc1
    buffer_load_dwordx4 v[168:171], v251, s[32:35], s77 offen offset:2048 sc1
    buffer_load_dwordx4 v[172:175], v251, s[32:35], s77 offen offset:2304 sc1
    s_waitcnt vmcnt(16)
    v_max3_u32 v9, v111, v103, v107
    v_max_u32 v9, v9, v99
    v_cmp_le_u32 vcc, 0xff800000, v9
    s_cbranch_vccnz L_slow_g1a_9
    s_waitcnt vmcnt(0)
    s_branch L_back_g1a_9
L_give_g1a_9:
    s_mov_b32 s27, 0
    s_waitcnt vmcnt(0)
    s_branch L_back_g1a_9
L_slow_g1a_10:
    s_sub_u32 s27, s27, 1
    s_cbranch_scc1 L_give_g1a_10
    s_sleep 1
    buffer_load_dwordx4 v[112:115], v251, s[32:35], s74 offen offset:0 sc1
    buffer_load_dwordx4 v[116:119], v251, s[32:35], s74 offen offset:256 sc1
    buffer_load_dwordx4 v[120:123], v251, s[32:35], s74 offen offset:2048 sc1
    buffer_load_dwordx4 v[124:127], v251, s[32:35], s74 offen offset:2304 sc1
    buffer_load_dwordx4 v[128:131], v251, s[32:35], s75 offen offset:0 sc1
    buffer_load_dwordx4 v[132:135], v251, s[32:35], s75 offen offset:256 sc1
    buffer_load_dwordx4 v[136:139], v251, s[32:35], s75 offen offset:2048 sc1
    buffer_load_dwordx4 v[140:143], v251, s[32:35], s75 offen offset:2304 sc1
    buffer_load_dwordx4 v[144:147], v251, s[32:35], s76 offen offset:0 sc1
    buffer_load_dwordx4 v[148:151], v251, s[32:35], s76 offen offset:256 sc1
    buffer_load_dwordx4 v[152:155], v251, s[32:35], s76 offen offset:2048 sc1
    buffer_load_dwordx4 v[156:159], v251, s[32:35], s76 offen offset:2304 sc1
    buffer_load_dwordx4 v[160:163], v251, s[32:35], s77 offen offset:0 sc1
    buffer_load_dwordx4 v[164:167], v251, s[32:35], s77 offen offset:256 sc1
    buffer_load_dwordx4 v[168:171], v251, s[32:35], s77 offen offset:2048 sc1
    buffer_load_dwordx4 v[172:175], v251, s[32:35], s77 offen offset:2304 sc1
    s_waitcnt vmcnt(12)
    v_max3_u32 v9, v127, v119, v123
    v_max_u32 v9, v9, v115
    v_cmp_le_u32 vcc, 0xff800000, v9
    s_cbranch_vccnz L_slow_g1a_10
    s_waitcnt vmcnt(0)
    s_branch L_back_g1a_10
L_give_g1a_10:
    s_mov_b32 s27, 0
    s_waitcnt vmcnt(0)
    s_branch L_back_g1a_10
L_slow_g1a_11:
    s_sub_u32 s27, s27, 1
    s_cbranch_scc1 L_give_g1a_11
    s_sleep 1
    buffer_load_dwordx4 v[128:131], v251, s[32:35], s75 offen offset:0 sc1
    buffer_load_dwordx4 v[132:135], v251, s[32:35], s75 offen offset:256 sc1
    buffer_load_dwordx4 v[136:139], v251, s[32:35], s75 offen offset:2048 sc1
    buffer_load_dwordx4 v[140:143], v251, s[32:35], s75 offen offset:2304 sc1
    buffer_load_dwordx4 v[144:147], v251, s[32:35], s76 offen offset:0 sc1
    buffer_load_dwordx4 v[148:151], v251, s[32:35], s76 offen offset:256 sc1
    buffer_load_dwordx4 v[152:155], v251, s[32:35], s76 offen offset:2048 sc1
    buffer_load_dwordx4 v[156:159], v251, s[32:35], s76 offen offset:2304 sc1
    buffer_load_dwordx4 v[160:163], v251, s[32:35], s77 offen offset:0 sc1
    buffer_load_dwordx4 v[164:167], v251, s[32:35], s77 offen offset:256 sc1
    buffer_load_dwordx4 v[168:171], v251, s[32:35], s77 offen offset:2048 sc1
    buffer_load_dwordx4 v[172:175], v251, s[32:35], s77 offen offset:2304 sc1
    s_waitcnt vmcnt(8)
    v_max3_u32 v9, v143, v135, v139
    v_max_u32 v9, v9, v131
    v_cmp_le_u32 vcc, 0xff800000, v9
    s_cbranch_vccnz L_slow_g1a_11
    s_waitcnt vmcnt(0)
    s_branch L_back_g1a_11
L_give_g1a_11:
    s_mov_b32 s27, 0
    s_waitcnt vmcnt(0)
    s_branch L_back_g1a_11
L_slow_g1a_12:
    s_sub_u32 s27, s27, 1
    s_cbranch_scc1 L_give_g1a_12
    s_sleep 1
    buffer_load_dwordx4 v[144:147], v251, s[32:35], s76 offen offset:0 sc1
    buffer_load_dwordx4 v[148:151], v251, s[32:35], s76 offen offset:256 sc1
    buffer_load_dwordx4 v[152:155], v251, s[32:35], s76 offen offset:2048 sc1
    buffer_load_dwordx4 v[156:159], v251, s[32:35], s76 offen offset:2304 sc1
    buffer_load_dwordx4 v[160:163], v251, s[32:35], s77 offen offset:0 sc1
    buffer_load_dwordx4 v[164:167], v251, s[32:35], s77 offen offset:256 sc1
    buffer_load_dwordx4 v[168:171], v251, s[32:35], s77 offen offset:2048 sc1
    buffer_load_dwordx4 v[172:175], v251, s[32:35], s77 offen offset:2304 sc1
    s_waitcnt vmcnt(4)
    v_max3_u32 v9, v159, v151, v155
    v_max_u32 v9, v9, v147
    v_cmp_le_u32 vcc, 0xff800000, v9
    s_cbranch_vccnz L_slow_g1a_12
    s_waitcnt vmcnt(0)
    s_branch L_back_g1a_12
L_give_g1a_12:
    s_mov_b32 s27, 0
    s_waitcnt vmcnt(0)
    s_branch L_back_g1a_12
L_slow_g1a_13:
    s_sub_u32 s27, s27, 1
    s_cbranch_scc1 L_give_g1a_13
    s_sleep 1
    buffer_load_dwordx4 v[160:163], v251, s[32:35], s77 offen offset:0 sc1
    buffer_load_dwordx4 v[164:167], v251, s[32:35], s77 offen offset:256 sc1
    buffer_load_dwordx4 v[168:171], v251, s[32:35], s77 offen offset:2048 sc1
    buffer_load_dwordx4 v[172:175], v251, s[32:35], s77 offen offset:2304 sc1
    s_waitcnt vmcnt(0)
    v_max3_u32 v9, v175, v167, v171
    v_max_u32 v9, v9, v163
    v_cmp_le_u32 vcc, 0xff800000, v9
    s_cbranch_vccnz L_slow_g1a_13
    s_branch L_back_g1a_13
L_give_g1a_13:
    s_mov_b32 s27, 0
    s_waitcnt vmcnt(0)
    s_branch L_back_g1a_13
L_slow_g1ars:
    s_sub_u32 s27, s27, 1
    s_cbranch_scc1 L_give_g1ars
    s_sleep 1
    buffer_load_dwordx4 v[176:179], v2, s[28:31], s9 offen offset:0 sc1
    buffer_load_dwordx4 v[180:183], v2, s[28:31], s9 offen offset:1024 sc1
    buffer_load_dwordx4 v[184:187], v2, s[28:31], s9 offen offset:2048 sc1
    s_mov_b32 exec_hi, 0
    buffer_load_dwordx4 v[188:191], v2, s[28:31], s9 offen offset:3072 sc1
    s_mov_b64 exec, -1
    s_waitcnt vmcnt(2)
    v_add_f32 v192, v176, v180
    v_add_f32 v193, v177, v181
    v_add_f32 v194, v178, v182
    v_add_f32 v195, v179, v183
    s_waitcnt vmcnt(0)
    v_add_f32 v196, v184, v188
    v_add_f32 v197, v185, v189
    v_add_f32 v198, v186, v190
    v_add_f32 v199, v187, v191
    v_add_f32 v192, v192, v196
    v_add_f32 v193, v193, v197
    v_add_f32 v194, v194, v198
    v_add_f32 v195, v195, v199
    s_nop 0
    v_permlane32_swap_b32 v192, v194
    v_permlane32_swap_b32 v193, v195
    v_add_f32 v192, v192, v194
    v_add_f32 v193, v193, v195
    s_nop 1
    v_permlane16_swap_b32 v192, v193
    v_add_f32 v192, v192, v193
    v_cmp_u_f32 s[98:99], v192, v192
    s_nop 0
    s_cmp_lg_u64 s[98:99], 0
    s_cbranch_scc1 L_slow_g1ars
    s_branch L_back_g1ars
L_give_g1ars:
    s_mov_b32 s27, 0
    s_waitcnt vmcnt(0)
    s_branch L_back_g1ars
L_slow_f0:
    s_sub_u32 s27, s27, 1
    s_cbranch_scc1 L_give_f0
    s_sleep 1
    s_sleep 2
    buffer_load_dwordx4 v[128:131], v13, s[28:31], s97 offen offset:8 sc1
    s_waitcnt vmcnt(0)
    v_cmp_ne_u64 vcc, s[12:13], v[130:131]
    s_cbranch_vccnz L_slow_f0
    s_branch L_back_f0
L_give_f0:
    s_mov_b32 s27, 0
    s_waitcnt vmcnt(0)
    s_branch L_back_f0
L_far_hp:
    s_waitcnt vmcnt(0)
    s_nop 15
    v_mov_b32 v244, -1
    v_mov_b32 v245, -1
    v_mov_b32 v246, -1
    v_mov_b32 v247, -1
    s_add_u32 s53, s61, 15114240
    buffer_store_dwordx4 v[244:247], v2, s[28:31], s53 offen offset:0 sc1
    s_add_u32 s53, s61, 15114240
    buffer_store_dwordx4 v[244:247], v2, s[28:31], s53 offen offset:1024 sc1
    s_add_u32 s53, s61, 15114240
    buffer_store_dwordx4 v[244:247], v2, s[28:31], s53 offen offset:2048 sc1
    s_add_u32 s53, s61, 15114240
    buffer_store_dwordx4 v[244:247], v2, s[28:31], s53 offen offset:3072 sc1
    s_add_u32 s53, s61, 15118336
    buffer_store_dwordx4 v[244:247], v2, s[28:31], s53 offen offset:0 sc1
    s_add_u32 s53, s61, 15118336
    buffer_store_dwordx4 v[244:247], v2, s[28:31], s53 offen offset:1024 sc1
    s_add_u32 s53, s61, 15118336
    buffer_store_dwordx4 v[244:247], v2, s[28:31], s53 offen offset:2048 sc1
    s_add_u32 s53, s61, 15118336
    buffer_store_dwordx4 v[244:247], v2, s[28:31], s53 offen offset:3072 sc1
    s_waitcnt vmcnt(0)
    s_mov_b64 exec, 1
    buffer_store_dwordx2 v[10:11], off, s[28:31], s96 offset:24 sc1
    s_mov_b64 exec, -1
    s_waitcnt vmcnt(0)
    s_branch L_near_hp
L_alt_g1ah00:
    buffer_store_dwordx4 v[208:211], v2, s[28:31], s55 offen offset:0 sc1
    buffer_store_dwordx4 v[212:215], v2, s[28:31], s55 offen offset:1024 sc1
    s_branch L_ret_g1ah00
L_alt_g1ah01:
    buffer_store_dwordx4 v[224:227], v2, s[28:31], s55 offen offset:2048 sc1
    buffer_store_dwordx4 v[228:231], v2, s[28:31], s55 offen offset:3072 sc1
    s_branch L_ret_g1ah01
L_slow_f3:
    s_sub_u32 s27, s27, 1
    s_cbranch_scc1 L_give_f3
    s_sleep 1
    s_sleep 2
    buffer_load_dwordx2 v[252:253], v13, s[28:31], s99 offen sc1
    s_waitcnt vmcnt(0)
    v_cmp_ne_u64 vcc, s[12:13], v[252:253]
    s_cbranch_vccnz L_slow_f3
    s_branch L_back_f3
L_give_f3:
    s_mov_b32 s27, 0
    s_waitcnt vmcnt(0)
    s_branch L_back_f3
L_far_hc:
    s_waitcnt vmcnt(0)
    s_nop 15
    s_add_u32 s99, s97, 24
    buffer_load_dwordx2 v[252:253], v13, s[28:31], s99 offen sc1
    s_waitcnt vmcnt(0)
    v_cmp_ne_u64 vcc, s[12:13], v[252:253]
    s_cbranch_vccnz L_slow_f3
L_back_f3:
    s_waitcnt vmcnt(0)
    s_branch L_near_hc
L_alt_g1ah11:
    buffer_store_dwordx4 v[208:211], v2, s[28:31], s59 offen offset:2048 sc1
    buffer_store_dwordx4 v[212:215], v2, s[28:31], s59 offen offset:3072 sc1
    s_branch L_ret_g1ah11
L_slow_g2a_0:
    s_sub_u32 s27, s27, 1
    s_cbranch_scc1 L_give_g2a_0
    s_sleep 1
    buffer_load_dwordx4 v[144:147], v2, s[40:43], s80 offen offset:0 sc1
    buffer_load_dwordx4 v[148:151], v2, s[40:43], s80 offen offset:1024 sc1
    buffer_load_dwordx4 v[152:155], v2, s[40:43], s81 offen offset:0 sc1
    buffer_load_dwordx4 v[156:159], v2, s[40:43], s81 offen offset:1024 sc1
    buffer_load_dwordx4 v[160:163], v2, s[40:43], s82 offen offset:0 sc1
    buffer_load_dwordx4 v[164:167], v2, s[40:43], s82 offen offset:1024 sc1
    buffer_load_dwordx4 v[168:171], v2, s[40:43], s83 offen offset:0 sc1
    buffer_load_dwordx4 v[172:175], v2, s[40:43], s83 offen offset:1024 sc1
    buffer_load_dwordx4 v[176:179], v2, s[40:43], s84 offen offset:0 sc1
    buffer_load_dwordx4 v[180:183], v2, s[40:43], s84 offen offset:1024 sc1
    buffer_load_dwordx4 v[184:187], v2, s[40:43], s85 offen offset:0 sc1
    buffer_load_dwordx4 v[188:191], v2, s[40:43], s85 offen offset:1024 sc1
    s_waitcnt vmcnt(8)
    v_max3_u32 v9, v156, v148, v152
    v_max_u32 v9, v9, v144
    v_cmp_eq_u32 vcc, -1, v9
    s_cbranch_vccnz L_slow_g2a_0
    s_waitcnt vmcnt(0)
    s_branch L_back_g2a_0
L_give_g2a_0:
    s_mov_b32 s27, 0
    s_waitcnt vmcnt(0)
    s_branch L_back_g2a_0
L_slow_g2a_1:
    s_sub_u32 s27, s27, 1
    s_cbranch_scc1 L_give_g2a_1
    s_sleep 1
    buffer_load_dwordx4 v[160:163], v2, s[40:43], s82 offen offset:0 sc1
    buffer_load_dwordx4 v[164:167], v2, s[40:43], s82 offen offset:1024 sc1
    buffer_load_dwordx4 v[168:171], v2, s[40:43], s83 offen offset:0 sc1
    buffer_load_dwordx4 v[172:175], v2, s[40:43], s83 offen offset:1024 sc1
    buffer_load_dwordx4 v[176:179], v2, s[40:43], s84 offen offset:0 sc1
    buffer_load_dwordx4 v[180:183], v2, s[40:43], s84 offen offset:1024 sc1
    buffer_load_dwordx4 v[184:187], v2, s[40:43], s85 offen offset:0 sc1
    buffer_load_dwordx4 v[188:191], v2, s[40:43], s85 offen offset:1024 sc1
    buffer_load_dwordx4 v[192:195], v2, s[40:43], s86 offen offset:0 sc1
    buffer_load_dwordx4 v[196:199], v2, s[40:43], s86 offen offset:1024 sc1
    buffer_load_dwordx4 v[200:203], v2, s[40:43], s80 offen offset:2048 sc1
    buffer_load_dwordx4 v[204:207], v2, s[40:43], s80 offen offset:3072 sc1
    buffer_load_dwordx4 v[80:83], v2, s[40:43], s81 offen offset:2048 sc1
    buffer_load_dwordx4 v[84:87], v2, s[40:43], s81 offen offset:3072 sc1
    buffer_load_dwordx4 v[88:91], v2, s[40:43], s82 offen offset:2048 sc1
    buffer_load_dwordx4 v[92:95], v2, s[40:43], s82 offen offset:3072 sc1
    s_waitcnt vmcnt(12)
    v_max3_u32 v9, v172, v164, v168
    v_max_u32 v9, v9, v160
    v_cmp_eq_u32 vcc, -1, v9
    s_cbranch_vccnz L_slow_g2a_1
    s_waitcnt vmcnt(0)
    s_branch L_back_g2a_1
L_give_g2a_1:
    s_mov_b32 s27, 0
    s_waitcnt vmcnt(0)
    s_branch L_back_g2a_1
L_slow_g2a_2:
    s_sub_u32 s27, s27, 1
    s_cbranch_scc1 L_give_g2a_2
    s_sleep 1
    buffer_load_dwordx4 v[176:179], v2, s[40:43], s84 offen offset:0 sc1
    buffer_load_dwordx4 v[180:183], v2, s[40:43], s84 offen offset:1024 sc1
    buffer_load_dwordx4 v[184:187], v2, s[40:43], s85 offen offset:0 sc1
    buffer_load_dwordx4 v[188:191], v2, s[40:43], s85 offen offset:1024 sc1
    buffer_load_dwordx4 v[192:195], v2, s[40:43], s86 offen offset:0 sc1
    buffer_load_dwordx4 v[196:199], v2, s[40:43], s86 offen offset:1024 sc1
    buffer_load_dwordx4 v[200:203], v2, s[40:43], s80 offen offset:2048 sc1
    buffer_load_dwordx4 v[204:207], v2, s[40:43], s80 offen offset:3072 sc1
    buffer_load_dwordx4 v[80:83], v2, s[40:43], s81 offen offset:2048 sc1
    buffer_load_dwordx4 v[84:87], v2, s[40:43], s81 offen offset:3072 sc1
    buffer_load_dwordx4 v[88:91], v2, s[40:43], s82 offen offset:2048 sc1
    buffer_load_dwordx4 v[92:95], v2, s[40:43], s82 offen offset:3072 sc1
    buffer_load_dwordx4 v[96:99], v2, s[40:43], s83 offen offset:2048 sc1
    buffer_load_dwordx4 v[100:103], v2, s[40:43], s83 offen offset:3072 sc1
    buffer_load_dwordx4 v[104:107], v2, s[40:43], s84 offen offset:2048 sc1
    buffer_load_dwordx4 v[108:111], v2, s[40:43], s84 offen offset:3072 sc1
    s_waitcnt vmcnt(12)
    v_max3_u32 v9, v188, v180, v184
    v_max_u32 v9, v9, v176
    v_cmp_eq_u32 vcc, -1, v9
    s_cbranch_vccnz L_slow_g2a_2
    s_waitcnt vmcnt(4)
    s_branch L_back_g2a_2
L_give_g2a_2:
    s_mov_b32 s27, 0
    s_waitcnt vmcnt(0)
    s_branch L_back_g2a_2
L_slow_g2a_3:
    s_sub_u32 s27, s27, 1
    s_cbranch_scc1 L_give_g2a_3
    s_sleep 1
    buffer_load_dwordx4 v[192:195], v2, s[40:43], s86 offen offset:0 sc1
    buffer_load_dwordx4 v[196:199], v2, s[40:43], s86 offen offset:1024 sc1
    buffer_load_dwordx4 v[200:203], v2, s[40:43], s80 offen offset:2048 sc1
    buffer_load_dwordx4 v[204:207], v2, s[40:43], s80 offen offset:3072 sc1
    buffer_load_dwordx4 v[80:83], v2, s[40:43], s81 offen offset:2048 sc1
    buffer_load_dwordx4 v[84:87], v2, s[40:43], s81 offen offset:3072 sc1
    buffer_load_dwordx4 v[88:91], v2, s[40:43], s82 offen offset:2048 sc1
    buffer_load_dwordx4 v[92:95], v2, s[40:43], s82 offen offset:3072 sc1
    buffer_load_dwordx4 v[96:99], v2, s[40:43], s83 offen offset:2048 sc1
    buffer_load_dwordx4 v[100:103], v2, s[40:43], s83 offen offset:3072 sc1
    buffer_load_dwordx4 v[104:107], v2, s[40:43], s84 offen offset:2048 sc1
    buffer_load_dwordx4 v[108:111], v2, s[40:43], s84 offen offset:3072 sc1
    buffer_load_dwordx4 v[144:147], v2, s[40:43], s85 offen offset:2048 sc1
    buffer_load_dwordx4 v[148:151], v2, s[40:43], s85 offen offset:3072 sc1
    buffer_load_dwordx4 v[152:155], v2, s[40:43], s86 offen offset:2048 sc1
    buffer_load_dwordx4 v[156:159], v2, s[40:43], s86 offen offset:3072 sc1
    s_waitcnt vmcnt(12)
    v_max3_u32 v9, v204, v196, v200
    v_max_u32 v9, v9, v192
    v_cmp_eq_u32 vcc, -1, v9
    s_cbranch_vccnz L_slow_g2a_3
    s_waitcnt vmcnt(0)
    s_branch L_back_g2a_3
L_give_g2a_3:
    s_mov_b32 s27, 0
    s_waitcnt vmcnt(0)
    s_branch L_back_g2a_3
L_alt_g1ah10:
    buffer_store_dwordx4 v[224:227], v2, s[28:31], s59 offen offset:0 sc1
    buffer_store_dwordx4 v[228:231], v2, s[28:31], s59 offen offset:1024 sc1
    s_branch L_ret_g1ah10
L_slow_g2a_4:
    s_sub_u32 s27, s27, 1
    s_cbranch_scc1 L_give_g2a_4
    s_sleep 1
    buffer_load_dwordx4 v[80:83], v2, s[40:43], s81 offen offset:2048 sc1
    buffer_load_dwordx4 v[84:87], v2, s[40:43], s81 offen offset:3072 sc1
    buffer_load_dwordx4 v[88:91], v2, s[40:43], s82 offen offset:2048 sc1
    buffer_load_dwordx4 v[92:95], v2, s[40:43], s82 offen offset:3072 sc1
    buffer_load_dwordx4 v[96:99], v2, s[40:43], s83 offen offset:2048 sc1
    buffer_load_dwordx4 v[100:103], v2, s[40:43], s83 offen offset:3072 sc1
    buffer_load_dwordx4 v[104:107], v2, s[40:43], s84 offen offset:2048 sc1
    buffer_load_dwordx4 v[108:111], v2, s[40:43], s84 offen offset:3072 sc1
    buffer_load_dwordx4 v[144:147], v2, s[40:43], s85 offen offset:2048 sc1
    buffer_load_dwordx4 v[148:151], v2, s[40:43], s85 offen offset:3072 sc1
    buffer_load_dwordx4 v[152:155], v2, s[40:43], s86 offen offset:2048 sc1
    buffer_load_dwordx4 v[156:159], v2, s[40:43], s86 offen offset:3072 sc1
    buffer_load_dwordx4 v[160:163], v2, s[40:43], s87 offen offset:2048 sc1
    buffer_load_dwordx4 v[164:167], v2, s[40:43], s87 offen offset:3072 sc1
    buffer_load_dwordx4 v[168:171], v2, s[40:43], s88 offen offset:2048 sc1
    buffer_load_dwordx4 v[172:175], v2, s[40:43], s88 offen offset:3072 sc1
    s_waitcnt vmcnt(12)
    v_max3_u32 v9, v92, v84, v88
    v_max_u32 v9, v9, v80
    v_cmp_eq_u32 vcc, -1, v9
    s_cbranch_vccnz L_slow_g2a_4
    s_waitcnt vmcnt(0)
    s_branch L_back_g2a_4
L_give_g2a_4:
    s_mov_b32 s27, 0
    s_waitcnt vmcnt(0)
    s_branch L_back_g2a_4
L_slow_ha:
    s_sub_u32 s27, s27, 1
    s_cbranch_scc1 L_give_ha
    s_sleep 1
    s_sleep 2
    buffer_load_dwordx2 v[252:253], v254, s[28:31], s79 offen sc1
    s_waitcnt vmcnt(0)
    v_cmp_ne_u64 s[98:99], s[12:13], v[252:253]
    s_nop 0
    s_cmp_lg_u64 s[98:99], 0
    s_cbranch_scc1 L_slow_ha
    s_branch L_back_ha
L_give_ha:
    s_mov_b32 s27, 0
    s_waitcnt vmcnt(0)
    s_branch L_back_ha
L_slow_g2a_5:
    s_sub_u32 s27, s27, 1
    s_cbranch_scc1 L_give_g2a_5
    s_sleep 1
    buffer_load_dwordx4 v[96:99], v2, s[40:43], s83 offen offset:2048 sc1
    buffer_load_dwordx4 v[100:103], v2, s[40:43], s83 offen offset:3072 sc1
    buffer_load_dwordx4 v[104:107], v2, s[40:43], s84 offen offset:2048 sc1
    buffer_load_dwordx4 v[108:111], v2, s[40:43], s84 offen offset:3072 sc1
    buffer_load_dwordx4 v[144:147], v2, s[40:43], s85 offen offset:2048 sc1
    buffer_load_dwordx4 v[148:151], v2, s[40:43], s85 offen offset:3072 sc1
    buffer_load_dwordx4 v[152:155], v2, s[40:43], s86 offen offset:2048 sc1
    buffer_load_dwordx4 v[156:159], v2, s[40:43], s86 offen offset:3072 sc1
    buffer_load_dwordx4 v[160:163], v2, s[40:43], s87 offen offset:2048 sc1
    buffer_load_dwordx4 v[164:167], v2, s[40:43], s87 offen offset:3072 sc1
    buffer_load_dwordx4 v[168:171], v2, s[40:43], s88 offen offset:2048 sc1
    buffer_load_dwordx4 v[172:175], v2, s[40:43], s88 offen offset:3072 sc1
    buffer_load_dwordx4 v[176:179], v2, s[40:43], s89 offen offset:2048 sc1
    buffer_load_dwordx4 v[180:183], v2, s[40:43], s89 offen offset:3072 sc1
    buffer_load_dwordx4 v[184:187], v2, s[40:43], s90 offen offset:2048 sc1
    buffer_load_dwordx4 v[188:191], v2, s[40:43], s90 offen offset:3072 sc1
    s_waitcnt vmcnt(12)
    v_max3_u32 v9, v108, v100, v104
    v_max_u32 v9, v9, v96
    v_cmp_eq_u32 vcc, -1, v9
    s_cbranch_vccnz L_slow_g2a_5
    s_waitcnt vmcnt(0)
    s_branch L_back_g2a_5
L_give_g2a_5:
    s_mov_b32 s27, 0
    s_waitcnt vmcnt(0)
    s_branch L_back_g2a_5
L_slow_g2a_6:
    s_sub_u32 s27, s27, 1
    s_cbranch_scc1 L_give_g2a_6
    s_sleep 1
    buffer_load_dwordx4 v[144:147], v2, s[40:43], s85 offen offset:2048 sc1
    buffer_load_dwordx4 v[148:151], v2, s[40:43], s85 offen offset:3072 sc1
    buffer_load_dwordx4 v[152:155], v2, s[40:43], s86 offen offset:2048 sc1
    buffer_load_dwordx4 v[156:159], v2, s[40:43], s86 offen offset:3072 sc1
    buffer_load_dwordx4 v[160:163], v2, s[40:43], s87 offen offset:2048 sc1
    buffer_load_dwordx4 v[164:167], v2, s[40:43], s87 offen offset:3072 sc1
    buffer_load_dwordx4 v[168:171], v2, s[40:43], s88 offen offset:2048 sc1
    buffer_load_dwordx4 v[172:175], v2, s[40:43], s88 offen offset:3072 sc1
    buffer_load_dwordx4 v[176:179], v2, s[40:43], s89 offen offset:2048 sc1
    buffer_load_dwordx4 v[180:183], v2, s[40:43], s89 offen offset:3072 sc1
    buffer_load_dwordx4 v[184:187], v2, s[40:43], s90 offen offset:2048 sc1
    buffer_load_dwordx4 v[188:191], v2, s[40:43], s90 offen offset:3072 sc1
    buffer_load_dwordx4 v[192:195], v2, s[40:43], s91 offen offset:2048 sc1
    buffer_load_dwordx4 v[196:199], v2, s[40:43], s91 offen offset:3072 sc1
    buffer_load_dwordx4 v[200:203], v2, s[40:43], s92 offen offset:2048 sc1
    buffer_load_dwordx4 v[204:207], v2, s[40:43], s92 offen offset:3072 sc1
    s_waitcnt vmcnt(12)
    v_max3_u32 v9, v156, v148, v152
    v_max_u32 v9, v9, v144
    v_cmp_eq_u32 vcc, -1, v9
    s_cbranch_vccnz L_slow_g2a_6
    s_waitcnt vmcnt(4)
    s_branch L_back_g2a_6
L_give_g2a_6:
    s_mov_b32 s27, 0
    s_waitcnt vmcnt(0)
    s_branch L_back_g2a_6
L_slow_g2a_7:
    s_sub_u32 s27, s27, 1
    s_cbranch_scc1 L_give_g2a_7
    s_sleep 1
    buffer_load_dwordx4 v[160:163], v2, s[40:43], s87 offen offset:2048 sc1
    buffer_load_dwordx4 v[164:167], v2, s[40:43], s87 offen offset:3072 sc1
    buffer_load_dwordx4 v[168:171], v2, s[40:43], s88 offen offset:2048 sc1
    buffer_load_dwordx4 v[172:175], v2, s[40:43], s88 offen offset:3072 sc1
    buffer_load_dwordx4 v[176:179], v2, s[40:43], s89 offen offset:2048 sc1
    buffer_load_dwordx4 v[180:183], v2, s[40:43], s89 offen offset:3072 sc1
    buffer_load_dwordx4 v[184:187], v2, s[40:43], s90 offen offset:2048 sc1
    buffer_load_dwordx4 v[188:191], v2, s[40:43], s90 offen offset:3072 sc1
    buffer_load_dwordx4 v[192:195], v2, s[40:43], s91 offen offset:2048 sc1
    buffer_load_dwordx4 v[196:199], v2, s[40:43], s91 offen offset:3072 sc1
    buffer_load_dwordx4 v[200:203], v2, s[40:43], s92 offen offset:2048 sc1
    buffer_load_dwordx4 v[204:207], v2, s[40:43], s92 offen offset:3072 sc1
    buffer_load_dwordx4 v[80:83], v2, s[40:43], s93 offen offset:2048 sc1
    buffer_load_dwordx4 v[84:87], v2, s[40:43], s93 offen offset:3072 sc1
    buffer_load_dwordx4 v[88:91], v2, s[40:43], s87 offen offset:0 sc1
    buffer_load_dwordx4 v[92:95], v2, s[40:43], s87 offen offset:1024 sc1
    s_waitcnt vmcnt(12)
    v_max3_u32 v9, v172, v164, v168
    v_max_u32 v9, v9, v160
    v_cmp_eq_u32 vcc, -1, v9
    s_cbranch_vccnz L_slow_g2a_7
    s_waitcnt vmcnt(8)
    s_branch L_back_g2a_7
L_give_g2a_7:
    s_mov_b32 s27, 0
    s_waitcnt vmcnt(0)
    s_branch L_back_g2a_7
L_slow_g2a_8:
    s_sub_u32 s27, s27, 1
    s_cbranch_scc1 L_give_g2a_8
    s_sleep 1
    buffer_load_dwordx4 v[176:179], v2, s[40:43], s89 offen offset:2048 sc1
    buffer_load_dwordx4 v[180:183], v2, s[40:43], s89 offen offset:3072 sc1
    buffer_load_dwordx4 v[184:187], v2, s[40:43], s90 offen offset:2048 sc1
    buffer_load_dwordx4 v[188:191], v2, s[40:43], s90 offen offset:3072 sc1
    buffer_load_dwordx4 v[192:195], v2, s[40:43], s91 offen offset:2048 sc1
    buffer_load_dwordx4 v[196:199], v2, s[40:43], s91 offen offset:3072 sc1
    buffer_load_dwordx4 v[200:203], v2, s[40:43], s92 offen offset:2048 sc1
    buffer_load_dwordx4 v[204:207], v2, s[40:43], s92 offen offset:3072 sc1
    buffer_load_dwordx4 v[80:83], v2, s[40:43], s93 offen offset:2048 sc1
    buffer_load_dwordx4 v[84:87], v2, s[40:43], s93 offen offset:3072 sc1
    buffer_load_dwordx4 v[88:91], v2, s[40:43], s87 offen offset:0 sc1
    buffer_load_dwordx4 v[92:95], v2, s[40:43], s87 offen offset:1024 sc1
    buffer_load_dwordx4 v[96:99], v2, s[40:43], s88 offen offset:0 sc1
    buffer_load_dwordx4 v[100:103], v2, s[40:43], s88 offen offset:1024 sc1
    buffer_load_dwordx4 v[104:107], v2, s[40:43], s89 offen offset:0 sc1
    buffer_load_dwordx4 v[108:111], v2, s[40:43], s89 offen offset:1024 sc1
    s_waitcnt vmcnt(12)
    v_max3_u32 v9, v188, v180, v184
    v_max_u32 v9, v9, v176
    v_cmp_eq_u32 vcc, -1, v9
    s_cbranch_vccnz L_slow_g2a_8
    s_branch L_back_g2a_8
L_give_g2a_8:
    s_mov_b32 s27, 0
    s_waitcnt vmcnt(0)
    s_branch L_back_g2a_8
L_slow_g2a_9:
    s_sub_u32 s27, s27, 1
    s_cbranch_scc1 L_give_g2a_9
    s_sleep 1
    buffer_load_dwordx4 v[192:195], v2, s[40:43], s91 offen offset:2048 sc1
    buffer_load_dwordx4 v[196:199], v2, s[40:43], s91 offen offset:3072 sc1
    buffer_load_dwordx4 v[200:203], v2, s[40:43], s92 offen offset:2048 sc1
    buffer_load_dwordx4 v[204:207], v2, s[40:43], s92 offen offset:3072 sc1
    buffer_load_dwordx4 v[80:83], v2, s[40:43], s93 offen offset:2048 sc1
    buffer_load_dwordx4 v[84:87], v2, s[40:43], s93 offen offset:3072 sc1
    buffer_load_dwordx4 v[88:91], v2, s[40:43], s87 offen offset:0 sc1
    buffer_load_dwordx4 v[92:95], v2, s[40:43], s87 offen offset:1024 sc1
    buffer_load_dwordx4 v[96:99], v2, s[40:43], s88 offen offset:0 sc1
    buffer_load_dwordx4 v[100:103], v2, s[40:43], s88 offen offset:1024 sc1
    buffer_load_dwordx4 v[104:107], v2, s[40:43], s89 offen offset:0 sc1
    buffer_load_dwordx4 v[108:111], v2, s[40:43], s89 offen offset:1024 sc1
    buffer_load_dwordx4 v[144:147], v2, s[40:43], s90 offen offset:0 sc1
    buffer_load_dwordx4 v[148:151], v2, s[40:43], s90 offen offset:1024 sc1
    buffer_load_dwordx4 v[152:155], v2, s[40:43], s91 offen offset:0 sc1
    buffer_load_dwordx4 v[156:159], v2, s[40:43], s91 offen offset:1024 sc1
    s_waitcnt vmcnt(12)
    v_max3_u32 v9, v204, v196, v200
    v_max_u32 v9, v9, v192
    v_cmp_eq_u32 vcc, -1, v9
    s_cbranch_vccnz L_slow_g2a_9
    s_branch L_back_g2a_9
L_give_g2a_9:
    s_mov_b32 s27, 0
    s_waitcnt vmcnt(0)
    s_branch L_back_g2a_9
L_slow_g2a_10:
    s_sub_u32 s27, s27, 1
    s_cbranch_scc1 L_give_g2a_10
    s_sleep 1
    buffer_load_dwordx4 v[80:83], v2, s[40:43], s93 offen offset:2048 sc1
    buffer_load_dwordx4 v[84:87], v2, s[40:43], s93 offen offset:3072 sc1
    buffer_load_dwordx4 v[88:91], v2, s[40:43], s87 offen offset:0 sc1
    buffer_load_dwordx4 v[92:95], v2, s[40:43], s87 offen offset:1024 sc1
    buffer_load_dwordx4 v[96:99], v2, s[40:43], s88 offen offset:0 sc1
    buffer_load_dwordx4 v[100:103], v2, s[40:43], s88 offen offset:1024 sc1
    buffer_load_dwordx4 v[104:107], v2, s[40:43], s89 offen offset:0 sc1
    buffer_load_dwordx4 v[108:111], v2, s[40:43], s89 offen offset:1024 sc1
    buffer_load_dwordx4 v[144:147], v2, s[40:43], s90 offen offset:0 sc1
    buffer_load_dwordx4 v[148:151], v2, s[40:43], s90 offen offset:1024 sc1
    buffer_load_dwordx4 v[152:155], v2, s[40:43], s91 offen offset:0 sc1
    buffer_load_dwordx4 v[156:159], v2, s[40:43], s91 offen offset:1024 sc1
    buffer_load_dwordx4 v[160:163], v2, s[40:43], s92 offen offset:0 sc1
    buffer_load_dwordx4 v[164:167], v2, s[40:43], s92 offen offset:1024 sc1
    buffer_load_dwordx4 v[168:171], v2, s[40:43], s93 offen offset:0 sc1
    buffer_load_dwordx4 v[172:175], v2, s[40:43], s93 offen offset:1024 sc1
    s_waitcnt vmcnt(12)
    v_max3_u32 v9, v92, v84, v88
    v_max_u32 v9, v9, v80
    v_cmp_eq_u32 vcc, -1, v9
    s_cbranch_vccnz L_slow_g2a_10
    s_branch L_back_g2a_10
L_give_g2a_10:
    s_mov_b32 s27, 0
    s_waitcnt vmcnt(0)
    s_branch L_back_g2a_10
L_slow_g2a_11:
    s_sub_u32 s27, s27, 1
    s_cbranch_scc1 L_give_g2a_11
    s_sleep 1
    buffer_load_dwordx4 v[96:99], v2, s[40:43], s88 offen offset:0 sc1
    buffer_load_dwordx4 v[100:103], v2, s[40:43], s88 offen offset:1024 sc1
    buffer_load_dwordx4 v[104:107], v2, s[40:43], s89 offen offset:0 sc1
    buffer_load_dwordx4 v[108:111], v2, s[40:43], s89 offen offset:1024 sc1
    buffer_load_dwordx4 v[144:147], v2, s[40:43], s90 offen offset:0 sc1
    buffer_load_dwordx4 v[148:151], v2, s[40:43], s90 offen offset:1024 sc1
    buffer_load_dwordx4 v[152:155], v2, s[40:43], s91 offen offset:0 sc1
    buffer_load_dwordx4 v[156:159], v2, s[40:43], s91 offen offset:1024 sc1
    buffer_load_dwordx4 v[160:163], v2, s[40:43], s92 offen offset:0 sc1
    buffer_load_dwordx4 v[164:167], v2, s[40:43], s92 offen offset:1024 sc1
    buffer_load_dwordx4 v[168:171], v2, s[40:43], s93 offen offset:0 sc1
    buffer_load_dwordx4 v[172:175], v2, s[40:43], s93 offen offset:1024 sc1
    s_waitcnt vmcnt(8)
    v_max3_u32 v9, v108, v100, v104
    v_max_u32 v9, v9, v96
    v_cmp_eq_u32 vcc, -1, v9
    s_cbranch_vccnz L_slow_g2a_11
    s_branch L_back_g2a_11
L_give_g2a_11:
    s_mov_b32 s27, 0
    s_waitcnt vmcnt(0)
    s_branch L_back_g2a_11
L_slow_g2a_12:
    s_sub_u32 s27, s27, 1
    s_cbranch_scc1 L_give_g2a_12
    s_sleep 1
    buffer_load_dwordx4 v[144:147], v2, s[40:43], s90 offen offset:0 sc1
    buffer_load_dwordx4 v[148:151], v2, s[40:43], s90 offen offset:1024 sc1
    buffer_load_dwordx4 v[152:155], v2, s[40:43], s91 offen offset:0 sc1
    buffer_load_dwordx4 v[156:159], v2, s[40:43], s91 offen offset:1024 sc1
    buffer_load_dwordx4 v[160:163], v2, s[40:43], s92 offen offset:0 sc1
    buffer_load_dwordx4 v[164:167], v2, s[40:43], s92 offen offset:1024 sc1
    buffer_load_dwordx4 v[168:171], v2, s[40:43], s93 offen offset:0 sc1
    buffer_load_dwordx4 v[172:175], v2, s[40:43], s93 offen offset:1024 sc1
    s_waitcnt vmcnt(4)
    v_max3_u32 v9, v156, v148, v152
    v_max_u32 v9, v9, v144
    v_cmp_eq_u32 vcc, -1, v9
    s_cbranch_vccnz L_slow_g2a_12
    s_waitcnt vmcnt(0)
    s_branch L_back_g2a_12
L_give_g2a_12:
    s_mov_b32 s27, 0
    s_waitcnt vmcnt(0)
    s_branch L_back_g2a_12
L_slow_g2a_13:
    s_sub_u32 s27, s27, 1
    s_cbranch_scc1 L_give_g2a_13
    s_sleep 1
    buffer_load_dwordx4 v[160:163], v2, s[40:43], s92 offen offset:0 sc1
    buffer_load_dwordx4 v[164:167], v2, s[40:43], s92 offen offset:1024 sc1
    buffer_load_dwordx4 v[168:171], v2, s[40:43], s93 offen offset:0 sc1
    buffer_load_dwordx4 v[172:175], v2, s[40:43], s93 offen offset:1024 sc1
    s_waitcnt vmcnt(0)
    v_max3_u32 v9, v172, v164, v168
    v_max_u32 v9, v9, v160
    v_cmp_eq_u32 vcc, -1, v9
    s_cbranch_vccnz L_slow_g2a_13
    s_branch L_back_g2a_13
L_give_g2a_13:
    s_mov_b32 s27, 0
    s_waitcnt vmcnt(0)
    s_branch L_back_g2a_13
L_slow_c2x:
    s_sub_u32 s27, s27, 1
    s_cbranch_scc1 L_give_c2x
    s_sleep 1
    buffer_load_dwordx4 v[176:179], v248, s[28:31], s78 offen sc1 nt
    buffer_load_dwordx4 v[180:183], v249, s[28:31], s78 offen sc1 nt
    buffer_load_dwordx4 v[104:107], v2, s[28:31], s79 offen offset:0 sc1
    buffer_load_dwordx4 v[108:111], v2, s[28:31], s79 offen offset:1024 sc1
    buffer_load_dwordx4 v[112:115], v2, s[28:31], s79 offen offset:2048 sc1
    buffer_load_dwordx4 v[116:119], v2, s[28:31], s79 offen offset:3072 sc1
    s_waitcnt vmcnt(4)
    v_max_u32 v16, v179, v183
    v_lshlrev_b32 v72, 16, v176
    v_lshlrev_b32 v73, 16, v177
    v_lshlrev_b32 v74, 16, v178
    v_lshlrev_b32 v75, 16, v179
    v_lshlrev_b32 v76, 16, v180
    v_lshlrev_b32 v77, 16, v181
    v_lshlrev_b32 v78, 16, v182
    v_lshlrev_b32 v79, 16, v183
    v_and_b32 v88, s57, v176
    v_and_b32 v89, s57, v177
    v_and_b32 v90, s57, v178
    v_and_b32 v91, s57, v179
    v_and_b32 v92, s57, v180
    v_and_b32 v93, s57, v181
    v_and_b32 v94, s57, v182
    v_and_b32 v95, s57, v183
    v_cmp_le_u32 vcc, 0xff800000, v16
    s_waitcnt vmcnt(3)
    v_bitop3_b32 v17, v104, v106, 7 bitop3:0x80
    v_cvt_f32_u32 v24, v104
    v_cvt_f32_u32 v25, v106
    s_waitcnt vmcnt(2)
    v_bitop3_b32 v17, v108, v110, v17 bitop3:0x80
    v_cvt_f32_u32 v26, v108
    v_cvt_f32_u32 v27, v110
    s_waitcnt vmcnt(1)
    v_bitop3_b32 v17, v112, v114, v17 bitop3:0x80
    v_cvt_f32_u32 v28, v112
    v_cvt_f32_u32 v29, v114
    s_waitcnt vmcnt(0)
    v_bitop3_b32 v17, v116, v118, v17 bitop3:0x80
    v_cvt_f32_u32 v30, v116
    v_cvt_f32_u32 v31, v118
    v_cmp_ne_u32 s[98:99], 7, v17
    v_cvt_f32_u32 v18, v105
    s_or_b64 vcc, vcc, s[98:99]
    s_cbranch_scc1 L_slow_c2x
    s_branch L_back_c2x
L_give_c2x:
    s_mov_b32 s27, 0
    s_waitcnt vmcnt(0)
    s_branch L_back_c2x
L_slow_g1b_0:
    s_sub_u32 s27, s27, 1
    s_cbranch_scc1 L_give_g1b_0
    s_sleep 1
    buffer_load_dwordx4 v[80:83], v251, s[32:35], s64 offen offset:0 sc1
    buffer_load_dwordx4 v[84:87], v251, s[32:35], s64 offen offset:256 sc1
    buffer_load_dwordx4 v[88:91], v251, s[32:35], s64 offen offset:2048 sc1
    buffer_load_dwordx4 v[92:95], v251, s[32:35], s64 offen offset:2304 sc1
    buffer_load_dwordx4 v[96:99], v251, s[32:35], s65 offen offset:0 sc1
    buffer_load_dwordx4 v[100:103], v251, s[32:35], s65 offen offset:256 sc1
    buffer_load_dwordx4 v[104:107], v251, s[32:35], s65 offen offset:2048 sc1
    buffer_load_dwordx4 v[108:111], v251, s[32:35], s65 offen offset:2304 sc1
    buffer_load_dwordx4 v[112:115], v251, s[32:35], s66 offen offset:0 sc1
    buffer_load_dwordx4 v[116:119], v251, s[32:35], s66 offen offset:256 sc1
    buffer_load_dwordx4 v[120:123], v251, s[32:35], s66 offen offset:2048 sc1
    buffer_load_dwordx4 v[124:127], v251, s[32:35], s66 offen offset:2304 sc1
    s_waitcnt vmcnt(8)
    v_bitop3_b32 v9, v95, v87, v91 bitop3:0x80
    v_bitop3_b32 v9, v9, v83, 1 bitop3:0x80
    v_cmp_eq_u32 vcc, 0, v9
    s_cbranch_vccnz L_slow_g1b_0
    s_branch L_back_g1b_0
L_give_g1b_0:
    s_mov_b32 s27, 0
    s_waitcnt vmcnt(0)
    s_branch L_back_g1b_0
L_slow_g1b_1:
    s_sub_u32 s27, s27, 1
    s_cbranch_scc1 L_give_g1b_1
    s_sleep 1
    buffer_load_dwordx4 v[96:99], v251, s[32:35], s65 offen offset:0 sc1
    buffer_load_dwordx4 v[100:103], v251, s[32:35], s65 offen offset:256 sc1
    buffer_load_dwordx4 v[104:107], v251, s[32:35], s65 offen offset:2048 sc1
    buffer_load_dwordx4 v[108:111], v251, s[32:35], s65 offen offset:2304 sc1
    buffer_load_dwordx4 v[112:115], v251, s[32:35], s66 offen offset:0 sc1
    buffer_load_dwordx4 v[116:119], v251, s[32:35], s66 offen offset:256 sc1
    buffer_load_dwordx4 v[120:123], v251, s[32:35], s66 offen offset:2048 sc1
    buffer_load_dwordx4 v[124:127], v251, s[32:35], s66 offen offset:2304 sc1
    buffer_load_dwordx4 v[128:131], v251, s[32:35], s67 offen offset:0 sc1
    buffer_load_dwordx4 v[132:135], v251, s[32:35], s67 offen offset:256 sc1
    buffer_load_dwordx4 v[136:139], v251, s[32:35], s67 offen offset:2048 sc1
    buffer_load_dwordx4 v[140:143], v251, s[32:35], s67 offen offset:2304 sc1
    buffer_load_dwordx4 v[144:147], v251, s[32:35], s68 offen offset:0 sc1
    buffer_load_dwordx4 v[148:151], v251, s[32:35], s68 offen offset:256 sc1
    buffer_load_dwordx4 v[152:155], v251, s[32:35], s68 offen offset:2048 sc1
    buffer_load_dwordx4 v[156:159], v251, s[32:35], s68 offen offset:2304 sc1
    s_waitcnt vmcnt(12)
    v_bitop3_b32 v9, v111, v103, v107 bitop3:0x80
    v_bitop3_b32 v9, v9, v99, 1 bitop3:0x80
    v_cmp_eq_u32 vcc, 0, v9
    s_cbranch_vccnz L_slow_g1b_1
    s_branch L_back_g1b_1
L_give_g1b_1:
    s_mov_b32 s27, 0
    s_waitcnt vmcnt(0)
    s_branch L_back_g1b_1
L_slow_g1b_2:
    s_sub_u32 s27, s27, 1
    s_cbranch_scc1 L_give_g1b_2
    s_sleep 1
    buffer_load_dwordx4 v[112:115], v251, s[32:35], s66 offen offset:0 sc1
    buffer_load_dwordx4 v[116:119], v251, s[32:35], s66 offen offset:256 sc1
    buffer_load_dwordx4 v[120:123], v251, s[32:35], s66 offen offset:2048 sc1
    buffer_load_dwordx4 v[124:127], v251, s[32:35], s66 offen offset:2304 sc1
    buffer_load_dwordx4 v[128:131], v251, s[32:35], s67 offen offset:0 sc1
    buffer_load_dwordx4 v[132:135], v251, s[32:35], s67 offen offset:256 sc1
    buffer_load_dwordx4 v[136:139], v251, s[32:35], s67 offen offset:2048 sc1
    buffer_load_dwordx4 v[140:143], v251, s[32:35], s67 offen offset:2304 sc1
    buffer_load_dwordx4 v[144:147], v251, s[32:35], s68 offen offset:0 sc1
    buffer_load_dwordx4 v[148:151], v251, s[32:35], s68 offen offset:256 sc1
    buffer_load_dwordx4 v[152:155], v251, s[32:35], s68 offen offset:2048 sc1
    buffer_load_dwordx4 v[156:159], v251, s[32:35], s68 offen offset:2304 sc1
    buffer_load_dwordx4 v[160:163], v251, s[32:35], s69 offen offset:0 sc1
    buffer_load_dwordx4 v[164:167], v251, s[32:35], s69 offen offset:256 sc1
    buffer_load_dwordx4 v[168:171], v251, s[32:35], s69 offen offset:2048 sc1
    buffer_load_dwordx4 v[172:175], v251, s[32:35], s69 offen offset:2304 sc1
    s_waitcnt vmcnt(12)
    v_bitop3_b32 v9, v127, v119, v123 bitop3:0x80
    v_bitop3_b32 v9, v9, v115, 1 bitop3:0x80
    v_cmp_eq_u32 vcc, 0, v9
    s_cbranch_vccnz L_slow_g1b_2
    s_branch L_back_g1b_2
L_give_g1b_2:
    s_mov_b32 s27, 0
    s_waitcnt vmcnt(0)
    s_branch L_back_g1b_2
L_slow_g1b_3:
    s_sub_u32 s27, s27, 1
    s_cbranch_scc1 L_give_g1b_3
    s_sleep 1
    buffer_load_dwordx4 v[128:131], v251, s[32:35], s67 offen offset:0 sc1
    buffer_load_dwordx4 v[132:135], v251, s[32:35], s67 offen offset:256 sc1
    buffer_load_dwordx4 v[136:139], v251, s[32:35], s67 offen offset:2048 sc1
    buffer_load_dwordx4 v[140:143], v251, s[32:35], s67 offen offset:2304 sc1
    buffer_load_dwordx4 v[144:147], v251, s[32:35], s68 offen offset:0 sc1
    buffer_load_dwordx4 v[148:151], v251, s[32:35], s68 offen offset:256 sc1
    buffer_load_dwordx4 v[152:155], v251, s[32:35], s68 offen offset:2048 sc1
    buffer_load_dwordx4 v[156:159], v251, s[32:35], s68 offen offset:2304 sc1
    buffer_load_dwordx4 v[160:163], v251, s[32:35], s69 offen offset:0 sc1
    buffer_load_dwordx4 v[164:167], v251, s[32:35], s69 offen offset:256 sc1
    buffer_load_dwordx4 v[168:171], v251, s[32:35], s69 offen offset:2048 sc1
    buffer_load_dwordx4 v[172:175], v251, s[32:35], s69 offen offset:2304 sc1
    buffer_load_dwordx4 v[176:179], v251, s[32:35], s70 offen offset:0 sc1
    buffer_load_dwordx4 v[180:183], v251, s[32:35], s70 offen offset:256 sc1
    buffer_load_dwordx4 v[184:187], v251, s[32:35], s70 offen offset:2048 sc1
    buffer_load_dwordx4 v[188:191], v251, s[32:35], s70 offen offset:2304 sc1
    s_waitcnt vmcnt(12)
    v_bitop3_b32 v9, v143, v135, v139 bitop3:0x80
    v_bitop3_b32 v9, v9, v131, 1 bitop3:0x80
    v_cmp_eq_u32 vcc, 0, v9
    s_cbranch_vccnz L_slow_g1b_3
    s_waitcnt vmcnt(4)
    s_branch L_back_g1b_3
L_give_g1b_3:
    s_mov_b32 s27, 0
    s_waitcnt vmcnt(0)
    s_branch L_back_g1b_3
L_slow_g1b_4:
    s_sub_u32 s27, s27, 1
    s_cbranch_scc1 L_give_g1b_4
    s_sleep 1
    buffer_load_dwordx4 v[144:147], v251, s[32:35], s68 offen offset:0 sc1
    buffer_load_dwordx4 v[148:151], v251, s[32:35], s68 offen offset:256 sc1
    buffer_load_dwordx4 v[152:155], v251, s[32:35], s68 offen offset:2048 sc1
    buffer_load_dwordx4 v[156:159], v251, s[32:35], s68 offen offset:2304 sc1
    buffer_load_dwordx4 v[160:163], v251, s[32:35], s69 offen offset:0 sc1
    buffer_load_dwordx4 v[164:167], v251, s[32:35], s69 offen offset:256 sc1
    buffer_load_dwordx4 v[168:171], v251, s[32:35], s69 offen offset:2048 sc1
    buffer_load_dwordx4 v[172:175], v251, s[32:35], s69 offen offset:2304 sc1
    buffer_load_dwordx4 v[176:179], v251, s[32:35], s70 offen offset:0 sc1
    buffer_load_dwordx4 v[180:183], v251, s[32:35], s70 offen offset:256 sc1
    buffer_load_dwordx4 v[184:187], v251, s[32:35], s70 offen offset:2048 sc1
    buffer_load_dwordx4 v[188:191], v251, s[32:35], s70 offen offset:2304 sc1
    buffer_load_dwordx4 v[192:195], v251, s[32:35], s71 offen offset:0 sc1
    buffer_load_dwordx4 v[196:199], v251, s[32:35], s71 offen offset:256 sc1
    buffer_load_dwordx4 v[200:203], v251, s[32:35], s71 offen offset:2048 sc1
    buffer_load_dwordx4 v[204:207], v251, s[32:35], s71 offen offset:2304 sc1
    s_waitcnt vmcnt(12)
    v_bitop3_b32 v9, v159, v151, v155 bitop3:0x80
    v_bitop3_b32 v9, v9, v147, 1 bitop3:0x80
    v_cmp_eq_u32 vcc, 0, v9
    s_cbranch_vccnz L_slow_g1b_4
    s_waitcnt vmcnt(8)
    s_branch L_back_g1b_4
L_give_g1b_4:
    s_mov_b32 s27, 0
    s_waitcnt vmcnt(0)
    s_branch L_back_g1b_4
L_slow_g1b_5:
    s_sub_u32 s27, s27, 1
    s_cbranch_scc1 L_give_g1b_5
    s_sleep 1
    buffer_load_dwordx4 v[160:163], v251, s[32:35], s69 offen offset:0 sc1
    buffer_load_dwordx4 v[164:167], v251, s[32:35], s69 offen offset:256 sc1
    buffer_load_dwordx4 v[168:171], v251, s[32:35], s69 offen offset:2048 sc1
    buffer_load_dwordx4 v[172:175], v251, s[32:35], s69 offen offset:2304 sc1
    buffer_load_dwordx4 v[176:179], v251, s[32:35], s70 offen offset:0 sc1
    buffer_load_dwordx4 v[180:183], v251, s[32:35], s70 offen offset:256 sc1
    buffer_load_dwordx4 v[184:187], v251, s[32:35], s70 offen offset:2048 sc1
    buffer_load_dwordx4 v[188:191], v251, s[32:35], s70 offen offset:2304 sc1
    buffer_load_dwordx4 v[192:195], v251, s[32:35], s71 offen offset:0 sc1
    buffer_load_dwordx4 v[196:199], v251, s[32:35], s71 offen offset:256 sc1
    buffer_load_dwordx4 v[200:203], v251, s[32:35], s71 offen offset:2048 sc1
    buffer_load_dwordx4 v[204:207], v251, s[32:35], s71 offen offset:2304 sc1
    buffer_load_dwordx4 v[80:83], v251, s[32:35], s72 offen offset:0 sc1
    buffer_load_dwordx4 v[84:87], v251, s[32:35], s72 offen offset:256 sc1
    buffer_load_dwordx4 v[88:91], v251, s[32:35], s72 offen offset:2048 sc1
    buffer_load_dwordx4 v[92:95], v251, s[32:35], s72 offen offset:2304 sc1
    s_waitcnt vmcnt(12)
    v_bitop3_b32 v9, v175, v167, v171 bitop3:0x80
    v_bitop3_b32 v9, v9, v163, 1 bitop3:0x80
    v_cmp_eq_u32 vcc, 0, v9
    s_cbranch_vccnz L_slow_g1b_5
    s_branch L_back_g1b_5
L_give_g1b_5:
    s_mov_b32 s27, 0
    s_waitcnt vmcnt(0)
    s_branch L_back_g1b_5
L_slow_g1b_6:
    s_sub_u32 s27, s27, 1
    s_cbranch_scc1 L_give_g1b_6
    s_sleep 1
    buffer_load_dwordx4 v[176:179], v251, s[32:35], s70 offen offset:0 sc1
    buffer_load_dwordx4 v[180:183], v251, s[32:35], s70 offen offset:256 sc1
    buffer_load_dwordx4 v[184:187], v251, s[32:35], s70 offen offset:2048 sc1
    buffer_load_dwordx4 v[188:191], v251, s[32:35], s70 offen offset:2304 sc1
    buffer_load_dwordx4 v[192:195], v251, s[32:35], s71 offen offset:0 sc1
    buffer_load_dwordx4 v[196:199], v251, s[32:35], s71 offen offset:256 sc1
    buffer_load_dwordx4 v[200:203], v251, s[32:35], s71 offen offset:2048 sc1
    buffer_load_dwordx4 v[204:207], v251, s[32:35], s71 offen offset:2304 sc1
    buffer_load_dwordx4 v[80:83], v251, s[32:35], s72 offen offset:0 sc1
    buffer_load_dwordx4 v[84:87], v251, s[32:35], s72 offen offset:256 sc1
    buffer_load_dwordx4 v[88:91], v251, s[32:35], s72 offen offset:2048 sc1
    buffer_load_dwordx4 v[92:95], v251, s[32:35], s72 offen offset:2304 sc1
    buffer_load_dwordx4 v[96:99], v251, s[32:35], s73 offen offset:0 sc1
    buffer_load_dwordx4 v[100:103], v251, s[32:35], s73 offen offset:256 sc1
    buffer_load_dwordx4 v[104:107], v251, s[32:35], s73 offen offset:2048 sc1
    buffer_load_dwordx4 v[108:111], v251, s[32:35], s73 offen offset:2304 sc1
    s_waitcnt vmcnt(12)
    v_bitop3_b32 v9, v191, v183, v187 bitop3:0x80
    v_bitop3_b32 v9, v9, v179, 1 bitop3:0x80
    v_cmp_eq_u32 vcc, 0, v9
    s_cbranch_vccnz L_slow_g1b_6
    s_branch L_back_g1b_6
L_give_g1b_6:
    s_mov_b32 s27, 0
    s_waitcnt vmcnt(0)
    s_branch L_back_g1b_6
L_slow_g1b_7:
    s_sub_u32 s27, s27, 1
    s_cbranch_scc1 L_give_g1b_7
    s_sleep 1
    buffer_load_dwordx4 v[192:195], v251, s[32:35], s71 offen offset:0 sc1
    buffer_load_dwordx4 v[196:199], v251, s[32:35], s71 offen offset:256 sc1
    buffer_load_dwordx4 v[200:203], v251, s[32:35], s71 offen offset:2048 sc1
    buffer_load_dwordx4 v[204:207], v251, s[32:35], s71 offen offset:2304 sc1
    buffer_load_dwordx4 v[80:83], v251, s[32:35], s72 offen offset:0 sc1
    buffer_load_dwordx4 v[84:87], v251, s[32:35], s72 offen offset:256 sc1
    buffer_load_dwordx4 v[88:91], v251, s[32:35], s72 offen offset:2048 sc1
    buffer_load_dwordx4 v[92:95], v251, s[32:35], s72 offen offset:2304 sc1
    buffer_load_dwordx4 v[96:99], v251, s[32:35], s73 offen offset:0 sc1
    buffer_load_dwordx4 v[100:103], v251, s[32:35], s73 offen offset:256 sc1
    buffer_load_dwordx4 v[104:107], v251, s[32:35], s73 offen offset:2048 sc1
    buffer_load_dwordx4 v[108:111], v251, s[32:35], s73 offen offset:2304 sc1
    buffer_load_dwordx4 v[112:115], v251, s[32:35], s74 offen offset:0 sc1
    buffer_load_dwordx4 v[116:119], v251, s[32:35], s74 offen offset:256 sc1
    buffer_load_dwordx4 v[120:123], v251, s[32:35], s74 offen offset:2048 sc1
    buffer_load_dwordx4 v[124:127], v251, s[32:35], s74 offen offset:2304 sc1
    s_waitcnt vmcnt(12)
    v_bitop3_b32 v9, v207, v199, v203 bitop3:0x80
    v_bitop3_b32 v9, v9, v195, 1 bitop3:0x80
    v_cmp_eq_u32 vcc, 0, v9
    s_cbranch_vccnz L_slow_g1b_7
    s_branch L_back_g1b_7
L_give_g1b_7:
    s_mov_b32 s27, 0
    s_waitcnt vmcnt(0)
    s_branch L_back_g1b_7
L_slow_g1b_8:
    s_sub_u32 s27, s27, 1
    s_cbranch_scc1 L_give_g1b_8
    s_sleep 1
    buffer_load_dwordx4 v[80:83], v251, s[32:35], s72 offen offset:0 sc1
    buffer_load_dwordx4 v[84:87], v251, s[32:35], s72 offen offset:256 sc1
    buffer_load_dwordx4 v[88:91], v251, s[32:35], s72 offen offset:2048 sc1
    buffer_load_dwordx4 v[92:95], v251, s[32:35], s72 offen offset:2304 sc1
    buffer_load_dwordx4 v[96:99], v251, s[32:35], s73 offen offset:0 sc1
    buffer_load_dwordx4 v[100:103], v251, s[32:35], s73 offen offset:256 sc1
    buffer_load_dwordx4 v[104:107], v251, s[32:35], s73 offen offset:2048 sc1
    buffer_load_dwordx4 v[108:111], v251, s[32:35], s73 offen offset:2304 sc1
    buffer_load_dwordx4 v[112:115], v251, s[32:35], s74 offen offset:0 sc1
    buffer_load_dwordx4 v[116:119], v251, s[32:35], s74 offen offset:256 sc1
    buffer_load_dwordx4 v[120:123], v251, s[32:35], s74 offen offset:2048 sc1
    buffer_load_dwordx4 v[124:127], v251, s[32:35], s74 offen offset:2304 sc1
    buffer_load_dwordx4 v[128:131], v251, s[32:35], s75 offen offset:0 sc1
    buffer_load_dwordx4 v[132:135], v251, s[32:35], s75 offen offset:256 sc1
    buffer_load_dwordx4 v[136:139], v251, s[32:35], s75 offen offset:2048 sc1
    buffer_load_dwordx4 v[140:143], v251, s[32:35], s75 offen offset:2304 sc1
    s_waitcnt vmcnt(12)
    v_bitop3_b32 v9, v95, v87, v91 bitop3:0x80
    v_bitop3_b32 v9, v9, v83, 1 bitop3:0x80
    v_cmp_eq_u32 vcc, 0, v9
    s_cbranch_vccnz L_slow_g1b_8
    s_branch L_back_g1b_8
L_give_g1b_8:
    s_mov_b32 s27, 0
    s_waitcnt vmcnt(0)
    s_branch L_back_g1b_8
L_slow_g1b_9:
    s_sub_u32 s27, s27, 1
    s_cbranch_scc1 L_give_g1b_9
    s_sleep 1
    buffer_load_dwordx4 v[96:99], v251, s[32:35], s73 offen offset:0 sc1
    buffer_load_dwordx4 v[100:103], v251, s[32:35], s73 offen offset:256 sc1
    buffer_load_dwordx4 v[104:107], v251, s[32:35], s73 offen offset:2048 sc1
    buffer_load_dwordx4 v[108:111], v251, s[32:35], s73 offen offset:2304 sc1
    buffer_load_dwordx4 v[112:115], v251, s[32:35], s74 offen offset:0 sc1
    buffer_load_dwordx4 v[116:119], v251, s[32:35], s74 offen offset:256 sc1
    buffer_load_dwordx4 v[120:123], v251, s[32:35], s74 offen offset:2048 sc1
    buffer_load_dwordx4 v[124:127], v251, s[32:35], s74 offen offset:2304 sc1
    buffer_load_dwordx4 v[128:131], v251, s[32:35], s75 offen offset:0 sc1
    buffer_load_dwordx4 v[132:135], v251, s[32:35], s75 offen offset:256 sc1
    buffer_load_dwordx4 v[136:139], v251, s[32:35], s75 offen offset:2048 sc1
    buffer_load_dwordx4 v[140:143], v251, s[32:35], s75 offen offset:2304 sc1
    buffer_load_dwordx4 v[144:147], v251, s[32:35], s76 offen offset:0 sc1
    buffer_load_dwordx4 v[148:151], v251, s[32:35], s76 offen offset:256 sc1
    buffer_load_dwordx4 v[152:155], v251, s[32:35], s76 offen offset:2048 sc1
    buffer_load_dwordx4 v[156:159], v251, s[32:35], s76 offen offset:2304 sc1
    s_waitcnt vmcnt(12)
    v_bitop3_b32 v9, v111, v103, v107 bitop3:0x80
    v_bitop3_b32 v9, v9, v99, 1 bitop3:0x80
    v_cmp_eq_u32 vcc, 0, v9
    s_cbranch_vccnz L_slow_g1b_9
    s_waitcnt vmcnt(0)
    s_branch L_back_g1b_9
L_give_g1b_9:
    s_mov_b32 s27, 0
    s_waitcnt vmcnt(0)
    s_branch L_back_g1b_9
L_slow_g1b_10:
    s_sub_u32 s27, s27, 1
    s_cbranch_scc1 L_give_g1b_10
    s_sleep 1
    buffer_load_dwordx4 v[112:115], v251, s[32:35], s74 offen offset:0 sc1
    buffer_load_dwordx4 v[116:119], v251, s[32:35], s74 offen offset:256 sc1
    buffer_load_dwordx4 v[120:123], v251, s[32:35], s74 offen offset:2048 sc1
    buffer_load_dwordx4 v[124:127], v251, s[32:35], s74 offen offset:2304 sc1
    buffer_load_dwordx4 v[128:131], v251, s[32:35], s75 offen offset:0 sc1
    buffer_load_dwordx4 v[132:135], v251, s[32:35], s75 offen offset:256 sc1
    buffer_load_dwordx4 v[136:139], v251, s[32:35], s75 offen offset:2048 sc1
    buffer_load_dwordx4 v[140:143], v251, s[32:35], s75 offen offset:2304 sc1
    buffer_load_dwordx4 v[144:147], v251, s[32:35], s76 offen offset:0 sc1
    buffer_load_dwordx4 v[148:151], v251, s[32:35], s76 offen offset:256 sc1
    buffer_load_dwordx4 v[152:155], v251, s[32:35], s76 offen offset:2048 sc1
    buffer_load_dwordx4 v[156:159], v251, s[32:35], s76 offen offset:2304 sc1
    buffer_load_dwordx4 v[160:163], v251, s[32:35], s77 offen offset:0 sc1
    buffer_load_dwordx4 v[164:167], v251, s[32:35], s77 offen offset:256 sc1
    buffer_load_dwordx4 v[168:171], v251, s[32:35], s77 offen offset:2048 sc1
    buffer_load_dwordx4 v[172:175], v251, s[32:35], s77 offen offset:2304 sc1
    s_waitcnt vmcnt(12)
    v_bitop3_b32 v9, v127, v119, v123 bitop3:0x80
    v_bitop3_b32 v9, v9, v115, 1 bitop3:0x80
    v_cmp_eq_u32 vcc, 0, v9
    s_cbranch_vccnz L_slow_g1b_10
    s_waitcnt vmcnt(0)
    s_branch L_back_g1b_10
L_give_g1b_10:
    s_mov_b32 s27, 0
    s_waitcnt vmcnt(0)
    s_branch L_back_g1b_10
L_slow_g1b_11:
    s_sub_u32 s27, s27, 1
    s_cbranch_scc1 L_give_g1b_11
    s_sleep 1
    buffer_load_dwordx4 v[128:131], v251, s[32:35], s75 offen offset:0 sc1
    buffer_load_dwordx4 v[132:135], v251, s[32:35], s75 offen offset:256 sc1
    buffer_load_dwordx4 v[136:139], v251, s[32:35], s75 offen offset:2048 sc1
    buffer_load_dwordx4 v[140:143], v251, s[32:35], s75 offen offset:2304 sc1
    buffer_load_dwordx4 v[144:147], v251, s[32:35], s76 offen offset:0 sc1
    buffer_load_dwordx4 v[148:151], v251, s[32:35], s76 offen offset:256 sc1
    buffer_load_dwordx4 v[152:155], v251, s[32:35], s76 offen offset:2048 sc1
    buffer_load_dwordx4 v[156:159], v251, s[32:35], s76 offen offset:2304 sc1
    buffer_load_dwordx4 v[160:163], v251, s[32:35], s77 offen offset:0 sc1
    buffer_load_dwordx4 v[164:167], v251, s[32:35], s77 offen offset:256 sc1
    buffer_load_dwordx4 v[168:171], v251, s[32:35], s77 offen offset:2048 sc1
    buffer_load_dwordx4 v[172:175], v251, s[32:35], s77 offen offset:2304 sc1
    s_waitcnt vmcnt(8)
    v_bitop3_b32 v9, v143, v135, v139 bitop3:0x80
    v_bitop3_b32 v9, v9, v131, 1 bitop3:0x80
    v_cmp_eq_u32 vcc, 0, v9
    s_cbranch_vccnz L_slow_g1b_11
    s_waitcnt vmcnt(0)
    s_branch L_back_g1b_11
L_give_g1b_11:
    s_mov_b32 s27, 0
    s_waitcnt vmcnt(0)
    s_branch L_back_g1b_11
L_slow_g1b_12:
    s_sub_u32 s27, s27, 1
    s_cbranch_scc1 L_give_g1b_12
    s_sleep 1
    buffer_load_dwordx4 v[144:147], v251, s[32:35], s76 offen offset:0 sc1
    buffer_load_dwordx4 v[148:151], v251, s[32:35], s76 offen offset:256 sc1
    buffer_load_dwordx4 v[152:155], v251, s[32:35], s76 offen offset:2048 sc1
    buffer_load_dwordx4 v[156:159], v251, s[32:35], s76 offen offset:2304 sc1
    buffer_load_dwordx4 v[160:163], v251, s[32:35], s77 offen offset:0 sc1
    buffer_load_dwordx4 v[164:167], v251, s[32:35], s77 offen offset:256 sc1
    buffer_load_dwordx4 v[168:171], v251, s[32:35], s77 offen offset:2048 sc1
    buffer_load_dwordx4 v[172:175], v251, s[32:35], s77 offen offset:2304 sc1
    s_waitcnt vmcnt(4)
    v_bitop3_b32 v9, v159, v151, v155 bitop3:0x80
    v_bitop3_b32 v9, v9, v147, 1 bitop3:0x80
    v_cmp_eq_u32 vcc, 0, v9
    s_cbranch_vccnz L_slow_g1b_12
    s_waitcnt vmcnt(0)
    s_branch L_back_g1b_12
L_give_g1b_12:
    s_mov_b32 s27, 0
    s_waitcnt vmcnt(0)
    s_branch L_back_g1b_12
L_slow_g1b_13:
    s_sub_u32 s27, s27, 1
    s_cbranch_scc1 L_give_g1b_13
    s_sleep 1
    buffer_load_dwordx4 v[160:163], v251, s[32:35], s77 offen offset:0 sc1
    buffer_load_dwordx4 v[164:167], v251, s[32:35], s77 offen offset:256 sc1
    buffer_load_dwordx4 v[168:171], v251, s[32:35], s77 offen offset:2048 sc1
    buffer_load_dwordx4 v[172:175], v251, s[32:35], s77 offen offset:2304 sc1
    s_waitcnt vmcnt(0)
    v_bitop3_b32 v9, v175, v167, v171 bitop3:0x80
    v_bitop3_b32 v9, v9, v163, 1 bitop3:0x80
    v_cmp_eq_u32 vcc, 0, v9
    s_cbranch_vccnz L_slow_g1b_13
    s_branch L_back_g1b_13
L_give_g1b_13:
    s_mov_b32 s27, 0
    s_waitcnt vmcnt(0)
    s_branch L_back_g1b_13
L_slow_g1brs:
    s_sub_u32 s27, s27, 1
    s_cbranch_scc1 L_give_g1brs
    s_sleep 1
    buffer_load_dwordx4 v[176:179], v2, s[28:31], s9 offen offset:0 sc1
    buffer_load_dwordx4 v[180:183], v2, s[28:31], s9 offen offset:1024 sc1
    buffer_load_dwordx4 v[184:187], v2, s[28:31], s9 offen offset:2048 sc1
    s_mov_b32 exec_hi, 0
    buffer_load_dwordx4 v[188:191], v2, s[28:31], s9 offen offset:3072 sc1
    s_mov_b64 exec, -1
    s_waitcnt vmcnt(2)
    v_add_f32 v192, v176, v180
    v_add_f32 v193, v177, v181
    v_add_f32 v194, v178, v182
    v_add_f32 v195, v179, v183
    s_waitcnt vmcnt(0)
    v_add_f32 v196, v184, v188
    v_add_f32 v197, v185, v189
    v_add_f32 v198, v186, v190
    v_add_f32 v199, v187, v191
    v_add_f32 v192, v192, v196
    v_add_f32 v193, v193, v197
    v_add_f32 v194, v194, v198
    v_add_f32 v195, v195, v199
    s_nop 0
    v_permlane32_swap_b32 v192, v194
    v_permlane32_swap_b32 v193, v195
    v_add_f32 v192, v192, v194
    v_add_f32 v193, v193, v195
    s_nop 1
    v_permlane16_swap_b32 v192, v193
    v_add_f32 v192, v192, v193
    v_cmp_u_f32 s[98:99], v192, v192
    s_nop 0
    s_cmp_lg_u64 s[98:99], 0
    s_cbranch_scc1 L_slow_g1brs
    s_branch L_back_g1brs
L_give_g1brs:
    s_mov_b32 s27, 0
    s_waitcnt vmcnt(0)
    s_branch L_back_g1brs
L_alt_g1bh00:
    buffer_store_dwordx4 v[208:211], v2, s[28:31], s55 offen offset:0 sc1
    buffer_store_dwordx4 v[212:215], v2, s[28:31], s55 offen offset:1024 sc1
    s_branch L_ret_g1bh00
L_alt_g1bh01:
    buffer_store_dwordx4 v[224:227], v2, s[28:31], s55 offen offset:2048 sc1
    buffer_store_dwordx4 v[228:231], v2, s[28:31], s55 offen offset:3072 sc1
    s_branch L_ret_g1bh01
L_alt_g1bh11:
    buffer_store_dwordx4 v[208:211], v2, s[28:31], s59 offen offset:2048 sc1
    buffer_store_dwordx4 v[212:215], v2, s[28:31], s59 offen offset:3072 sc1
    s_branch L_ret_g1bh11
L_slow_g2b_0:
    s_sub_u32 s27, s27, 1
    s_cbranch_scc1 L_give_g2b_0
    s_sleep 1
    buffer_load_dwordx4 v[144:147], v7, s[40:43], s80 offen offset:0 sc1 nt
    buffer_load_dwordx4 v[148:151], v8, s[40:43], s80 offen offset:0 sc1 nt
    buffer_load_dwordx4 v[152:155], v7, s[40:43], s81 offen offset:0 sc1 nt
    buffer_load_dwordx4 v[156:159], v8, s[40:43], s81 offen offset:0 sc1 nt
    buffer_load_dwordx4 v[160:163], v7, s[40:43], s82 offen offset:0 sc1 nt
    buffer_load_dwordx4 v[164:167], v8, s[40:43], s82 offen offset:0 sc1 nt
    buffer_load_dwordx4 v[168:171], v7, s[40:43], s83 offen offset:0 sc1 nt
    buffer_load_dwordx4 v[172:175], v8, s[40:43], s83 offen offset:0 sc1 nt
    buffer_load_dwordx4 v[176:179], v7, s[40:43], s84 offen offset:0 sc1 nt
    buffer_load_dwordx4 v[180:183], v8, s[40:43], s84 offen offset:0 sc1 nt
    buffer_load_dwordx4 v[184:187], v7, s[40:43], s85 offen offset:0 sc1 nt
    buffer_load_dwordx4 v[188:191], v8, s[40:43], s85 offen offset:0 sc1 nt
    s_waitcnt vmcnt(8)
    v_bitop3_b32 v9, v156, v148, v152 bitop3:0x80
    v_bitop3_b32 v9, v9, v144, 1 bitop3:0x80
    v_cmp_eq_u32 vcc, 0, v9
    s_cbranch_vccnz L_slow_g2b_0
    s_waitcnt vmcnt(4)
    s_branch L_back_g2b_0
L_give_g2b_0:
    s_mov_b32 s27, 0
    s_waitcnt vmcnt(0)
    s_branch L_back_g2b_0
L_slow_g2b_1:
    s_sub_u32 s27, s27, 1
    s_cbranch_scc1 L_give_g2b_1
    s_sleep 1
    buffer_load_dwordx4 v[160:163], v7, s[40:43], s82 offen offset:0 sc1 nt
    buffer_load_dwordx4 v[164:167], v8, s[40:43], s82 offen offset:0 sc1 nt
    buffer_load_dwordx4 v[168:171], v7, s[40:43], s83 offen offset:0 sc1 nt
    buffer_load_dwordx4 v[172:175], v8, s[40:43], s83 offen offset:0 sc1 nt
    buffer_load_dwordx4 v[176:179], v7, s[40:43], s84 offen offset:0 sc1 nt
    buffer_load_dwordx4 v[180:183], v8, s[40:43], s84 offen offset:0 sc1 nt
    buffer_load_dwordx4 v[184:187], v7, s[40:43], s85 offen offset:0 sc1 nt
    buffer_load_dwordx4 v[188:191], v8, s[40:43], s85 offen offset:0 sc1 nt
    buffer_load_dwordx4 v[192:195], v7, s[40:43], s86 offen offset:0 sc1 nt
    buffer_load_dwordx4 v[196:199], v8, s[40:43], s86 offen offset:0 sc1 nt
    buffer_load_dwordx4 v[200:203], v7, s[40:43], s80 offen offset:2048 sc1 nt
    buffer_load_dwordx4 v[204:207], v8, s[40:43], s80 offen offset:2048 sc1 nt
    buffer_load_dwordx4 v[80:83], v7, s[40:43], s81 offen offset:2048 sc1 nt
    buffer_load_dwordx4 v[84:87], v8, s[40:43], s81 offen offset:2048 sc1 nt
    buffer_load_dwordx4 v[88:91], v7, s[40:43], s82 offen offset:2048 sc1 nt
    buffer_load_dwordx4 v[92:95], v8, s[40:43], s82 offen offset:2048 sc1 nt
    s_waitcnt vmcnt(12)
    v_bitop3_b32 v9, v172, v164, v168 bitop3:0x80
    v_bitop3_b32 v9, v9, v160, 1 bitop3:0x80
    v_cmp_eq_u32 vcc, 0, v9
    s_cbranch_vccnz L_slow_g2b_1
    s_branch L_back_g2b_1
L_give_g2b_1:
    s_mov_b32 s27, 0
    s_waitcnt vmcnt(0)
    s_branch L_back_g2b_1
L_alt_g1bh10:
    buffer_store_dwordx4 v[224:227], v2, s[28:31], s59 offen offset:0 sc1
    buffer_store_dwordx4 v[228:231], v2, s[28:31], s59 offen offset:1024 sc1
    s_branch L_ret_g1bh10
L_slow_g2b_2:
    s_sub_u32 s27, s27, 1
    s_cbranch_scc1 L_give_g2b_2
    s_sleep 1
    buffer_load_dwordx4 v[176:179], v7, s[40:43], s84 offen offset:0 sc1 nt
    buffer_load_dwordx4 v[180:183], v8, s[40:43], s84 offen offset:0 sc1 nt
    buffer_load_dwordx4 v[184:187], v7, s[40:43], s85 offen offset:0 sc1 nt
    buffer_load_dwordx4 v[188:191], v8, s[40:43], s85 offen offset:0 sc1 nt
    buffer_load_dwordx4 v[192:195], v7, s[40:43], s86 offen offset:0 sc1 nt
    buffer_load_dwordx4 v[196:199], v8, s[40:43], s86 offen offset:0 sc1 nt
    buffer_load_dwordx4 v[200:203], v7, s[40:43], s80 offen offset:2048 sc1 nt
    buffer_load_dwordx4 v[204:207], v8, s[40:43], s80 offen offset:2048 sc1 nt
    buffer_load_dwordx4 v[80:83], v7, s[40:43], s81 offen offset:2048 sc1 nt
    buffer_load_dwordx4 v[84:87], v8, s[40:43], s81 offen offset:2048 sc1 nt
    buffer_load_dwordx4 v[88:91], v7, s[40:43], s82 offen offset:2048 sc1 nt
    buffer_load_dwordx4 v[92:95], v8, s[40:43], s82 offen offset:2048 sc1 nt
    buffer_load_dwordx4 v[96:99], v7, s[40:43], s83 offen offset:2048 sc1 nt
    buffer_load_dwordx4 v[100:103], v8, s[40:43], s83 offen offset:2048 sc1 nt
    buffer_load_dwordx4 v[104:107], v7, s[40:43], s84 offen offset:2048 sc1 nt
    buffer_load_dwordx4 v[108:111], v8, s[40:43], s84 offen offset:2048 sc1 nt
    s_waitcnt vmcnt(12)
    v_bitop3_b32 v9, v188, v180, v184 bitop3:0x80
    v_bitop3_b32 v9, v9, v176, 1 bitop3:0x80
    v_cmp_eq_u32 vcc, 0, v9
    s_cbranch_vccnz L_slow_g2b_2
    s_waitcnt vmcnt(0)
    s_branch L_back_g2b_2
L_give_g2b_2:
    s_mov_b32 s27, 0
    s_waitcnt vmcnt(0)
    s_branch L_back_g2b_2
L_slow_g2b_3:
    s_sub_u32 s27, s27, 1
    s_cbranch_scc1 L_give_g2b_3
    s_sleep 1
    buffer_load_dwordx4 v[192:195], v7, s[40:43], s86 offen offset:0 sc1 nt
    buffer_load_dwordx4 v[196:199], v8, s[40:43], s86 offen offset:0 sc1 nt
    buffer_load_dwordx4 v[200:203], v7, s[40:43], s80 offen offset:2048 sc1 nt
    buffer_load_dwordx4 v[204:207], v8, s[40:43], s80 offen offset:2048 sc1 nt
    buffer_load_dwordx4 v[80:83], v7, s[40:43], s81 offen offset:2048 sc1 nt
    buffer_load_dwordx4 v[84:87], v8, s[40:43], s81 offen offset:2048 sc1 nt
    buffer_load_dwordx4 v[88:91], v7, s[40:43], s82 offen offset:2048 sc1 nt
    buffer_load_dwordx4 v[92:95], v8, s[40:43], s82 offen offset:2048 sc1 nt
    buffer_load_dwordx4 v[96:99], v7, s[40:43], s83 offen offset:2048 sc1 nt
    buffer_load_dwordx4 v[100:103], v8, s[40:43], s83 offen offset:2048 sc1 nt
    buffer_load_dwordx4 v[104:107], v7, s[40:43], s84 offen offset:2048 sc1 nt
    buffer_load_dwordx4 v[108:111], v8, s[40:43], s84 offen offset:2048 sc1 nt
    buffer_load_dwordx4 v[144:147], v7, s[40:43], s85 offen offset:2048 sc1 nt
    buffer_load_dwordx4 v[148:151], v8, s[40:43], s85 offen offset:2048 sc1 nt
    buffer_load_dwordx4 v[152:155], v7, s[40:43], s86 offen offset:2048 sc1 nt
    buffer_load_dwordx4 v[156:159], v8, s[40:43], s86 offen offset:2048 sc1 nt
    s_waitcnt vmcnt(12)
    v_bitop3_b32 v9, v204, v196, v200 bitop3:0x80
    v_bitop3_b32 v9, v9, v192, 1 bitop3:0x80
    v_cmp_eq_u32 vcc, 0, v9
    s_cbranch_vccnz L_slow_g2b_3
    s_waitcnt vmcnt(4)
    s_branch L_back_g2b_3
L_give_g2b_3:
    s_mov_b32 s27, 0
    s_waitcnt vmcnt(0)
    s_branch L_back_g2b_3
L_slow_g2b_4:
    s_sub_u32 s27, s27, 1
    s_cbranch_scc1 L_give_g2b_4
    s_sleep 1
    buffer_load_dwordx4 v[80:83], v7, s[40:43], s81 offen offset:2048 sc1 nt
    buffer_load_dwordx4 v[84:87], v8, s[40:43], s81 offen offset:2048 sc1 nt
    buffer_load_dwordx4 v[88:91], v7, s[40:43], s82 offen offset:2048 sc1 nt
    buffer_load_dwordx4 v[92:95], v8, s[40:43], s82 offen offset:2048 sc1 nt
    buffer_load_dwordx4 v[96:99], v7, s[40:43], s83 offen offset:2048 sc1 nt
    buffer_load_dwordx4 v[100:103], v8, s[40:43], s83 offen offset:2048 sc1 nt
    buffer_load_dwordx4 v[104:107], v7, s[40:43], s84 offen offset:2048 sc1 nt
    buffer_load_dwordx4 v[108:111], v8, s[40:43], s84 offen offset:2048 sc1 nt
    buffer_load_dwordx4 v[144:147], v7, s[40:43], s85 offen offset:2048 sc1 nt
    buffer_load_dwordx4 v[148:151], v8, s[40:43], s85 offen offset:2048 sc1 nt
    buffer_load_dwordx4 v[152:155], v7, s[40:43], s86 offen offset:2048 sc1 nt
    buffer_load_dwordx4 v[156:159], v8, s[40:43], s86 offen offset:2048 sc1 nt
    buffer_load_dwordx4 v[160:163], v7, s[40:43], s87 offen offset:2048 sc1 nt
    buffer_load_dwordx4 v[164:167], v8, s[40:43], s87 offen offset:2048 sc1 nt
    buffer_load_dwordx4 v[168:171], v7, s[40:43], s88 offen offset:2048 sc1 nt
    buffer_load_dwordx4 v[172:175], v8, s[40:43], s88 offen offset:2048 sc1 nt
    s_waitcnt vmcnt(12)
    v_bitop3_b32 v9, v92, v84, v88 bitop3:0x80
    v_bitop3_b32 v9, v9, v80, 1 bitop3:0x80
    v_cmp_eq_u32 vcc, 0, v9
    s_cbranch_vccnz L_slow_g2b_4
    s_waitcnt vmcnt(8)
    s_branch L_back_g2b_4
L_give_g2b_4:
    s_mov_b32 s27, 0
    s_waitcnt vmcnt(0)
    s_branch L_back_g2b_4
L_slow_g2b_5:
    s_sub_u32 s27, s27, 1
    s_cbranch_scc1 L_give_g2b_5
    s_sleep 1
    buffer_load_dwordx4 v[96:99], v7, s[40:43], s83 offen offset:2048 sc1 nt
    buffer_load_dwordx4 v[100:103], v8, s[40:43], s83 offen offset:2048 sc1 nt
    buffer_load_dwordx4 v[104:107], v7, s[40:43], s84 offen offset:2048 sc1 nt
    buffer_load_dwordx4 v[108:111], v8, s[40:43], s84 offen offset:2048 sc1 nt
    buffer_load_dwordx4 v[144:147], v7, s[40:43], s85 offen offset:2048 sc1 nt
    buffer_load_dwordx4 v[148:151], v8, s[40:43], s85 offen offset:2048 sc1 nt
    buffer_load_dwordx4 v[152:155], v7, s[40:43], s86 offen offset:2048 sc1 nt
    buffer_load_dwordx4 v[156:159], v8, s[40:43], s86 offen offset:2048 sc1 nt
    buffer_load_dwordx4 v[160:163], v7, s[40:43], s87 offen offset:2048 sc1 nt
    buffer_load_dwordx4 v[164:167], v8, s[40:43], s87 offen offset:2048 sc1 nt
    buffer_load_dwordx4 v[168:171], v7, s[40:43], s88 offen offset:2048 sc1 nt
    buffer_load_dwordx4 v[172:175], v8, s[40:43], s88 offen offset:2048 sc1 nt
    buffer_load_dwordx4 v[176:179], v7, s[40:43], s89 offen offset:2048 sc1 nt
    buffer_load_dwordx4 v[180:183], v8, s[40:43], s89 offen offset:2048 sc1 nt
    buffer_load_dwordx4 v[184:187], v7, s[40:43], s90 offen offset:2048 sc1 nt
    buffer_load_dwordx4 v[188:191], v8, s[40:43], s90 offen offset:2048 sc1 nt
    s_waitcnt vmcnt(12)
    v_bitop3_b32 v9, v108, v100, v104 bitop3:0x80
    v_bitop3_b32 v9, v9, v96, 1 bitop3:0x80
    v_cmp_eq_u32 vcc, 0, v9
    s_cbranch_vccnz L_slow_g2b_5
    s_branch L_back_g2b_5
L_give_g2b_5:
    s_mov_b32 s27, 0
    s_waitcnt vmcnt(0)
    s_branch L_back_g2b_5
L_slow_g2b_6:
    s_sub_u32 s27, s27, 1
    s_cbranch_scc1 L_give_g2b_6
    s_sleep 1
    buffer_load_dwordx4 v[144:147], v7, s[40:43], s85 offen offset:2048 sc1 nt
    buffer_load_dwordx4 v[148:151], v8, s[40:43], s85 offen offset:2048 sc1 nt
    buffer_load_dwordx4 v[152:155], v7, s[40:43], s86 offen offset:2048 sc1 nt
    buffer_load_dwordx4 v[156:159], v8, s[40:43], s86 offen offset:2048 sc1 nt
    buffer_load_dwordx4 v[160:163], v7, s[40:43], s87 offen offset:2048 sc1 nt
    buffer_load_dwordx4 v[164:167], v8, s[40:43], s87 offen offset:2048 sc1 nt
    buffer_load_dwordx4 v[168:171], v7, s[40:43], s88 offen offset:2048 sc1 nt
    buffer_load_dwordx4 v[172:175], v8, s[40:43], s88 offen offset:2048 sc1 nt
    buffer_load_dwordx4 v[176:179], v7, s[40:43], s89 offen offset:2048 sc1 nt
    buffer_load_dwordx4 v[180:183], v8, s[40:43], s89 offen offset:2048 sc1 nt
    buffer_load_dwordx4 v[184:187], v7, s[40:43], s90 offen offset:2048 sc1 nt
    buffer_load_dwordx4 v[188:191], v8, s[40:43], s90 offen offset:2048 sc1 nt
    buffer_load_dwordx4 v[192:195], v7, s[40:43], s91 offen offset:2048 sc1 nt
    buffer_load_dwordx4 v[196:199], v8, s[40:43], s91 offen offset:2048 sc1 nt
    buffer_load_dwordx4 v[200:203], v7, s[40:43], s92 offen offset:2048 sc1 nt
    buffer_load_dwordx4 v[204:207], v8, s[40:43], s92 offen offset:2048 sc1 nt
    s_waitcnt vmcnt(12)
    v_bitop3_b32 v9, v156, v148, v152 bitop3:0x80
    v_bitop3_b32 v9, v9, v144, 1 bitop3:0x80
    v_cmp_eq_u32 vcc, 0, v9
    s_cbranch_vccnz L_slow_g2b_6
    s_waitcnt vmcnt(0)
    s_branch L_back_g2b_6
L_give_g2b_6:
    s_mov_b32 s27, 0
    s_waitcnt vmcnt(0)
    s_branch L_back_g2b_6
L_slow_g2b_7:
    s_sub_u32 s27, s27, 1
    s_cbranch_scc1 L_give_g2b_7
    s_sleep 1
    buffer_load_dwordx4 v[160:163], v7, s[40:43], s87 offen offset:2048 sc1 nt
    buffer_load_dwordx4 v[164:167], v8, s[40:43], s87 offen offset:2048 sc1 nt
    buffer_load_dwordx4 v[168:171], v7, s[40:43], s88 offen offset:2048 sc1 nt
    buffer_load_dwordx4 v[172:175], v8, s[40:43], s88 offen offset:2048 sc1 nt
    buffer_load_dwordx4 v[176:179], v7, s[40:43], s89 offen offset:2048 sc1 nt
    buffer_load_dwordx4 v[180:183], v8, s[40:43], s89 offen offset:2048 sc1 nt
    buffer_load_dwordx4 v[184:187], v7, s[40:43], s90 offen offset:2048 sc1 nt
    buffer_load_dwordx4 v[188:191], v8, s[40:43], s90 offen offset:2048 sc1 nt
    buffer_load_dwordx4 v[192:195], v7, s[40:43], s91 offen offset:2048 sc1 nt
    buffer_load_dwordx4 v[196:199], v8, s[40:43], s91 offen offset:2048 sc1 nt
    buffer_load_dwordx4 v[200:203], v7, s[40:43], s92 offen offset:2048 sc1 nt
    buffer_load_dwordx4 v[204:207], v8, s[40:43], s92 offen offset:2048 sc1 nt
    buffer_load_dwordx4 v[80:83], v7, s[40:43], s93 offen offset:2048 sc1 nt
    buffer_load_dwordx4 v[84:87], v8, s[40:43], s93 offen offset:2048 sc1 nt
    buffer_load_dwordx4 v[88:91], v7, s[40:43], s87 offen offset:0 sc1 nt
    buffer_load_dwordx4 v[92:95], v8, s[40:43], s87 offen offset:0 sc1 nt
    s_waitcnt vmcnt(12)
    v_bitop3_b32 v9, v172, v164, v168 bitop3:0x80
    v_bitop3_b32 v9, v9, v160, 1 bitop3:0x80
    v_cmp_eq_u32 vcc, 0, v9
    s_cbranch_vccnz L_slow_g2b_7
    s_waitcnt vmcnt(4)
    s_branch L_back_g2b_7
L_give_g2b_7:
    s_mov_b32 s27, 0
    s_waitcnt vmcnt(0)
    s_branch L_back_g2b_7
L_slow_g2b_8:
    s_sub_u32 s27, s27, 1
    s_cbranch_scc1 L_give_g2b_8
    s_sleep 1
    buffer_load_dwordx4 v[176:179], v7, s[40:43], s89 offen offset:2048 sc1 nt
    buffer_load_dwordx4 v[180:183], v8, s[40:43], s89 offen offset:2048 sc1 nt
    buffer_load_dwordx4 v[184:187], v7, s[40:43], s90 offen offset:2048 sc1 nt
    buffer_load_dwordx4 v[188:191], v8, s[40:43], s90 offen offset:2048 sc1 nt
    buffer_load_dwordx4 v[192:195], v7, s[40:43], s91 offen offset:2048 sc1 nt
    buffer_load_dwordx4 v[196:199], v8, s[40:43], s91 offen offset:2048 sc1 nt
    buffer_load_dwordx4 v[200:203], v7, s[40:43], s92 offen offset:2048 sc1 nt
    buffer_load_dwordx4 v[204:207], v8, s[40:43], s92 offen offset:2048 sc1 nt
    buffer_load_dwordx4 v[80:83], v7, s[40:43], s93 offen offset:2048 sc1 nt
    buffer_load_dwordx4 v[84:87], v8, s[40:43], s93 offen offset:2048 sc1 nt
    buffer_load_dwordx4 v[88:91], v7, s[40:43], s87 offen offset:0 sc1 nt
    buffer_load_dwordx4 v[92:95], v8, s[40:43], s87 offen offset:0 sc1 nt
    buffer_load_dwordx4 v[96:99], v7, s[40:43], s88 offen offset:0 sc1 nt
    buffer_load_dwordx4 v[100:103], v8, s[40:43], s88 offen offset:0 sc1 nt
    buffer_load_dwordx4 v[104:107], v7, s[40:43], s89 offen offset:0 sc1 nt
    buffer_load_dwordx4 v[108:111], v8, s[40:43], s89 offen offset:0 sc1 nt
    s_waitcnt vmcnt(12)
    v_bitop3_b32 v9, v188, v180, v184 bitop3:0x80
    v_bitop3_b32 v9, v9, v176, 1 bitop3:0x80
    v_cmp_eq_u32 vcc, 0, v9
    s_cbranch_vccnz L_slow_g2b_8
    s_waitcnt vmcnt(8)
    s_branch L_back_g2b_8
L_give_g2b_8:
    s_mov_b32 s27, 0
    s_waitcnt vmcnt(0)
    s_branch L_back_g2b_8
L_slow_hb:
    s_sub_u32 s27, s27, 1
    s_cbranch_scc1 L_give_hb
    s_sleep 1
    s_sleep 2
    buffer_load_dwordx2 v[252:253], v254, s[28:31], s79 offen sc1
    s_waitcnt vmcnt(0)
    v_cmp_ne_u64 s[98:99], s[12:13], v[252:253]
    s_nop 0
    s_cmp_lg_u64 s[98:99], 0
    s_cbranch_scc1 L_slow_hb
    s_branch L_back_hb
L_give_hb:
    s_mov_b32 s27, 0
    s_waitcnt vmcnt(0)
    s_branch L_back_hb
L_slow_g2b_9:
    s_sub_u32 s27, s27, 1
    s_cbranch_scc1 L_give_g2b_9
    s_sleep 1
    buffer_load_dwordx4 v[192:195], v7, s[40:43], s91 offen offset:2048 sc1 nt
    buffer_load_dwordx4 v[196:199], v8, s[40:43], s91 offen offset:2048 sc1 nt
    buffer_load_dwordx4 v[200:203], v7, s[40:43], s92 offen offset:2048 sc1 nt
    buffer_load_dwordx4 v[204:207], v8, s[40:43], s92 offen offset:2048 sc1 nt
    buffer_load_dwordx4 v[80:83], v7, s[40:43], s93 offen offset:2048 sc1 nt
    buffer_load_dwordx4 v[84:87], v8, s[40:43], s93 offen offset:2048 sc1 nt
    buffer_load_dwordx4 v[88:91], v7, s[40:43], s87 offen offset:0 sc1 nt
    buffer_load_dwordx4 v[92:95], v8, s[40:43], s87 offen offset:0 sc1 nt
    buffer_load_dwordx4 v[96:99], v7, s[40:43], s88 offen offset:0 sc1 nt
    buffer_load_dwordx4 v[100:103], v8, s[40:43], s88 offen offset:0 sc1 nt
    buffer_load_dwordx4 v[104:107], v7, s[40:43], s89 offen offset:0 sc1 nt
    buffer_load_dwordx4 v[108:111], v8, s[40:43], s89 offen offset:0 sc1 nt
    buffer_load_dwordx4 v[144:147], v7, s[40:43], s90 offen offset:0 sc1 nt
    buffer_load_dwordx4 v[148:151], v8, s[40:43], s90 offen offset:0 sc1 nt
    buffer_load_dwordx4 v[152:155], v7, s[40:43], s91 offen offset:0 sc1 nt
    buffer_load_dwordx4 v[156:159], v8, s[40:43], s91 offen offset:0 sc1 nt
    s_waitcnt vmcnt(12)
    v_bitop3_b32 v9, v204, v196, v200 bitop3:0x80
    v_bitop3_b32 v9, v9, v192, 1 bitop3:0x80
    v_cmp_eq_u32 vcc, 0, v9
    s_cbranch_vccnz L_slow_g2b_9
    s_branch L_back_g2b_9
L_give_g2b_9:
    s_mov_b32 s27, 0
    s_waitcnt vmcnt(0)
    s_branch L_back_g2b_9
L_slow_g2b_10:
    s_sub_u32 s27, s27, 1
    s_cbranch_scc1 L_give_g2b_10
    s_sleep 1
    buffer_load_dwordx4 v[80:83], v7, s[40:43], s93 offen offset:2048 sc1 nt
    buffer_load_dwordx4 v[84:87], v8, s[40:43], s93 offen offset:2048 sc1 nt
    buffer_load_dwordx4 v[88:91], v7, s[40:43], s87 offen offset:0 sc1 nt
    buffer_load_dwordx4 v[92:95], v8, s[40:43], s87 offen offset:0 sc1 nt
    buffer_load_dwordx4 v[96:99], v7, s[40:43], s88 offen offset:0 sc1 nt
    buffer_load_dwordx4 v[100:103], v8, s[40:43], s88 offen offset:0 sc1 nt
    buffer_load_dwordx4 v[104:107], v7, s[40:43], s89 offen offset:0 sc1 nt
    buffer_load_dwordx4 v[108:111], v8, s[40:43], s89 offen offset:0 sc1 nt
    buffer_load_dwordx4 v[144:147], v7, s[40:43], s90 offen offset:0 sc1 nt
    buffer_load_dwordx4 v[148:151], v8, s[40:43], s90 offen offset:0 sc1 nt
    buffer_load_dwordx4 v[152:155], v7, s[40:43], s91 offen offset:0 sc1 nt
    buffer_load_dwordx4 v[156:159], v8, s[40:43], s91 offen offset:0 sc1 nt
    buffer_load_dwordx4 v[160:163], v7, s[40:43], s92 offen offset:0 sc1 nt
    buffer_load_dwordx4 v[164:167], v8, s[40:43], s92 offen offset:0 sc1 nt
    buffer_load_dwordx4 v[168:171], v7, s[40:43], s93 offen offset:0 sc1 nt
    buffer_load_dwordx4 v[172:175], v8, s[40:43], s93 offen offset:0 sc1 nt
    s_waitcnt vmcnt(12)
    v_bitop3_b32 v9, v92, v84, v88 bitop3:0x80
    v_bitop3_b32 v9, v9, v80, 1 bitop3:0x80
    v_cmp_eq_u32 vcc, 0, v9
    s_cbranch_vccnz L_slow_g2b_10
    s_waitcnt vmcnt(0)
    s_branch L_back_g2b_10
L_give_g2b_10:
    s_mov_b32 s27, 0
    s_waitcnt vmcnt(0)
    s_branch L_back_g2b_10
L_slow_g2b_11:
    s_sub_u32 s27, s27, 1
    s_cbranch_scc1 L_give_g2b_11
    s_sleep 1
    buffer_load_dwordx4 v[96:99], v7, s[40:43], s88 offen offset:0 sc1 nt
    buffer_load_dwordx4 v[100:103], v8, s[40:43], s88 offen offset:0 sc1 nt
    buffer_load_dwordx4 v[104:107], v7, s[40:43], s89 offen offset:0 sc1 nt
    buffer_load_dwordx4 v[108:111], v8, s[40:43], s89 offen offset:0 sc1 nt
    buffer_load_dwordx4 v[144:147], v7, s[40:43], s90 offen offset:0 sc1 nt
    buffer_load_dwordx4 v[148:151], v8, s[40:43], s90 offen offset:0 sc1 nt
    buffer_load_dwordx4 v[152:155], v7, s[40:43], s91 offen offset:0 sc1 nt
    buffer_load_dwordx4 v[156:159], v8, s[40:43], s91 offen offset:0 sc1 nt
    buffer_load_dwordx4 v[160:163], v7, s[40:43], s92 offen offset:0 sc1 nt
    buffer_load_dwordx4 v[164:167], v8, s[40:43], s92 offen offset:0 sc1 nt
    buffer_load_dwordx4 v[168:171], v7, s[40:43], s93 offen offset:0 sc1 nt
    buffer_load_dwordx4 v[172:175], v8, s[40:43], s93 offen offset:0 sc1 nt
    s_waitcnt vmcnt(8)
    v_bitop3_b32 v9, v108, v100, v104 bitop3:0x80
    v_bitop3_b32 v9, v9, v96, 1 bitop3:0x80
    v_cmp_eq_u32 vcc, 0, v9
    s_cbranch_vccnz L_slow_g2b_11
    s_waitcnt vmcnt(0)
    s_branch L_back_g2b_11
L_give_g2b_11:
    s_mov_b32 s27, 0
    s_waitcnt vmcnt(0)
    s_branch L_back_g2b_11
L_slow_g2b_12:
    s_sub_u32 s27, s27, 1
    s_cbranch_scc1 L_give_g2b_12
    s_sleep 1
    buffer_load_dwordx4 v[144:147], v7, s[40:43], s90 offen offset:0 sc1 nt
    buffer_load_dwordx4 v[148:151], v8, s[40:43], s90 offen offset:0 sc1 nt
    buffer_load_dwordx4 v[152:155], v7, s[40:43], s91 offen offset:0 sc1 nt
    buffer_load_dwordx4 v[156:159], v8, s[40:43], s91 offen offset:0 sc1 nt
    buffer_load_dwordx4 v[160:163], v7, s[40:43], s92 offen offset:0 sc1 nt
    buffer_load_dwordx4 v[164:167], v8, s[40:43], s92 offen offset:0 sc1 nt
    buffer_load_dwordx4 v[168:171], v7, s[40:43], s93 offen offset:0 sc1 nt
    buffer_load_dwordx4 v[172:175], v8, s[40:43], s93 offen offset:0 sc1 nt
    s_waitcnt vmcnt(4)
    v_bitop3_b32 v9, v156, v148, v152 bitop3:0x80
    v_bitop3_b32 v9, v9, v144, 1 bitop3:0x80
    v_cmp_eq_u32 vcc, 0, v9
    s_cbranch_vccnz L_slow_g2b_12
    s_waitcnt vmcnt(0)
    s_branch L_back_g2b_12
L_give_g2b_12:
    s_mov_b32 s27, 0
    s_waitcnt vmcnt(0)
    s_branch L_back_g2b_12
L_slow_rf:
    s_sub_u32 s27, s27, 1
    s_cbranch_scc1 L_give_rf
    s_sleep 1
    buffer_load_dwordx4 v[208:211], v5, s[28:31], s58 offen offset:0 sc1
    buffer_load_dwordx4 v[212:215], v5, s[28:31], s58 offen offset:1024 sc1
    buffer_load_dwordx4 v[216:219], v5, s[28:31], s60 offen offset:0 sc1
    buffer_load_dwordx4 v[220:223], v5, s[28:31], s60 offen offset:1024 sc1
    s_waitcnt vmcnt(0)
    v_max3_u32 v10, v220, v212, v216
    v_max_u32 v10, v10, v208
    v_cmp_eq_u32 s[98:99], -1, v10
    s_nop 0
    s_cmp_lg_u64 s[98:99], 0
    s_cbranch_scc1 L_slow_rf
    s_branch L_back_rf
L_give_rf:
    s_mov_b32 s27, 0
    s_waitcnt vmcnt(0)
    s_branch L_back_rf
L_slow_g2b_13:
    s_sub_u32 s27, s27, 1
    s_cbranch_scc1 L_give_g2b_13
    s_sleep 1
    buffer_load_dwordx4 v[160:163], v7, s[40:43], s92 offen offset:0 sc1 nt
    buffer_load_dwordx4 v[164:167], v8, s[40:43], s92 offen offset:0 sc1 nt
    buffer_load_dwordx4 v[168:171], v7, s[40:43], s93 offen offset:0 sc1 nt
    buffer_load_dwordx4 v[172:175], v8, s[40:43], s93 offen offset:0 sc1 nt
    s_waitcnt vmcnt(0)
    v_bitop3_b32 v9, v172, v164, v168 bitop3:0x80
    v_bitop3_b32 v9, v9, v160, 1 bitop3:0x80
    v_cmp_eq_u32 vcc, 0, v9
    s_cbranch_vccnz L_slow_g2b_13
    s_branch L_back_g2b_13
L_give_g2b_13:
    s_mov_b32 s27, 0
    s_waitcnt vmcnt(0)
    s_branch L_back_g2b_13
L_slow_hf1:
    s_sub_u32 s27, s27, 1
    s_cbranch_scc1 L_give_hf1
    s_sleep 1
    s_sleep 2
    buffer_load_dwordx2 v[252:253], v11, s[28:31], s4 offen sc1
    s_waitcnt vmcnt(0)
    v_cmp_ne_u64 vcc, s[12:13], v[252:253]
    s_cbranch_vccnz L_slow_hf1
    s_branch L_back_hf1
L_give_hf1:
    s_mov_b32 s27, 0
    s_waitcnt vmcnt(0)
    s_branch L_back_hf1
L_slow_hpl:
    s_sub_u32 s27, s27, 1
    s_cbranch_scc1 L_give_hpl
    s_sleep 1
    s_sleep 8
    buffer_load_dword v10, off, s[32:35], s64 offset:12 sc1
    s_waitcnt vmcnt(0)
    v_and_b32 v10, 1, v10
    v_cmp_eq_u32 vcc, 0, v10
    s_cbranch_vccnz L_slow_hpl
    s_branch L_back_hpl
L_give_hpl:
    s_mov_b32 s27, 0
    s_waitcnt vmcnt(0)
    s_branch L_back_hpl
L_slow_hr_0:
    s_sub_u32 s27, s27, 1
    s_cbranch_scc1 L_give_hr_0
    s_sleep 1
    buffer_load_dwordx4 v[144:147], v251, s[32:35], s64 offen offset:0 sc1
    buffer_load_dwordx4 v[148:151], v251, s[32:35], s64 offen offset:2048 sc1
    buffer_load_dwordx4 v[152:155], v12, s[32:35], s64 offen offset:0 sc1
    buffer_load_dwordx4 v[156:159], v12, s[32:35], s64 offen offset:2048 sc1
    buffer_load_dwordx4 v[160:163], v251, s[32:35], s64 offen offset:256 sc1
    buffer_load_dwordx4 v[164:167], v251, s[32:35], s64 offen offset:2304 sc1
    buffer_load_dwordx4 v[168:171], v12, s[32:35], s64 offen offset:256 sc1
    buffer_load_dwordx4 v[172:175], v12, s[32:35], s64 offen offset:2304 sc1
    buffer_load_dwordx4 v[176:179], v251, s[32:35], s65 offen offset:0 sc1
    buffer_load_dwordx4 v[180:183], v251, s[32:35], s65 offen offset:2048 sc1
    buffer_load_dwordx4 v[184:187], v12, s[32:35], s65 offen offset:0 sc1
    buffer_load_dwordx4 v[188:191], v12, s[32:35], s65 offen offset:2048 sc1
    buffer_load_dwordx4 v[192:195], v251, s[32:35], s65 offen offset:256 sc1
    buffer_load_dwordx4 v[196:199], v251, s[32:35], s65 offen offset:2304 sc1
    buffer_load_dwordx4 v[200:203], v12, s[32:35], s65 offen offset:256 sc1
    buffer_load_dwordx4 v[204:207], v12, s[32:35], s65 offen offset:2304 sc1
    buffer_load_dwordx4 v[208:211], v251, s[32:35], s66 offen offset:0 sc1
    buffer_load_dwordx4 v[212:215], v251, s[32:35], s66 offen offset:2048 sc1
    buffer_load_dwordx4 v[216:219], v12, s[32:35], s66 offen offset:0 sc1
    buffer_load_dwordx4 v[220:223], v12, s[32:35], s66 offen offset:2048 sc1
    s_waitcnt vmcnt(17)
    v_bitop3_b32 v9, v147, v151, v155 bitop3:0x80
    s_waitcnt vmcnt(16)
    v_bitop3_b32 v9, v9, v159, 1 bitop3:0x80
    v_cmp_eq_u32 vcc, 0, v9
    s_cbranch_vccnz L_slow_hr_0
    s_branch L_back_hr_0
L_give_hr_0:
    s_mov_b32 s27, 0
    s_waitcnt vmcnt(0)
    s_branch L_back_hr_0
L_slow_hr_1:
    s_sub_u32 s27, s27, 1
    s_cbranch_scc1 L_give_hr_1
    s_sleep 1
    buffer_load_dwordx4 v[160:163], v251, s[32:35], s64 offen offset:256 sc1
    buffer_load_dwordx4 v[164:167], v251, s[32:35], s64 offen offset:2304 sc1
    buffer_load_dwordx4 v[168:171], v12, s[32:35], s64 offen offset:256 sc1
    buffer_load_dwordx4 v[172:175], v12, s[32:35], s64 offen offset:2304 sc1
    buffer_load_dwordx4 v[176:179], v251, s[32:35], s65 offen offset:0 sc1
    buffer_load_dwordx4 v[180:183], v251, s[32:35], s65 offen offset:2048 sc1
    buffer_load_dwordx4 v[184:187], v12, s[32:35], s65 offen offset:0 sc1
    buffer_load_dwordx4 v[188:191], v12, s[32:35], s65 offen offset:2048 sc1
    buffer_load_dwordx4 v[192:195], v251, s[32:35], s65 offen offset:256 sc1
    buffer_load_dwordx4 v[196:199], v251, s[32:35], s65 offen offset:2304 sc1
    buffer_load_dwordx4 v[200:203], v12, s[32:35], s65 offen offset:256 sc1
    buffer_load_dwordx4 v[204:207], v12, s[32:35], s65 offen offset:2304 sc1
    buffer_load_dwordx4 v[208:211], v251, s[32:35], s66 offen offset:0 sc1
    buffer_load_dwordx4 v[212:215], v251, s[32:35], s66 offen offset:2048 sc1
    buffer_load_dwordx4 v[216:219], v12, s[32:35], s66 offen offset:0 sc1
    buffer_load_dwordx4 v[220:223], v12, s[32:35], s66 offen offset:2048 sc1
    buffer_load_dwordx4 v[224:227], v251, s[32:35], s66 offen offset:256 sc1
    buffer_load_dwordx4 v[228:231], v251, s[32:35], s66 offen offset:2304 sc1
    buffer_load_dwordx4 v[232:235], v12, s[32:35], s66 offen offset:256 sc1
    buffer_load_dwordx4 v[236:239], v12, s[32:35], s66 offen offset:2304 sc1
    s_waitcnt vmcnt(17)
    v_bitop3_b32 v9, v163, v167, v171 bitop3:0x80
    s_waitcnt vmcnt(16)
    v_bitop3_b32 v9, v9, v175, 1 bitop3:0x80
    v_cmp_eq_u32 vcc, 0, v9
    s_cbranch_vccnz L_slow_hr_1
    s_branch L_back_hr_1
L_give_hr_1:
    s_mov_b32 s27, 0
    s_waitcnt vmcnt(0)
    s_branch L_back_hr_1
L_slow_hr_2:
    s_sub_u32 s27, s27, 1
    s_cbranch_scc1 L_give_hr_2
    s_sleep 1
    buffer_load_dwordx4 v[176:179], v251, s[32:35], s65 offen offset:0 sc1
    buffer_load_dwordx4 v[180:183], v251, s[32:35], s65 offen offset:2048 sc1
    buffer_load_dwordx4 v[184:187], v12, s[32:35], s65 offen offset:0 sc1
    buffer_load_dwordx4 v[188:191], v12, s[32:35], s65 offen offset:2048 sc1
    buffer_load_dwordx4 v[192:195], v251, s[32:35], s65 offen offset:256 sc1
    buffer_load_dwordx4 v[196:199], v251, s[32:35], s65 offen offset:2304 sc1
    buffer_load_dwordx4 v[200:203], v12, s[32:35], s65 offen offset:256 sc1
    buffer_load_dwordx4 v[204:207], v12, s[32:35], s65 offen offset:2304 sc1
    buffer_load_dwordx4 v[208:211], v251, s[32:35], s66 offen offset:0 sc1
    buffer_load_dwordx4 v[212:215], v251, s[32:35], s66 offen offset:2048 sc1
    buffer_load_dwordx4 v[216:219], v12, s[32:35], s66 offen offset:0 sc1
    buffer_load_dwordx4 v[220:223], v12, s[32:35], s66 offen offset:2048 sc1
    buffer_load_dwordx4 v[224:227], v251, s[32:35], s66 offen offset:256 sc1
    buffer_load_dwordx4 v[228:231], v251, s[32:35], s66 offen offset:2304 sc1
    buffer_load_dwordx4 v[232:235], v12, s[32:35], s66 offen offset:256 sc1
    buffer_load_dwordx4 v[236:239], v12, s[32:35], s66 offen offset:2304 sc1
    buffer_load_dwordx4 v[144:147], v251, s[32:35], s67 offen offset:0 sc1
    buffer_load_dwordx4 v[148:151], v251, s[32:35], s67 offen offset:2048 sc1
    buffer_load_dwordx4 v[152:155], v12, s[32:35], s67 offen offset:0 sc1
    buffer_load_dwordx4 v[156:159], v12, s[32:35], s67 offen offset:2048 sc1
    s_waitcnt vmcnt(17)
    v_bitop3_b32 v9, v179, v183, v187 bitop3:0x80
    s_waitcnt vmcnt(16)
    v_bitop3_b32 v9, v9, v191, 1 bitop3:0x80
    v_cmp_eq_u32 vcc, 0, v9
    s_cbranch_vccnz L_slow_hr_2
    s_branch L_back_hr_2
L_give_hr_2:
    s_mov_b32 s27, 0
    s_waitcnt vmcnt(0)
    s_branch L_back_hr_2
L_slow_hr_3:
    s_sub_u32 s27, s27, 1
    s_cbranch_scc1 L_give_hr_3
    s_sleep 1
    buffer_load_dwordx4 v[192:195], v251, s[32:35], s65 offen offset:256 sc1
    buffer_load_dwordx4 v[196:199], v251, s[32:35], s65 offen offset:2304 sc1
    buffer_load_dwordx4 v[200:203], v12, s[32:35], s65 offen offset:256 sc1
    buffer_load_dwordx4 v[204:207], v12, s[32:35], s65 offen offset:2304 sc1
    buffer_load_dwordx4 v[208:211], v251, s[32:35], s66 offen offset:0 sc1
    buffer_load_dwordx4 v[212:215], v251, s[32:35], s66 offen offset:2048 sc1
    buffer_load_dwordx4 v[216:219], v12, s[32:35], s66 offen offset:0 sc1
    buffer_load_dwordx4 v[220:223], v12, s[32:35], s66 offen offset:2048 sc1
    buffer_load_dwordx4 v[224:227], v251, s[32:35], s66 offen offset:256 sc1
    buffer_load_dwordx4 v[228:231], v251, s[32:35], s66 offen offset:2304 sc1
    buffer_load_dwordx4 v[232:235], v12, s[32:35], s66 offen offset:256 sc1
    buffer_load_dwordx4 v[236:239], v12, s[32:35], s66 offen offset:2304 sc1
    buffer_load_dwordx4 v[144:147], v251, s[32:35], s67 offen offset:0 sc1
    buffer_load_dwordx4 v[148:151], v251, s[32:35], s67 offen offset:2048 sc1
    buffer_load_dwordx4 v[152:155], v12, s[32:35], s67 offen offset:0 sc1
    buffer_load_dwordx4 v[156:159], v12, s[32:35], s67 offen offset:2048 sc1
    buffer_load_dwordx4 v[160:163], v251, s[32:35], s67 offen offset:256 sc1
    buffer_load_dwordx4 v[164:167], v251, s[32:35], s67 offen offset:2304 sc1
    buffer_load_dwordx4 v[168:171], v12, s[32:35], s67 offen offset:256 sc1
    buffer_load_dwordx4 v[172:175], v12, s[32:35], s67 offen offset:2304 sc1
    s_waitcnt vmcnt(17)
    v_bitop3_b32 v9, v195, v199, v203 bitop3:0x80
    s_waitcnt vmcnt(16)
    v_bitop3_b32 v9, v9, v207, 1 bitop3:0x80
    v_cmp_eq_u32 vcc, 0, v9
    s_cbranch_vccnz L_slow_hr_3
    s_branch L_back_hr_3
L_give_hr_3:
    s_mov_b32 s27, 0
    s_waitcnt vmcnt(0)
    s_branch L_back_hr_3
L_slow_hr_4:
    s_sub_u32 s27, s27, 1
    s_cbranch_scc1 L_give_hr_4
    s_sleep 1
    buffer_load_dwordx4 v[208:211], v251, s[32:35], s66 offen offset:0 sc1
    buffer_load_dwordx4 v[212:215], v251, s[32:35], s66 offen offset:2048 sc1
    buffer_load_dwordx4 v[216:219], v12, s[32:35], s66 offen offset:0 sc1
    buffer_load_dwordx4 v[220:223], v12, s[32:35], s66 offen offset:2048 sc1
    buffer_load_dwordx4 v[224:227], v251, s[32:35], s66 offen offset:256 sc1
    buffer_load_dwordx4 v[228:231], v251, s[32:35], s66 offen offset:2304 sc1
    buffer_load_dwordx4 v[232:235], v12, s[32:35], s66 offen offset:256 sc1
    buffer_load_dwordx4 v[236:239], v12, s[32:35], s66 offen offset:2304 sc1
    buffer_load_dwordx4 v[144:147], v251, s[32:35], s67 offen offset:0 sc1
    buffer_load_dwordx4 v[148:151], v251, s[32:35], s67 offen offset:2048 sc1
    buffer_load_dwordx4 v[152:155], v12, s[32:35], s67 offen offset:0 sc1
    buffer_load_dwordx4 v[156:159], v12, s[32:35], s67 offen offset:2048 sc1
    buffer_load_dwordx4 v[160:163], v251, s[32:35], s67 offen offset:256 sc1
    buffer_load_dwordx4 v[164:167], v251, s[32:35], s67 offen offset:2304 sc1
    buffer_load_dwordx4 v[168:171], v12, s[32:35], s67 offen offset:256 sc1
    buffer_load_dwordx4 v[172:175], v12, s[32:35], s67 offen offset:2304 sc1
    buffer_load_dwordx4 v[176:179], v251, s[32:35], s68 offen offset:0 sc1
    buffer_load_dwordx4 v[180:183], v251, s[32:35], s68 offen offset:2048 sc1
    buffer_load_dwordx4 v[184:187], v12, s[32:35], s68 offen offset:0 sc1
    buffer_load_dwordx4 v[188:191], v12, s[32:35], s68 offen offset:2048 sc1
    s_waitcnt vmcnt(17)
    v_bitop3_b32 v9, v211, v215, v219 bitop3:0x80
    s_waitcnt vmcnt(16)
    v_bitop3_b32 v9, v9, v223, 1 bitop3:0x80
    v_cmp_eq_u32 vcc, 0, v9
    s_cbranch_vccnz L_slow_hr_4
    s_branch L_back_hr_4
L_give_hr_4:
    s_mov_b32 s27, 0
    s_waitcnt vmcnt(0)
    s_branch L_back_hr_4
L_slow_hr_5:
    s_sub_u32 s27, s27, 1
    s_cbranch_scc1 L_give_hr_5
    s_sleep 1
    buffer_load_dwordx4 v[224:227], v251, s[32:35], s66 offen offset:256 sc1
    buffer_load_dwordx4 v[228:231], v251, s[32:35], s66 offen offset:2304 sc1
    buffer_load_dwordx4 v[232:235], v12, s[32:35], s66 offen offset:256 sc1
    buffer_load_dwordx4 v[236:239], v12, s[32:35], s66 offen offset:2304 sc1
    buffer_load_dwordx4 v[144:147], v251, s[32:35], s67 offen offset:0 sc1
    buffer_load_dwordx4 v[148:151], v251, s[32:35], s67 offen offset:2048 sc1
    buffer_load_dwordx4 v[152:155], v12, s[32:35], s67 offen offset:0 sc1
    buffer_load_dwordx4 v[156:159], v12, s[32:35], s67 offen offset:2048 sc1
    buffer_load_dwordx4 v[160:163], v251, s[32:35], s67 offen offset:256 sc1
    buffer_load_dwordx4 v[164:167], v251, s[32:35], s67 offen offset:2304 sc1
    buffer_load_dwordx4 v[168:171], v12, s[32:35], s67 offen offset:256 sc1
    buffer_load_dwordx4 v[172:175], v12, s[32:35], s67 offen offset:2304 sc1
    buffer_load_dwordx4 v[176:179], v251, s[32:35], s68 offen offset:0 sc1
    buffer_load_dwordx4 v[180:183], v251, s[32:35], s68 offen offset:2048 sc1
    buffer_load_dwordx4 v[184:187], v12, s[32:35], s68 offen offset:0 sc1
    buffer_load_dwordx4 v[188:191], v12, s[32:35], s68 offen offset:2048 sc1
    buffer_load_dwordx4 v[192:195], v251, s[32:35], s68 offen offset:256 sc1
    buffer_load_dwordx4 v[196:199], v251, s[32:35], s68 offen offset:2304 sc1
    buffer_load_dwordx4 v[200:203], v12, s[32:35], s68 offen offset:256 sc1
    buffer_load_dwordx4 v[204:207], v12, s[32:35], s68 offen offset:2304 sc1
    s_waitcnt vmcnt(17)
    v_bitop3_b32 v9, v227, v231, v235 bitop3:0x80
    s_waitcnt vmcnt(16)
    v_bitop3_b32 v9, v9, v239, 1 bitop3:0x80
    v_cmp_eq_u32 vcc, 0, v9
    s_cbranch_vccnz L_slow_hr_5
    s_branch L_back_hr_5
L_give_hr_5:
    s_mov_b32 s27, 0
    s_waitcnt vmcnt(0)
    s_branch L_back_hr_5
L_slow_hr_6:
    s_sub_u32 s27, s27, 1
    s_cbranch_scc1 L_give_hr_6
    s_sleep 1
    buffer_load_dwordx4 v[144:147], v251, s[32:35], s67 offen offset:0 sc1
    buffer_load_dwordx4 v[148:151], v251, s[32:35], s67 offen offset:2048 sc1
    buffer_load_dwordx4 v[152:155], v12, s[32:35], s67 offen offset:0 sc1
    buffer_load_dwordx4 v[156:159], v12, s[32:35], s67 offen offset:2048 sc1
    buffer_load_dwordx4 v[160:163], v251, s[32:35], s67 offen offset:256 sc1
    buffer_load_dwordx4 v[164:167], v251, s[32:35], s67 offen offset:2304 sc1
    buffer_load_dwordx4 v[168:171], v12, s[32:35], s67 offen offset:256 sc1
    buffer_load_dwordx4 v[172:175], v12, s[32:35], s67 offen offset:2304 sc1
    buffer_load_dwordx4 v[176:179], v251, s[32:35], s68 offen offset:0 sc1
    buffer_load_dwordx4 v[180:183], v251, s[32:35], s68 offen offset:2048 sc1
    buffer_load_dwordx4 v[184:187], v12, s[32:35], s68 offen offset:0 sc1
    buffer_load_dwordx4 v[188:191], v12, s[32:35], s68 offen offset:2048 sc1
    buffer_load_dwordx4 v[192:195], v251, s[32:35], s68 offen offset:256 sc1
    buffer_load_dwordx4 v[196:199], v251, s[32:35], s68 offen offset:2304 sc1
    buffer_load_dwordx4 v[200:203], v12, s[32:35], s68 offen offset:256 sc1
    buffer_load_dwordx4 v[204:207], v12, s[32:35], s68 offen offset:2304 sc1
    buffer_load_dwordx4 v[208:211], v251, s[32:35], s69 offen offset:0 sc1
    buffer_load_dwordx4 v[212:215], v251, s[32:35], s69 offen offset:2048 sc1
    buffer_load_dwordx4 v[216:219], v12, s[32:35], s69 offen offset:0 sc1
    buffer_load_dwordx4 v[220:223], v12, s[32:35], s69 offen offset:2048 sc1
    s_waitcnt vmcnt(17)
    v_bitop3_b32 v9, v147, v151, v155 bitop3:0x80
    s_waitcnt vmcnt(16)
    v_bitop3_b32 v9, v9, v159, 1 bitop3:0x80
    v_cmp_eq_u32 vcc, 0, v9
    s_cbranch_vccnz L_slow_hr_6
    s_branch L_back_hr_6
L_give_hr_6:
    s_mov_b32 s27, 0
    s_waitcnt vmcnt(0)
    s_branch L_back_hr_6
L_slow_hr_7:
    s_sub_u32 s27, s27, 1
    s_cbranch_scc1 L_give_hr_7
    s_sleep 1
    buffer_load_dwordx4 v[160:163], v251, s[32:35], s67 offen offset:256 sc1
    buffer_load_dwordx4 v[164:167], v251, s[32:35], s67 offen offset:2304 sc1
    buffer_load_dwordx4 v[168:171], v12, s[32:35], s67 offen offset:256 sc1
    buffer_load_dwordx4 v[172:175], v12, s[32:35], s67 offen offset:2304 sc1
    buffer_load_dwordx4 v[176:179], v251, s[32:35], s68 offen offset:0 sc1
    buffer_load_dwordx4 v[180:183], v251, s[32:35], s68 offen offset:2048 sc1
    buffer_load_dwordx4 v[184:187], v12, s[32:35], s68 offen offset:0 sc1
    buffer_load_dwordx4 v[188:191], v12, s[32:35], s68 offen offset:2048 sc1
    buffer_load_dwordx4 v[192:195], v251, s[32:35], s68 offen offset:256 sc1
    buffer_load_dwordx4 v[196:199], v251, s[32:35], s68 offen offset:2304 sc1
    buffer_load_dwordx4 v[200:203], v12, s[32:35], s68 offen offset:256 sc1
    buffer_load_dwordx4 v[204:207], v12, s[32:35], s68 offen offset:2304 sc1
    buffer_load_dwordx4 v[208:211], v251, s[32:35], s69 offen offset:0 sc1
    buffer_load_dwordx4 v[212:215], v251, s[32:35], s69 offen offset:2048 sc1
    buffer_load_dwordx4 v[216:219], v12, s[32:35], s69 offen offset:0 sc1
    buffer_load_dwordx4 v[220:223], v12, s[32:35], s69 offen offset:2048 sc1
    buffer_load_dwordx4 v[224:227], v251, s[32:35], s69 offen offset:256 sc1
    buffer_load_dwordx4 v[228:231], v251, s[32:35], s69 offen offset:2304 sc1
    buffer_load_dwordx4 v[232:235], v12, s[32:35], s69 offen offset:256 sc1
    buffer_load_dwordx4 v[236:239], v12, s[32:35], s69 offen offset:2304 sc1
    s_waitcnt vmcnt(17)
    v_bitop3_b32 v9, v163, v167, v171 bitop3:0x80
    s_waitcnt vmcnt(16)
    v_bitop3_b32 v9, v9, v175, 1 bitop3:0x80
    v_cmp_eq_u32 vcc, 0, v9
    s_cbranch_vccnz L_slow_hr_7
    s_branch L_back_hr_7
L_give_hr_7:
    s_mov_b32 s27, 0
    s_waitcnt vmcnt(0)
    s_branch L_back_hr_7
L_slow_hr_8:
    s_sub_u32 s27, s27, 1
    s_cbranch_scc1 L_give_hr_8
    s_sleep 1
    buffer_load_dwordx4 v[176:179], v251, s[32:35], s68 offen offset:0 sc1
    buffer_load_dwordx4 v[180:183], v251, s[32:35], s68 offen offset:2048 sc1
    buffer_load_dwordx4 v[184:187], v12, s[32:35], s68 offen offset:0 sc1
    buffer_load_dwordx4 v[188:191], v12, s[32:35], s68 offen offset:2048 sc1
    buffer_load_dwordx4 v[192:195], v251, s[32:35], s68 offen offset:256 sc1
    buffer_load_dwordx4 v[196:199], v251, s[32:35], s68 offen offset:2304 sc1
    buffer_load_dwordx4 v[200:203], v12, s[32:35], s68 offen offset:256 sc1
    buffer_load_dwordx4 v[204:207], v12, s[32:35], s68 offen offset:2304 sc1
    buffer_load_dwordx4 v[208:211], v251, s[32:35], s69 offen offset:0 sc1
    buffer_load_dwordx4 v[212:215], v251, s[32:35], s69 offen offset:2048 sc1
    buffer_load_dwordx4 v[216:219], v12, s[32:35], s69 offen offset:0 sc1
    buffer_load_dwordx4 v[220:223], v12, s[32:35], s69 offen offset:2048 sc1
    buffer_load_dwordx4 v[224:227], v251, s[32:35], s69 offen offset:256 sc1
    buffer_load_dwordx4 v[228:231], v251, s[32:35], s69 offen offset:2304 sc1
    buffer_load_dwordx4 v[232:235], v12, s[32:35], s69 offen offset:256 sc1
    buffer_load_dwordx4 v[236:239], v12, s[32:35], s69 offen offset:2304 sc1
    buffer_load_dwordx4 v[144:147], v251, s[32:35], s70 offen offset:0 sc1
    buffer_load_dwordx4 v[148:151], v251, s[32:35], s70 offen offset:2048 sc1
    buffer_load_dwordx4 v[152:155], v12, s[32:35], s70 offen offset:0 sc1
    buffer_load_dwordx4 v[156:159], v12, s[32:35], s70 offen offset:2048 sc1
    s_waitcnt vmcnt(17)
    v_bitop3_b32 v9, v179, v183, v187 bitop3:0x80
    s_waitcnt vmcnt(16)
    v_bitop3_b32 v9, v9, v191, 1 bitop3:0x80
    v_cmp_eq_u32 vcc, 0, v9
    s_cbranch_vccnz L_slow_hr_8
    s_branch L_back_hr_8
L_give_hr_8:
    s_mov_b32 s27, 0
    s_waitcnt vmcnt(0)
    s_branch L_back_hr_8
L_slow_hr_9:
    s_sub_u32 s27, s27, 1
    s_cbranch_scc1 L_give_hr_9
    s_sleep 1
    buffer_load_dwordx4 v[192:195], v251, s[32:35], s68 offen offset:256 sc1
    buffer_load_dwordx4 v[196:199], v251, s[32:35], s68 offen offset:2304 sc1
    buffer_load_dwordx4 v[200:203], v12, s[32:35], s68 offen offset:256 sc1
    buffer_load_dwordx4 v[204:207], v12, s[32:35], s68 offen offset:2304 sc1
    buffer_load_dwordx4 v[208:211], v251, s[32:35], s69 offen offset:0 sc1
    buffer_load_dwordx4 v[212:215], v251, s[32:35], s69 offen offset:2048 sc1
    buffer_load_dwordx4 v[216:219], v12, s[32:35], s69 offen offset:0 sc1
    buffer_load_dwordx4 v[220:223], v12, s[32:35], s69 offen offset:2048 sc1
    buffer_load_dwordx4 v[224:227], v251, s[32:35], s69 offen offset:256 sc1
    buffer_load_dwordx4 v[228:231], v251, s[32:35], s69 offen offset:2304 sc1
    buffer_load_dwordx4 v[232:235], v12, s[32:35], s69 offen offset:256 sc1
    buffer_load_dwordx4 v[236:239], v12, s[32:35], s69 offen offset:2304 sc1
    buffer_load_dwordx4 v[144:147], v251, s[32:35], s70 offen offset:0 sc1
    buffer_load_dwordx4 v[148:151], v251, s[32:35], s70 offen offset:2048 sc1
    buffer_load_dwordx4 v[152:155], v12, s[32:35], s70 offen offset:0 sc1
    buffer_load_dwordx4 v[156:159], v12, s[32:35], s70 offen offset:2048 sc1
    buffer_load_dwordx4 v[160:163], v251, s[32:35], s70 offen offset:256 sc1
    buffer_load_dwordx4 v[164:167], v251, s[32:35], s70 offen offset:2304 sc1
    buffer_load_dwordx4 v[168:171], v12, s[32:35], s70 offen offset:256 sc1
    buffer_load_dwordx4 v[172:175], v12, s[32:35], s70 offen offset:2304 sc1
    s_waitcnt vmcnt(17)
    v_bitop3_b32 v9, v195, v199, v203 bitop3:0x80
    s_waitcnt vmcnt(16)
    v_bitop3_b32 v9, v9, v207, 1 bitop3:0x80
    v_cmp_eq_u32 vcc, 0, v9
    s_cbranch_vccnz L_slow_hr_9
    s_branch L_back_hr_9
L_give_hr_9:
    s_mov_b32 s27, 0
    s_waitcnt vmcnt(0)
    s_branch L_back_hr_9
L_slow_hr_10:
    s_sub_u32 s27, s27, 1
    s_cbranch_scc1 L_give_hr_10
    s_sleep 1
    buffer_load_dwordx4 v[208:211], v251, s[32:35], s69 offen offset:0 sc1
    buffer_load_dwordx4 v[212:215], v251, s[32:35], s69 offen offset:2048 sc1
    buffer_load_dwordx4 v[216:219], v12, s[32:35], s69 offen offset:0 sc1
    buffer_load_dwordx4 v[220:223], v12, s[32:35], s69 offen offset:2048 sc1
    buffer_load_dwordx4 v[224:227], v251, s[32:35], s69 offen offset:256 sc1
    buffer_load_dwordx4 v[228:231], v251, s[32:35], s69 offen offset:2304 sc1
    buffer_load_dwordx4 v[232:235], v12, s[32:35], s69 offen offset:256 sc1
    buffer_load_dwordx4 v[236:239], v12, s[32:35], s69 offen offset:2304 sc1
    buffer_load_dwordx4 v[144:147], v251, s[32:35], s70 offen offset:0 sc1
    buffer_load_dwordx4 v[148:151], v251, s[32:35], s70 offen offset:2048 sc1
    buffer_load_dwordx4 v[152:155], v12, s[32:35], s70 offen offset:0 sc1
    buffer_load_dwordx4 v[156:159], v12, s[32:35], s70 offen offset:2048 sc1
    buffer_load_dwordx4 v[160:163], v251, s[32:35], s70 offen offset:256 sc1
    buffer_load_dwordx4 v[164:167], v251, s[32:35], s70 offen offset:2304 sc1
    buffer_load_dwordx4 v[168:171], v12, s[32:35], s70 offen offset:256 sc1
    buffer_load_dwordx4 v[172:175], v12, s[32:35], s70 offen offset:2304 sc1
    s_waitcnt vmcnt(13)
    v_bitop3_b32 v9, v211, v215, v219 bitop3:0x80
    s_waitcnt vmcnt(12)
    v_bitop3_b32 v9, v9, v223, 1 bitop3:0x80
    v_cmp_eq_u32 vcc, 0, v9
    s_cbranch_vccnz L_slow_hr_10
    s_branch L_back_hr_10
L_give_hr_10:
    s_mov_b32 s27, 0
    s_waitcnt vmcnt(0)
    s_branch L_back_hr_10
L_slow_hr_11:
    s_sub_u32 s27, s27, 1
    s_cbranch_scc1 L_give_hr_11
    s_sleep 1
    buffer_load_dwordx4 v[224:227], v251, s[32:35], s69 offen offset:256 sc1
    buffer_load_dwordx4 v[228:231], v251, s[32:35], s69 offen offset:2304 sc1
    buffer_load_dwordx4 v[232:235], v12, s[32:35], s69 offen offset:256 sc1
    buffer_load_dwordx4 v[236:239], v12, s[32:35], s69 offen offset:2304 sc1
    buffer_load_dwordx4 v[144:147], v251, s[32:35], s70 offen offset:0 sc1
    buffer_load_dwordx4 v[148:151], v251, s[32:35], s70 offen offset:2048 sc1
    buffer_load_dwordx4 v[152:155], v12, s[32:35], s70 offen offset:0 sc1
    buffer_load_dwordx4 v[156:159], v12, s[32:35], s70 offen offset:2048 sc1
    buffer_load_dwordx4 v[160:163], v251, s[32:35], s70 offen offset:256 sc1
    buffer_load_dwordx4 v[164:167], v251, s[32:35], s70 offen offset:2304 sc1
    buffer_load_dwordx4 v[168:171], v12, s[32:35], s70 offen offset:256 sc1
    buffer_load_dwordx4 v[172:175], v12, s[32:35], s70 offen offset:2304 sc1
    s_waitcnt vmcnt(9)
    v_bitop3_b32 v9, v227, v231, v235 bitop3:0x80
    s_waitcnt vmcnt(8)
    v_bitop3_b32 v9, v9, v239, 1 bitop3:0x80
    v_cmp_eq_u32 vcc, 0, v9
    s_cbranch_vccnz L_slow_hr_11
    s_branch L_back_hr_11
L_give_hr_11:
    s_mov_b32 s27, 0
    s_waitcnt vmcnt(0)
    s_branch L_back_hr_11
L_slow_hr_12:
    s_sub_u32 s27, s27, 1
    s_cbranch_scc1 L_give_hr_12
    s_sleep 1
    buffer_load_dwordx4 v[144:147], v251, s[32:35], s70 offen offset:0 sc1
    buffer_load_dwordx4 v[148:151], v251, s[32:35], s70 offen offset:2048 sc1
    buffer_load_dwordx4 v[152:155], v12, s[32:35], s70 offen offset:0 sc1
    buffer_load_dwordx4 v[156:159], v12, s[32:35], s70 offen offset:2048 sc1
    buffer_load_dwordx4 v[160:163], v251, s[32:35], s70 offen offset:256 sc1
    buffer_load_dwordx4 v[164:167], v251, s[32:35], s70 offen offset:2304 sc1
    buffer_load_dwordx4 v[168:171], v12, s[32:35], s70 offen offset:256 sc1
    buffer_load_dwordx4 v[172:175], v12, s[32:35], s70 offen offset:2304 sc1
    s_waitcnt vmcnt(5)
    v_bitop3_b32 v9, v147, v151, v155 bitop3:0x80
    s_waitcnt vmcnt(4)
    v_bitop3_b32 v9, v9, v159, 1 bitop3:0x80
    v_cmp_eq_u32 vcc, 0, v9
    s_cbranch_vccnz L_slow_hr_12
    s_branch L_back_hr_12
L_give_hr_12:
    s_mov_b32 s27, 0
    s_waitcnt vmcnt(0)
    s_branch L_back_hr_12
L_slow_hr_13:
    s_sub_u32 s27, s27, 1
    s_cbranch_scc1 L_give_hr_13
    s_sleep 1
    buffer_load_dwordx4 v[160:163], v251, s[32:35], s70 offen offset:256 sc1
    buffer_load_dwordx4 v[164:167], v251, s[32:35], s70 offen offset:2304 sc1
    buffer_load_dwordx4 v[168:171], v12, s[32:35], s70 offen offset:256 sc1
    buffer_load_dwordx4 v[172:175], v12, s[32:35], s70 offen offset:2304 sc1
    s_waitcnt vmcnt(1)
    v_bitop3_b32 v9, v163, v167, v171 bitop3:0x80
    s_waitcnt vmcnt(0)
    v_bitop3_b32 v9, v9, v175, 1 bitop3:0x80
    v_cmp_eq_u32 vcc, 0, v9
    s_cbranch_vccnz L_slow_hr_13
    s_branch L_back_hr_13
L_give_hr_13:
    s_mov_b32 s27, 0
    s_waitcnt vmcnt(0)
    s_branch L_back_hr_13
L_code_end:

.section .rodata,"a"
.p2align 6
.amdhsa_kernel interleave_layers__spectral_gfnet__mixer_channel_mlp__prompt_kernel
  .amdhsa_next_free_vgpr 512
  .amdhsa_next_free_sgpr 102
  .amdhsa_accum_offset 256
  .amdhsa_group_segment_fixed_size 0
  .amdhsa_kernarg_size 88
  .amdhsa_user_sgpr_count 2
  .amdhsa_user_sgpr_kernarg_segment_ptr 1
  .amdhsa_system_sgpr_workgroup_id_x 1
.end_amdhsa_kernel
```
